```python
import torch

def _softmax(x, axis=-1):
    return torch.softmax(x, dim=axis)
def _gelu(x):
    return torch.nn.functional.gelu(x, approximate="tanh")
def _silu(x):
    return torch.nn.functional.silu(x)
def _sigmoid(x):
    return torch.sigmoid(x)
def _layernorm(x, axis=-1, eps=1e-5):
    m = x.mean(dim=axis, keepdim=True)
    v = x.var(dim=axis, keepdim=True, unbiased=False)
    return (x - m) / torch.sqrt(v + eps)
def _scatter_add(tgt, idx, src, axis=0):
    return tgt.clone().index_add_(axis, idx, src)
def _segment_sum(src, seg, n):
    out = torch.zeros((n,) + src.shape[1:], dtype=src.dtype)
    return out.index_add_(0, seg, src)
def _pad(x, pw):
    flat = tuple(v for pair in reversed(pw) for v in pair)
    return torch.nn.functional.pad(x, flat)

kernel_name = 'standalone__gqa_block_cached__sampling'

def setup_inputs():

    _w = (lambda a: (lambda t: t.to(torch.bfloat16) if t.is_floating_point() else t)(torch.as_tensor(a)))
    B, Sq, D = 8, 16, 576
    Hq, Hkv, Sk, Dh = 32, 16, 8192, 128
    assert Hq % Hkv == 0, (Hq, Hkv)
    return {
        "x": _w((lambda *s: torch.randn(*s, dtype=torch.bfloat16) * 0.8)(B, Sq, D)),
        "k_cache": _w((lambda *s: torch.randn(*s, dtype=torch.bfloat16) * 0.8)(B, Hkv, Sk, Dh)),
        "v_cache": _w((lambda *s: torch.randn(*s, dtype=torch.bfloat16) * 0.05)(B, Hkv, Sk, Dh)),
        "wq": _w((lambda *s: torch.randn(*s, dtype=torch.bfloat16) * 0.8)(D, Hq * Dh) * (D ** -0.5)),
        "wo": _w((lambda *s: torch.randn(*s, dtype=torch.bfloat16) * 0.05)(Hq * Dh, D) * ((Hq * Dh) ** -0.5)),
    }

def reference(x, k_cache, v_cache, wq, wo):
    B, Sq, D = x.shape
    Hq, Dh = 32, 128
    Hkv = k_cache.shape[1]
    rep = Hq // Hkv
    q = (lambda x, *d: x.permute(*d))((x @ wq).reshape(B, Sq, Hq, Dh), 0, 2, 1, 3)
    k = (lambda x, n, axis: torch.repeat_interleave(x, n, dim=axis))(k_cache, rep, axis=1)
    v = (lambda x, n, axis: torch.repeat_interleave(x, n, dim=axis))(v_cache, rep, axis=1)
    scores = torch.einsum("bhqd,bhkd->bhqk", q, k) * (Dh ** -0.5)
    p = _softmax(scores, axis=-1)
    o = torch.einsum("bhqk,bhkd->bhqd", p, v)
    return (lambda x, *d: x.permute(*d))(o, 0, 2, 1, 3).reshape(B, Sq, Hq * Dh) @ wo
```

```asm
; @launch grid=(256,1,1) block=(256,1,1) lds=163840
.amdgcn_target "amdgcn-amd-amdhsa--gfx950"
.text
.globl standalone__gqa_block_cached__sampling_kernel
.p2align 8
.type standalone__gqa_block_cached__sampling_kernel,@function
standalone__gqa_block_cached__sampling_kernel:
    s_cmp_ge_u32 s2, 256
    s_cbranch_scc1 L_end
    s_load_dwordx16 s[36:51], s[0:1], 0
    v_lshrrev_b32 v1, 6, v0
    v_and_b32 v254, 63, v0
    v_readfirstlane_b32 s52, v1
    s_getpc_b64 s[96:97]
L_pc0:
    s_lshr_b32 s3, s2, 3
    s_lshl_b32 s3, s3, 2
    s_add_u32 s3, s3, s52
    s_cmp_gt_u32 s3, (L_end-L_pc0)>>10
    s_cbranch_scc1 L_npf
    s_lshl_b32 s3, s3, 6
    v_add_lshl_u32 v6, s3, v254, 4
    v_min_u32 v6, L_end-L_pc0-16, v6
    v_mov_b32 v7, s97
    v_add_co_u32 v6, s[100:101], s96, v6
    s_nop 1
    v_addc_co_u32 v7, s[100:101], v7, 0, s[100:101]
    global_load_dword v6, v[6:7], off
L_npf:
    s_and_b32 s53, s2, 7
    s_bfe_u32 s55, s2, 0x20003
    s_lshr_b32 s54, s2, 5
    s_lshl_b32 s3, s53, 2
    s_or_b32 s3, s3, s55
    s_and_b32 s63, s2, 0xe0
    s_or_b32 s63, s63, s3
    s_and_b32 s3, s63, 1
    s_lshl_b32 s99, s3, 20
    s_and_b32 s3, s52, 1
    s_lshl_b32 s3, s3, 13
    s_or_b32 s99, s99, s3
    s_lshr_b32 s3, s52, 1
    s_lshl_b32 s3, s3, 15
    s_or_b32 s99, s99, s3
    s_bfe_u32 s3, s2, 0x10003
    s_lshl_b32 s3, s3, 14
    s_xor_b32 s99, s99, s3
    s_bfe_u32 s3, s2, 0x10005
    s_lshl_b32 s3, s3, 17
    s_xor_b32 s99, s99, s3
    v_and_b32 v250, 15, v254
    v_lshrrev_b32 v251, 4, v254
    v_lshlrev_b32 v248, 4, v254
    v_xor_b32 v1, v250, v251
    v_lshlrev_b32 v2, 8, v251
    v_lshl_or_b32 v8, v1, 4, v2
    v_xor_b32 v9, 64, v8
    v_xor_b32 v10, 128, v8
    v_xor_b32 v11, 192, v8
    v_lshlrev_b32 v1, 16, v251
    v_lshl_or_b32 v62, v250, 4, v1
    v_mul_u32_u24 v1, 1152, v250
    v_lshl_add_u32 v63, v251, 4, v1
    s_lshl_b32 s56, s52, 15
    s_lshr_b32 s68, s63, 1
    s_lshl_b32 s68, s68, 21
    s_mov_b32 s6, 2097152
    s_mov_b32 s7, 0x20000
    s_mov_b32 s14, 4718592
    s_mov_b32 s15, 0x20000
    s_mov_b32 s18, 147456
    s_mov_b32 s19, 0x20000
    s_mov_b32 s22, 4718592
    s_mov_b32 s23, 0x20000
    s_mov_b32 s26, 4456448
    s_mov_b32 s27, 0x20000
    s_lshr_b32 s69, s52, 1
    s_mul_i32 s70, s69, 2359296
    s_mul_i32 s71, s69, 576
    s_and_b32 s3, s63, 30
    s_and_b32 s69, s52, 1
    s_or_b32 s3, s3, s69
    s_lshl_b32 s3, s3, 8
    s_add_u32 s70, s70, s3
    s_add_u32 s71, s71, 131072
    s_lshl_b32 s3, s54, 1
    s_and_b32 s69, s55, 1
    s_or_b32 s3, s3, s69
    s_mul_i32 s3, s3, 9
    s_lshr_b32 s64, s3, 4
    s_lshl_b32 s3, s64, 18
    s_add_u32 s70, s70, s3
    s_lshl_b32 s3, s64, 6
    s_add_u32 s71, s71, s3
    s_mul_i32 s74, s63, 12288
    s_add_u32 s74, s74, 262144
    v_mov_b32 v244, -1
    v_mov_b32 v245, -1
    v_mov_b32 v246, -1
    v_mov_b32 v247, -1
    s_getreg_b32 s65, hwreg(HW_REG_XCC_ID, 0, 4)
    s_cmp_eq_u32 s52, 2
    s_cselect_b32 s69, s65, -1
    v_mov_b32 v232, s69
    v_mov_b32 v233, s69
    v_mov_b32 v234, s69
    v_mov_b32 v235, s69
    s_waitcnt lgkmcnt(0)
    s_add_u32 s4, s38, s68
    s_addc_u32 s5, s39, 0
    s_mov_b64 s[24:25], s[50:51]
    s_mov_b64 s[12:13], s[42:43]
    s_mov_b64 s[16:17], s[36:37]
    s_mov_b64 s[20:21], s[44:45]
    s_mul_i32 s3, s52, 3072
    s_add_u32 s3, s3, s74
    buffer_store_dwordx4 v[244:247], v248, s[24:27], s3 offen offset:0 sc1
    buffer_store_dwordx4 v[244:247], v248, s[24:27], s3 offen offset:1024 sc1
    buffer_store_dwordx4 v[244:247], v248, s[24:27], s3 offen offset:2048 sc1
    s_lshl_b32 s3, s63, 2
    s_add_u32 s3, s3, s52
    s_lshl_b32 s3, s3, 7
    s_add_u32 s3, s3, 131072
    s_mov_b64 exec, 0xff
    buffer_store_dwordx4 v[232:235], v248, s[24:27], s3 offen sc1
    s_mov_b64 exec, -1
    buffer_load_dwordx4 v[64:67], v62, s[12:15], s70 offen
    s_add_u32 s70, s70, 8192
    buffer_load_dwordx4 v[68:71], v62, s[12:15], s70 offen
    s_add_u32 s70, s70, 8192
    buffer_load_dwordx4 v[72:75], v62, s[12:15], s70 offen
    s_add_u32 s70, s70, 8192
    buffer_load_dwordx4 v[76:79], v62, s[12:15], s70 offen
    s_add_u32 s70, s70, 8192
    buffer_load_dwordx4 v[80:83], v62, s[12:15], s70 offen
    s_add_u32 s70, s70, 8192
    buffer_load_dwordx4 v[84:87], v62, s[12:15], s70 offen
    s_add_u32 s70, s70, 8192
    buffer_load_dwordx4 v[88:91], v62, s[12:15], s70 offen
    s_add_u32 s70, s70, 8192
    s_xor_b32 s57, s99, 0
    s_add_u32 m0, s56, 0
    s_nop 0
    buffer_load_dwordx4 v8, s[4:7], s57 offen offset:0 nt lds
    s_lshl_b32 s3, s54, 2
    s_add_u32 s3, s3, s55
    s_lshl_b32 s3, s3, 2
    s_add_u32 s3, s3, s52
    s_mul_i32 s3, s3, 4608
    s_mul_i32 s36, s53, 589824
    s_add_u32 s36, s36, s3
    buffer_load_dwordx4 v[48:51], v248, s[20:23], s36 offen offset:0
    buffer_load_dwordx4 v9, s[4:7], s57 offen offset:1024 nt lds
    s_mul_i32 s3, s52, 4608
    s_add_u32 s67, s3, 131072
    s_mul_i32 s73, s54, 18432
    s_add_u32 s73, s73, s3
    s_add_u32 m0, s67, 0
    s_nop 0
    buffer_load_dwordx4 v248, s[16:19], s73 offen offset:0 lds
    buffer_load_dwordx4 v[48:51], v248, s[20:23], s36 offen offset:1024
    s_add_u32 m0, s56, 0
    s_nop 0
    buffer_load_dwordx4 v10, s[4:7], s57 offen offset:2048 nt lds
    s_add_u32 m0, s67, 0
    s_nop 0
    buffer_load_dwordx4 v248, s[16:19], s73 offen offset:1024 lds
    buffer_load_dwordx4 v[48:51], v248, s[20:23], s36 offen offset:2048
    s_add_u32 m0, s56, 0
    s_nop 0
    buffer_load_dwordx4 v11, s[4:7], s57 offen offset:3072 nt lds
    s_add_u32 m0, s67, 0
    s_nop 0
    buffer_load_dwordx4 v248, s[16:19], s73 offen offset:2048 lds
    buffer_load_dwordx4 v[48:51], v248, s[20:23], s36 offen offset:3072
    s_xor_b32 s57, s99, 4096
    s_add_u32 m0, s56, 4096
    s_nop 0
    buffer_load_dwordx4 v8, s[4:7], s57 offen offset:0 nt lds
    s_add_u32 m0, s67, 0
    s_nop 0
    buffer_load_dwordx4 v248, s[16:19], s73 offen offset:3072 lds
    s_add_u32 s36, s36, 4096
    s_mov_b32 exec_hi, 0
    buffer_load_dwordx4 v[48:51], v248, s[20:23], s36 offen offset:0
    s_mov_b32 exec_hi, -1
    s_add_u32 m0, s56, 4096
    s_nop 0
    buffer_load_dwordx4 v9, s[4:7], s57 offen offset:1024 nt lds
    s_add_u32 s73, s73, 4096
    s_mov_b32 exec_hi, 0
    s_add_u32 m0, s67, 4096
    s_nop 0
    buffer_load_dwordx4 v248, s[16:19], s73 offen offset:0 lds
    s_mov_b32 exec_hi, -1
    s_add_u32 m0, s56, 4096
    s_nop 0
    buffer_load_dwordx4 v10, s[4:7], s57 offen offset:2048 nt lds
    buffer_load_dwordx4 v11, s[4:7], s57 offen offset:3072 nt lds
    s_add_u32 s8, s40, s68
    s_addc_u32 s9, s41, 0
    s_mov_b64 s[28:29], s[46:47]
    s_mov_b32 s48, s65
    s_mov_b32 s10, 2097152
    s_mov_b32 s11, 0x20000
    s_mov_b32 s30, 147456
    s_mov_b32 s31, 0x20000
    v_and_b32 v252, 31, v254
    v_lshrrev_b32 v253, 5, v254
    s_mov_b32 s61, 0x05040100
    s_mov_b32 s62, 0x07060302
    v_lshlrev_b32 v1, 3, v253
    v_xor_b32 v1, v1, v250
    v_lshlrev_b32 v2, 8, v252
    v_lshl_or_b32 v1, v1, 4, v2
    v_or_b32 v16, s56, v1
    v_xor_b32 v17, 16, v16
    v_xor_b32 v18, 32, v16
    v_xor_b32 v19, 48, v16
    v_xor_b32 v20, 64, v16
    v_xor_b32 v21, 80, v16
    v_xor_b32 v22, 96, v16
    v_xor_b32 v23, 112, v16
    s_xor_b32 s57, s99, 16384
    s_add_u32 m0, s56, 8192
    s_nop 0
    buffer_load_dwordx4 v8, s[4:7], s57 offen offset:0 nt lds
    buffer_load_dwordx4 v9, s[4:7], s57 offen offset:1024 nt lds
    buffer_load_dwordx4 v10, s[4:7], s57 offen offset:2048 nt lds
    buffer_load_dwordx4 v[92:95], v62, s[12:15], s70 offen
    s_add_u32 s70, s70, 204800
    s_cmp_eq_u32 s64, 8
    s_cselect_b32 s3, 2359296, 0
    s_sub_u32 s70, s70, s3
    buffer_load_dwordx4 v11, s[4:7], s57 offen offset:3072 nt lds
    buffer_load_dwordx4 v[96:99], v62, s[12:15], s70 offen
    s_add_u32 s70, s70, 8192
    s_xor_b32 s57, s99, 20480
    s_add_u32 m0, s56, 12288
    s_nop 0
    buffer_load_dwordx4 v8, s[4:7], s57 offen offset:0 nt lds
    buffer_load_dwordx4 v[100:103], v62, s[12:15], s70 offen
    s_add_u32 s70, s70, 8192
    buffer_load_dwordx4 v9, s[4:7], s57 offen offset:1024 nt lds
    buffer_load_dwordx4 v[104:107], v62, s[12:15], s70 offen
    s_add_u32 s70, s70, 8192
    buffer_load_dwordx4 v10, s[4:7], s57 offen offset:2048 nt lds
    buffer_load_dwordx4 v11, s[4:7], s57 offen offset:3072 nt lds
    buffer_load_dwordx4 v[108:111], v62, s[12:15], s70 offen
    s_add_u32 s70, s70, 8192
    s_xor_b32 s57, s99, 65536
    s_add_u32 m0, s56, 16384
    s_waitcnt vmcnt(8)
    buffer_load_dwordx4 v8, s[4:7], s57 offen offset:0 nt lds
    buffer_load_dwordx4 v[112:115], v62, s[12:15], s70 offen
    s_add_u32 s70, s70, 8192
    v_add_u32 v63, s71, v63
    s_barrier
    ds_read_b128 v[192:195], v63 offset:0
    s_cmp_eq_u32 s64, 8
    s_cselect_b32 s3, 576, 0
    v_subrev_u32 v63, s3, v63
    ds_read_b128 v[196:199], v63 offset:64
    s_cmp_eq_u32 s64, 7
    s_cselect_b32 s3, 576, 0
    v_subrev_u32 v63, s3, v63
    ds_read_b128 v[200:203], v63 offset:128
    s_cmp_eq_u32 s64, 6
    s_cselect_b32 s3, 576, 0
    v_subrev_u32 v63, s3, v63
    ds_read_b128 v[204:207], v63 offset:192
    s_cmp_eq_u32 s64, 5
    s_cselect_b32 s3, 576, 0
    v_subrev_u32 v63, s3, v63
    ds_read_b128 v[208:211], v63 offset:256
    s_cmp_eq_u32 s64, 4
    s_cselect_b32 s3, 576, 0
    v_subrev_u32 v63, s3, v63
    ds_read_b128 v[212:215], v63 offset:320
    s_cmp_eq_u32 s64, 3
    s_cselect_b32 s3, 576, 0
    v_subrev_u32 v63, s3, v63
    ds_read_b128 v[216:219], v63 offset:384
    s_waitcnt vmcnt(8)
    buffer_load_dwordx4 v9, s[4:7], s57 offen offset:1024 nt lds
    buffer_load_dwordx4 v[116:119], v62, s[12:15], s70 offen
    s_add_u32 s70, s70, 8192
    s_cmp_eq_u32 s64, 2
    s_cselect_b32 s3, 576, 0
    v_subrev_u32 v63, s3, v63
    ds_read_b128 v[220:223], v63 offset:448
    s_cmp_eq_u32 s64, 1
    s_cselect_b32 s3, 576, 0
    v_subrev_u32 v63, s3, v63
    ds_read_b128 v[224:227], v63 offset:512
    s_waitcnt lgkmcnt(0)
    ds_read_b128 v[128:131], v16 offset:0
    ds_read_b128 v[132:135], v17 offset:0
    ds_read_b128 v[136:139], v18 offset:0
    ds_read_b128 v[140:143], v19 offset:0
    ds_read_b128 v[144:147], v20 offset:0
    ds_read_b128 v[148:151], v21 offset:0
    ds_read_b128 v[152:155], v22 offset:0
    ds_read_b128 v[156:159], v23 offset:0
    s_waitcnt lgkmcnt(0)
    v_perm_b32 v32, v68, v64, s61
    v_perm_b32 v33, v76, v72, s61
    v_perm_b32 v34, v84, v80, s61
    v_perm_b32 v35, v92, v88, s61
    v_perm_b32 v36, v68, v64, s62
    v_perm_b32 v37, v76, v72, s62
    v_perm_b32 v38, v84, v80, s62
    v_perm_b32 v39, v92, v88, s62
    s_waitcnt vmcnt(8)
    buffer_load_dwordx4 v10, s[4:7], s57 offen offset:2048 nt lds
    v_mfma_f32_16x16x32_bf16 v[160:163], v[32:35], v[192:195], 0
    v_perm_b32 v40, v69, v65, s61
    v_perm_b32 v41, v77, v73, s61
    v_perm_b32 v42, v85, v81, s61
    v_perm_b32 v43, v93, v89, s61
    v_mfma_f32_16x16x32_bf16 v[164:167], v[36:39], v[192:195], 0
    v_perm_b32 v44, v69, v65, s62
    v_perm_b32 v45, v77, v73, s62
    v_perm_b32 v46, v85, v81, s62
    v_perm_b32 v47, v93, v89, s62
    v_mfma_f32_16x16x32_bf16 v[168:171], v[40:43], v[192:195], 0
    s_waitcnt vmcnt(7)
    buffer_load_dwordx4 v11, s[4:7], s57 offen offset:3072 nt lds
    buffer_load_dwordx4 v[120:123], v62, s[12:15], s70 offen
    s_add_u32 s70, s70, 8192
    v_perm_b32 v32, v70, v66, s61
    v_perm_b32 v33, v78, v74, s61
    v_perm_b32 v34, v86, v82, s61
    v_perm_b32 v35, v94, v90, s61
    v_mfma_f32_16x16x32_bf16 v[172:175], v[44:47], v[192:195], 0
    v_perm_b32 v36, v70, v66, s62
    v_perm_b32 v37, v78, v74, s62
    v_perm_b32 v38, v86, v82, s62
    v_perm_b32 v39, v94, v90, s62
    v_mfma_f32_16x16x32_bf16 v[176:179], v[32:35], v[192:195], 0
    v_perm_b32 v40, v71, v67, s61
    v_perm_b32 v41, v79, v75, s61
    v_perm_b32 v42, v87, v83, s61
    v_perm_b32 v43, v95, v91, s61
    s_xor_b32 s57, s99, 69632
    s_add_u32 m0, s56, 20480
    s_waitcnt vmcnt(8)
    buffer_load_dwordx4 v8, s[4:7], s57 offen offset:0 nt lds
    buffer_load_dwordx4 v[124:127], v62, s[12:15], s70 offen
    s_add_u32 s70, s70, 204800
    s_cmp_eq_u32 s64, 7
    s_cselect_b32 s3, 2359296, 0
    s_sub_u32 s70, s70, s3
    v_mfma_f32_16x16x32_bf16 v[180:183], v[36:39], v[192:195], 0
    v_perm_b32 v44, v71, v67, s62
    v_perm_b32 v45, v79, v75, s62
    v_perm_b32 v46, v87, v83, s62
    v_perm_b32 v47, v95, v91, s62
    v_mfma_f32_16x16x32_bf16 v[184:187], v[40:43], v[192:195], 0
    s_nop 0
    v_mfma_f32_16x16x32_bf16 v[188:191], v[44:47], v[192:195], 0
    s_barrier
    ds_read_b128 a[0:3], v16 offset:8192
    ds_read_b128 a[4:7], v17 offset:8192
    ds_read_b128 a[8:11], v18 offset:8192
    ds_read_b128 a[12:15], v19 offset:8192
    ds_read_b128 a[16:19], v20 offset:8192
    ds_read_b128 a[20:23], v21 offset:8192
    ds_read_b128 a[24:27], v22 offset:8192
    ds_read_b128 a[28:31], v23 offset:8192
    s_waitcnt lgkmcnt(0)
    s_waitcnt vmcnt(8)
    buffer_load_dwordx4 v9, s[4:7], s57 offen offset:1024 nt lds
    buffer_load_dwordx4 v[64:67], v62, s[12:15], s70 offen
    s_add_u32 s70, s70, 8192
    s_waitcnt vmcnt(8)
    buffer_load_dwordx4 v10, s[4:7], s57 offen offset:2048 nt lds
    s_waitcnt vmcnt(7)
    buffer_load_dwordx4 v11, s[4:7], s57 offen offset:3072 nt lds
    buffer_load_dwordx4 v[68:71], v62, s[12:15], s70 offen
    s_add_u32 s70, s70, 8192
    s_xor_b32 s57, s99, 81920
    s_add_u32 m0, s56, 24576
    s_waitcnt vmcnt(8)
    buffer_load_dwordx4 v8, s[4:7], s57 offen offset:0 nt lds
    buffer_load_dwordx4 v[72:75], v62, s[12:15], s70 offen
    s_add_u32 s70, s70, 8192
    s_lshl_b32 s3, s53, 2
    s_lshl_b32 s76, 15, s3
    s_lshl_b32 s3, 0x11111111, s55
    s_or_b32 s76, s76, s3
    s_lshl_b32 s3, 1, s63
    s_cmp_eq_u32 s52, 0
    s_cselect_b32 s76, s76, s3
    s_mov_b32 s77, 0
    s_lshl_b32 s65, s54, 13
    s_lshl_b32 s78, s63, 8
    v_lshlrev_b32 v249, 8, v252
    v_mov_b32 v243, 1
    s_mov_b64 exec, s[76:77]
    buffer_load_dword v255, v249, s[24:27], s65 offen sc1
    s_mov_b64 exec, -1
    s_and_b32 s35, s2, 7
    s_lshr_b32 s69, s2, 3
    s_mul_i32 s44, s69, 2
    s_add_u32 s44, s44, 14
    s_and_b32 s3, s69, 3
    s_cmp_eq_u32 s3, s52
    s_cselect_b32 s44, s44, -1
    s_cbranch_scc0 L_nrs
    s_lshl_b32 s3, s69, 8
    s_add_u32 s3, s3, 81920
    buffer_load_dword v245, off, s[24:27], s3 sc1
L_nrs:
    s_lshl_b32 s3, s35, 10
    buffer_load_dword v0, off, s[24:27], s3 sc1
    s_waitcnt vmcnt(10)
    buffer_load_dwordx4 v9, s[4:7], s57 offen offset:1024 nt lds
    buffer_load_dwordx4 v[76:79], v62, s[12:15], s70 offen
    s_add_u32 s70, s70, 8192
    v_lshlrev_b32 v242, 2, v254
    s_lshl_b32 s35, s35, 2
    s_add_u32 s35, s35, s52
    s_lshl_b32 s35, s35, 8
    s_add_u32 s35, s35, 65536
    s_lshr_b32 s3, s2, 3
    s_lshl_b32 s32, 1, s3
    s_mov_b32 s33, 0
    s_lshl_b32 s49, s52, 2
    s_mov_b32 s100, 20
    s_waitcnt vmcnt(10)
    buffer_load_dwordx4 v10, s[4:7], s57 offen offset:2048 nt lds
    v_perm_b32 v32, v100, v96, s61
    v_perm_b32 v33, v108, v104, s61
    v_perm_b32 v34, v116, v112, s61
    v_perm_b32 v35, v124, v120, s61
    v_perm_b32 v36, v100, v96, s62
    v_perm_b32 v37, v108, v104, s62
    v_perm_b32 v38, v116, v112, s62
    v_perm_b32 v39, v124, v120, s62
    v_mfma_f32_16x16x32_bf16 v[160:163], v[32:35], v[196:199], v[160:163]
    v_perm_b32 v40, v101, v97, s61
    v_perm_b32 v41, v109, v105, s61
    v_perm_b32 v42, v117, v113, s61
    v_perm_b32 v43, v125, v121, s61
    v_mfma_f32_16x16x32_bf16 v[164:167], v[36:39], v[196:199], v[164:167]
    s_waitcnt vmcnt(9)
    buffer_load_dwordx4 v11, s[4:7], s57 offen offset:3072 nt lds
    buffer_load_dwordx4 v[80:83], v62, s[12:15], s70 offen
    s_add_u32 s70, s70, 8192
    v_perm_b32 v44, v101, v97, s62
    v_perm_b32 v45, v109, v105, s62
    v_perm_b32 v46, v117, v113, s62
    v_perm_b32 v47, v125, v121, s62
    v_mfma_f32_16x16x32_bf16 v[168:171], v[40:43], v[196:199], v[168:171]
    v_perm_b32 v32, v102, v98, s61
    v_perm_b32 v33, v110, v106, s61
    v_perm_b32 v34, v118, v114, s61
    v_perm_b32 v35, v126, v122, s61
    v_mfma_f32_16x16x32_bf16 v[172:175], v[44:47], v[196:199], v[172:175]
    v_perm_b32 v36, v102, v98, s62
    v_perm_b32 v37, v110, v106, s62
    v_perm_b32 v38, v118, v114, s62
    v_perm_b32 v39, v126, v122, s62
    s_xor_b32 s57, s99, 86016
    s_add_u32 m0, s56, 28672
    s_waitcnt vmcnt(10)
    buffer_load_dwordx4 v8, s[4:7], s57 offen offset:0 nt lds
    buffer_load_dwordx4 v[84:87], v62, s[12:15], s70 offen
    s_add_u32 s70, s70, 8192
    v_mfma_f32_16x16x32_bf16 v[176:179], v[32:35], v[196:199], v[176:179]
    v_perm_b32 v40, v103, v99, s61
    v_perm_b32 v41, v111, v107, s61
    v_perm_b32 v42, v119, v115, s61
    v_perm_b32 v43, v127, v123, s61
    v_mfma_f32_16x16x32_bf16 v[180:183], v[36:39], v[196:199], v[180:183]
    v_perm_b32 v44, v103, v99, s62
    v_perm_b32 v45, v111, v107, s62
    v_perm_b32 v46, v119, v115, s62
    v_perm_b32 v47, v127, v123, s62
    v_mfma_f32_16x16x32_bf16 v[184:187], v[40:43], v[196:199], v[184:187]
    s_nop 0
    v_mfma_f32_16x16x32_bf16 v[188:191], v[44:47], v[196:199], v[188:191]
    ds_read_b128 a[32:35], v16 offset:16384
    ds_read_b128 a[36:39], v17 offset:16384
    s_waitcnt vmcnt(10)
    buffer_load_dwordx4 v9, s[4:7], s57 offen offset:1024 nt lds
    buffer_load_dwordx4 v[88:91], v62, s[12:15], s70 offen
    s_add_u32 s70, s70, 8192
    ds_read_b128 a[40:43], v18 offset:16384
    ds_read_b128 a[44:47], v19 offset:16384
    ds_read_b128 a[48:51], v20 offset:16384
    ds_read_b128 a[52:55], v21 offset:16384
    ds_read_b128 a[56:59], v22 offset:16384
    ds_read_b128 a[60:63], v23 offset:16384
    s_waitcnt lgkmcnt(0)
    s_waitcnt vmcnt(8)
    buffer_load_dwordx4 v10, s[4:7], s57 offen offset:2048 nt lds
    s_waitcnt vmcnt(7)
    buffer_load_dwordx4 v11, s[4:7], s57 offen offset:3072 nt lds
    buffer_load_dwordx4 v[92:95], v62, s[12:15], s70 offen
    s_add_u32 s70, s70, 204800
    s_cmp_eq_u32 s64, 6
    s_cselect_b32 s3, 2359296, 0
    s_sub_u32 s70, s70, s3
    s_xor_b32 s57, s99, 131072
    s_add_u32 m0, s56, 0
    s_waitcnt vmcnt(8)
    buffer_load_dwordx4 v8, s[4:7], s57 offen offset:0 nt lds
    buffer_load_dwordx4 v[96:99], v62, s[12:15], s70 offen
    s_add_u32 s70, s70, 8192
    s_waitcnt vmcnt(8)
    buffer_load_dwordx4 v9, s[4:7], s57 offen offset:1024 nt lds
    buffer_load_dwordx4 v[100:103], v62, s[12:15], s70 offen
    s_add_u32 s70, s70, 8192
    s_waitcnt vmcnt(8)
    buffer_load_dwordx4 v10, s[4:7], s57 offen offset:2048 nt lds
    buffer_load_dwordx4 v[104:107], v62, s[12:15], s70 offen
    s_add_u32 s70, s70, 8192
    s_waitcnt vmcnt(8)
    buffer_load_dwordx4 v11, s[4:7], s57 offen offset:3072 nt lds
    s_xor_b32 s57, s99, 135168
    s_add_u32 m0, s56, 4096
    s_waitcnt vmcnt(8)
    buffer_load_dwordx4 v8, s[4:7], s57 offen offset:0 nt lds
    buffer_load_dwordx4 v[108:111], v62, s[12:15], s70 offen
    s_add_u32 s70, s70, 8192
    s_waitcnt vmcnt(8)
    buffer_load_dwordx4 v9, s[4:7], s57 offen offset:1024 nt lds
    buffer_load_dwordx4 v[112:115], v62, s[12:15], s70 offen
    s_add_u32 s70, s70, 8192
    v_perm_b32 v32, v68, v64, s61
    v_perm_b32 v33, v76, v72, s61
    v_perm_b32 v34, v84, v80, s61
    v_perm_b32 v35, v92, v88, s61
    v_perm_b32 v36, v68, v64, s62
    v_perm_b32 v37, v76, v72, s62
    v_perm_b32 v38, v84, v80, s62
    v_perm_b32 v39, v92, v88, s62
    v_mfma_f32_16x16x32_bf16 v[160:163], v[32:35], v[200:203], v[160:163]
    v_perm_b32 v40, v69, v65, s61
    v_perm_b32 v41, v77, v73, s61
    v_perm_b32 v42, v85, v81, s61
    v_perm_b32 v43, v93, v89, s61
    v_mfma_f32_16x16x32_bf16 v[164:167], v[36:39], v[200:203], v[164:167]
    v_perm_b32 v44, v69, v65, s62
    v_perm_b32 v45, v77, v73, s62
    v_perm_b32 v46, v85, v81, s62
    v_perm_b32 v47, v93, v89, s62
    v_mfma_f32_16x16x32_bf16 v[168:171], v[40:43], v[200:203], v[168:171]
    s_waitcnt vmcnt(8)
    buffer_load_dwordx4 v10, s[4:7], s57 offen offset:2048 nt lds
    buffer_load_dwordx4 v[116:119], v62, s[12:15], s70 offen
    s_add_u32 s70, s70, 8192
    v_perm_b32 v32, v70, v66, s61
    v_perm_b32 v33, v78, v74, s61
    v_perm_b32 v34, v86, v82, s61
    v_perm_b32 v35, v94, v90, s61
    v_mfma_f32_16x16x32_bf16 v[172:175], v[44:47], v[200:203], v[172:175]
    v_perm_b32 v36, v70, v66, s62
    v_perm_b32 v37, v78, v74, s62
    v_perm_b32 v38, v86, v82, s62
    v_perm_b32 v39, v94, v90, s62
    v_mfma_f32_16x16x32_bf16 v[176:179], v[32:35], v[200:203], v[176:179]
    v_perm_b32 v40, v71, v67, s61
    v_perm_b32 v41, v79, v75, s61
    v_perm_b32 v42, v87, v83, s61
    v_perm_b32 v43, v95, v91, s61
    v_mfma_f32_16x16x32_bf16 v[180:183], v[36:39], v[200:203], v[180:183]
    v_perm_b32 v44, v71, v67, s62
    v_perm_b32 v45, v79, v75, s62
    s_waitcnt vmcnt(8)
    buffer_load_dwordx4 v11, s[4:7], s57 offen offset:3072 nt lds
    v_perm_b32 v46, v87, v83, s62
    v_perm_b32 v47, v95, v91, s62
    v_mfma_f32_16x16x32_bf16 v[184:187], v[40:43], v[200:203], v[184:187]
    s_nop 0
    v_mfma_f32_16x16x32_bf16 v[188:191], v[44:47], v[200:203], v[188:191]
    ds_read_b128 a[64:67], v16 offset:24576
    ds_read_b128 a[68:71], v17 offset:24576
    ds_read_b128 a[72:75], v18 offset:24576
    ds_read_b128 a[76:79], v19 offset:24576
    ds_read_b128 a[80:83], v20 offset:24576
    ds_read_b128 a[84:87], v21 offset:24576
    ds_read_b128 a[88:91], v22 offset:24576
    ds_read_b128 a[92:95], v23 offset:24576
    s_waitcnt lgkmcnt(0)
    s_xor_b32 s57, s99, 147456
    s_add_u32 m0, s56, 8192
    s_waitcnt vmcnt(7)
    buffer_load_dwordx4 v8, s[4:7], s57 offen offset:0 nt lds
    buffer_load_dwordx4 v[120:123], v62, s[12:15], s70 offen
    s_add_u32 s70, s70, 8192
    s_mov_b32 s60, 0x3e0293ee
    v_mov_b32 v14, 0xff7fffff
    v_mov_b32 v15, 0
    s_mul_i32 s67, s52, 5120
    s_add_u32 s67, s67, 131072
    v_lshlrev_b32 v1, 2, v251
    v_xor_b32 v1, v1, v250
    v_lshlrev_b32 v2, 8, v251
    v_lshl_or_b32 v12, v1, 4, v2
    v_lshrrev_b32 v1, 2, v250
    v_lshl_add_u32 v2, v253, 2, v1
    v_lshlrev_b32 v2, 8, v2
    v_lshl_or_b32 v2, v1, 6, v2
    v_and_b32 v3, 1, v251
    v_lshl_or_b32 v2, v3, 5, v2
    v_and_b32 v3, 3, v250
    v_lshl_or_b32 v2, v3, 3, v2
    v_or_b32 v24, s56, v2
    v_xor_b32 v25, 64, v24
    v_xor_b32 v26, 128, v24
    s_waitcnt vmcnt(8)
    buffer_load_dwordx4 v9, s[4:7], s57 offen offset:1024 nt lds
    buffer_load_dwordx4 v[124:127], v62, s[12:15], s70 offen
    s_add_u32 s70, s70, 204800
    s_cmp_eq_u32 s64, 5
    s_cselect_b32 s3, 2359296, 0
    s_sub_u32 s70, s70, s3
    v_xor_b32 v27, 192, v24
    v_add_u32 v1, 0, v254
    v_mul_u32_u24 v2, 3641, v1
    v_lshrrev_b32 v2, 16, v2
    v_mul_u32_u24 v3, 18, v2
    v_sub_u32 v3, v1, v3
    v_and_b32 v4, 3, v2
    v_bfe_u32 v5, v2, 2, 1
    v_lshl_or_b32 v4, v5, 4, v4
    v_bfe_u32 v5, v2, 3, 1
    v_lshl_or_b32 v4, v5, 2, v4
    v_mul_u32_u24 v4, 1152, v4
    v_lshl_add_u32 v56, v3, 4, v4
    v_add_u32 v1, 64, v254
    v_mul_u32_u24 v2, 3641, v1
    v_lshrrev_b32 v2, 16, v2
    v_mul_u32_u24 v3, 18, v2
    v_sub_u32 v3, v1, v3
    v_and_b32 v4, 3, v2
    v_bfe_u32 v5, v2, 2, 1
    v_lshl_or_b32 v4, v5, 4, v4
    v_bfe_u32 v5, v2, 3, 1
    v_lshl_or_b32 v4, v5, 2, v4
    s_waitcnt vmcnt(8)
    buffer_load_dwordx4 v10, s[4:7], s57 offen offset:2048 nt lds
    buffer_load_dwordx4 v[64:67], v62, s[12:15], s70 offen
    s_add_u32 s70, s70, 8192
    v_mul_u32_u24 v4, 1152, v4
    v_lshl_add_u32 v57, v3, 4, v4
    v_add_u32 v1, 128, v254
    v_mul_u32_u24 v2, 3641, v1
    v_lshrrev_b32 v2, 16, v2
    v_mul_u32_u24 v3, 18, v2
    v_sub_u32 v3, v1, v3
    v_and_b32 v4, 3, v2
    v_bfe_u32 v5, v2, 2, 1
    v_lshl_or_b32 v4, v5, 4, v4
    v_bfe_u32 v5, v2, 3, 1
    v_lshl_or_b32 v4, v5, 2, v4
    v_mul_u32_u24 v4, 1152, v4
    v_lshl_add_u32 v58, v3, 4, v4
    v_add_u32 v1, 192, v254
    v_mul_u32_u24 v2, 3641, v1
    v_lshrrev_b32 v2, 16, v2
    v_mul_u32_u24 v3, 18, v2
    v_sub_u32 v3, v1, v3
    v_and_b32 v4, 3, v2
    v_bfe_u32 v5, v2, 2, 1
    v_lshl_or_b32 v4, v5, 4, v4
    v_bfe_u32 v5, v2, 3, 1
    v_lshl_or_b32 v4, v5, 2, v4
    s_waitcnt vmcnt(8)
    buffer_load_dwordx4 v11, s[4:7], s57 offen offset:3072 nt lds
    v_mul_u32_u24 v4, 1152, v4
    v_lshl_add_u32 v59, v3, 4, v4
    v_add_u32 v1, 256, v254
    v_mul_u32_u24 v2, 3641, v1
    v_lshrrev_b32 v2, 16, v2
    v_mul_u32_u24 v3, 18, v2
    v_sub_u32 v3, v1, v3
    v_and_b32 v4, 3, v2
    v_bfe_u32 v5, v2, 2, 1
    v_lshl_or_b32 v4, v5, 4, v4
    v_bfe_u32 v5, v2, 3, 1
    v_lshl_or_b32 v4, v5, 2, v4
    v_mul_u32_u24 v4, 1152, v4
    v_lshl_add_u32 v60, v3, 4, v4
    v_lshlrev_b32 v1, 31, v253
    v_or_b32 v60, v60, v1
    v_lshrrev_b32 v1, 2, v254
    v_mul_u32_u24 v1, 288, v1
    v_and_b32 v2, 3, v254
    v_lshl_add_u32 v1, v2, 3, v1
    v_add_u32 v61, s67, v1
    s_xor_b32 s57, s99, 151552
    s_add_u32 m0, s56, 12288
    s_waitcnt vmcnt(7)
    buffer_load_dwordx4 v8, s[4:7], s57 offen offset:0 nt lds
    buffer_load_dwordx4 v[68:71], v62, s[12:15], s70 offen
    s_add_u32 s70, s70, 8192
    s_lshr_b32 s3, s63, 1
    s_and_b32 s3, s3, 15
    s_lshl_b32 s3, s3, 3
    s_add_u32 s3, s3, s52
    s_mul_i32 s72, s3, 36864
    s_xor_b32 s3, s3, 8
    s_mul_i32 s58, s3, 36864
    s_mul_i32 s3, s55, 288
    s_add_u32 s72, s72, s3
    s_add_u32 s58, s58, s3
    s_lshl_b32 s3, s52, 11
    s_add_u32 s73, s74, s3
    s_add_u32 s3, s3, 262144
    s_xor_b32 s96, s63, 1
    s_mul_i32 s96, s96, 12288
    s_add_u32 s96, s96, s3
    s_xor_b32 s97, s63, 2
    s_mul_i32 s97, s97, 12288
    s_add_u32 s97, s97, s3
    s_xor_b32 s98, s63, 3
    s_mul_i32 s98, s98, 12288
    s_add_u32 s98, s98, s3
    s_lshl_b32 s3, s52, 7
    s_add_u32 s3, s3, 0
    v_add_u32 v1, s3, v254
    v_mul_u32_u24 v2, 3641, v1
    v_lshrrev_b32 v2, 16, v2
    v_mul_u32_u24 v3, 18, v2
    v_sub_u32 v3, v1, v3
    s_waitcnt vmcnt(8)
    buffer_load_dwordx4 v9, s[4:7], s57 offen offset:1024 nt lds
    buffer_load_dwordx4 v[72:75], v62, s[12:15], s70 offen
    s_add_u32 s70, s70, 8192
    v_lshrrev_b32 v4, 1, v2
    v_add_u32 v4, 1, v4
    v_lshlrev_b32 v5, 28, v4
    v_and_b32 v5, 0x80000000, v5
    v_xor_b32 v4, s53, v4
    v_and_b32 v4, 7, v4
    v_lshl_or_b32 v5, v1, 4, v5
    v_mul_u32_u24 v1, 49152, v4
    v_add_u32 v236, v1, v5
    v_and_b32 v2, 1, v2
    v_lshl_or_b32 v2, v4, 1, v2
    v_mul_u32_u24 v2, 592, v2
    v_lshl_add_u32 v239, v3, 4, v2
    s_lshl_b32 s3, s52, 7
    s_add_u32 s3, s3, 64
    v_add_u32 v1, s3, v254
    v_mul_u32_u24 v2, 3641, v1
    v_lshrrev_b32 v2, 16, v2
    v_mul_u32_u24 v3, 18, v2
    v_sub_u32 v3, v1, v3
    v_lshrrev_b32 v4, 1, v2
    v_add_u32 v4, 1, v4
    v_lshlrev_b32 v5, 28, v4
    v_and_b32 v5, 0x80000000, v5
    v_xor_b32 v4, s53, v4
    v_and_b32 v4, 7, v4
    v_lshl_or_b32 v5, v1, 4, v5
    v_mul_u32_u24 v1, 49152, v4
    v_add_u32 v237, v1, v5
    s_waitcnt vmcnt(8)
    buffer_load_dwordx4 v10, s[4:7], s57 offen offset:2048 nt lds
    buffer_load_dwordx4 v[76:79], v62, s[12:15], s70 offen
    s_add_u32 s70, s70, 8192
    v_and_b32 v2, 1, v2
    v_lshl_or_b32 v2, v4, 1, v2
    v_mul_u32_u24 v2, 592, v2
    v_lshl_add_u32 v240, v3, 4, v2
    s_and_b32 s3, s63, 0xe3
    s_mul_i32 s3, s3, 12288
    s_add_u32 s47, s3, 270336
    ds_read_b128 a[96:99], v16 offset:0
    ds_read_b128 a[100:103], v17 offset:0
    ds_read_b128 a[104:107], v18 offset:0
    ds_read_b128 a[108:111], v19 offset:0
    ds_read_b128 a[112:115], v20 offset:0
    ds_read_b128 a[116:119], v21 offset:0
    ds_read_b128 a[120:123], v22 offset:0
    ds_read_b128 a[124:127], v23 offset:0
    s_waitcnt lgkmcnt(0)
    s_waitcnt vmcnt(8)
    buffer_load_dwordx4 v11, s[4:7], s57 offen offset:3072 nt lds
    v_perm_b32 v32, v100, v96, s61
    v_perm_b32 v33, v108, v104, s61
    v_perm_b32 v34, v116, v112, s61
    v_perm_b32 v35, v124, v120, s61
    v_perm_b32 v36, v100, v96, s62
    v_perm_b32 v37, v108, v104, s62
    v_perm_b32 v38, v116, v112, s62
    v_perm_b32 v39, v124, v120, s62
    v_mfma_f32_16x16x32_bf16 v[160:163], v[32:35], v[204:207], v[160:163]
    v_perm_b32 v40, v101, v97, s61
    v_perm_b32 v41, v109, v105, s61
    v_perm_b32 v42, v117, v113, s61
    v_perm_b32 v43, v125, v121, s61
    v_mfma_f32_16x16x32_bf16 v[164:167], v[36:39], v[204:207], v[164:167]
    s_xor_b32 s57, s99, 196608
    s_add_u32 m0, s56, 16384
    s_waitcnt vmcnt(7)
    buffer_load_dwordx4 v8, s[4:7], s57 offen offset:0 nt lds
    buffer_load_dwordx4 v[80:83], v62, s[12:15], s70 offen
    s_add_u32 s70, s70, 8192
    v_add_u32 v0, 1, v0
    v_lshlrev_b32 v0, 8, v0
    s_nop 0
    v_readlane_b32 s45, v0, 0
    v_perm_b32 v44, v101, v97, s62
    v_perm_b32 v45, v109, v105, s62
    v_perm_b32 v46, v117, v113, s62
    v_perm_b32 v47, v125, v121, s62
    v_mfma_f32_16x16x32_bf16 v[168:171], v[40:43], v[204:207], v[168:171]
    v_perm_b32 v32, v102, v98, s61
    v_perm_b32 v33, v110, v106, s61
    v_perm_b32 v34, v118, v114, s61
    v_perm_b32 v35, v126, v122, s61
    v_mfma_f32_16x16x32_bf16 v[172:175], v[44:47], v[204:207], v[172:175]
    v_perm_b32 v36, v102, v98, s62
    v_perm_b32 v37, v110, v106, s62
    v_perm_b32 v38, v118, v114, s62
    v_perm_b32 v39, v126, v122, s62
    s_waitcnt vmcnt(8)
    buffer_load_dwordx4 v9, s[4:7], s57 offen offset:1024 nt lds
    buffer_load_dwordx4 v[84:87], v62, s[12:15], s70 offen
    s_add_u32 s70, s70, 8192
    v_mfma_f32_16x16x32_bf16 v[176:179], v[32:35], v[204:207], v[176:179]
    v_perm_b32 v40, v103, v99, s61
    v_perm_b32 v41, v111, v107, s61
    v_perm_b32 v42, v119, v115, s61
    v_perm_b32 v43, v127, v123, s61
    v_mfma_f32_16x16x32_bf16 v[180:183], v[36:39], v[204:207], v[180:183]
    v_perm_b32 v44, v103, v99, s62
    v_perm_b32 v45, v111, v107, s62
    v_perm_b32 v46, v119, v115, s62
    v_perm_b32 v47, v127, v123, s62
    v_mfma_f32_16x16x32_bf16 v[184:187], v[40:43], v[204:207], v[184:187]
    s_waitcnt vmcnt(8)
    buffer_load_dwordx4 v10, s[4:7], s57 offen offset:2048 nt lds
    buffer_load_dwordx4 v[88:91], v62, s[12:15], s70 offen
    s_add_u32 s70, s70, 8192
    v_mfma_f32_16x16x32_bf16 v[188:191], v[44:47], v[204:207], v[188:191]
    s_waitcnt vmcnt(8)
    buffer_load_dwordx4 v11, s[4:7], s57 offen offset:3072 nt lds
    s_xor_b32 s57, s99, 200704
    s_add_u32 m0, s56, 20480
    s_waitcnt vmcnt(7)
    buffer_load_dwordx4 v8, s[4:7], s57 offen offset:0 nt lds
    buffer_load_dwordx4 v[92:95], v62, s[12:15], s70 offen
    s_add_u32 s70, s70, 204800
    s_cmp_eq_u32 s64, 4
    s_cselect_b32 s3, 2359296, 0
    s_sub_u32 s70, s70, s3
    ds_read_b128 a[128:131], v16 offset:8192
    ds_read_b128 a[132:135], v17 offset:8192
    ds_read_b128 a[136:139], v18 offset:8192
    ds_read_b128 a[140:143], v19 offset:8192
    ds_read_b128 a[144:147], v20 offset:8192
    ds_read_b128 a[148:151], v21 offset:8192
    ds_read_b128 a[152:155], v22 offset:8192
    ds_read_b128 a[156:159], v23 offset:8192
    s_waitcnt lgkmcnt(0)
    s_waitcnt vmcnt(8)
    buffer_load_dwordx4 v9, s[4:7], s57 offen offset:1024 nt lds
    buffer_load_dwordx4 v[96:99], v62, s[12:15], s70 offen
    s_add_u32 s70, s70, 8192
    s_waitcnt vmcnt(8)
    buffer_load_dwordx4 v10, s[4:7], s57 offen offset:2048 nt lds
    buffer_load_dwordx4 v[100:103], v62, s[12:15], s70 offen
    s_add_u32 s70, s70, 8192
    s_waitcnt vmcnt(8)
    buffer_load_dwordx4 v11, s[4:7], s57 offen offset:3072 nt lds
    buffer_load_dwordx4 v[104:107], v62, s[12:15], s70 offen
    s_add_u32 s70, s70, 8192
    s_xor_b32 s57, s99, 212992
    s_add_u32 m0, s56, 24576
    s_waitcnt vmcnt(8)
    buffer_load_dwordx4 v8, s[4:7], s57 offen offset:0 nt lds
    s_waitcnt vmcnt(8)
    buffer_load_dwordx4 v9, s[4:7], s57 offen offset:1024 nt lds
    buffer_load_dwordx4 v[108:111], v62, s[12:15], s70 offen
    s_add_u32 s70, s70, 8192
    s_waitcnt vmcnt(8)
    buffer_load_dwordx4 v10, s[4:7], s57 offen offset:2048 nt lds
    buffer_load_dwordx4 v[112:115], v62, s[12:15], s70 offen
    s_add_u32 s70, s70, 8192
    v_perm_b32 v32, v68, v64, s61
    v_perm_b32 v33, v76, v72, s61
    v_perm_b32 v34, v84, v80, s61
    v_perm_b32 v35, v92, v88, s61
    v_perm_b32 v36, v68, v64, s62
    v_perm_b32 v37, v76, v72, s62
    v_perm_b32 v38, v84, v80, s62
    v_perm_b32 v39, v92, v88, s62
    v_mfma_f32_16x16x32_bf16 v[160:163], v[32:35], v[208:211], v[160:163]
    v_perm_b32 v40, v69, v65, s61
    v_perm_b32 v41, v77, v73, s61
    v_perm_b32 v42, v85, v81, s61
    v_perm_b32 v43, v93, v89, s61
    v_mfma_f32_16x16x32_bf16 v[164:167], v[36:39], v[208:211], v[164:167]
    s_waitcnt vmcnt(8)
    buffer_load_dwordx4 v11, s[4:7], s57 offen offset:3072 nt lds
    buffer_load_dwordx4 v[116:119], v62, s[12:15], s70 offen
    s_add_u32 s70, s70, 8192
    v_perm_b32 v44, v69, v65, s62
    v_perm_b32 v45, v77, v73, s62
    v_perm_b32 v46, v85, v81, s62
    v_perm_b32 v47, v93, v89, s62
    v_mfma_f32_16x16x32_bf16 v[168:171], v[40:43], v[208:211], v[168:171]
    v_perm_b32 v32, v70, v66, s61
    v_perm_b32 v33, v78, v74, s61
    v_perm_b32 v34, v86, v82, s61
    v_perm_b32 v35, v94, v90, s61
    v_mfma_f32_16x16x32_bf16 v[172:175], v[44:47], v[208:211], v[172:175]
    v_perm_b32 v36, v70, v66, s62
    v_perm_b32 v37, v78, v74, s62
    v_perm_b32 v38, v86, v82, s62
    v_perm_b32 v39, v94, v90, s62
    s_xor_b32 s57, s99, 217088
    s_add_u32 m0, s56, 28672
    s_waitcnt vmcnt(8)
    buffer_load_dwordx4 v8, s[4:7], s57 offen offset:0 nt lds
    v_mfma_f32_16x16x32_bf16 v[176:179], v[32:35], v[208:211], v[176:179]
    v_perm_b32 v40, v71, v67, s61
    v_perm_b32 v41, v79, v75, s61
    v_perm_b32 v42, v87, v83, s61
    v_perm_b32 v43, v95, v91, s61
    v_mfma_f32_16x16x32_bf16 v[180:183], v[36:39], v[208:211], v[180:183]
    v_perm_b32 v44, v71, v67, s62
    v_perm_b32 v45, v79, v75, s62
    v_perm_b32 v46, v87, v83, s62
    v_perm_b32 v47, v95, v91, s62
    v_mfma_f32_16x16x32_bf16 v[184:187], v[40:43], v[208:211], v[184:187]
    s_nop 0
    v_mfma_f32_16x16x32_bf16 v[188:191], v[44:47], v[208:211], v[188:191]
    ds_read_b128 a[160:163], v16 offset:16384
    ds_read_b128 a[164:167], v17 offset:16384
    s_waitcnt vmcnt(7)
    buffer_load_dwordx4 v9, s[4:7], s57 offen offset:1024 nt lds
    buffer_load_dwordx4 v[120:123], v62, s[12:15], s70 offen
    s_add_u32 s70, s70, 8192
    ds_read_b128 a[168:171], v18 offset:16384
    ds_read_b128 a[172:175], v19 offset:16384
    ds_read_b128 a[176:179], v20 offset:16384
    ds_read_b128 a[180:183], v21 offset:16384
    ds_read_b128 a[184:187], v22 offset:16384
    ds_read_b128 a[188:191], v23 offset:16384
    s_waitcnt lgkmcnt(0)
    s_waitcnt vmcnt(8)
    buffer_load_dwordx4 v10, s[4:7], s57 offen offset:2048 nt lds
    buffer_load_dwordx4 v[124:127], v62, s[12:15], s70 offen
    s_add_u32 s70, s70, 204800
    s_cmp_eq_u32 s64, 3
    s_cselect_b32 s3, 2359296, 0
    s_sub_u32 s70, s70, s3
    s_waitcnt vmcnt(8)
    buffer_load_dwordx4 v11, s[4:7], s57 offen offset:3072 nt lds
    buffer_load_dwordx4 v[64:67], v62, s[12:15], s70 offen
    s_add_u32 s70, s70, 8192
    s_xor_b32 s57, s99, 262144
    s_add_u32 m0, s56, 0
    s_waitcnt vmcnt(8)
    buffer_load_dwordx4 v8, s[4:7], s57 offen offset:0 nt lds
    s_waitcnt vmcnt(7)
    buffer_load_dwordx4 v9, s[4:7], s57 offen offset:1024 nt lds
    buffer_load_dwordx4 v[68:71], v62, s[12:15], s70 offen
    s_add_u32 s70, s70, 8192
    s_waitcnt vmcnt(8)
    buffer_load_dwordx4 v10, s[4:7], s57 offen offset:2048 nt lds
    buffer_load_dwordx4 v[72:75], v62, s[12:15], s70 offen
    s_add_u32 s70, s70, 8192
    s_waitcnt vmcnt(8)
    buffer_load_dwordx4 v11, s[4:7], s57 offen offset:3072 nt lds
    buffer_load_dwordx4 v[76:79], v62, s[12:15], s70 offen
    s_add_u32 s70, s70, 8192
    s_xor_b32 s57, s99, 266240
    s_add_u32 m0, s56, 4096
    s_waitcnt vmcnt(8)
    buffer_load_dwordx4 v8, s[4:7], s57 offen offset:0 nt lds
    v_perm_b32 v32, v100, v96, s61
    v_perm_b32 v33, v108, v104, s61
    v_perm_b32 v34, v116, v112, s61
    v_perm_b32 v35, v124, v120, s61
    v_perm_b32 v36, v100, v96, s62
    v_perm_b32 v37, v108, v104, s62
    v_perm_b32 v38, v116, v112, s62
    v_perm_b32 v39, v124, v120, s62
    v_mfma_f32_16x16x32_bf16 v[160:163], v[32:35], v[212:215], v[160:163]
    v_perm_b32 v40, v101, v97, s61
    v_perm_b32 v41, v109, v105, s61
    v_perm_b32 v42, v117, v113, s61
    v_perm_b32 v43, v125, v121, s61
    v_mfma_f32_16x16x32_bf16 v[164:167], v[36:39], v[212:215], v[164:167]
    v_perm_b32 v44, v101, v97, s62
    v_perm_b32 v45, v109, v105, s62
    v_perm_b32 v46, v117, v113, s62
    v_perm_b32 v47, v125, v121, s62
    v_mfma_f32_16x16x32_bf16 v[168:171], v[40:43], v[212:215], v[168:171]
    s_waitcnt vmcnt(7)
    buffer_load_dwordx4 v9, s[4:7], s57 offen offset:1024 nt lds
    buffer_load_dwordx4 v[80:83], v62, s[12:15], s70 offen
    s_add_u32 s70, s70, 8192
    v_perm_b32 v32, v102, v98, s61
    v_perm_b32 v33, v110, v106, s61
    v_perm_b32 v34, v118, v114, s61
    v_perm_b32 v35, v126, v122, s61
    v_mfma_f32_16x16x32_bf16 v[172:175], v[44:47], v[212:215], v[172:175]
    v_perm_b32 v36, v102, v98, s62
    v_perm_b32 v37, v110, v106, s62
    v_perm_b32 v38, v118, v114, s62
    v_perm_b32 v39, v126, v122, s62
    v_mfma_f32_16x16x32_bf16 v[176:179], v[32:35], v[212:215], v[176:179]
    v_perm_b32 v40, v103, v99, s61
    v_perm_b32 v41, v111, v107, s61
    v_perm_b32 v42, v119, v115, s61
    v_perm_b32 v43, v127, v123, s61
    v_mfma_f32_16x16x32_bf16 v[180:183], v[36:39], v[212:215], v[180:183]
    v_perm_b32 v44, v103, v99, s62
    v_perm_b32 v45, v111, v107, s62
    s_waitcnt vmcnt(8)
    buffer_load_dwordx4 v10, s[4:7], s57 offen offset:2048 nt lds
    buffer_load_dwordx4 v[84:87], v62, s[12:15], s70 offen
    s_add_u32 s70, s70, 8192
    v_perm_b32 v46, v119, v115, s62
    v_perm_b32 v47, v127, v123, s62
    v_mfma_f32_16x16x32_bf16 v[184:187], v[40:43], v[212:215], v[184:187]
    s_nop 0
    v_mfma_f32_16x16x32_bf16 v[188:191], v[44:47], v[212:215], v[188:191]
    ds_read_b128 a[192:195], v16 offset:24576
    ds_read_b128 a[196:199], v17 offset:24576
    ds_read_b128 a[200:203], v18 offset:24576
    ds_read_b128 a[204:207], v19 offset:24576
    ds_read_b128 a[208:211], v20 offset:24576
    ds_read_b128 a[212:215], v21 offset:24576
    ds_read_b128 a[216:219], v22 offset:24576
    ds_read_b128 a[220:223], v23 offset:24576
    s_waitcnt lgkmcnt(0)
    s_waitcnt vmcnt(8)
    buffer_load_dwordx4 v11, s[4:7], s57 offen offset:3072 nt lds
    buffer_load_dwordx4 v[88:91], v62, s[12:15], s70 offen
    s_add_u32 s70, s70, 8192
    s_xor_b32 s57, s99, 278528
    s_add_u32 m0, s56, 8192
    s_waitcnt vmcnt(8)
    buffer_load_dwordx4 v8, s[4:7], s57 offen offset:0 nt lds
    s_waitcnt vmcnt(7)
    buffer_load_dwordx4 v9, s[4:7], s57 offen offset:1024 nt lds
    buffer_load_dwordx4 v[92:95], v62, s[12:15], s70 offen
    s_add_u32 s70, s70, 204800
    s_cmp_eq_u32 s64, 2
    s_cselect_b32 s3, 2359296, 0
    s_sub_u32 s70, s70, s3
    s_waitcnt vmcnt(8)
    buffer_load_dwordx4 v10, s[4:7], s57 offen offset:2048 nt lds
    buffer_load_dwordx4 v[96:99], v62, s[12:15], s70 offen
    s_add_u32 s70, s70, 8192
    s_waitcnt vmcnt(8)
    buffer_load_dwordx4 v11, s[4:7], s57 offen offset:3072 nt lds
    buffer_load_dwordx4 v[100:103], v62, s[12:15], s70 offen
    s_add_u32 s70, s70, 8192
    s_xor_b32 s57, s99, 282624
    s_add_u32 m0, s56, 12288
    s_waitcnt vmcnt(8)
    buffer_load_dwordx4 v8, s[4:7], s57 offen offset:0 nt lds
    buffer_load_dwordx4 v[104:107], v62, s[12:15], s70 offen
    s_add_u32 s70, s70, 8192
    ds_read_b128 a[224:227], v16 offset:0
    ds_read_b128 a[228:231], v17 offset:0
    ds_read_b128 a[232:235], v18 offset:0
    ds_read_b128 a[236:239], v19 offset:0
    ds_read_b128 a[240:243], v20 offset:0
    ds_read_b128 a[244:247], v21 offset:0
    ds_read_b128 a[248:251], v22 offset:0
    ds_read_b128 a[252:255], v23 offset:0
    s_waitcnt lgkmcnt(0)
    s_waitcnt vmcnt(8)
    buffer_load_dwordx4 v9, s[4:7], s57 offen offset:1024 nt lds
    s_waitcnt vmcnt(8)
    buffer_load_dwordx4 v10, s[4:7], s57 offen offset:2048 nt lds
    buffer_load_dwordx4 v[108:111], v62, s[12:15], s70 offen
    s_add_u32 s70, s70, 8192
    s_waitcnt vmcnt(8)
    buffer_load_dwordx4 v11, s[4:7], s57 offen offset:3072 nt lds
    buffer_load_dwordx4 v[112:115], v62, s[12:15], s70 offen
    s_add_u32 s70, s70, 8192
    v_perm_b32 v32, v68, v64, s61
    v_perm_b32 v33, v76, v72, s61
    v_perm_b32 v34, v84, v80, s61
    v_perm_b32 v35, v92, v88, s61
    v_perm_b32 v36, v68, v64, s62
    v_perm_b32 v37, v76, v72, s62
    v_perm_b32 v38, v84, v80, s62
    v_perm_b32 v39, v92, v88, s62
    v_mfma_f32_16x16x32_bf16 v[160:163], v[32:35], v[216:219], v[160:163]
    v_perm_b32 v40, v69, v65, s61
    v_perm_b32 v41, v77, v73, s61
    v_perm_b32 v42, v85, v81, s61
    v_perm_b32 v43, v93, v89, s61
    v_mfma_f32_16x16x32_bf16 v[164:167], v[36:39], v[216:219], v[164:167]
    s_xor_b32 s57, s99, 327680
    s_add_u32 m0, s56, 16384
    s_waitcnt vmcnt(8)
    buffer_load_dwordx4 v8, s[4:7], s57 offen offset:0 nt lds
    buffer_load_dwordx4 v[116:119], v62, s[12:15], s70 offen
    s_add_u32 s70, s70, 8192
    v_perm_b32 v44, v69, v65, s62
    v_perm_b32 v45, v77, v73, s62
    v_perm_b32 v46, v85, v81, s62
    v_perm_b32 v47, v93, v89, s62
    v_mfma_f32_16x16x32_bf16 v[168:171], v[40:43], v[216:219], v[168:171]
    v_perm_b32 v32, v70, v66, s61
    v_perm_b32 v33, v78, v74, s61
    v_perm_b32 v34, v86, v82, s61
    v_perm_b32 v35, v94, v90, s61
    v_mfma_f32_16x16x32_bf16 v[172:175], v[44:47], v[216:219], v[172:175]
    v_perm_b32 v36, v70, v66, s62
    v_perm_b32 v37, v78, v74, s62
    v_perm_b32 v38, v86, v82, s62
    v_perm_b32 v39, v94, v90, s62
    s_waitcnt vmcnt(8)
    buffer_load_dwordx4 v9, s[4:7], s57 offen offset:1024 nt lds
    v_mfma_f32_16x16x32_bf16 v[176:179], v[32:35], v[216:219], v[176:179]
    v_perm_b32 v40, v71, v67, s61
    v_perm_b32 v41, v79, v75, s61
    v_perm_b32 v42, v87, v83, s61
    v_perm_b32 v43, v95, v91, s61
    v_mfma_f32_16x16x32_bf16 v[180:183], v[36:39], v[216:219], v[180:183]
    v_perm_b32 v44, v71, v67, s62
    v_perm_b32 v45, v79, v75, s62
    v_perm_b32 v46, v87, v83, s62
    v_perm_b32 v47, v95, v91, s62
    v_mfma_f32_16x16x32_bf16 v[184:187], v[40:43], v[216:219], v[184:187]
    s_waitcnt vmcnt(7)
    buffer_load_dwordx4 v10, s[4:7], s57 offen offset:2048 nt lds
    buffer_load_dwordx4 v[120:123], v62, s[12:15], s70 offen
    s_add_u32 s70, s70, 8192
    v_mfma_f32_16x16x32_bf16 v[188:191], v[44:47], v[216:219], v[188:191]
    s_waitcnt vmcnt(8)
    buffer_load_dwordx4 v11, s[4:7], s57 offen offset:3072 nt lds
    buffer_load_dwordx4 v[124:127], v62, s[12:15], s70 offen
    s_add_u32 s70, s70, 204800
    s_cmp_eq_u32 s64, 1
    s_cselect_b32 s3, 2359296, 0
    s_sub_u32 s70, s70, s3
    s_xor_b32 s57, s99, 331776
    s_add_u32 m0, s56, 20480
    s_waitcnt vmcnt(8)
    buffer_load_dwordx4 v8, s[4:7], s57 offen offset:0 nt lds
    buffer_load_dwordx4 v[64:67], v62, s[12:15], s70 offen
    s_add_u32 s70, s70, 8192
    s_waitcnt vmcnt(8)
    buffer_load_dwordx4 v9, s[4:7], s57 offen offset:1024 nt lds
    s_waitcnt vmcnt(7)
    buffer_load_dwordx4 v10, s[4:7], s57 offen offset:2048 nt lds
    buffer_load_dwordx4 v[68:71], v62, s[12:15], s70 offen
    s_add_u32 s70, s70, 8192
    s_waitcnt vmcnt(8)
    buffer_load_dwordx4 v11, s[4:7], s57 offen offset:3072 nt lds
    buffer_load_dwordx4 v[72:75], v62, s[12:15], s70 offen
    s_add_u32 s70, s70, 8192
    s_xor_b32 s57, s99, 344064
    s_add_u32 m0, s56, 24576
    s_waitcnt vmcnt(8)
    buffer_load_dwordx4 v8, s[4:7], s57 offen offset:0 nt lds
    buffer_load_dwordx4 v[76:79], v62, s[12:15], s70 offen
    s_add_u32 s70, s70, 8192
    s_waitcnt vmcnt(8)
    buffer_load_dwordx4 v9, s[4:7], s57 offen offset:1024 nt lds
    v_perm_b32 v32, v100, v96, s61
    v_perm_b32 v33, v108, v104, s61
    v_perm_b32 v34, v116, v112, s61
    v_perm_b32 v35, v124, v120, s61
    v_perm_b32 v36, v100, v96, s62
    v_perm_b32 v37, v108, v104, s62
    v_perm_b32 v38, v116, v112, s62
    v_perm_b32 v39, v124, v120, s62
    v_mfma_f32_16x16x32_bf16 v[160:163], v[32:35], v[220:223], v[160:163]
    v_perm_b32 v40, v101, v97, s61
    v_perm_b32 v41, v109, v105, s61
    v_perm_b32 v42, v117, v113, s61
    v_perm_b32 v43, v125, v121, s61
    v_mfma_f32_16x16x32_bf16 v[164:167], v[36:39], v[220:223], v[164:167]
    v_perm_b32 v44, v101, v97, s62
    v_perm_b32 v45, v109, v105, s62
    v_perm_b32 v46, v117, v113, s62
    v_perm_b32 v47, v125, v121, s62
    v_mfma_f32_16x16x32_bf16 v[168:171], v[40:43], v[220:223], v[168:171]
    s_waitcnt vmcnt(7)
    buffer_load_dwordx4 v10, s[4:7], s57 offen offset:2048 nt lds
    buffer_load_dwordx4 v[80:83], v62, s[12:15], s70 offen
    s_add_u32 s70, s70, 8192
    v_perm_b32 v32, v102, v98, s61
    v_perm_b32 v33, v110, v106, s61
    v_perm_b32 v34, v118, v114, s61
    v_perm_b32 v35, v126, v122, s61
    v_mfma_f32_16x16x32_bf16 v[172:175], v[44:47], v[220:223], v[172:175]
    v_perm_b32 v36, v102, v98, s62
    v_perm_b32 v37, v110, v106, s62
    v_perm_b32 v38, v118, v114, s62
    v_perm_b32 v39, v126, v122, s62
    v_mfma_f32_16x16x32_bf16 v[176:179], v[32:35], v[220:223], v[176:179]
    v_perm_b32 v40, v103, v99, s61
    v_perm_b32 v41, v111, v107, s61
    v_perm_b32 v42, v119, v115, s61
    v_perm_b32 v43, v127, v123, s61
    v_mfma_f32_16x16x32_bf16 v[180:183], v[36:39], v[220:223], v[180:183]
    v_perm_b32 v44, v103, v99, s62
    v_perm_b32 v45, v111, v107, s62
    s_waitcnt vmcnt(8)
    buffer_load_dwordx4 v11, s[4:7], s57 offen offset:3072 nt lds
    buffer_load_dwordx4 v[84:87], v62, s[12:15], s70 offen
    s_add_u32 s70, s70, 8192
    v_perm_b32 v46, v119, v115, s62
    v_perm_b32 v47, v127, v123, s62
    v_mfma_f32_16x16x32_bf16 v[184:187], v[40:43], v[220:223], v[184:187]
    s_nop 0
    v_mfma_f32_16x16x32_bf16 v[188:191], v[44:47], v[220:223], v[188:191]
    ds_read_b128 v[96:99], v16 offset:8192
    ds_read_b128 v[100:103], v17 offset:8192
    ds_read_b128 v[104:107], v18 offset:8192
    ds_read_b128 v[108:111], v19 offset:8192
    ds_read_b128 v[112:115], v20 offset:8192
    ds_read_b128 v[116:119], v21 offset:8192
    ds_read_b128 v[120:123], v22 offset:8192
    ds_read_b128 v[124:127], v23 offset:8192
    s_waitcnt lgkmcnt(0)
    v_add_u32 v1, s67, v248
    s_xor_b32 s3, s52, 2
    s_mul_i32 s3, s3, 5120
    s_add_u32 s3, s3, 131072
    v_add_u32 v2, s3, v248
    s_and_b32 s3, s52, 1
    s_lshl_b32 s3, s3, 12
    s_lshr_b32 s69, s52, 1
    s_lshl_b32 s69, s69, 3
    s_add_u32 s3, s3, s69
    s_add_u32 s3, s3, 151552
    v_lshlrev_b32 v3, 2, v251
    v_xor_b32 v3, v3, v250
    v_lshlrev_b32 v3, 4, v3
    v_lshl_or_b32 v3, v250, 8, v3
    v_xor_b32 v4, 0, v3
    v_add_u32 v4, s3, v4
    v_xor_b32 v5, 16, v3
    v_add_u32 v5, s3, v5
    v_xor_b32 v6, 32, v3
    v_add_u32 v6, s3, v6
    v_xor_b32 v7, 48, v3
    v_add_u32 v7, s3, v7
    s_xor_b32 s57, s99, 348160
    s_add_u32 m0, s56, 28672
    s_waitcnt vmcnt(8)
    buffer_load_dwordx4 v8, s[4:7], s57 offen offset:0 nt lds
    buffer_load_dwordx4 v[88:91], v62, s[12:15], s70 offen
    s_add_u32 s70, s70, 8192
    s_sub_u32 s3, 151552, s56
    v_add_u32 v48, s3, v16
    v_add_u32 v49, s3, v17
    v_add_u32 v50, s3, v18
    v_add_u32 v51, s3, v19
    v_add_u32 v52, s3, v20
    v_add_u32 v53, s3, v21
    v_add_u32 v54, s3, v22
    v_add_u32 v55, s3, v23
    s_waitcnt vmcnt(8)
    buffer_load_dwordx4 v9, s[4:7], s57 offen offset:1024 nt lds
    s_waitcnt vmcnt(7)
    buffer_load_dwordx4 v10, s[4:7], s57 offen offset:2048 nt lds
    buffer_load_dwordx4 v[92:95], v62, s[12:15], s70 offen
    buffer_load_dwordx4 v11, s[4:7], s57 offen offset:3072 nt lds
    s_xor_b32 s57, s99, 393216
    s_add_u32 m0, s56, 0
    s_waitcnt vmcnt(9)
    buffer_load_dwordx4 v8, s[4:7], s57 offen offset:0 nt lds
    s_waitcnt vmcnt(8)
    buffer_load_dwordx4 v9, s[4:7], s57 offen offset:1024 nt lds
    s_waitcnt vmcnt(7)
    buffer_load_dwordx4 v10, s[4:7], s57 offen offset:2048 nt lds
    s_waitcnt vmcnt(6)
    buffer_load_dwordx4 v11, s[4:7], s57 offen offset:3072 nt lds
    s_xor_b32 s57, s99, 397312
    s_add_u32 m0, s56, 4096
    s_waitcnt vmcnt(6)
    buffer_load_dwordx4 v8, s[4:7], s57 offen offset:0 nt lds
    s_waitcnt vmcnt(5)
    buffer_load_dwordx4 v9, s[4:7], s57 offen offset:1024 nt lds
    v_perm_b32 v32, v68, v64, s61
    v_perm_b32 v33, v76, v72, s61
    v_perm_b32 v34, v84, v80, s61
    v_perm_b32 v35, v92, v88, s61
    v_perm_b32 v36, v68, v64, s62
    v_perm_b32 v37, v76, v72, s62
    v_perm_b32 v38, v84, v80, s62
    v_perm_b32 v39, v92, v88, s62
    v_mfma_f32_16x16x32_bf16 v[160:163], v[32:35], v[224:227], v[160:163]
    v_perm_b32 v40, v69, v65, s61
    v_perm_b32 v41, v77, v73, s61
    v_perm_b32 v42, v85, v81, s61
    v_perm_b32 v43, v93, v89, s61
    v_mfma_f32_16x16x32_bf16 v[164:167], v[36:39], v[224:227], v[164:167]
    v_perm_b32 v44, v69, v65, s62
    v_perm_b32 v45, v77, v73, s62
    v_perm_b32 v46, v85, v81, s62
    v_perm_b32 v47, v93, v89, s62
    s_waitcnt vmcnt(5)
    buffer_load_dwordx4 v10, s[4:7], s57 offen offset:2048 nt lds
    v_mfma_f32_16x16x32_bf16 v[168:171], v[40:43], v[224:227], v[168:171]
    v_perm_b32 v32, v70, v66, s61
    v_perm_b32 v33, v78, v74, s61
    v_perm_b32 v34, v86, v82, s61
    v_perm_b32 v35, v94, v90, s61
    v_mfma_f32_16x16x32_bf16 v[172:175], v[44:47], v[224:227], v[172:175]
    v_perm_b32 v36, v70, v66, s62
    v_perm_b32 v37, v78, v74, s62
    v_perm_b32 v38, v86, v82, s62
    v_perm_b32 v39, v94, v90, s62
    v_mfma_f32_16x16x32_bf16 v[176:179], v[32:35], v[224:227], v[176:179]
    v_perm_b32 v40, v71, v67, s61
    v_perm_b32 v41, v79, v75, s61
    v_perm_b32 v42, v87, v83, s61
    v_perm_b32 v43, v95, v91, s61
    s_waitcnt vmcnt(5)
    buffer_load_dwordx4 v11, s[4:7], s57 offen offset:3072 nt lds
    v_mfma_f32_16x16x32_bf16 v[180:183], v[36:39], v[224:227], v[180:183]
    v_perm_b32 v44, v71, v67, s62
    v_perm_b32 v45, v79, v75, s62
    v_perm_b32 v46, v87, v83, s62
    v_perm_b32 v47, v95, v91, s62
    v_mfma_f32_16x16x32_bf16 v[184:187], v[40:43], v[224:227], v[184:187]
    s_nop 0
    v_mfma_f32_16x16x32_bf16 v[188:191], v[44:47], v[224:227], v[188:191]
    ds_read_b128 v[64:67], v16 offset:16384
    ds_read_b128 v[68:71], v17 offset:16384
    ds_read_b128 v[72:75], v18 offset:16384
    ds_read_b128 v[76:79], v19 offset:16384
    ds_read_b128 v[80:83], v20 offset:16384
    ds_read_b128 v[84:87], v21 offset:16384
    ds_read_b128 v[88:91], v22 offset:16384
    ds_read_b128 v[92:95], v23 offset:16384
    s_xor_b32 s57, s99, 409600
    s_add_u32 m0, s56, 8192
    s_nop 0
    buffer_load_dwordx4 v8, s[4:7], s57 offen offset:0 nt lds
    s_waitcnt lgkmcnt(0)
    s_cmp_ge_u32 s52, 2
    s_cbranch_scc1 L_kh1
    ds_write_b128 v1, v[176:179] offset:0
    ds_write_b128 v1, v[180:183] offset:1024
    ds_write_b128 v1, v[184:187] offset:2048
    ds_write_b128 v1, v[188:191] offset:3072
    s_branch L_kh
L_kh1:
    ds_write_b128 v1, v[160:163] offset:0
    ds_write_b128 v1, v[164:167] offset:1024
    ds_write_b128 v1, v[168:171] offset:2048
    ds_write_b128 v1, v[172:175] offset:3072
    v_mov_b32 v160, v176
    v_mov_b32 v161, v177
    v_mov_b32 v162, v178
    v_mov_b32 v163, v179
    v_mov_b32 v164, v180
    v_mov_b32 v165, v181
    v_mov_b32 v166, v182
    v_mov_b32 v167, v183
    v_mov_b32 v168, v184
    v_mov_b32 v169, v185
    v_mov_b32 v170, v186
    v_mov_b32 v171, v187
    v_mov_b32 v172, v188
    v_mov_b32 v173, v189
    v_mov_b32 v174, v190
    v_mov_b32 v175, v191
L_kh:
    buffer_load_dwordx4 v9, s[4:7], s57 offen offset:1024 nt lds
    s_waitcnt lgkmcnt(0)
    s_barrier
    ds_read_b128 v[176:179], v2 offset:0
    ds_read_b128 v[180:183], v2 offset:1024
    ds_read_b128 v[184:187], v2 offset:2048
    ds_read_b128 v[188:191], v2 offset:3072
    s_waitcnt lgkmcnt(0)
    v_pk_add_f32 v[160:161], v[160:161], v[176:177]
    v_pk_add_f32 v[162:163], v[162:163], v[178:179]
    v_pk_add_f32 v[164:165], v[164:165], v[180:181]
    v_pk_add_f32 v[166:167], v[166:167], v[182:183]
    v_pk_add_f32 v[168:169], v[168:169], v[184:185]
    v_pk_add_f32 v[170:171], v[170:171], v[186:187]
    v_pk_add_f32 v[172:173], v[172:173], v[188:189]
    v_pk_add_f32 v[174:175], v[174:175], v[190:191]
    v_cvt_pk_bf16_f32 v32, v160, v164
    v_cvt_pk_bf16_f32 v33, v168, v172
    ds_write_b64 v4, v[32:33]
    v_cvt_pk_bf16_f32 v34, v161, v165
    v_cvt_pk_bf16_f32 v35, v169, v173
    ds_write_b64 v5, v[34:35]
    v_cvt_pk_bf16_f32 v36, v162, v166
    v_cvt_pk_bf16_f32 v37, v170, v174
    ds_write_b64 v6, v[36:37]
    s_waitcnt vmcnt(7)
    buffer_load_dwordx4 v10, s[4:7], s57 offen offset:2048 nt lds
    v_cvt_pk_bf16_f32 v38, v163, v167
    v_cvt_pk_bf16_f32 v39, v171, v175
    ds_write_b64 v7, v[38:39]
    s_waitcnt lgkmcnt(0)
    s_barrier
    ds_read_b128 v[192:195], v48
    ds_read_b128 v[196:199], v49
    ds_read_b128 v[200:203], v50
    ds_read_b128 v[204:207], v51
    ds_read_b128 v[208:211], v52
    ds_read_b128 v[212:215], v53
    ds_read_b128 v[216:219], v54
    ds_read_b128 v[220:223], v55
    s_waitcnt lgkmcnt(0)
    v_mfma_f32_32x32x16_bf16 v[32:47], v[128:131], v[192:195], 0
    v_mfma_f32_32x32x16_bf16 v[32:47], v[132:135], v[196:199], v[32:47]
    s_waitcnt vmcnt(5)
    buffer_load_dwordx4 v11, s[4:7], s57 offen offset:3072 nt lds
    v_mfma_f32_32x32x16_bf16 v[32:47], v[136:139], v[200:203], v[32:47]
    v_mfma_f32_32x32x16_bf16 v[32:47], v[140:143], v[204:207], v[32:47]
    v_mfma_f32_32x32x16_bf16 v[32:47], v[144:147], v[208:211], v[32:47]
    v_mfma_f32_32x32x16_bf16 v[32:47], v[148:151], v[212:215], v[32:47]
    s_xor_b32 s57, s99, 413696
    s_add_u32 m0, s56, 12288
    s_waitcnt vmcnt(5)
    buffer_load_dwordx4 v8, s[4:7], s57 offen offset:0 nt lds
    v_mfma_f32_32x32x16_bf16 v[32:47], v[152:155], v[216:219], v[32:47]
    v_mfma_f32_32x32x16_bf16 v[32:47], v[156:159], v[220:223], v[32:47]
    ds_read_b128 v[128:131], v16 offset:24576
    ds_read_b128 v[132:135], v17 offset:24576
    ds_read_b128 v[136:139], v18 offset:24576
    ds_read_b128 v[140:143], v19 offset:24576
    ds_read_b128 v[144:147], v20 offset:24576
    ds_read_b128 v[148:151], v21 offset:24576
    ds_read_b128 v[152:155], v22 offset:24576
    ds_read_b128 v[156:159], v23 offset:24576
    s_nop 3
    v_max3_f32 v13, v32, v33, v34
    v_max3_f32 v31, v35, v36, v37
    v_max3_f32 v13, v13, v38, v39
    v_max3_f32 v31, v31, v40, v41
    v_max3_f32 v13, v13, v42, v43
    v_max3_f32 v31, v31, v44, v45
    v_max3_f32 v13, v13, v46, v47
    v_max3_f32 v13, v13, v31, v14
    v_mov_b32 v31, v13
    s_nop 1
    v_permlane32_swap_b32 v13, v31
    s_waitcnt vmcnt(5)
    buffer_load_dwordx4 v9, s[4:7], s57 offen offset:1024 nt lds
    v_max_f32 v13, v13, v31
    v_sub_f32 v31, v14, v13
    v_mul_f32 v30, s60, v13
    v_mul_f32 v31, s60, v31
    v_mov_b32 v14, v13
    v_exp_f32 v160, v31
    s_waitcnt lgkmcnt(0)
    v_pk_fma_f32 v[32:33], v[32:33], s[60:61], v[30:31] op_sel_hi:[1,0,0] neg_lo:[0,0,1] neg_hi:[0,0,1]
    v_pk_fma_f32 v[34:35], v[34:35], s[60:61], v[30:31] op_sel_hi:[1,0,0] neg_lo:[0,0,1] neg_hi:[0,0,1]
    v_pk_fma_f32 v[36:37], v[36:37], s[60:61], v[30:31] op_sel_hi:[1,0,0] neg_lo:[0,0,1] neg_hi:[0,0,1]
    v_pk_fma_f32 v[38:39], v[38:39], s[60:61], v[30:31] op_sel_hi:[1,0,0] neg_lo:[0,0,1] neg_hi:[0,0,1]
    v_pk_fma_f32 v[40:41], v[40:41], s[60:61], v[30:31] op_sel_hi:[1,0,0] neg_lo:[0,0,1] neg_hi:[0,0,1]
    v_pk_fma_f32 v[42:43], v[42:43], s[60:61], v[30:31] op_sel_hi:[1,0,0] neg_lo:[0,0,1] neg_hi:[0,0,1]
    v_pk_fma_f32 v[44:45], v[44:45], s[60:61], v[30:31] op_sel_hi:[1,0,0] neg_lo:[0,0,1] neg_hi:[0,0,1]
    v_pk_fma_f32 v[46:47], v[46:47], s[60:61], v[30:31] op_sel_hi:[1,0,0] neg_lo:[0,0,1] neg_hi:[0,0,1]
    v_mul_f32 v15, v15, v160
    v_exp_f32 v32, v32
    v_exp_f32 v33, v33
    v_exp_f32 v34, v34
    v_exp_f32 v35, v35
    v_exp_f32 v36, v36
    s_waitcnt vmcnt(5)
    buffer_load_dwordx4 v10, s[4:7], s57 offen offset:2048 nt lds
    v_exp_f32 v37, v37
    v_exp_f32 v38, v38
    v_exp_f32 v39, v39
    v_exp_f32 v40, v40
    v_exp_f32 v41, v41
    v_exp_f32 v42, v42
    v_exp_f32 v43, v43
    v_exp_f32 v44, v44
    v_exp_f32 v45, v45
    v_exp_f32 v46, v46
    v_exp_f32 v47, v47
    v_pk_add_f32 v[2:3], v[32:33], v[34:35]
    v_pk_add_f32 v[4:5], v[36:37], v[38:39]
    v_pk_add_f32 v[2:3], v[2:3], v[40:41]
    v_pk_add_f32 v[4:5], v[4:5], v[42:43]
    s_waitcnt vmcnt(5)
    buffer_load_dwordx4 v11, s[4:7], s57 offen offset:3072 nt lds
    v_pk_add_f32 v[2:3], v[2:3], v[44:45]
    v_pk_add_f32 v[4:5], v[4:5], v[46:47]
    v_pk_add_f32 v[2:3], v[2:3], v[4:5]
    v_add_f32 v2, v2, v3
    v_add_f32 v15, v15, v2
    v_cvt_pk_bf16_f32 v224, v32, v33
    v_cvt_pk_bf16_f32 v225, v34, v35
    v_cvt_pk_bf16_f32 v226, v36, v37
    v_cvt_pk_bf16_f32 v227, v38, v39
    v_cvt_pk_bf16_f32 v228, v40, v41
    v_cvt_pk_bf16_f32 v229, v42, v43
    v_cvt_pk_bf16_f32 v230, v44, v45
    v_cvt_pk_bf16_f32 v231, v46, v47
    v_mfma_f32_32x32x16_bf16 v[32:47], a[0:3], v[192:195], 0
    v_mfma_f32_32x32x16_bf16 v[32:47], a[4:7], v[196:199], v[32:47]
    s_add_u32 s49, s49, s100
    s_lshr_b32 s34, s49, 4
    s_and_b32 s49, s49, 15
    s_cmp_ge_u32 s34, 2
    s_cselect_b64 vcc, -1, 0
    s_cmp_lg_u32 s44, 14
    s_cbranch_scc1 L_nr14
    s_mov_b32 s3, 81920
    v_mov_b32 v246, 1
    s_mov_b64 exec, 1
    buffer_atomic_add v246, off, s[24:27], s3 sc0
    s_mov_b64 exec, -1
L_nr14:
    v_add_u32 v0, 1, v0
    s_mov_b64 exec, s[32:33]
    buffer_store_dword v0, v242, s[24:27], s35 offen
    s_mov_b64 exec, -1
    buffer_load_dword v244, v242, s[24:27], s35 offen sc1
    s_xor_b32 s57, s99, 458752
    s_add_u32 m0, s56, 16384
    s_cbranch_vccnz L_w2_202
    s_bitcmp1_b32 s34, 0
    s_cbranch_scc1 L_w1_202
    s_waitcnt vmcnt(5)
L_w1_202:
    s_waitcnt vmcnt(6)
L_w2_202:
    s_waitcnt vmcnt(7)
    buffer_load_dwordx4 v8, s[4:7], s57 offen offset:0 nt lds
    v_mfma_f32_32x32x16_bf16 v[32:47], a[8:11], v[200:203], v[32:47]
    v_mfma_f32_32x32x16_bf16 v[32:47], a[12:15], v[204:207], v[32:47]
    v_mfma_f32_32x32x16_bf16 v[32:47], a[16:19], v[208:211], v[32:47]
    v_mfma_f32_32x32x16_bf16 v[32:47], a[20:23], v[212:215], v[32:47]
    s_cbranch_vccnz L_w2_203
    s_bitcmp1_b32 s34, 0
    s_cbranch_scc1 L_w1_203
    s_waitcnt vmcnt(5)
L_w1_203:
    s_waitcnt vmcnt(6)
L_w2_203:
    s_waitcnt vmcnt(7)
    buffer_load_dwordx4 v9, s[4:7], s57 offen offset:1024 nt lds
    v_mfma_f32_32x32x16_bf16 v[32:47], a[24:27], v[216:219], v[32:47]
    v_mfma_f32_32x32x16_bf16 v[32:47], a[28:31], v[220:223], v[32:47]
    s_nop 11
    v_max3_f32 v13, v32, v33, v34
    v_max3_f32 v31, v35, v36, v37
    v_max3_f32 v13, v13, v38, v39
    v_max3_f32 v31, v31, v40, v41
    v_max3_f32 v13, v13, v42, v43
    v_max3_f32 v31, v31, v44, v45
    v_max3_f32 v13, v13, v46, v47
    v_max3_f32 v13, v13, v31, v14
    v_mov_b32 v31, v13
    s_nop 1
    v_permlane32_swap_b32 v13, v31
    s_cbranch_vccnz L_w2_204
    s_bitcmp1_b32 s34, 0
    s_cbranch_scc1 L_w1_204
    s_waitcnt vmcnt(5)
L_w1_204:
    s_waitcnt vmcnt(6)
L_w2_204:
    s_waitcnt vmcnt(7)
    buffer_load_dwordx4 v10, s[4:7], s57 offen offset:2048 nt lds
    v_max_f32 v13, v13, v31
    v_sub_f32 v31, v14, v13
    v_mul_f32 v30, s60, v13
    v_mul_f32 v31, s60, v31
    v_mov_b32 v14, v13
    v_exp_f32 v161, v31
    v_pk_fma_f32 v[32:33], v[32:33], s[60:61], v[30:31] op_sel_hi:[1,0,0] neg_lo:[0,0,1] neg_hi:[0,0,1]
    v_pk_fma_f32 v[34:35], v[34:35], s[60:61], v[30:31] op_sel_hi:[1,0,0] neg_lo:[0,0,1] neg_hi:[0,0,1]
    v_pk_fma_f32 v[36:37], v[36:37], s[60:61], v[30:31] op_sel_hi:[1,0,0] neg_lo:[0,0,1] neg_hi:[0,0,1]
    v_pk_fma_f32 v[38:39], v[38:39], s[60:61], v[30:31] op_sel_hi:[1,0,0] neg_lo:[0,0,1] neg_hi:[0,0,1]
    v_pk_fma_f32 v[40:41], v[40:41], s[60:61], v[30:31] op_sel_hi:[1,0,0] neg_lo:[0,0,1] neg_hi:[0,0,1]
    v_pk_fma_f32 v[42:43], v[42:43], s[60:61], v[30:31] op_sel_hi:[1,0,0] neg_lo:[0,0,1] neg_hi:[0,0,1]
    v_pk_fma_f32 v[44:45], v[44:45], s[60:61], v[30:31] op_sel_hi:[1,0,0] neg_lo:[0,0,1] neg_hi:[0,0,1]
    v_pk_fma_f32 v[46:47], v[46:47], s[60:61], v[30:31] op_sel_hi:[1,0,0] neg_lo:[0,0,1] neg_hi:[0,0,1]
    v_mul_f32 v15, v15, v161
    v_exp_f32 v32, v32
    v_exp_f32 v33, v33
    v_exp_f32 v34, v34
    v_exp_f32 v35, v35
    v_exp_f32 v36, v36
    s_cbranch_vccnz L_w2_205
    s_bitcmp1_b32 s34, 0
    s_cbranch_scc1 L_w1_205
    s_waitcnt vmcnt(5)
L_w1_205:
    s_waitcnt vmcnt(6)
L_w2_205:
    s_waitcnt vmcnt(7)
    buffer_load_dwordx4 v11, s[4:7], s57 offen offset:3072 nt lds
    v_exp_f32 v37, v37
    v_exp_f32 v38, v38
    v_exp_f32 v39, v39
    v_exp_f32 v40, v40
    v_exp_f32 v41, v41
    v_exp_f32 v42, v42
    v_exp_f32 v43, v43
    v_exp_f32 v44, v44
    v_exp_f32 v45, v45
    v_exp_f32 v46, v46
    v_exp_f32 v47, v47
    v_pk_add_f32 v[2:3], v[32:33], v[34:35]
    v_pk_add_f32 v[4:5], v[36:37], v[38:39]
    v_pk_add_f32 v[2:3], v[2:3], v[40:41]
    v_pk_add_f32 v[4:5], v[4:5], v[42:43]
    s_add_u32 s49, s49, s100
    s_lshr_b32 s34, s49, 4
    s_and_b32 s49, s49, 15
    s_cmp_ge_u32 s34, 2
    s_cselect_b64 vcc, -1, 0
    s_xor_b32 s57, s99, 462848
    s_add_u32 m0, s56, 20480
    s_cbranch_vccnz L_w2_206
    s_bitcmp1_b32 s34, 0
    s_cbranch_scc1 L_w1_206
    s_waitcnt vmcnt(3)
L_w1_206:
    s_waitcnt vmcnt(6)
L_w2_206:
    s_waitcnt vmcnt(7)
    buffer_load_dwordx4 v8, s[4:7], s57 offen offset:0 nt lds
    v_pk_add_f32 v[2:3], v[2:3], v[44:45]
    v_pk_add_f32 v[4:5], v[4:5], v[46:47]
    v_pk_add_f32 v[2:3], v[2:3], v[4:5]
    v_add_f32 v2, v2, v3
    v_add_f32 v15, v15, v2
    v_cvt_pk_bf16_f32 v48, v32, v33
    v_cvt_pk_bf16_f32 v49, v34, v35
    v_cvt_pk_bf16_f32 v50, v36, v37
    v_cvt_pk_bf16_f32 v51, v38, v39
    v_cvt_pk_bf16_f32 v52, v40, v41
    v_cvt_pk_bf16_f32 v53, v42, v43
    v_cvt_pk_bf16_f32 v54, v44, v45
    v_cvt_pk_bf16_f32 v55, v46, v47
    v_accvgpr_write_b32 a0, v48
    v_accvgpr_write_b32 a1, v49
    v_accvgpr_write_b32 a2, v50
    v_accvgpr_write_b32 a3, v51
    v_accvgpr_write_b32 a4, v52
    v_accvgpr_write_b32 a5, v53
    v_accvgpr_write_b32 a6, v54
    v_accvgpr_write_b32 a7, v55
    v_mfma_f32_32x32x16_bf16 v[32:47], v[128:131], v[192:195], 0
    s_cbranch_vccnz L_w2_207
    s_bitcmp1_b32 s34, 0
    s_cbranch_scc1 L_w1_207
    s_waitcnt vmcnt(3)
L_w1_207:
    s_waitcnt vmcnt(4)
L_w2_207:
    s_waitcnt vmcnt(7)
    buffer_load_dwordx4 v9, s[4:7], s57 offen offset:1024 nt lds
    v_mfma_f32_32x32x16_bf16 v[32:47], v[132:135], v[196:199], v[32:47]
    v_mfma_f32_32x32x16_bf16 v[32:47], v[136:139], v[200:203], v[32:47]
    v_mfma_f32_32x32x16_bf16 v[32:47], v[140:143], v[204:207], v[32:47]
    v_mfma_f32_32x32x16_bf16 v[32:47], v[144:147], v[208:211], v[32:47]
    s_cbranch_vccnz L_w2_208
    s_bitcmp1_b32 s34, 0
    s_cbranch_scc1 L_w1_208
    s_waitcnt vmcnt(3)
L_w1_208:
    s_waitcnt vmcnt(4)
L_w2_208:
    s_waitcnt vmcnt(5)
    buffer_load_dwordx4 v10, s[4:7], s57 offen offset:2048 nt lds
    v_mfma_f32_32x32x16_bf16 v[32:47], v[148:151], v[212:215], v[32:47]
    v_mfma_f32_32x32x16_bf16 v[32:47], v[152:155], v[216:219], v[32:47]
    v_mfma_f32_32x32x16_bf16 v[32:47], v[156:159], v[220:223], v[32:47]
    ds_read_b128 v[128:131], v16 offset:0
    ds_read_b128 v[132:135], v17 offset:0
    ds_read_b128 v[136:139], v18 offset:0
    ds_read_b128 v[140:143], v19 offset:0
    ds_read_b128 v[144:147], v20 offset:0
    ds_read_b128 v[148:151], v21 offset:0
    ds_read_b128 v[152:155], v22 offset:0
    ds_read_b128 v[156:159], v23 offset:0
    s_nop 3
    v_max3_f32 v13, v32, v33, v34
    v_max3_f32 v31, v35, v36, v37
    s_cbranch_vccnz L_w2_209
    s_bitcmp1_b32 s34, 0
    s_cbranch_scc1 L_w1_209
    s_waitcnt vmcnt(3)
L_w1_209:
    s_waitcnt vmcnt(4)
L_w2_209:
    s_waitcnt vmcnt(5)
    buffer_load_dwordx4 v11, s[4:7], s57 offen offset:3072 nt lds
    v_max3_f32 v13, v13, v38, v39
    v_max3_f32 v31, v31, v40, v41
    v_max3_f32 v13, v13, v42, v43
    v_max3_f32 v31, v31, v44, v45
    v_max3_f32 v13, v13, v46, v47
    v_max3_f32 v13, v13, v31, v14
    v_mov_b32 v31, v13
    s_nop 1
    v_permlane32_swap_b32 v13, v31
    v_max_f32 v13, v13, v31
    v_sub_f32 v31, v14, v13
    v_mul_f32 v30, s60, v13
    v_mul_f32 v31, s60, v31
    v_mov_b32 v14, v13
    v_exp_f32 v162, v31
    s_waitcnt lgkmcnt(0)
    v_pk_fma_f32 v[32:33], v[32:33], s[60:61], v[30:31] op_sel_hi:[1,0,0] neg_lo:[0,0,1] neg_hi:[0,0,1]
    v_pk_fma_f32 v[34:35], v[34:35], s[60:61], v[30:31] op_sel_hi:[1,0,0] neg_lo:[0,0,1] neg_hi:[0,0,1]
    v_pk_fma_f32 v[36:37], v[36:37], s[60:61], v[30:31] op_sel_hi:[1,0,0] neg_lo:[0,0,1] neg_hi:[0,0,1]
    v_pk_fma_f32 v[38:39], v[38:39], s[60:61], v[30:31] op_sel_hi:[1,0,0] neg_lo:[0,0,1] neg_hi:[0,0,1]
    v_pk_fma_f32 v[40:41], v[40:41], s[60:61], v[30:31] op_sel_hi:[1,0,0] neg_lo:[0,0,1] neg_hi:[0,0,1]
    v_pk_fma_f32 v[42:43], v[42:43], s[60:61], v[30:31] op_sel_hi:[1,0,0] neg_lo:[0,0,1] neg_hi:[0,0,1]
    v_pk_fma_f32 v[44:45], v[44:45], s[60:61], v[30:31] op_sel_hi:[1,0,0] neg_lo:[0,0,1] neg_hi:[0,0,1]
    v_pk_fma_f32 v[46:47], v[46:47], s[60:61], v[30:31] op_sel_hi:[1,0,0] neg_lo:[0,0,1] neg_hi:[0,0,1]
    v_mul_f32 v15, v15, v162
    v_exp_f32 v32, v32
    s_cmp_lg_u32 s44, 14
    s_cbranch_scc1 L_nc14
    v_sub_u32 v247, v246, v245
    v_lshlrev_b32 v246, 8, v254
    v_readfirstlane_b32 s3, v247
    s_nop 0
    s_min_u32 s3, s3, 7
    s_mul_i32 s3, s3, 6
    s_add_u32 s3, s3, s45
    v_mov_b32 v247, s3
    s_and_b32 s3, s35, 0xfffffcff
    s_mov_b64 exec, 15
    buffer_store_dword v247, v246, s[24:27], s3 offen offset:128
    s_mov_b64 exec, -1
L_nc14:
    v_sub_u32 v244, v244, v0
    v_cmp_gt_u32 s[100:101], 64, v244
    v_readlane_b32 s46, v244, 32
    s_bcnt1_i32_b32 s3, s100
    s_mul_i32 s3, s3, 3
    s_add_u32 s46, s46, 1
    s_cmp_lt_u32 s46, 128
    s_cselect_b32 s46, s46, 21
    s_add_u32 s3, s3, s46
    s_ashr_i32 s3, s3, 2
    s_add_i32 s3, s3, 2
    s_max_i32 s3, s3, 8
    s_min_i32 s100, s3, 32
    s_add_u32 s49, s49, s100
    s_lshr_b32 s34, s49, 4
    s_and_b32 s49, s49, 15
    s_cmp_ge_u32 s34, 2
    s_cselect_b64 vcc, -1, 0
    s_xor_b32 s57, s99, 475136
    s_add_u32 m0, s56, 24576
    s_cbranch_vccnz L_w2_210
    s_bitcmp1_b32 s34, 0
    s_cbranch_scc1 L_w1_210
    s_waitcnt vmcnt(3)
L_w1_210:
    s_waitcnt vmcnt(4)
L_w2_210:
    s_waitcnt vmcnt(5)
    buffer_load_dwordx4 v8, s[4:7], s57 offen offset:0 nt lds
    v_exp_f32 v33, v33
    v_exp_f32 v34, v34
    v_exp_f32 v35, v35
    v_exp_f32 v36, v36
    v_exp_f32 v37, v37
    v_exp_f32 v38, v38
    v_exp_f32 v39, v39
    v_exp_f32 v40, v40
    v_exp_f32 v41, v41
    v_exp_f32 v42, v42
    v_exp_f32 v43, v43
    v_exp_f32 v44, v44
    v_exp_f32 v45, v45
    s_cbranch_vccnz L_w2_211
    s_bitcmp1_b32 s34, 0
    s_cbranch_scc1 L_w1_211
    s_waitcnt vmcnt(3)
L_w1_211:
    s_waitcnt vmcnt(4)
L_w2_211:
    s_waitcnt vmcnt(5)
    buffer_load_dwordx4 v9, s[4:7], s57 offen offset:1024 nt lds
    v_exp_f32 v46, v46
    v_exp_f32 v47, v47
    v_pk_add_f32 v[2:3], v[32:33], v[34:35]
    v_pk_add_f32 v[4:5], v[36:37], v[38:39]
    v_pk_add_f32 v[2:3], v[2:3], v[40:41]
    v_pk_add_f32 v[4:5], v[4:5], v[42:43]
    v_pk_add_f32 v[2:3], v[2:3], v[44:45]
    v_pk_add_f32 v[4:5], v[4:5], v[46:47]
    v_pk_add_f32 v[2:3], v[2:3], v[4:5]
    v_add_f32 v2, v2, v3
    v_add_f32 v15, v15, v2
    v_cvt_pk_bf16_f32 v48, v32, v33
    v_cvt_pk_bf16_f32 v49, v34, v35
    v_cvt_pk_bf16_f32 v50, v36, v37
    v_cvt_pk_bf16_f32 v51, v38, v39
    v_cvt_pk_bf16_f32 v52, v40, v41
    v_cvt_pk_bf16_f32 v53, v42, v43
    v_cvt_pk_bf16_f32 v54, v44, v45
    v_cvt_pk_bf16_f32 v55, v46, v47
    v_accvgpr_write_b32 a8, v48
    v_accvgpr_write_b32 a9, v49
    v_accvgpr_write_b32 a10, v50
    v_accvgpr_write_b32 a11, v51
    v_accvgpr_write_b32 a12, v52
    s_cbranch_vccnz L_w2_212
    s_bitcmp1_b32 s34, 0
    s_cbranch_scc1 L_w1_212
    s_waitcnt vmcnt(3)
L_w1_212:
    s_waitcnt vmcnt(4)
L_w2_212:
    s_waitcnt vmcnt(5)
    buffer_load_dwordx4 v10, s[4:7], s57 offen offset:2048 nt lds
    v_accvgpr_write_b32 a13, v53
    v_accvgpr_write_b32 a14, v54
    v_accvgpr_write_b32 a15, v55
    v_mfma_f32_32x32x16_bf16 v[32:47], v[128:131], v[192:195], 0
    v_mfma_f32_32x32x16_bf16 v[32:47], v[132:135], v[196:199], v[32:47]
    v_mfma_f32_32x32x16_bf16 v[32:47], v[136:139], v[200:203], v[32:47]
    s_cbranch_vccnz L_w2_213
    s_bitcmp1_b32 s34, 0
    s_cbranch_scc1 L_w1_213
    s_waitcnt vmcnt(3)
L_w1_213:
    s_waitcnt vmcnt(4)
L_w2_213:
    s_waitcnt vmcnt(5)
    buffer_load_dwordx4 v11, s[4:7], s57 offen offset:3072 nt lds
    v_mfma_f32_32x32x16_bf16 v[32:47], v[140:143], v[204:207], v[32:47]
    v_mfma_f32_32x32x16_bf16 v[32:47], v[144:147], v[208:211], v[32:47]
    v_mfma_f32_32x32x16_bf16 v[32:47], v[148:151], v[212:215], v[32:47]
    v_mfma_f32_32x32x16_bf16 v[32:47], v[152:155], v[216:219], v[32:47]
    s_add_u32 s49, s49, s100
    s_lshr_b32 s34, s49, 4
    s_and_b32 s49, s49, 15
    s_cmp_ge_u32 s34, 2
    s_cselect_b64 vcc, -1, 0
    s_xor_b32 s57, s99, 479232
    s_add_u32 m0, s56, 28672
    s_cbranch_vccnz L_w2_214
    s_bitcmp1_b32 s34, 0
    s_cbranch_scc1 L_w1_214
    s_waitcnt vmcnt(3)
L_w1_214:
    s_waitcnt vmcnt(4)
L_w2_214:
    s_waitcnt vmcnt(5)
    buffer_load_dwordx4 v8, s[4:7], s57 offen offset:0 nt lds
    s_lshl_b32 s3, s52, 3
    s_or_b32 s3, s3, s54
    s_cmp_lg_u32 s3, 0
    s_cbranch_scc1 L_nb0
    s_mov_b64 exec, 1
    buffer_atomic_add v243, off, s[24:27], s78
    s_mov_b64 exec, -1
L_nb0:
    v_mfma_f32_32x32x16_bf16 v[32:47], v[156:159], v[220:223], v[32:47]
    ds_read_b128 v[128:131], v16 offset:8192
    ds_read_b128 v[132:135], v17 offset:8192
    ds_read_b128 v[136:139], v18 offset:8192
    ds_read_b128 v[140:143], v19 offset:8192
    ds_read_b128 v[144:147], v20 offset:8192
    ds_read_b128 v[148:151], v21 offset:8192
    ds_read_b128 v[152:155], v22 offset:8192
    ds_read_b128 v[156:159], v23 offset:8192
    s_nop 3
    v_max3_f32 v13, v32, v33, v34
    v_max3_f32 v31, v35, v36, v37
    v_max3_f32 v13, v13, v38, v39
    v_max3_f32 v31, v31, v40, v41
    v_max3_f32 v13, v13, v42, v43
    v_max3_f32 v31, v31, v44, v45
    v_max3_f32 v13, v13, v46, v47
    v_max3_f32 v13, v13, v31, v14
    v_mov_b32 v31, v13
    s_nop 1
    v_permlane32_swap_b32 v13, v31
    v_max_f32 v13, v13, v31
    v_sub_f32 v31, v14, v13
    v_mul_f32 v30, s60, v13
    v_mul_f32 v31, s60, v31
    v_mov_b32 v14, v13
    v_exp_f32 v163, v31
    s_waitcnt lgkmcnt(0)
    v_pk_fma_f32 v[32:33], v[32:33], s[60:61], v[30:31] op_sel_hi:[1,0,0] neg_lo:[0,0,1] neg_hi:[0,0,1]
    s_cbranch_vccnz L_w2_215
    s_bitcmp1_b32 s34, 0
    s_cbranch_scc1 L_w1_215
    s_waitcnt vmcnt(3)
L_w1_215:
    s_waitcnt vmcnt(4)
L_w2_215:
    s_waitcnt vmcnt(5)
    buffer_load_dwordx4 v9, s[4:7], s57 offen offset:1024 nt lds
    v_pk_fma_f32 v[34:35], v[34:35], s[60:61], v[30:31] op_sel_hi:[1,0,0] neg_lo:[0,0,1] neg_hi:[0,0,1]
    v_pk_fma_f32 v[36:37], v[36:37], s[60:61], v[30:31] op_sel_hi:[1,0,0] neg_lo:[0,0,1] neg_hi:[0,0,1]
    v_pk_fma_f32 v[38:39], v[38:39], s[60:61], v[30:31] op_sel_hi:[1,0,0] neg_lo:[0,0,1] neg_hi:[0,0,1]
    v_pk_fma_f32 v[40:41], v[40:41], s[60:61], v[30:31] op_sel_hi:[1,0,0] neg_lo:[0,0,1] neg_hi:[0,0,1]
    v_pk_fma_f32 v[42:43], v[42:43], s[60:61], v[30:31] op_sel_hi:[1,0,0] neg_lo:[0,0,1] neg_hi:[0,0,1]
    v_pk_fma_f32 v[44:45], v[44:45], s[60:61], v[30:31] op_sel_hi:[1,0,0] neg_lo:[0,0,1] neg_hi:[0,0,1]
    v_pk_fma_f32 v[46:47], v[46:47], s[60:61], v[30:31] op_sel_hi:[1,0,0] neg_lo:[0,0,1] neg_hi:[0,0,1]
    v_mul_f32 v15, v15, v163
    v_exp_f32 v32, v32
    v_exp_f32 v33, v33
    v_exp_f32 v34, v34
    v_exp_f32 v35, v35
    v_exp_f32 v36, v36
    v_exp_f32 v37, v37
    v_exp_f32 v38, v38
    v_exp_f32 v39, v39
    v_exp_f32 v40, v40
    s_cbranch_vccnz L_w2_216
    s_bitcmp1_b32 s34, 0
    s_cbranch_scc1 L_w1_216
    s_waitcnt vmcnt(3)
L_w1_216:
    s_waitcnt vmcnt(4)
L_w2_216:
    s_waitcnt vmcnt(5)
    buffer_load_dwordx4 v10, s[4:7], s57 offen offset:2048 nt lds
    v_exp_f32 v41, v41
    v_exp_f32 v42, v42
    v_exp_f32 v43, v43
    v_exp_f32 v44, v44
    v_exp_f32 v45, v45
    v_exp_f32 v46, v46
    v_exp_f32 v47, v47
    v_pk_add_f32 v[2:3], v[32:33], v[34:35]
    v_pk_add_f32 v[4:5], v[36:37], v[38:39]
    v_pk_add_f32 v[2:3], v[2:3], v[40:41]
    v_pk_add_f32 v[4:5], v[4:5], v[42:43]
    v_pk_add_f32 v[2:3], v[2:3], v[44:45]
    v_pk_add_f32 v[4:5], v[4:5], v[46:47]
    v_pk_add_f32 v[2:3], v[2:3], v[4:5]
    v_add_f32 v2, v2, v3
    v_add_f32 v15, v15, v2
    v_cvt_pk_bf16_f32 v48, v32, v33
    v_cvt_pk_bf16_f32 v49, v34, v35
    v_cvt_pk_bf16_f32 v50, v36, v37
    s_cbranch_vccnz L_w2_217
    s_bitcmp1_b32 s34, 0
    s_cbranch_scc1 L_w1_217
    s_waitcnt vmcnt(3)
L_w1_217:
    s_waitcnt vmcnt(4)
L_w2_217:
    s_waitcnt vmcnt(5)
    buffer_load_dwordx4 v11, s[4:7], s57 offen offset:3072 nt lds
    v_cvt_pk_bf16_f32 v51, v38, v39
    v_cvt_pk_bf16_f32 v52, v40, v41
    v_cvt_pk_bf16_f32 v53, v42, v43
    v_cvt_pk_bf16_f32 v54, v44, v45
    v_cvt_pk_bf16_f32 v55, v46, v47
    v_accvgpr_write_b32 a16, v48
    v_accvgpr_write_b32 a17, v49
    v_accvgpr_write_b32 a18, v50
    v_accvgpr_write_b32 a19, v51
    v_accvgpr_write_b32 a20, v52
    v_accvgpr_write_b32 a21, v53
    v_accvgpr_write_b32 a22, v54
    v_accvgpr_write_b32 a23, v55
    v_mfma_f32_32x32x16_bf16 v[32:47], a[32:35], v[192:195], 0
    v_mfma_f32_32x32x16_bf16 v[32:47], a[36:39], v[196:199], v[32:47]
    s_add_u32 s49, s49, s100
    s_lshr_b32 s34, s49, 4
    s_and_b32 s49, s49, 15
    s_cmp_ge_u32 s34, 2
    s_cselect_b64 vcc, -1, 0
    s_cmp_lg_u32 s44, 16
    s_cbranch_scc1 L_nr16
    s_mov_b32 s3, 82176
    v_mov_b32 v246, 1
    s_mov_b64 exec, 1
    buffer_atomic_add v246, off, s[24:27], s3 sc0
    s_mov_b64 exec, -1
L_nr16:
    v_add_u32 v0, 1, v0
    s_mov_b64 exec, s[32:33]
    buffer_store_dword v0, v242, s[24:27], s35 offen
    s_mov_b64 exec, -1
    buffer_load_dword v244, v242, s[24:27], s35 offen sc1
    s_xor_b32 s57, s99, 524288
    s_add_u32 m0, s56, 0
    s_cbranch_vccnz L_w2_220
    s_bitcmp1_b32 s34, 0
    s_cbranch_scc1 L_w1_220
    s_waitcnt vmcnt(5)
L_w1_220:
    s_waitcnt vmcnt(6)
L_w2_220:
    s_waitcnt vmcnt(7)
    buffer_load_dwordx4 v8, s[4:7], s57 offen offset:0 nt lds
    s_lshl_b32 s3, s52, 3
    s_or_b32 s3, s3, s54
    s_cmp_lg_u32 s3, 9
    s_cbranch_scc1 L_nb1
    s_mov_b64 exec, 1
    buffer_atomic_add v243, off, s[24:27], s78
    s_mov_b64 exec, -1
L_nb1:
    v_mfma_f32_32x32x16_bf16 v[32:47], a[40:43], v[200:203], v[32:47]
    v_mfma_f32_32x32x16_bf16 v[32:47], a[44:47], v[204:207], v[32:47]
    v_mfma_f32_32x32x16_bf16 v[32:47], a[48:51], v[208:211], v[32:47]
    v_mfma_f32_32x32x16_bf16 v[32:47], a[52:55], v[212:215], v[32:47]
    s_cbranch_vccnz L_w2_221
    s_bitcmp1_b32 s34, 0
    s_cbranch_scc1 L_w1_221
    s_waitcnt vmcnt(5)
L_w1_221:
    s_waitcnt vmcnt(6)
L_w2_221:
    s_waitcnt vmcnt(7)
    buffer_load_dwordx4 v9, s[4:7], s57 offen offset:1024 nt lds
    v_mfma_f32_32x32x16_bf16 v[32:47], a[56:59], v[216:219], v[32:47]
    v_mfma_f32_32x32x16_bf16 v[32:47], a[60:63], v[220:223], v[32:47]
    s_nop 11
    v_max3_f32 v13, v32, v33, v34
    v_max3_f32 v31, v35, v36, v37
    v_max3_f32 v13, v13, v38, v39
    v_max3_f32 v31, v31, v40, v41
    v_max3_f32 v13, v13, v42, v43
    v_max3_f32 v31, v31, v44, v45
    v_max3_f32 v13, v13, v46, v47
    v_max3_f32 v13, v13, v31, v14
    v_mov_b32 v31, v13
    s_nop 1
    v_permlane32_swap_b32 v13, v31
    s_cbranch_vccnz L_w2_222
    s_bitcmp1_b32 s34, 0
    s_cbranch_scc1 L_w1_222
    s_waitcnt vmcnt(5)
L_w1_222:
    s_waitcnt vmcnt(6)
L_w2_222:
    s_waitcnt vmcnt(7)
    buffer_load_dwordx4 v10, s[4:7], s57 offen offset:2048 nt lds
    v_max_f32 v13, v13, v31
    v_sub_f32 v31, v14, v13
    v_mul_f32 v30, s60, v13
    v_mul_f32 v31, s60, v31
    v_mov_b32 v14, v13
    v_exp_f32 v164, v31
    v_pk_fma_f32 v[32:33], v[32:33], s[60:61], v[30:31] op_sel_hi:[1,0,0] neg_lo:[0,0,1] neg_hi:[0,0,1]
    v_pk_fma_f32 v[34:35], v[34:35], s[60:61], v[30:31] op_sel_hi:[1,0,0] neg_lo:[0,0,1] neg_hi:[0,0,1]
    v_pk_fma_f32 v[36:37], v[36:37], s[60:61], v[30:31] op_sel_hi:[1,0,0] neg_lo:[0,0,1] neg_hi:[0,0,1]
    v_pk_fma_f32 v[38:39], v[38:39], s[60:61], v[30:31] op_sel_hi:[1,0,0] neg_lo:[0,0,1] neg_hi:[0,0,1]
    v_pk_fma_f32 v[40:41], v[40:41], s[60:61], v[30:31] op_sel_hi:[1,0,0] neg_lo:[0,0,1] neg_hi:[0,0,1]
    v_pk_fma_f32 v[42:43], v[42:43], s[60:61], v[30:31] op_sel_hi:[1,0,0] neg_lo:[0,0,1] neg_hi:[0,0,1]
    v_pk_fma_f32 v[44:45], v[44:45], s[60:61], v[30:31] op_sel_hi:[1,0,0] neg_lo:[0,0,1] neg_hi:[0,0,1]
    v_pk_fma_f32 v[46:47], v[46:47], s[60:61], v[30:31] op_sel_hi:[1,0,0] neg_lo:[0,0,1] neg_hi:[0,0,1]
    v_mul_f32 v15, v15, v164
    v_exp_f32 v32, v32
    v_exp_f32 v33, v33
    v_exp_f32 v34, v34
    v_exp_f32 v35, v35
    v_exp_f32 v36, v36
    s_cbranch_vccnz L_w2_223
    s_bitcmp1_b32 s34, 0
    s_cbranch_scc1 L_w1_223
    s_waitcnt vmcnt(5)
L_w1_223:
    s_waitcnt vmcnt(6)
L_w2_223:
    s_waitcnt vmcnt(7)
    buffer_load_dwordx4 v11, s[4:7], s57 offen offset:3072 nt lds
    v_exp_f32 v37, v37
    v_exp_f32 v38, v38
    v_exp_f32 v39, v39
    v_exp_f32 v40, v40
    v_exp_f32 v41, v41
    v_exp_f32 v42, v42
    v_exp_f32 v43, v43
    v_exp_f32 v44, v44
    v_exp_f32 v45, v45
    v_exp_f32 v46, v46
    v_exp_f32 v47, v47
    v_pk_add_f32 v[2:3], v[32:33], v[34:35]
    v_pk_add_f32 v[4:5], v[36:37], v[38:39]
    v_pk_add_f32 v[2:3], v[2:3], v[40:41]
    v_pk_add_f32 v[4:5], v[4:5], v[42:43]
    s_add_u32 s49, s49, s100
    s_lshr_b32 s34, s49, 4
    s_and_b32 s49, s49, 15
    s_cmp_ge_u32 s34, 2
    s_cselect_b64 vcc, -1, 0
    s_xor_b32 s57, s99, 528384
    s_add_u32 m0, s56, 4096
    s_cbranch_vccnz L_w2_224
    s_bitcmp1_b32 s34, 0
    s_cbranch_scc1 L_w1_224
    s_waitcnt vmcnt(3)
L_w1_224:
    s_waitcnt vmcnt(6)
L_w2_224:
    s_waitcnt vmcnt(7)
    buffer_load_dwordx4 v8, s[4:7], s57 offen offset:0 nt lds
    s_lshl_b32 s3, s52, 3
    s_or_b32 s3, s3, s54
    s_cmp_lg_u32 s3, 18
    s_cbranch_scc1 L_nb2
    s_mov_b64 exec, 1
    buffer_atomic_add v243, off, s[24:27], s78
    s_mov_b64 exec, -1
L_nb2:
    v_pk_add_f32 v[2:3], v[2:3], v[44:45]
    v_pk_add_f32 v[4:5], v[4:5], v[46:47]
    v_pk_add_f32 v[2:3], v[2:3], v[4:5]
    v_add_f32 v2, v2, v3
    v_add_f32 v15, v15, v2
    v_cvt_pk_bf16_f32 v48, v32, v33
    v_cvt_pk_bf16_f32 v49, v34, v35
    v_cvt_pk_bf16_f32 v50, v36, v37
    v_cvt_pk_bf16_f32 v51, v38, v39
    v_cvt_pk_bf16_f32 v52, v40, v41
    v_cvt_pk_bf16_f32 v53, v42, v43
    v_cvt_pk_bf16_f32 v54, v44, v45
    v_cvt_pk_bf16_f32 v55, v46, v47
    v_accvgpr_write_b32 a24, v48
    v_accvgpr_write_b32 a25, v49
    v_accvgpr_write_b32 a26, v50
    v_accvgpr_write_b32 a27, v51
    v_accvgpr_write_b32 a28, v52
    v_accvgpr_write_b32 a29, v53
    v_accvgpr_write_b32 a30, v54
    v_accvgpr_write_b32 a31, v55
    v_mfma_f32_32x32x16_bf16 v[32:47], v[128:131], v[192:195], 0
    s_cbranch_vccnz L_w2_225
    s_bitcmp1_b32 s34, 0
    s_cbranch_scc1 L_w1_225
    s_waitcnt vmcnt(3)
L_w1_225:
    s_waitcnt vmcnt(4)
L_w2_225:
    s_waitcnt vmcnt(7)
    buffer_load_dwordx4 v9, s[4:7], s57 offen offset:1024 nt lds
    v_mfma_f32_32x32x16_bf16 v[32:47], v[132:135], v[196:199], v[32:47]
    v_mfma_f32_32x32x16_bf16 v[32:47], v[136:139], v[200:203], v[32:47]
    v_mfma_f32_32x32x16_bf16 v[32:47], v[140:143], v[204:207], v[32:47]
    v_mfma_f32_32x32x16_bf16 v[32:47], v[144:147], v[208:211], v[32:47]
    s_cbranch_vccnz L_w2_226
    s_bitcmp1_b32 s34, 0
    s_cbranch_scc1 L_w1_226
    s_waitcnt vmcnt(3)
L_w1_226:
    s_waitcnt vmcnt(4)
L_w2_226:
    s_waitcnt vmcnt(5)
    buffer_load_dwordx4 v10, s[4:7], s57 offen offset:2048 nt lds
    v_mfma_f32_32x32x16_bf16 v[32:47], v[148:151], v[212:215], v[32:47]
    v_mfma_f32_32x32x16_bf16 v[32:47], v[152:155], v[216:219], v[32:47]
    v_mfma_f32_32x32x16_bf16 v[32:47], v[156:159], v[220:223], v[32:47]
    ds_read_b128 v[128:131], v16 offset:16384
    ds_read_b128 v[132:135], v17 offset:16384
    ds_read_b128 v[136:139], v18 offset:16384
    ds_read_b128 v[140:143], v19 offset:16384
    ds_read_b128 v[144:147], v20 offset:16384
    ds_read_b128 v[148:151], v21 offset:16384
    ds_read_b128 v[152:155], v22 offset:16384
    ds_read_b128 v[156:159], v23 offset:16384
    s_nop 3
    v_max3_f32 v13, v32, v33, v34
    v_max3_f32 v31, v35, v36, v37
    s_cbranch_vccnz L_w2_227
    s_bitcmp1_b32 s34, 0
    s_cbranch_scc1 L_w1_227
    s_waitcnt vmcnt(3)
L_w1_227:
    s_waitcnt vmcnt(4)
L_w2_227:
    s_waitcnt vmcnt(5)
    buffer_load_dwordx4 v11, s[4:7], s57 offen offset:3072 nt lds
    v_max3_f32 v13, v13, v38, v39
    v_max3_f32 v31, v31, v40, v41
    v_max3_f32 v13, v13, v42, v43
    v_max3_f32 v31, v31, v44, v45
    v_max3_f32 v13, v13, v46, v47
    v_max3_f32 v13, v13, v31, v14
    v_mov_b32 v31, v13
    s_nop 1
    v_permlane32_swap_b32 v13, v31
    v_max_f32 v13, v13, v31
    v_sub_f32 v31, v14, v13
    v_mul_f32 v30, s60, v13
    v_mul_f32 v31, s60, v31
    v_mov_b32 v14, v13
    v_exp_f32 v165, v31
    s_waitcnt lgkmcnt(0)
    v_pk_fma_f32 v[32:33], v[32:33], s[60:61], v[30:31] op_sel_hi:[1,0,0] neg_lo:[0,0,1] neg_hi:[0,0,1]
    v_pk_fma_f32 v[34:35], v[34:35], s[60:61], v[30:31] op_sel_hi:[1,0,0] neg_lo:[0,0,1] neg_hi:[0,0,1]
    v_pk_fma_f32 v[36:37], v[36:37], s[60:61], v[30:31] op_sel_hi:[1,0,0] neg_lo:[0,0,1] neg_hi:[0,0,1]
    v_pk_fma_f32 v[38:39], v[38:39], s[60:61], v[30:31] op_sel_hi:[1,0,0] neg_lo:[0,0,1] neg_hi:[0,0,1]
    v_pk_fma_f32 v[40:41], v[40:41], s[60:61], v[30:31] op_sel_hi:[1,0,0] neg_lo:[0,0,1] neg_hi:[0,0,1]
    v_pk_fma_f32 v[42:43], v[42:43], s[60:61], v[30:31] op_sel_hi:[1,0,0] neg_lo:[0,0,1] neg_hi:[0,0,1]
    v_pk_fma_f32 v[44:45], v[44:45], s[60:61], v[30:31] op_sel_hi:[1,0,0] neg_lo:[0,0,1] neg_hi:[0,0,1]
    v_pk_fma_f32 v[46:47], v[46:47], s[60:61], v[30:31] op_sel_hi:[1,0,0] neg_lo:[0,0,1] neg_hi:[0,0,1]
    v_mul_f32 v15, v15, v165
    v_exp_f32 v32, v32
    s_cmp_lg_u32 s44, 16
    s_cbranch_scc1 L_nc16
    v_sub_u32 v247, v246, v245
    v_lshlrev_b32 v246, 8, v254
    v_readfirstlane_b32 s3, v247
    s_nop 0
    s_min_u32 s3, s3, 7
    s_mul_i32 s3, s3, 6
    s_add_u32 s3, s3, s45
    v_mov_b32 v247, s3
    s_and_b32 s3, s35, 0xfffffcff
    s_mov_b64 exec, 15
    buffer_store_dword v247, v246, s[24:27], s3 offen offset:128
    s_mov_b64 exec, -1
L_nc16:
    v_sub_u32 v244, v244, v0
    v_cmp_gt_u32 s[100:101], 64, v244
    v_readlane_b32 s46, v244, 32
    s_bcnt1_i32_b32 s3, s100
    s_mul_i32 s3, s3, 3
    s_add_u32 s46, s46, 2
    s_cmp_lt_u32 s46, 128
    s_cselect_b32 s46, s46, 21
    s_add_u32 s3, s3, s46
    s_ashr_i32 s3, s3, 2
    s_add_i32 s3, s3, 2
    s_max_i32 s3, s3, 8
    s_min_i32 s100, s3, 32
    s_add_u32 s49, s49, s100
    s_lshr_b32 s34, s49, 4
    s_and_b32 s49, s49, 15
    s_cmp_ge_u32 s34, 2
    s_cselect_b64 vcc, -1, 0
    s_xor_b32 s57, s99, 540672
    s_add_u32 m0, s56, 8192
    s_cbranch_vccnz L_w2_228
    s_bitcmp1_b32 s34, 0
    s_cbranch_scc1 L_w1_228
    s_waitcnt vmcnt(3)
L_w1_228:
    s_waitcnt vmcnt(4)
L_w2_228:
    s_waitcnt vmcnt(5)
    buffer_load_dwordx4 v8, s[4:7], s57 offen offset:0 nt lds
    s_lshl_b32 s3, s52, 3
    s_or_b32 s3, s3, s54
    s_cmp_lg_u32 s3, 27
    s_cbranch_scc1 L_nb3
    s_mov_b64 exec, 1
    buffer_atomic_add v243, off, s[24:27], s78
    s_mov_b64 exec, -1
L_nb3:
    v_exp_f32 v33, v33
    v_exp_f32 v34, v34
    v_exp_f32 v35, v35
    v_exp_f32 v36, v36
    v_exp_f32 v37, v37
    v_exp_f32 v38, v38
    v_exp_f32 v39, v39
    v_exp_f32 v40, v40
    v_exp_f32 v41, v41
    v_exp_f32 v42, v42
    v_exp_f32 v43, v43
    v_exp_f32 v44, v44
    v_exp_f32 v45, v45
    s_cbranch_vccnz L_w2_229
    s_bitcmp1_b32 s34, 0
    s_cbranch_scc1 L_w1_229
    s_waitcnt vmcnt(3)
L_w1_229:
    s_waitcnt vmcnt(4)
L_w2_229:
    s_waitcnt vmcnt(5)
    buffer_load_dwordx4 v9, s[4:7], s57 offen offset:1024 nt lds
    v_exp_f32 v46, v46
    v_exp_f32 v47, v47
    v_pk_add_f32 v[2:3], v[32:33], v[34:35]
    v_pk_add_f32 v[4:5], v[36:37], v[38:39]
    v_pk_add_f32 v[2:3], v[2:3], v[40:41]
    v_pk_add_f32 v[4:5], v[4:5], v[42:43]
    v_pk_add_f32 v[2:3], v[2:3], v[44:45]
    v_pk_add_f32 v[4:5], v[4:5], v[46:47]
    v_pk_add_f32 v[2:3], v[2:3], v[4:5]
    v_add_f32 v2, v2, v3
    v_add_f32 v15, v15, v2
    v_cvt_pk_bf16_f32 v48, v32, v33
    v_cvt_pk_bf16_f32 v49, v34, v35
    v_cvt_pk_bf16_f32 v50, v36, v37
    v_cvt_pk_bf16_f32 v51, v38, v39
    v_cvt_pk_bf16_f32 v52, v40, v41
    v_cvt_pk_bf16_f32 v53, v42, v43
    v_cvt_pk_bf16_f32 v54, v44, v45
    v_cvt_pk_bf16_f32 v55, v46, v47
    v_accvgpr_write_b32 a32, v48
    v_accvgpr_write_b32 a33, v49
    v_accvgpr_write_b32 a34, v50
    v_accvgpr_write_b32 a35, v51
    v_accvgpr_write_b32 a36, v52
    s_cbranch_vccnz L_w2_230
    s_bitcmp1_b32 s34, 0
    s_cbranch_scc1 L_w1_230
    s_waitcnt vmcnt(3)
L_w1_230:
    s_waitcnt vmcnt(4)
L_w2_230:
    s_waitcnt vmcnt(5)
    buffer_load_dwordx4 v10, s[4:7], s57 offen offset:2048 nt lds
    v_accvgpr_write_b32 a37, v53
    v_accvgpr_write_b32 a38, v54
    v_accvgpr_write_b32 a39, v55
    v_mfma_f32_32x32x16_bf16 v[32:47], v[128:131], v[192:195], 0
    v_mfma_f32_32x32x16_bf16 v[32:47], v[132:135], v[196:199], v[32:47]
    v_mfma_f32_32x32x16_bf16 v[32:47], v[136:139], v[200:203], v[32:47]
    s_cbranch_vccnz L_w2_231
    s_bitcmp1_b32 s34, 0
    s_cbranch_scc1 L_w1_231
    s_waitcnt vmcnt(3)
L_w1_231:
    s_waitcnt vmcnt(4)
L_w2_231:
    s_waitcnt vmcnt(5)
    buffer_load_dwordx4 v11, s[4:7], s57 offen offset:3072 nt lds
    v_mfma_f32_32x32x16_bf16 v[32:47], v[140:143], v[204:207], v[32:47]
    v_mfma_f32_32x32x16_bf16 v[32:47], v[144:147], v[208:211], v[32:47]
    v_mfma_f32_32x32x16_bf16 v[32:47], v[148:151], v[212:215], v[32:47]
    v_mfma_f32_32x32x16_bf16 v[32:47], v[152:155], v[216:219], v[32:47]
    s_add_u32 s49, s49, s100
    s_lshr_b32 s34, s49, 4
    s_and_b32 s49, s49, 15
    s_cmp_ge_u32 s34, 2
    s_cselect_b64 vcc, -1, 0
    s_xor_b32 s57, s99, 544768
    s_add_u32 m0, s56, 12288
    s_cbranch_vccnz L_w2_232
    s_bitcmp1_b32 s34, 0
    s_cbranch_scc1 L_w1_232
    s_waitcnt vmcnt(3)
L_w1_232:
    s_waitcnt vmcnt(4)
L_w2_232:
    s_waitcnt vmcnt(5)
    buffer_load_dwordx4 v8, s[4:7], s57 offen offset:0 nt lds
    s_lshl_b32 s3, s52, 3
    s_or_b32 s3, s3, s54
    s_cmp_lg_u32 s3, 4
    s_cbranch_scc1 L_nb4
    s_mov_b64 exec, 1
    buffer_atomic_add v243, off, s[24:27], s78
    s_mov_b64 exec, -1
L_nb4:
    v_mfma_f32_32x32x16_bf16 v[32:47], v[156:159], v[220:223], v[32:47]
    ds_read_b128 v[128:131], v16 offset:24576
    ds_read_b128 v[132:135], v17 offset:24576
    ds_read_b128 v[136:139], v18 offset:24576
    ds_read_b128 v[140:143], v19 offset:24576
    ds_read_b128 v[144:147], v20 offset:24576
    ds_read_b128 v[148:151], v21 offset:24576
    ds_read_b128 v[152:155], v22 offset:24576
    ds_read_b128 v[156:159], v23 offset:24576
    s_nop 3
    v_max3_f32 v13, v32, v33, v34
    v_max3_f32 v31, v35, v36, v37
    v_max3_f32 v13, v13, v38, v39
    v_max3_f32 v31, v31, v40, v41
    v_max3_f32 v13, v13, v42, v43
    v_max3_f32 v31, v31, v44, v45
    v_max3_f32 v13, v13, v46, v47
    v_max3_f32 v13, v13, v31, v14
    v_mov_b32 v31, v13
    s_nop 1
    v_permlane32_swap_b32 v13, v31
    v_max_f32 v13, v13, v31
    v_sub_f32 v31, v14, v13
    v_mul_f32 v30, s60, v13
    v_mul_f32 v31, s60, v31
    v_mov_b32 v14, v13
    v_exp_f32 v166, v31
    s_waitcnt lgkmcnt(0)
    v_pk_fma_f32 v[32:33], v[32:33], s[60:61], v[30:31] op_sel_hi:[1,0,0] neg_lo:[0,0,1] neg_hi:[0,0,1]
    s_cbranch_vccnz L_w2_233
    s_bitcmp1_b32 s34, 0
    s_cbranch_scc1 L_w1_233
    s_waitcnt vmcnt(3)
L_w1_233:
    s_waitcnt vmcnt(4)
L_w2_233:
    s_waitcnt vmcnt(5)
    buffer_load_dwordx4 v9, s[4:7], s57 offen offset:1024 nt lds
    v_pk_fma_f32 v[34:35], v[34:35], s[60:61], v[30:31] op_sel_hi:[1,0,0] neg_lo:[0,0,1] neg_hi:[0,0,1]
    v_pk_fma_f32 v[36:37], v[36:37], s[60:61], v[30:31] op_sel_hi:[1,0,0] neg_lo:[0,0,1] neg_hi:[0,0,1]
    v_pk_fma_f32 v[38:39], v[38:39], s[60:61], v[30:31] op_sel_hi:[1,0,0] neg_lo:[0,0,1] neg_hi:[0,0,1]
    v_pk_fma_f32 v[40:41], v[40:41], s[60:61], v[30:31] op_sel_hi:[1,0,0] neg_lo:[0,0,1] neg_hi:[0,0,1]
    v_pk_fma_f32 v[42:43], v[42:43], s[60:61], v[30:31] op_sel_hi:[1,0,0] neg_lo:[0,0,1] neg_hi:[0,0,1]
    v_pk_fma_f32 v[44:45], v[44:45], s[60:61], v[30:31] op_sel_hi:[1,0,0] neg_lo:[0,0,1] neg_hi:[0,0,1]
    v_pk_fma_f32 v[46:47], v[46:47], s[60:61], v[30:31] op_sel_hi:[1,0,0] neg_lo:[0,0,1] neg_hi:[0,0,1]
    v_mul_f32 v15, v15, v166
    v_exp_f32 v32, v32
    v_exp_f32 v33, v33
    v_exp_f32 v34, v34
    v_exp_f32 v35, v35
    v_exp_f32 v36, v36
    v_exp_f32 v37, v37
    v_exp_f32 v38, v38
    v_exp_f32 v39, v39
    v_exp_f32 v40, v40
    s_cbranch_vccnz L_w2_234
    s_bitcmp1_b32 s34, 0
    s_cbranch_scc1 L_w1_234
    s_waitcnt vmcnt(3)
L_w1_234:
    s_waitcnt vmcnt(4)
L_w2_234:
    s_waitcnt vmcnt(5)
    buffer_load_dwordx4 v10, s[4:7], s57 offen offset:2048 nt lds
    v_exp_f32 v41, v41
    v_exp_f32 v42, v42
    v_exp_f32 v43, v43
    v_exp_f32 v44, v44
    v_exp_f32 v45, v45
    v_exp_f32 v46, v46
    v_exp_f32 v47, v47
    v_pk_add_f32 v[2:3], v[32:33], v[34:35]
    v_pk_add_f32 v[4:5], v[36:37], v[38:39]
    v_pk_add_f32 v[2:3], v[2:3], v[40:41]
    v_pk_add_f32 v[4:5], v[4:5], v[42:43]
    v_pk_add_f32 v[2:3], v[2:3], v[44:45]
    v_pk_add_f32 v[4:5], v[4:5], v[46:47]
    v_pk_add_f32 v[2:3], v[2:3], v[4:5]
    v_add_f32 v2, v2, v3
    v_add_f32 v15, v15, v2
    v_cvt_pk_bf16_f32 v48, v32, v33
    v_cvt_pk_bf16_f32 v49, v34, v35
    v_cvt_pk_bf16_f32 v50, v36, v37
    s_cbranch_vccnz L_w2_235
    s_bitcmp1_b32 s34, 0
    s_cbranch_scc1 L_w1_235
    s_waitcnt vmcnt(3)
L_w1_235:
    s_waitcnt vmcnt(4)
L_w2_235:
    s_waitcnt vmcnt(5)
    buffer_load_dwordx4 v11, s[4:7], s57 offen offset:3072 nt lds
    v_cvt_pk_bf16_f32 v51, v38, v39
    v_cvt_pk_bf16_f32 v52, v40, v41
    v_cvt_pk_bf16_f32 v53, v42, v43
    v_cvt_pk_bf16_f32 v54, v44, v45
    v_cvt_pk_bf16_f32 v55, v46, v47
    v_accvgpr_write_b32 a40, v48
    v_accvgpr_write_b32 a41, v49
    v_accvgpr_write_b32 a42, v50
    v_accvgpr_write_b32 a43, v51
    v_accvgpr_write_b32 a44, v52
    v_accvgpr_write_b32 a45, v53
    v_accvgpr_write_b32 a46, v54
    v_accvgpr_write_b32 a47, v55
    v_mfma_f32_32x32x16_bf16 v[32:47], a[64:67], v[192:195], 0
    v_mfma_f32_32x32x16_bf16 v[32:47], a[68:71], v[196:199], v[32:47]
    s_add_u32 s49, s49, s100
    s_lshr_b32 s34, s49, 4
    s_and_b32 s49, s49, 15
    s_cmp_ge_u32 s34, 2
    s_cselect_b64 vcc, -1, 0
    s_cmp_lg_u32 s44, 18
    s_cbranch_scc1 L_nr18
    s_mov_b32 s3, 82432
    v_mov_b32 v246, 1
    s_mov_b64 exec, 1
    buffer_atomic_add v246, off, s[24:27], s3 sc0
    s_mov_b64 exec, -1
L_nr18:
    v_add_u32 v0, 1, v0
    s_mov_b64 exec, s[32:33]
    buffer_store_dword v0, v242, s[24:27], s35 offen
    s_mov_b64 exec, -1
    buffer_load_dword v244, v242, s[24:27], s35 offen sc1
    s_xor_b32 s57, s99, 589824
    s_add_u32 m0, s56, 16384
    s_cbranch_vccnz L_w2_238
    s_bitcmp1_b32 s34, 0
    s_cbranch_scc1 L_w1_238
    s_waitcnt vmcnt(5)
L_w1_238:
    s_waitcnt vmcnt(6)
L_w2_238:
    s_waitcnt vmcnt(7)
    buffer_load_dwordx4 v8, s[4:7], s57 offen offset:0 nt lds
    s_lshl_b32 s3, s52, 3
    s_or_b32 s3, s3, s54
    s_cmp_lg_u32 s3, 13
    s_cbranch_scc1 L_nb5
    s_mov_b64 exec, 1
    buffer_atomic_add v243, off, s[24:27], s78
    s_mov_b64 exec, -1
L_nb5:
    v_mfma_f32_32x32x16_bf16 v[32:47], a[72:75], v[200:203], v[32:47]
    v_mfma_f32_32x32x16_bf16 v[32:47], a[76:79], v[204:207], v[32:47]
    v_mfma_f32_32x32x16_bf16 v[32:47], a[80:83], v[208:211], v[32:47]
    v_mfma_f32_32x32x16_bf16 v[32:47], a[84:87], v[212:215], v[32:47]
    s_cbranch_vccnz L_w2_239
    s_bitcmp1_b32 s34, 0
    s_cbranch_scc1 L_w1_239
    s_waitcnt vmcnt(5)
L_w1_239:
    s_waitcnt vmcnt(6)
L_w2_239:
    s_waitcnt vmcnt(7)
    buffer_load_dwordx4 v9, s[4:7], s57 offen offset:1024 nt lds
    v_mfma_f32_32x32x16_bf16 v[32:47], a[88:91], v[216:219], v[32:47]
    v_mfma_f32_32x32x16_bf16 v[32:47], a[92:95], v[220:223], v[32:47]
    s_nop 11
    v_max3_f32 v13, v32, v33, v34
    v_max3_f32 v31, v35, v36, v37
    v_max3_f32 v13, v13, v38, v39
    v_max3_f32 v31, v31, v40, v41
    v_max3_f32 v13, v13, v42, v43
    v_max3_f32 v31, v31, v44, v45
    v_max3_f32 v13, v13, v46, v47
    v_max3_f32 v13, v13, v31, v14
    v_mov_b32 v31, v13
    s_nop 1
    v_permlane32_swap_b32 v13, v31
    s_cbranch_vccnz L_w2_240
    s_bitcmp1_b32 s34, 0
    s_cbranch_scc1 L_w1_240
    s_waitcnt vmcnt(5)
L_w1_240:
    s_waitcnt vmcnt(6)
L_w2_240:
    s_waitcnt vmcnt(7)
    buffer_load_dwordx4 v10, s[4:7], s57 offen offset:2048 nt lds
    v_max_f32 v13, v13, v31
    v_sub_f32 v31, v14, v13
    v_mul_f32 v30, s60, v13
    v_mul_f32 v31, s60, v31
    v_mov_b32 v14, v13
    v_exp_f32 v167, v31
    v_pk_fma_f32 v[32:33], v[32:33], s[60:61], v[30:31] op_sel_hi:[1,0,0] neg_lo:[0,0,1] neg_hi:[0,0,1]
    v_pk_fma_f32 v[34:35], v[34:35], s[60:61], v[30:31] op_sel_hi:[1,0,0] neg_lo:[0,0,1] neg_hi:[0,0,1]
    v_pk_fma_f32 v[36:37], v[36:37], s[60:61], v[30:31] op_sel_hi:[1,0,0] neg_lo:[0,0,1] neg_hi:[0,0,1]
    v_pk_fma_f32 v[38:39], v[38:39], s[60:61], v[30:31] op_sel_hi:[1,0,0] neg_lo:[0,0,1] neg_hi:[0,0,1]
    v_pk_fma_f32 v[40:41], v[40:41], s[60:61], v[30:31] op_sel_hi:[1,0,0] neg_lo:[0,0,1] neg_hi:[0,0,1]
    v_pk_fma_f32 v[42:43], v[42:43], s[60:61], v[30:31] op_sel_hi:[1,0,0] neg_lo:[0,0,1] neg_hi:[0,0,1]
    v_pk_fma_f32 v[44:45], v[44:45], s[60:61], v[30:31] op_sel_hi:[1,0,0] neg_lo:[0,0,1] neg_hi:[0,0,1]
    v_pk_fma_f32 v[46:47], v[46:47], s[60:61], v[30:31] op_sel_hi:[1,0,0] neg_lo:[0,0,1] neg_hi:[0,0,1]
    v_mul_f32 v15, v15, v167
    v_exp_f32 v32, v32
    v_exp_f32 v33, v33
    v_exp_f32 v34, v34
    v_exp_f32 v35, v35
    v_exp_f32 v36, v36
    s_cbranch_vccnz L_w2_241
    s_bitcmp1_b32 s34, 0
    s_cbranch_scc1 L_w1_241
    s_waitcnt vmcnt(5)
L_w1_241:
    s_waitcnt vmcnt(6)
L_w2_241:
    s_waitcnt vmcnt(7)
    buffer_load_dwordx4 v11, s[4:7], s57 offen offset:3072 nt lds
    v_exp_f32 v37, v37
    v_exp_f32 v38, v38
    v_exp_f32 v39, v39
    v_exp_f32 v40, v40
    v_exp_f32 v41, v41
    v_exp_f32 v42, v42
    v_exp_f32 v43, v43
    v_exp_f32 v44, v44
    v_exp_f32 v45, v45
    v_exp_f32 v46, v46
    v_exp_f32 v47, v47
    v_pk_add_f32 v[2:3], v[32:33], v[34:35]
    v_pk_add_f32 v[4:5], v[36:37], v[38:39]
    v_pk_add_f32 v[2:3], v[2:3], v[40:41]
    v_pk_add_f32 v[4:5], v[4:5], v[42:43]
    s_add_u32 s49, s49, s100
    s_lshr_b32 s34, s49, 4
    s_and_b32 s49, s49, 15
    s_cmp_ge_u32 s34, 2
    s_cselect_b64 vcc, -1, 0
    s_xor_b32 s57, s99, 593920
    s_add_u32 m0, s56, 20480
    s_cbranch_vccnz L_w2_242
    s_bitcmp1_b32 s34, 0
    s_cbranch_scc1 L_w1_242
    s_waitcnt vmcnt(3)
L_w1_242:
    s_waitcnt vmcnt(6)
L_w2_242:
    s_waitcnt vmcnt(7)
    buffer_load_dwordx4 v8, s[4:7], s57 offen offset:0 nt lds
    s_lshl_b32 s3, s52, 3
    s_or_b32 s3, s3, s54
    s_cmp_lg_u32 s3, 22
    s_cbranch_scc1 L_nb6
    s_mov_b64 exec, 1
    buffer_atomic_add v243, off, s[24:27], s78
    s_mov_b64 exec, -1
L_nb6:
    v_pk_add_f32 v[2:3], v[2:3], v[44:45]
    v_pk_add_f32 v[4:5], v[4:5], v[46:47]
    v_pk_add_f32 v[2:3], v[2:3], v[4:5]
    v_add_f32 v2, v2, v3
    v_add_f32 v15, v15, v2
    v_cvt_pk_bf16_f32 v48, v32, v33
    v_cvt_pk_bf16_f32 v49, v34, v35
    v_cvt_pk_bf16_f32 v50, v36, v37
    v_cvt_pk_bf16_f32 v51, v38, v39
    v_cvt_pk_bf16_f32 v52, v40, v41
    v_cvt_pk_bf16_f32 v53, v42, v43
    v_cvt_pk_bf16_f32 v54, v44, v45
    v_cvt_pk_bf16_f32 v55, v46, v47
    v_accvgpr_write_b32 a48, v48
    v_accvgpr_write_b32 a49, v49
    v_accvgpr_write_b32 a50, v50
    v_accvgpr_write_b32 a51, v51
    v_accvgpr_write_b32 a52, v52
    v_accvgpr_write_b32 a53, v53
    v_accvgpr_write_b32 a54, v54
    v_accvgpr_write_b32 a55, v55
    v_mfma_f32_32x32x16_bf16 v[32:47], v[128:131], v[192:195], 0
    s_cbranch_vccnz L_w2_243
    s_bitcmp1_b32 s34, 0
    s_cbranch_scc1 L_w1_243
    s_waitcnt vmcnt(3)
L_w1_243:
    s_waitcnt vmcnt(4)
L_w2_243:
    s_waitcnt vmcnt(7)
    buffer_load_dwordx4 v9, s[4:7], s57 offen offset:1024 nt lds
    v_mfma_f32_32x32x16_bf16 v[32:47], v[132:135], v[196:199], v[32:47]
    v_mfma_f32_32x32x16_bf16 v[32:47], v[136:139], v[200:203], v[32:47]
    v_mfma_f32_32x32x16_bf16 v[32:47], v[140:143], v[204:207], v[32:47]
    v_mfma_f32_32x32x16_bf16 v[32:47], v[144:147], v[208:211], v[32:47]
    s_cbranch_vccnz L_w2_244
    s_bitcmp1_b32 s34, 0
    s_cbranch_scc1 L_w1_244
    s_waitcnt vmcnt(3)
L_w1_244:
    s_waitcnt vmcnt(4)
L_w2_244:
    s_waitcnt vmcnt(5)
    buffer_load_dwordx4 v10, s[4:7], s57 offen offset:2048 nt lds
    v_mfma_f32_32x32x16_bf16 v[32:47], v[148:151], v[212:215], v[32:47]
    v_mfma_f32_32x32x16_bf16 v[32:47], v[152:155], v[216:219], v[32:47]
    v_mfma_f32_32x32x16_bf16 v[32:47], v[156:159], v[220:223], v[32:47]
    ds_read_b128 v[128:131], v16 offset:0
    ds_read_b128 v[132:135], v17 offset:0
    ds_read_b128 v[136:139], v18 offset:0
    ds_read_b128 v[140:143], v19 offset:0
    ds_read_b128 v[144:147], v20 offset:0
    ds_read_b128 v[148:151], v21 offset:0
    ds_read_b128 v[152:155], v22 offset:0
    ds_read_b128 v[156:159], v23 offset:0
    s_nop 3
    v_max3_f32 v13, v32, v33, v34
    v_max3_f32 v31, v35, v36, v37
    s_cbranch_vccnz L_w2_245
    s_bitcmp1_b32 s34, 0
    s_cbranch_scc1 L_w1_245
    s_waitcnt vmcnt(3)
L_w1_245:
    s_waitcnt vmcnt(4)
L_w2_245:
    s_waitcnt vmcnt(5)
    buffer_load_dwordx4 v11, s[4:7], s57 offen offset:3072 nt lds
    v_max3_f32 v13, v13, v38, v39
    v_max3_f32 v31, v31, v40, v41
    v_max3_f32 v13, v13, v42, v43
    v_max3_f32 v31, v31, v44, v45
    v_max3_f32 v13, v13, v46, v47
    v_max3_f32 v13, v13, v31, v14
    v_mov_b32 v31, v13
    s_nop 1
    v_permlane32_swap_b32 v13, v31
    v_max_f32 v13, v13, v31
    v_sub_f32 v31, v14, v13
    v_mul_f32 v30, s60, v13
    v_mul_f32 v31, s60, v31
    v_mov_b32 v14, v13
    v_exp_f32 v168, v31
    s_waitcnt lgkmcnt(0)
    v_pk_fma_f32 v[32:33], v[32:33], s[60:61], v[30:31] op_sel_hi:[1,0,0] neg_lo:[0,0,1] neg_hi:[0,0,1]
    v_pk_fma_f32 v[34:35], v[34:35], s[60:61], v[30:31] op_sel_hi:[1,0,0] neg_lo:[0,0,1] neg_hi:[0,0,1]
    v_pk_fma_f32 v[36:37], v[36:37], s[60:61], v[30:31] op_sel_hi:[1,0,0] neg_lo:[0,0,1] neg_hi:[0,0,1]
    v_pk_fma_f32 v[38:39], v[38:39], s[60:61], v[30:31] op_sel_hi:[1,0,0] neg_lo:[0,0,1] neg_hi:[0,0,1]
    v_pk_fma_f32 v[40:41], v[40:41], s[60:61], v[30:31] op_sel_hi:[1,0,0] neg_lo:[0,0,1] neg_hi:[0,0,1]
    v_pk_fma_f32 v[42:43], v[42:43], s[60:61], v[30:31] op_sel_hi:[1,0,0] neg_lo:[0,0,1] neg_hi:[0,0,1]
    v_pk_fma_f32 v[44:45], v[44:45], s[60:61], v[30:31] op_sel_hi:[1,0,0] neg_lo:[0,0,1] neg_hi:[0,0,1]
    v_pk_fma_f32 v[46:47], v[46:47], s[60:61], v[30:31] op_sel_hi:[1,0,0] neg_lo:[0,0,1] neg_hi:[0,0,1]
    v_mul_f32 v15, v15, v168
    v_exp_f32 v32, v32
    s_cmp_lg_u32 s44, 18
    s_cbranch_scc1 L_nc18
    v_sub_u32 v247, v246, v245
    v_lshlrev_b32 v246, 8, v254
    v_readfirstlane_b32 s3, v247
    s_nop 0
    s_min_u32 s3, s3, 7
    s_mul_i32 s3, s3, 6
    s_add_u32 s3, s3, s45
    v_mov_b32 v247, s3
    s_and_b32 s3, s35, 0xfffffcff
    s_mov_b64 exec, 15
    buffer_store_dword v247, v246, s[24:27], s3 offen offset:128
    s_mov_b64 exec, -1
L_nc18:
    v_sub_u32 v244, v244, v0
    v_cmp_gt_u32 s[100:101], 64, v244
    v_readlane_b32 s46, v244, 32
    s_bcnt1_i32_b32 s3, s100
    s_mul_i32 s3, s3, 3
    s_add_u32 s46, s46, 3
    s_cmp_lt_u32 s46, 128
    s_cselect_b32 s46, s46, 21
    s_add_u32 s3, s3, s46
    s_ashr_i32 s3, s3, 2
    s_add_i32 s3, s3, 2
    s_max_i32 s3, s3, 8
    s_min_i32 s100, s3, 32
    s_add_u32 s49, s49, s100
    s_lshr_b32 s34, s49, 4
    s_and_b32 s49, s49, 15
    s_cmp_ge_u32 s34, 2
    s_cselect_b64 vcc, -1, 0
    s_xor_b32 s57, s99, 606208
    s_add_u32 m0, s56, 24576
    s_cbranch_vccnz L_w2_246
    s_bitcmp1_b32 s34, 0
    s_cbranch_scc1 L_w1_246
    s_waitcnt vmcnt(3)
L_w1_246:
    s_waitcnt vmcnt(4)
L_w2_246:
    s_waitcnt vmcnt(5)
    buffer_load_dwordx4 v8, s[4:7], s57 offen offset:0 nt lds
    s_lshl_b32 s3, s52, 3
    s_or_b32 s3, s3, s54
    s_cmp_lg_u32 s3, 31
    s_cbranch_scc1 L_nb7
    s_mov_b64 exec, 1
    buffer_atomic_add v243, off, s[24:27], s78
    s_mov_b64 exec, -1
L_nb7:
    v_exp_f32 v33, v33
    v_exp_f32 v34, v34
    v_exp_f32 v35, v35
    v_exp_f32 v36, v36
    v_exp_f32 v37, v37
    v_exp_f32 v38, v38
    v_exp_f32 v39, v39
    v_exp_f32 v40, v40
    v_exp_f32 v41, v41
    v_exp_f32 v42, v42
    v_exp_f32 v43, v43
    v_exp_f32 v44, v44
    v_exp_f32 v45, v45
    s_cbranch_vccnz L_w2_247
    s_bitcmp1_b32 s34, 0
    s_cbranch_scc1 L_w1_247
    s_waitcnt vmcnt(3)
L_w1_247:
    s_waitcnt vmcnt(4)
L_w2_247:
    s_waitcnt vmcnt(5)
    buffer_load_dwordx4 v9, s[4:7], s57 offen offset:1024 nt lds
    v_exp_f32 v46, v46
    v_exp_f32 v47, v47
    v_pk_add_f32 v[2:3], v[32:33], v[34:35]
    v_pk_add_f32 v[4:5], v[36:37], v[38:39]
    v_pk_add_f32 v[2:3], v[2:3], v[40:41]
    v_pk_add_f32 v[4:5], v[4:5], v[42:43]
    v_pk_add_f32 v[2:3], v[2:3], v[44:45]
    v_pk_add_f32 v[4:5], v[4:5], v[46:47]
    v_pk_add_f32 v[2:3], v[2:3], v[4:5]
    v_add_f32 v2, v2, v3
    v_add_f32 v15, v15, v2
    v_cvt_pk_bf16_f32 v48, v32, v33
    v_cvt_pk_bf16_f32 v49, v34, v35
    v_cvt_pk_bf16_f32 v50, v36, v37
    v_cvt_pk_bf16_f32 v51, v38, v39
    v_cvt_pk_bf16_f32 v52, v40, v41
    v_cvt_pk_bf16_f32 v53, v42, v43
    v_cvt_pk_bf16_f32 v54, v44, v45
    v_cvt_pk_bf16_f32 v55, v46, v47
    v_accvgpr_write_b32 a56, v48
    v_accvgpr_write_b32 a57, v49
    v_accvgpr_write_b32 a58, v50
    v_accvgpr_write_b32 a59, v51
    v_accvgpr_write_b32 a60, v52
    s_cbranch_vccnz L_w2_248
    s_bitcmp1_b32 s34, 0
    s_cbranch_scc1 L_w1_248
    s_waitcnt vmcnt(3)
L_w1_248:
    s_waitcnt vmcnt(4)
L_w2_248:
    s_waitcnt vmcnt(5)
    buffer_load_dwordx4 v10, s[4:7], s57 offen offset:2048 nt lds
    v_accvgpr_write_b32 a61, v53
    v_accvgpr_write_b32 a62, v54
    v_accvgpr_write_b32 a63, v55
    v_mfma_f32_32x32x16_bf16 v[32:47], v[128:131], v[192:195], 0
    v_mfma_f32_32x32x16_bf16 v[32:47], v[132:135], v[196:199], v[32:47]
    v_mfma_f32_32x32x16_bf16 v[32:47], v[136:139], v[200:203], v[32:47]
    s_cbranch_vccnz L_w2_249
    s_bitcmp1_b32 s34, 0
    s_cbranch_scc1 L_w1_249
    s_waitcnt vmcnt(3)
L_w1_249:
    s_waitcnt vmcnt(4)
L_w2_249:
    s_waitcnt vmcnt(5)
    buffer_load_dwordx4 v11, s[4:7], s57 offen offset:3072 nt lds
    v_mfma_f32_32x32x16_bf16 v[32:47], v[140:143], v[204:207], v[32:47]
    v_mfma_f32_32x32x16_bf16 v[32:47], v[144:147], v[208:211], v[32:47]
    v_mfma_f32_32x32x16_bf16 v[32:47], v[148:151], v[212:215], v[32:47]
    v_mfma_f32_32x32x16_bf16 v[32:47], v[152:155], v[216:219], v[32:47]
    s_add_u32 s49, s49, s100
    s_lshr_b32 s34, s49, 4
    s_and_b32 s49, s49, 15
    s_cmp_ge_u32 s34, 2
    s_cselect_b64 vcc, -1, 0
    s_xor_b32 s57, s99, 610304
    s_add_u32 m0, s56, 28672
    s_cbranch_vccnz L_w2_250
    s_bitcmp1_b32 s34, 0
    s_cbranch_scc1 L_w1_250
    s_waitcnt vmcnt(3)
L_w1_250:
    s_waitcnt vmcnt(4)
L_w2_250:
    s_waitcnt vmcnt(5)
    buffer_load_dwordx4 v8, s[4:7], s57 offen offset:0 nt lds
    v_mfma_f32_32x32x16_bf16 v[32:47], v[156:159], v[220:223], v[32:47]
    ds_read_b128 v[128:131], v16 offset:8192
    ds_read_b128 v[132:135], v17 offset:8192
    ds_read_b128 v[136:139], v18 offset:8192
    ds_read_b128 v[140:143], v19 offset:8192
    ds_read_b128 v[144:147], v20 offset:8192
    ds_read_b128 v[148:151], v21 offset:8192
    ds_read_b128 v[152:155], v22 offset:8192
    ds_read_b128 v[156:159], v23 offset:8192
    s_nop 3
    v_max3_f32 v13, v32, v33, v34
    v_max3_f32 v31, v35, v36, v37
    v_max3_f32 v13, v13, v38, v39
    v_max3_f32 v31, v31, v40, v41
    v_max3_f32 v13, v13, v42, v43
    v_max3_f32 v31, v31, v44, v45
    v_max3_f32 v13, v13, v46, v47
    v_max3_f32 v13, v13, v31, v14
    v_mov_b32 v31, v13
    s_nop 1
    v_permlane32_swap_b32 v13, v31
    v_max_f32 v13, v13, v31
    v_sub_f32 v31, v14, v13
    v_mul_f32 v30, s60, v13
    v_mul_f32 v31, s60, v31
    v_mov_b32 v14, v13
    v_exp_f32 v169, v31
    s_waitcnt lgkmcnt(0)
    v_pk_fma_f32 v[32:33], v[32:33], s[60:61], v[30:31] op_sel_hi:[1,0,0] neg_lo:[0,0,1] neg_hi:[0,0,1]
    s_cbranch_vccnz L_w2_251
    s_bitcmp1_b32 s34, 0
    s_cbranch_scc1 L_w1_251
    s_waitcnt vmcnt(3)
L_w1_251:
    s_waitcnt vmcnt(4)
L_w2_251:
    s_waitcnt vmcnt(5)
    buffer_load_dwordx4 v9, s[4:7], s57 offen offset:1024 nt lds
    v_pk_fma_f32 v[34:35], v[34:35], s[60:61], v[30:31] op_sel_hi:[1,0,0] neg_lo:[0,0,1] neg_hi:[0,0,1]
    v_pk_fma_f32 v[36:37], v[36:37], s[60:61], v[30:31] op_sel_hi:[1,0,0] neg_lo:[0,0,1] neg_hi:[0,0,1]
    v_pk_fma_f32 v[38:39], v[38:39], s[60:61], v[30:31] op_sel_hi:[1,0,0] neg_lo:[0,0,1] neg_hi:[0,0,1]
    v_pk_fma_f32 v[40:41], v[40:41], s[60:61], v[30:31] op_sel_hi:[1,0,0] neg_lo:[0,0,1] neg_hi:[0,0,1]
    v_pk_fma_f32 v[42:43], v[42:43], s[60:61], v[30:31] op_sel_hi:[1,0,0] neg_lo:[0,0,1] neg_hi:[0,0,1]
    v_pk_fma_f32 v[44:45], v[44:45], s[60:61], v[30:31] op_sel_hi:[1,0,0] neg_lo:[0,0,1] neg_hi:[0,0,1]
    v_pk_fma_f32 v[46:47], v[46:47], s[60:61], v[30:31] op_sel_hi:[1,0,0] neg_lo:[0,0,1] neg_hi:[0,0,1]
    v_mul_f32 v15, v15, v169
    v_exp_f32 v32, v32
    v_exp_f32 v33, v33
    v_exp_f32 v34, v34
    v_exp_f32 v35, v35
    v_exp_f32 v36, v36
    v_exp_f32 v37, v37
    v_exp_f32 v38, v38
    v_exp_f32 v39, v39
    v_exp_f32 v40, v40
    s_cbranch_vccnz L_w2_252
    s_bitcmp1_b32 s34, 0
    s_cbranch_scc1 L_w1_252
    s_waitcnt vmcnt(3)
L_w1_252:
    s_waitcnt vmcnt(4)
L_w2_252:
    s_waitcnt vmcnt(5)
    buffer_load_dwordx4 v10, s[4:7], s57 offen offset:2048 nt lds
    v_exp_f32 v41, v41
    v_exp_f32 v42, v42
    v_exp_f32 v43, v43
    v_exp_f32 v44, v44
    v_exp_f32 v45, v45
    v_exp_f32 v46, v46
    v_exp_f32 v47, v47
    v_pk_add_f32 v[2:3], v[32:33], v[34:35]
    v_pk_add_f32 v[4:5], v[36:37], v[38:39]
    v_pk_add_f32 v[2:3], v[2:3], v[40:41]
    v_pk_add_f32 v[4:5], v[4:5], v[42:43]
    v_pk_add_f32 v[2:3], v[2:3], v[44:45]
    v_pk_add_f32 v[4:5], v[4:5], v[46:47]
    v_pk_add_f32 v[2:3], v[2:3], v[4:5]
    v_add_f32 v2, v2, v3
    v_add_f32 v15, v15, v2
    v_cvt_pk_bf16_f32 v48, v32, v33
    v_cvt_pk_bf16_f32 v49, v34, v35
    v_cvt_pk_bf16_f32 v50, v36, v37
    s_cbranch_vccnz L_w2_253
    s_bitcmp1_b32 s34, 0
    s_cbranch_scc1 L_w1_253
    s_waitcnt vmcnt(3)
L_w1_253:
    s_waitcnt vmcnt(4)
L_w2_253:
    s_waitcnt vmcnt(5)
    buffer_load_dwordx4 v11, s[4:7], s57 offen offset:3072 nt lds
    v_cvt_pk_bf16_f32 v51, v38, v39
    v_cvt_pk_bf16_f32 v52, v40, v41
    v_cvt_pk_bf16_f32 v53, v42, v43
    v_cvt_pk_bf16_f32 v54, v44, v45
    v_cvt_pk_bf16_f32 v55, v46, v47
    v_accvgpr_write_b32 a64, v48
    v_accvgpr_write_b32 a65, v49
    v_accvgpr_write_b32 a66, v50
    v_accvgpr_write_b32 a67, v51
    v_accvgpr_write_b32 a68, v52
    v_accvgpr_write_b32 a69, v53
    v_accvgpr_write_b32 a70, v54
    v_accvgpr_write_b32 a71, v55
    v_mfma_f32_32x32x16_bf16 v[32:47], v[96:99], v[192:195], 0
    v_mfma_f32_32x32x16_bf16 v[32:47], v[100:103], v[196:199], v[32:47]
    s_add_u32 s49, s49, s100
    s_lshr_b32 s34, s49, 4
    s_and_b32 s49, s49, 15
    s_cmp_ge_u32 s34, 2
    s_cselect_b64 vcc, -1, 0
    s_cmp_lg_u32 s44, 20
    s_cbranch_scc1 L_nr20
    s_mov_b32 s3, 82688
    v_mov_b32 v246, 1
    s_mov_b64 exec, 1
    buffer_atomic_add v246, off, s[24:27], s3 sc0
    s_mov_b64 exec, -1
L_nr20:
    v_add_u32 v0, 1, v0
    s_mov_b64 exec, s[32:33]
    buffer_store_dword v0, v242, s[24:27], s35 offen
    s_mov_b64 exec, -1
    buffer_load_dword v244, v242, s[24:27], s35 offen sc1
    s_xor_b32 s57, s99, 655360
    s_add_u32 m0, s56, 0
    s_cbranch_vccnz L_w2_256
    s_bitcmp1_b32 s34, 0
    s_cbranch_scc1 L_w1_256
    s_waitcnt vmcnt(5)
L_w1_256:
    s_waitcnt vmcnt(6)
L_w2_256:
    s_waitcnt vmcnt(7)
    buffer_load_dwordx4 v8, s[4:7], s57 offen offset:0 nt lds
    v_mfma_f32_32x32x16_bf16 v[32:47], v[104:107], v[200:203], v[32:47]
    v_mfma_f32_32x32x16_bf16 v[32:47], v[108:111], v[204:207], v[32:47]
    v_mfma_f32_32x32x16_bf16 v[32:47], v[112:115], v[208:211], v[32:47]
    v_mfma_f32_32x32x16_bf16 v[32:47], v[116:119], v[212:215], v[32:47]
    s_cbranch_vccnz L_w2_257
    s_bitcmp1_b32 s34, 0
    s_cbranch_scc1 L_w1_257
    s_waitcnt vmcnt(5)
L_w1_257:
    s_waitcnt vmcnt(6)
L_w2_257:
    s_waitcnt vmcnt(7)
    buffer_load_dwordx4 v9, s[4:7], s57 offen offset:1024 nt lds
    v_mfma_f32_32x32x16_bf16 v[32:47], v[120:123], v[216:219], v[32:47]
    v_mfma_f32_32x32x16_bf16 v[32:47], v[124:127], v[220:223], v[32:47]
    s_nop 11
    v_max3_f32 v13, v32, v33, v34
    v_max3_f32 v31, v35, v36, v37
    v_max3_f32 v13, v13, v38, v39
    v_max3_f32 v31, v31, v40, v41
    v_max3_f32 v13, v13, v42, v43
    v_max3_f32 v31, v31, v44, v45
    v_max3_f32 v13, v13, v46, v47
    v_max3_f32 v13, v13, v31, v14
    v_mov_b32 v31, v13
    s_nop 1
    v_permlane32_swap_b32 v13, v31
    s_cbranch_vccnz L_w2_258
    s_bitcmp1_b32 s34, 0
    s_cbranch_scc1 L_w1_258
    s_waitcnt vmcnt(5)
L_w1_258:
    s_waitcnt vmcnt(6)
L_w2_258:
    s_waitcnt vmcnt(7)
    buffer_load_dwordx4 v10, s[4:7], s57 offen offset:2048 nt lds
    v_max_f32 v13, v13, v31
    v_sub_f32 v31, v14, v13
    v_mul_f32 v30, s60, v13
    v_mul_f32 v31, s60, v31
    v_mov_b32 v14, v13
    v_exp_f32 v170, v31
    v_pk_fma_f32 v[32:33], v[32:33], s[60:61], v[30:31] op_sel_hi:[1,0,0] neg_lo:[0,0,1] neg_hi:[0,0,1]
    v_pk_fma_f32 v[34:35], v[34:35], s[60:61], v[30:31] op_sel_hi:[1,0,0] neg_lo:[0,0,1] neg_hi:[0,0,1]
    v_pk_fma_f32 v[36:37], v[36:37], s[60:61], v[30:31] op_sel_hi:[1,0,0] neg_lo:[0,0,1] neg_hi:[0,0,1]
    v_pk_fma_f32 v[38:39], v[38:39], s[60:61], v[30:31] op_sel_hi:[1,0,0] neg_lo:[0,0,1] neg_hi:[0,0,1]
    v_pk_fma_f32 v[40:41], v[40:41], s[60:61], v[30:31] op_sel_hi:[1,0,0] neg_lo:[0,0,1] neg_hi:[0,0,1]
    v_pk_fma_f32 v[42:43], v[42:43], s[60:61], v[30:31] op_sel_hi:[1,0,0] neg_lo:[0,0,1] neg_hi:[0,0,1]
    v_pk_fma_f32 v[44:45], v[44:45], s[60:61], v[30:31] op_sel_hi:[1,0,0] neg_lo:[0,0,1] neg_hi:[0,0,1]
    v_pk_fma_f32 v[46:47], v[46:47], s[60:61], v[30:31] op_sel_hi:[1,0,0] neg_lo:[0,0,1] neg_hi:[0,0,1]
    v_mul_f32 v15, v15, v170
    v_exp_f32 v32, v32
    v_exp_f32 v33, v33
    v_exp_f32 v34, v34
    v_exp_f32 v35, v35
    v_exp_f32 v36, v36
    s_cbranch_vccnz L_w2_259
    s_bitcmp1_b32 s34, 0
    s_cbranch_scc1 L_w1_259
    s_waitcnt vmcnt(5)
L_w1_259:
    s_waitcnt vmcnt(6)
L_w2_259:
    s_waitcnt vmcnt(7)
    buffer_load_dwordx4 v11, s[4:7], s57 offen offset:3072 nt lds
    v_exp_f32 v37, v37
    v_exp_f32 v38, v38
    v_exp_f32 v39, v39
    v_exp_f32 v40, v40
    v_exp_f32 v41, v41
    v_exp_f32 v42, v42
    v_exp_f32 v43, v43
    v_exp_f32 v44, v44
    v_exp_f32 v45, v45
    v_exp_f32 v46, v46
    v_exp_f32 v47, v47
    v_pk_add_f32 v[2:3], v[32:33], v[34:35]
    v_pk_add_f32 v[4:5], v[36:37], v[38:39]
    v_pk_add_f32 v[2:3], v[2:3], v[40:41]
    v_pk_add_f32 v[4:5], v[4:5], v[42:43]
    s_add_u32 s49, s49, s100
    s_lshr_b32 s34, s49, 4
    s_and_b32 s49, s49, 15
    s_cmp_ge_u32 s34, 2
    s_cselect_b64 vcc, -1, 0
    s_xor_b32 s57, s99, 659456
    s_add_u32 m0, s56, 4096
    s_cbranch_vccnz L_w2_260
    s_bitcmp1_b32 s34, 0
    s_cbranch_scc1 L_w1_260
    s_waitcnt vmcnt(3)
L_w1_260:
    s_waitcnt vmcnt(6)
L_w2_260:
    s_waitcnt vmcnt(7)
    buffer_load_dwordx4 v8, s[4:7], s57 offen offset:0 nt lds
    v_pk_add_f32 v[2:3], v[2:3], v[44:45]
    v_pk_add_f32 v[4:5], v[4:5], v[46:47]
    v_pk_add_f32 v[2:3], v[2:3], v[4:5]
    v_add_f32 v2, v2, v3
    v_add_f32 v15, v15, v2
    v_cvt_pk_bf16_f32 v48, v32, v33
    v_cvt_pk_bf16_f32 v49, v34, v35
    v_cvt_pk_bf16_f32 v50, v36, v37
    v_cvt_pk_bf16_f32 v51, v38, v39
    v_cvt_pk_bf16_f32 v52, v40, v41
    v_cvt_pk_bf16_f32 v53, v42, v43
    v_cvt_pk_bf16_f32 v54, v44, v45
    v_cvt_pk_bf16_f32 v55, v46, v47
    v_accvgpr_write_b32 a72, v48
    v_accvgpr_write_b32 a73, v49
    v_accvgpr_write_b32 a74, v50
    v_accvgpr_write_b32 a75, v51
    v_accvgpr_write_b32 a76, v52
    v_accvgpr_write_b32 a77, v53
    v_accvgpr_write_b32 a78, v54
    v_accvgpr_write_b32 a79, v55
    v_mfma_f32_32x32x16_bf16 v[32:47], v[128:131], v[192:195], 0
    s_cbranch_vccnz L_w2_261
    s_bitcmp1_b32 s34, 0
    s_cbranch_scc1 L_w1_261
    s_waitcnt vmcnt(3)
L_w1_261:
    s_waitcnt vmcnt(4)
L_w2_261:
    s_waitcnt vmcnt(7)
    buffer_load_dwordx4 v9, s[4:7], s57 offen offset:1024 nt lds
    v_mfma_f32_32x32x16_bf16 v[32:47], v[132:135], v[196:199], v[32:47]
    v_mfma_f32_32x32x16_bf16 v[32:47], v[136:139], v[200:203], v[32:47]
    v_mfma_f32_32x32x16_bf16 v[32:47], v[140:143], v[204:207], v[32:47]
    v_mfma_f32_32x32x16_bf16 v[32:47], v[144:147], v[208:211], v[32:47]
    s_cbranch_vccnz L_w2_262
    s_bitcmp1_b32 s34, 0
    s_cbranch_scc1 L_w1_262
    s_waitcnt vmcnt(3)
L_w1_262:
    s_waitcnt vmcnt(4)
L_w2_262:
    s_waitcnt vmcnt(5)
    buffer_load_dwordx4 v10, s[4:7], s57 offen offset:2048 nt lds
    v_mfma_f32_32x32x16_bf16 v[32:47], v[148:151], v[212:215], v[32:47]
    v_mfma_f32_32x32x16_bf16 v[32:47], v[152:155], v[216:219], v[32:47]
    v_mfma_f32_32x32x16_bf16 v[32:47], v[156:159], v[220:223], v[32:47]
    ds_read_b128 v[128:131], v16 offset:16384
    ds_read_b128 v[132:135], v17 offset:16384
    ds_read_b128 v[136:139], v18 offset:16384
    ds_read_b128 v[140:143], v19 offset:16384
    ds_read_b128 v[144:147], v20 offset:16384
    ds_read_b128 v[148:151], v21 offset:16384
    ds_read_b128 v[152:155], v22 offset:16384
    ds_read_b128 v[156:159], v23 offset:16384
    s_nop 3
    v_max3_f32 v13, v32, v33, v34
    v_max3_f32 v31, v35, v36, v37
    s_cbranch_vccnz L_w2_263
    s_bitcmp1_b32 s34, 0
    s_cbranch_scc1 L_w1_263
    s_waitcnt vmcnt(3)
L_w1_263:
    s_waitcnt vmcnt(4)
L_w2_263:
    s_waitcnt vmcnt(5)
    buffer_load_dwordx4 v11, s[4:7], s57 offen offset:3072 nt lds
    v_max3_f32 v13, v13, v38, v39
    v_max3_f32 v31, v31, v40, v41
    v_max3_f32 v13, v13, v42, v43
    v_max3_f32 v31, v31, v44, v45
    v_max3_f32 v13, v13, v46, v47
    v_max3_f32 v13, v13, v31, v14
    v_mov_b32 v31, v13
    s_nop 1
    v_permlane32_swap_b32 v13, v31
    v_max_f32 v13, v13, v31
    v_sub_f32 v31, v14, v13
    v_mul_f32 v30, s60, v13
    v_mul_f32 v31, s60, v31
    v_mov_b32 v14, v13
    v_exp_f32 v171, v31
    s_waitcnt lgkmcnt(0)
    v_pk_fma_f32 v[32:33], v[32:33], s[60:61], v[30:31] op_sel_hi:[1,0,0] neg_lo:[0,0,1] neg_hi:[0,0,1]
    v_pk_fma_f32 v[34:35], v[34:35], s[60:61], v[30:31] op_sel_hi:[1,0,0] neg_lo:[0,0,1] neg_hi:[0,0,1]
    v_pk_fma_f32 v[36:37], v[36:37], s[60:61], v[30:31] op_sel_hi:[1,0,0] neg_lo:[0,0,1] neg_hi:[0,0,1]
    v_pk_fma_f32 v[38:39], v[38:39], s[60:61], v[30:31] op_sel_hi:[1,0,0] neg_lo:[0,0,1] neg_hi:[0,0,1]
    v_pk_fma_f32 v[40:41], v[40:41], s[60:61], v[30:31] op_sel_hi:[1,0,0] neg_lo:[0,0,1] neg_hi:[0,0,1]
    v_pk_fma_f32 v[42:43], v[42:43], s[60:61], v[30:31] op_sel_hi:[1,0,0] neg_lo:[0,0,1] neg_hi:[0,0,1]
    v_pk_fma_f32 v[44:45], v[44:45], s[60:61], v[30:31] op_sel_hi:[1,0,0] neg_lo:[0,0,1] neg_hi:[0,0,1]
    v_pk_fma_f32 v[46:47], v[46:47], s[60:61], v[30:31] op_sel_hi:[1,0,0] neg_lo:[0,0,1] neg_hi:[0,0,1]
    v_mul_f32 v15, v15, v171
    v_exp_f32 v32, v32
    s_cmp_lg_u32 s44, 20
    s_cbranch_scc1 L_nc20
    v_sub_u32 v247, v246, v245
    v_lshlrev_b32 v246, 8, v254
    v_readfirstlane_b32 s3, v247
    s_nop 0
    s_min_u32 s3, s3, 7
    s_mul_i32 s3, s3, 6
    s_add_u32 s3, s3, s45
    v_mov_b32 v247, s3
    s_and_b32 s3, s35, 0xfffffcff
    s_mov_b64 exec, 15
    buffer_store_dword v247, v246, s[24:27], s3 offen offset:128
    s_mov_b64 exec, -1
L_nc20:
    v_sub_u32 v244, v244, v0
    v_cmp_gt_u32 s[100:101], 64, v244
    v_readlane_b32 s46, v244, 32
    s_bcnt1_i32_b32 s3, s100
    s_mul_i32 s3, s3, 3
    s_add_u32 s46, s46, 4
    s_cmp_lt_u32 s46, 128
    s_cselect_b32 s46, s46, 21
    s_add_u32 s3, s3, s46
    s_ashr_i32 s3, s3, 2
    s_add_i32 s3, s3, 2
    s_max_i32 s3, s3, 8
    s_min_i32 s100, s3, 32
    s_add_u32 s49, s49, s100
    s_lshr_b32 s34, s49, 4
    s_and_b32 s49, s49, 15
    s_cmp_ge_u32 s34, 2
    s_cselect_b64 vcc, -1, 0
    s_xor_b32 s57, s99, 671744
    s_add_u32 m0, s56, 8192
    s_cbranch_vccnz L_w2_264
    s_bitcmp1_b32 s34, 0
    s_cbranch_scc1 L_w1_264
    s_waitcnt vmcnt(3)
L_w1_264:
    s_waitcnt vmcnt(4)
L_w2_264:
    s_waitcnt vmcnt(5)
    buffer_load_dwordx4 v8, s[4:7], s57 offen offset:0 nt lds
    v_exp_f32 v33, v33
    v_exp_f32 v34, v34
    v_exp_f32 v35, v35
    v_exp_f32 v36, v36
    v_exp_f32 v37, v37
    v_exp_f32 v38, v38
    v_exp_f32 v39, v39
    v_exp_f32 v40, v40
    v_exp_f32 v41, v41
    v_exp_f32 v42, v42
    v_exp_f32 v43, v43
    v_exp_f32 v44, v44
    v_exp_f32 v45, v45
    s_cbranch_vccnz L_w2_265
    s_bitcmp1_b32 s34, 0
    s_cbranch_scc1 L_w1_265
    s_waitcnt vmcnt(3)
L_w1_265:
    s_waitcnt vmcnt(4)
L_w2_265:
    s_waitcnt vmcnt(5)
    buffer_load_dwordx4 v9, s[4:7], s57 offen offset:1024 nt lds
    v_exp_f32 v46, v46
    v_exp_f32 v47, v47
    v_pk_add_f32 v[2:3], v[32:33], v[34:35]
    v_pk_add_f32 v[4:5], v[36:37], v[38:39]
    v_pk_add_f32 v[2:3], v[2:3], v[40:41]
    v_pk_add_f32 v[4:5], v[4:5], v[42:43]
    v_pk_add_f32 v[2:3], v[2:3], v[44:45]
    v_pk_add_f32 v[4:5], v[4:5], v[46:47]
    v_pk_add_f32 v[2:3], v[2:3], v[4:5]
    v_add_f32 v2, v2, v3
    v_add_f32 v15, v15, v2
    v_cvt_pk_bf16_f32 v48, v32, v33
    v_cvt_pk_bf16_f32 v49, v34, v35
    v_cvt_pk_bf16_f32 v50, v36, v37
    v_cvt_pk_bf16_f32 v51, v38, v39
    v_cvt_pk_bf16_f32 v52, v40, v41
    v_cvt_pk_bf16_f32 v53, v42, v43
    v_cvt_pk_bf16_f32 v54, v44, v45
    v_cvt_pk_bf16_f32 v55, v46, v47
    v_accvgpr_write_b32 a80, v48
    v_accvgpr_write_b32 a81, v49
    v_accvgpr_write_b32 a82, v50
    v_accvgpr_write_b32 a83, v51
    v_accvgpr_write_b32 a84, v52
    s_cbranch_vccnz L_w2_266
    s_bitcmp1_b32 s34, 0
    s_cbranch_scc1 L_w1_266
    s_waitcnt vmcnt(3)
L_w1_266:
    s_waitcnt vmcnt(4)
L_w2_266:
    s_waitcnt vmcnt(5)
    buffer_load_dwordx4 v10, s[4:7], s57 offen offset:2048 nt lds
    v_accvgpr_write_b32 a85, v53
    v_accvgpr_write_b32 a86, v54
    v_accvgpr_write_b32 a87, v55
    v_mfma_f32_32x32x16_bf16 v[32:47], v[128:131], v[192:195], 0
    v_mfma_f32_32x32x16_bf16 v[32:47], v[132:135], v[196:199], v[32:47]
    v_mfma_f32_32x32x16_bf16 v[32:47], v[136:139], v[200:203], v[32:47]
    s_cbranch_vccnz L_w2_267
    s_bitcmp1_b32 s34, 0
    s_cbranch_scc1 L_w1_267
    s_waitcnt vmcnt(3)
L_w1_267:
    s_waitcnt vmcnt(4)
L_w2_267:
    s_waitcnt vmcnt(5)
    buffer_load_dwordx4 v11, s[4:7], s57 offen offset:3072 nt lds
    v_mfma_f32_32x32x16_bf16 v[32:47], v[140:143], v[204:207], v[32:47]
    v_mfma_f32_32x32x16_bf16 v[32:47], v[144:147], v[208:211], v[32:47]
    v_mfma_f32_32x32x16_bf16 v[32:47], v[148:151], v[212:215], v[32:47]
    v_mfma_f32_32x32x16_bf16 v[32:47], v[152:155], v[216:219], v[32:47]
    s_add_u32 s49, s49, s100
    s_lshr_b32 s34, s49, 4
    s_and_b32 s49, s49, 15
    s_cmp_ge_u32 s34, 2
    s_cselect_b64 vcc, -1, 0
    s_xor_b32 s57, s99, 675840
    s_add_u32 m0, s56, 12288
    s_cbranch_vccnz L_w2_268
    s_bitcmp1_b32 s34, 0
    s_cbranch_scc1 L_w1_268
    s_waitcnt vmcnt(3)
L_w1_268:
    s_waitcnt vmcnt(4)
L_w2_268:
    s_waitcnt vmcnt(5)
    buffer_load_dwordx4 v8, s[4:7], s57 offen offset:0 nt lds
    v_mfma_f32_32x32x16_bf16 v[32:47], v[156:159], v[220:223], v[32:47]
    ds_read_b128 v[128:131], v16 offset:24576
    ds_read_b128 v[132:135], v17 offset:24576
    ds_read_b128 v[136:139], v18 offset:24576
    ds_read_b128 v[140:143], v19 offset:24576
    ds_read_b128 v[144:147], v20 offset:24576
    ds_read_b128 v[148:151], v21 offset:24576
    ds_read_b128 v[152:155], v22 offset:24576
    ds_read_b128 v[156:159], v23 offset:24576
    s_nop 3
    v_max3_f32 v13, v32, v33, v34
    v_max3_f32 v31, v35, v36, v37
    v_max3_f32 v13, v13, v38, v39
    v_max3_f32 v31, v31, v40, v41
    v_max3_f32 v13, v13, v42, v43
    v_max3_f32 v31, v31, v44, v45
    v_max3_f32 v13, v13, v46, v47
    v_max3_f32 v13, v13, v31, v14
    v_mov_b32 v31, v13
    s_nop 1
    v_permlane32_swap_b32 v13, v31
    v_max_f32 v13, v13, v31
    v_sub_f32 v31, v14, v13
    v_mul_f32 v30, s60, v13
    v_mul_f32 v31, s60, v31
    v_mov_b32 v14, v13
    v_exp_f32 v172, v31
    s_waitcnt lgkmcnt(0)
    v_pk_fma_f32 v[32:33], v[32:33], s[60:61], v[30:31] op_sel_hi:[1,0,0] neg_lo:[0,0,1] neg_hi:[0,0,1]
    s_cbranch_vccnz L_w2_269
    s_bitcmp1_b32 s34, 0
    s_cbranch_scc1 L_w1_269
    s_waitcnt vmcnt(3)
L_w1_269:
    s_waitcnt vmcnt(4)
L_w2_269:
    s_waitcnt vmcnt(5)
    buffer_load_dwordx4 v9, s[4:7], s57 offen offset:1024 nt lds
    v_pk_fma_f32 v[34:35], v[34:35], s[60:61], v[30:31] op_sel_hi:[1,0,0] neg_lo:[0,0,1] neg_hi:[0,0,1]
    v_pk_fma_f32 v[36:37], v[36:37], s[60:61], v[30:31] op_sel_hi:[1,0,0] neg_lo:[0,0,1] neg_hi:[0,0,1]
    v_pk_fma_f32 v[38:39], v[38:39], s[60:61], v[30:31] op_sel_hi:[1,0,0] neg_lo:[0,0,1] neg_hi:[0,0,1]
    v_pk_fma_f32 v[40:41], v[40:41], s[60:61], v[30:31] op_sel_hi:[1,0,0] neg_lo:[0,0,1] neg_hi:[0,0,1]
    v_pk_fma_f32 v[42:43], v[42:43], s[60:61], v[30:31] op_sel_hi:[1,0,0] neg_lo:[0,0,1] neg_hi:[0,0,1]
    v_pk_fma_f32 v[44:45], v[44:45], s[60:61], v[30:31] op_sel_hi:[1,0,0] neg_lo:[0,0,1] neg_hi:[0,0,1]
    v_pk_fma_f32 v[46:47], v[46:47], s[60:61], v[30:31] op_sel_hi:[1,0,0] neg_lo:[0,0,1] neg_hi:[0,0,1]
    v_mul_f32 v15, v15, v172
    v_exp_f32 v32, v32
    v_exp_f32 v33, v33
    v_exp_f32 v34, v34
    v_exp_f32 v35, v35
    v_exp_f32 v36, v36
    v_exp_f32 v37, v37
    v_exp_f32 v38, v38
    v_exp_f32 v39, v39
    v_exp_f32 v40, v40
    s_cbranch_vccnz L_w2_270
    s_bitcmp1_b32 s34, 0
    s_cbranch_scc1 L_w1_270
    s_waitcnt vmcnt(3)
L_w1_270:
    s_waitcnt vmcnt(4)
L_w2_270:
    s_waitcnt vmcnt(5)
    buffer_load_dwordx4 v10, s[4:7], s57 offen offset:2048 nt lds
    v_exp_f32 v41, v41
    v_exp_f32 v42, v42
    v_exp_f32 v43, v43
    v_exp_f32 v44, v44
    v_exp_f32 v45, v45
    v_exp_f32 v46, v46
    v_exp_f32 v47, v47
    v_pk_add_f32 v[2:3], v[32:33], v[34:35]
    v_pk_add_f32 v[4:5], v[36:37], v[38:39]
    v_pk_add_f32 v[2:3], v[2:3], v[40:41]
    v_pk_add_f32 v[4:5], v[4:5], v[42:43]
    v_pk_add_f32 v[2:3], v[2:3], v[44:45]
    v_pk_add_f32 v[4:5], v[4:5], v[46:47]
    v_pk_add_f32 v[2:3], v[2:3], v[4:5]
    v_add_f32 v2, v2, v3
    v_add_f32 v15, v15, v2
    v_cvt_pk_bf16_f32 v48, v32, v33
    v_cvt_pk_bf16_f32 v49, v34, v35
    v_cvt_pk_bf16_f32 v50, v36, v37
    s_cbranch_vccnz L_w2_271
    s_bitcmp1_b32 s34, 0
    s_cbranch_scc1 L_w1_271
    s_waitcnt vmcnt(3)
L_w1_271:
    s_waitcnt vmcnt(4)
L_w2_271:
    s_waitcnt vmcnt(5)
    buffer_load_dwordx4 v11, s[4:7], s57 offen offset:3072 nt lds
    v_cvt_pk_bf16_f32 v51, v38, v39
    v_cvt_pk_bf16_f32 v52, v40, v41
    v_cvt_pk_bf16_f32 v53, v42, v43
    v_cvt_pk_bf16_f32 v54, v44, v45
    v_cvt_pk_bf16_f32 v55, v46, v47
    v_accvgpr_write_b32 a88, v48
    v_accvgpr_write_b32 a89, v49
    v_accvgpr_write_b32 a90, v50
    v_accvgpr_write_b32 a91, v51
    v_accvgpr_write_b32 a92, v52
    v_accvgpr_write_b32 a93, v53
    v_accvgpr_write_b32 a94, v54
    v_accvgpr_write_b32 a95, v55
    v_mfma_f32_32x32x16_bf16 v[32:47], a[96:99], v[192:195], 0
    v_mfma_f32_32x32x16_bf16 v[32:47], a[100:103], v[196:199], v[32:47]
    s_add_u32 s49, s49, s100
    s_lshr_b32 s34, s49, 4
    s_and_b32 s49, s49, 15
    s_cmp_ge_u32 s34, 2
    s_cselect_b64 vcc, -1, 0
    s_cmp_lg_u32 s44, 22
    s_cbranch_scc1 L_nr22
    s_mov_b32 s3, 82944
    v_mov_b32 v246, 1
    s_mov_b64 exec, 1
    buffer_atomic_add v246, off, s[24:27], s3 sc0
    s_mov_b64 exec, -1
L_nr22:
    v_add_u32 v0, 1, v0
    s_mov_b64 exec, s[32:33]
    buffer_store_dword v0, v242, s[24:27], s35 offen
    s_mov_b64 exec, -1
    buffer_load_dword v244, v242, s[24:27], s35 offen sc1
    s_xor_b32 s57, s99, 720896
    s_add_u32 m0, s56, 16384
    s_cbranch_vccnz L_w2_274
    s_bitcmp1_b32 s34, 0
    s_cbranch_scc1 L_w1_274
    s_waitcnt vmcnt(5)
L_w1_274:
    s_waitcnt vmcnt(6)
L_w2_274:
    s_waitcnt vmcnt(7)
    buffer_load_dwordx4 v8, s[4:7], s57 offen offset:0 nt lds
    v_mfma_f32_32x32x16_bf16 v[32:47], a[104:107], v[200:203], v[32:47]
    v_mfma_f32_32x32x16_bf16 v[32:47], a[108:111], v[204:207], v[32:47]
    v_mfma_f32_32x32x16_bf16 v[32:47], a[112:115], v[208:211], v[32:47]
    v_mfma_f32_32x32x16_bf16 v[32:47], a[116:119], v[212:215], v[32:47]
    s_cbranch_vccnz L_w2_275
    s_bitcmp1_b32 s34, 0
    s_cbranch_scc1 L_w1_275
    s_waitcnt vmcnt(5)
L_w1_275:
    s_waitcnt vmcnt(6)
L_w2_275:
    s_waitcnt vmcnt(7)
    buffer_load_dwordx4 v9, s[4:7], s57 offen offset:1024 nt lds
    v_mfma_f32_32x32x16_bf16 v[32:47], a[120:123], v[216:219], v[32:47]
    v_mfma_f32_32x32x16_bf16 v[32:47], a[124:127], v[220:223], v[32:47]
    s_nop 11
    v_max3_f32 v13, v32, v33, v34
    v_max3_f32 v31, v35, v36, v37
    v_max3_f32 v13, v13, v38, v39
    v_max3_f32 v31, v31, v40, v41
    v_max3_f32 v13, v13, v42, v43
    v_max3_f32 v31, v31, v44, v45
    v_max3_f32 v13, v13, v46, v47
    v_max3_f32 v13, v13, v31, v14
    v_mov_b32 v31, v13
    s_nop 1
    v_permlane32_swap_b32 v13, v31
    s_cbranch_vccnz L_w2_276
    s_bitcmp1_b32 s34, 0
    s_cbranch_scc1 L_w1_276
    s_waitcnt vmcnt(5)
L_w1_276:
    s_waitcnt vmcnt(6)
L_w2_276:
    s_waitcnt vmcnt(7)
    buffer_load_dwordx4 v10, s[4:7], s57 offen offset:2048 nt lds
    v_max_f32 v13, v13, v31
    v_sub_f32 v31, v14, v13
    v_mul_f32 v30, s60, v13
    v_mul_f32 v31, s60, v31
    v_mov_b32 v14, v13
    v_exp_f32 v173, v31
    v_pk_fma_f32 v[32:33], v[32:33], s[60:61], v[30:31] op_sel_hi:[1,0,0] neg_lo:[0,0,1] neg_hi:[0,0,1]
    v_pk_fma_f32 v[34:35], v[34:35], s[60:61], v[30:31] op_sel_hi:[1,0,0] neg_lo:[0,0,1] neg_hi:[0,0,1]
    v_pk_fma_f32 v[36:37], v[36:37], s[60:61], v[30:31] op_sel_hi:[1,0,0] neg_lo:[0,0,1] neg_hi:[0,0,1]
    v_pk_fma_f32 v[38:39], v[38:39], s[60:61], v[30:31] op_sel_hi:[1,0,0] neg_lo:[0,0,1] neg_hi:[0,0,1]
    v_pk_fma_f32 v[40:41], v[40:41], s[60:61], v[30:31] op_sel_hi:[1,0,0] neg_lo:[0,0,1] neg_hi:[0,0,1]
    v_pk_fma_f32 v[42:43], v[42:43], s[60:61], v[30:31] op_sel_hi:[1,0,0] neg_lo:[0,0,1] neg_hi:[0,0,1]
    v_pk_fma_f32 v[44:45], v[44:45], s[60:61], v[30:31] op_sel_hi:[1,0,0] neg_lo:[0,0,1] neg_hi:[0,0,1]
    v_pk_fma_f32 v[46:47], v[46:47], s[60:61], v[30:31] op_sel_hi:[1,0,0] neg_lo:[0,0,1] neg_hi:[0,0,1]
    v_mul_f32 v15, v15, v173
    v_exp_f32 v32, v32
    v_exp_f32 v33, v33
    v_exp_f32 v34, v34
    v_exp_f32 v35, v35
    v_exp_f32 v36, v36
    s_cbranch_vccnz L_w2_277
    s_bitcmp1_b32 s34, 0
    s_cbranch_scc1 L_w1_277
    s_waitcnt vmcnt(5)
L_w1_277:
    s_waitcnt vmcnt(6)
L_w2_277:
    s_waitcnt vmcnt(7)
    buffer_load_dwordx4 v11, s[4:7], s57 offen offset:3072 nt lds
    v_exp_f32 v37, v37
    v_exp_f32 v38, v38
    v_exp_f32 v39, v39
    v_exp_f32 v40, v40
    v_exp_f32 v41, v41
    v_exp_f32 v42, v42
    v_exp_f32 v43, v43
    v_exp_f32 v44, v44
    v_exp_f32 v45, v45
    v_exp_f32 v46, v46
    v_exp_f32 v47, v47
    v_pk_add_f32 v[2:3], v[32:33], v[34:35]
    v_pk_add_f32 v[4:5], v[36:37], v[38:39]
    v_pk_add_f32 v[2:3], v[2:3], v[40:41]
    v_pk_add_f32 v[4:5], v[4:5], v[42:43]
    s_add_u32 s49, s49, s100
    s_lshr_b32 s34, s49, 4
    s_and_b32 s49, s49, 15
    s_cmp_ge_u32 s34, 2
    s_cselect_b64 vcc, -1, 0
    s_xor_b32 s57, s99, 724992
    s_add_u32 m0, s56, 20480
    s_cbranch_vccnz L_w2_278
    s_bitcmp1_b32 s34, 0
    s_cbranch_scc1 L_w1_278
    s_waitcnt vmcnt(3)
L_w1_278:
    s_waitcnt vmcnt(6)
L_w2_278:
    s_waitcnt vmcnt(7)
    buffer_load_dwordx4 v8, s[4:7], s57 offen offset:0 nt lds
    v_pk_add_f32 v[2:3], v[2:3], v[44:45]
    v_pk_add_f32 v[4:5], v[4:5], v[46:47]
    v_pk_add_f32 v[2:3], v[2:3], v[4:5]
    v_add_f32 v2, v2, v3
    v_add_f32 v15, v15, v2
    v_cvt_pk_bf16_f32 v48, v32, v33
    v_cvt_pk_bf16_f32 v49, v34, v35
    v_cvt_pk_bf16_f32 v50, v36, v37
    v_cvt_pk_bf16_f32 v51, v38, v39
    v_cvt_pk_bf16_f32 v52, v40, v41
    v_cvt_pk_bf16_f32 v53, v42, v43
    v_cvt_pk_bf16_f32 v54, v44, v45
    v_cvt_pk_bf16_f32 v55, v46, v47
    v_accvgpr_write_b32 a96, v48
    v_accvgpr_write_b32 a97, v49
    v_accvgpr_write_b32 a98, v50
    v_accvgpr_write_b32 a99, v51
    v_accvgpr_write_b32 a100, v52
    v_accvgpr_write_b32 a101, v53
    v_accvgpr_write_b32 a102, v54
    v_accvgpr_write_b32 a103, v55
    v_mfma_f32_32x32x16_bf16 v[32:47], v[128:131], v[192:195], 0
    s_cbranch_vccnz L_w2_279
    s_bitcmp1_b32 s34, 0
    s_cbranch_scc1 L_w1_279
    s_waitcnt vmcnt(3)
L_w1_279:
    s_waitcnt vmcnt(4)
L_w2_279:
    s_waitcnt vmcnt(7)
    buffer_load_dwordx4 v9, s[4:7], s57 offen offset:1024 nt lds
    v_mfma_f32_32x32x16_bf16 v[32:47], v[132:135], v[196:199], v[32:47]
    v_mfma_f32_32x32x16_bf16 v[32:47], v[136:139], v[200:203], v[32:47]
    v_mfma_f32_32x32x16_bf16 v[32:47], v[140:143], v[204:207], v[32:47]
    v_mfma_f32_32x32x16_bf16 v[32:47], v[144:147], v[208:211], v[32:47]
    s_cbranch_vccnz L_w2_280
    s_bitcmp1_b32 s34, 0
    s_cbranch_scc1 L_w1_280
    s_waitcnt vmcnt(3)
L_w1_280:
    s_waitcnt vmcnt(4)
L_w2_280:
    s_waitcnt vmcnt(5)
    buffer_load_dwordx4 v10, s[4:7], s57 offen offset:2048 nt lds
    v_mfma_f32_32x32x16_bf16 v[32:47], v[148:151], v[212:215], v[32:47]
    v_mfma_f32_32x32x16_bf16 v[32:47], v[152:155], v[216:219], v[32:47]
    v_mfma_f32_32x32x16_bf16 v[32:47], v[156:159], v[220:223], v[32:47]
    ds_read_b128 v[128:131], v16 offset:0
    ds_read_b128 v[132:135], v17 offset:0
    ds_read_b128 v[136:139], v18 offset:0
    ds_read_b128 v[140:143], v19 offset:0
    ds_read_b128 v[144:147], v20 offset:0
    ds_read_b128 v[148:151], v21 offset:0
    ds_read_b128 v[152:155], v22 offset:0
    ds_read_b128 v[156:159], v23 offset:0
    s_nop 3
    v_max3_f32 v13, v32, v33, v34
    v_max3_f32 v31, v35, v36, v37
    s_cbranch_vccnz L_w2_281
    s_bitcmp1_b32 s34, 0
    s_cbranch_scc1 L_w1_281
    s_waitcnt vmcnt(3)
L_w1_281:
    s_waitcnt vmcnt(4)
L_w2_281:
    s_waitcnt vmcnt(5)
    buffer_load_dwordx4 v11, s[4:7], s57 offen offset:3072 nt lds
    v_max3_f32 v13, v13, v38, v39
    v_max3_f32 v31, v31, v40, v41
    v_max3_f32 v13, v13, v42, v43
    v_max3_f32 v31, v31, v44, v45
    v_max3_f32 v13, v13, v46, v47
    v_max3_f32 v13, v13, v31, v14
    v_mov_b32 v31, v13
    s_nop 1
    v_permlane32_swap_b32 v13, v31
    v_max_f32 v13, v13, v31
    v_sub_f32 v31, v14, v13
    v_mul_f32 v30, s60, v13
    v_mul_f32 v31, s60, v31
    v_mov_b32 v14, v13
    v_exp_f32 v174, v31
    s_waitcnt lgkmcnt(0)
    v_pk_fma_f32 v[32:33], v[32:33], s[60:61], v[30:31] op_sel_hi:[1,0,0] neg_lo:[0,0,1] neg_hi:[0,0,1]
    v_pk_fma_f32 v[34:35], v[34:35], s[60:61], v[30:31] op_sel_hi:[1,0,0] neg_lo:[0,0,1] neg_hi:[0,0,1]
    v_pk_fma_f32 v[36:37], v[36:37], s[60:61], v[30:31] op_sel_hi:[1,0,0] neg_lo:[0,0,1] neg_hi:[0,0,1]
    v_pk_fma_f32 v[38:39], v[38:39], s[60:61], v[30:31] op_sel_hi:[1,0,0] neg_lo:[0,0,1] neg_hi:[0,0,1]
    v_pk_fma_f32 v[40:41], v[40:41], s[60:61], v[30:31] op_sel_hi:[1,0,0] neg_lo:[0,0,1] neg_hi:[0,0,1]
    v_pk_fma_f32 v[42:43], v[42:43], s[60:61], v[30:31] op_sel_hi:[1,0,0] neg_lo:[0,0,1] neg_hi:[0,0,1]
    v_pk_fma_f32 v[44:45], v[44:45], s[60:61], v[30:31] op_sel_hi:[1,0,0] neg_lo:[0,0,1] neg_hi:[0,0,1]
    v_pk_fma_f32 v[46:47], v[46:47], s[60:61], v[30:31] op_sel_hi:[1,0,0] neg_lo:[0,0,1] neg_hi:[0,0,1]
    v_mul_f32 v15, v15, v174
    v_exp_f32 v32, v32
    s_cmp_lg_u32 s44, 22
    s_cbranch_scc1 L_nc22
    v_sub_u32 v247, v246, v245
    v_lshlrev_b32 v246, 8, v254
    v_readfirstlane_b32 s3, v247
    s_nop 0
    s_min_u32 s3, s3, 7
    s_mul_i32 s3, s3, 6
    s_add_u32 s3, s3, s45
    v_mov_b32 v247, s3
    s_and_b32 s3, s35, 0xfffffcff
    s_mov_b64 exec, 15
    buffer_store_dword v247, v246, s[24:27], s3 offen offset:128
    s_mov_b64 exec, -1
L_nc22:
    v_sub_u32 v244, v244, v0
    v_cmp_gt_u32 s[100:101], 64, v244
    v_readlane_b32 s46, v244, 32
    s_bcnt1_i32_b32 s3, s100
    s_mul_i32 s3, s3, 3
    s_add_u32 s46, s46, 5
    s_cmp_lt_u32 s46, 128
    s_cselect_b32 s46, s46, 21
    s_add_u32 s3, s3, s46
    s_ashr_i32 s3, s3, 2
    s_add_i32 s3, s3, 2
    s_max_i32 s3, s3, 8
    s_min_i32 s100, s3, 32
    s_add_u32 s49, s49, s100
    s_lshr_b32 s34, s49, 4
    s_and_b32 s49, s49, 15
    s_cmp_ge_u32 s34, 2
    s_cselect_b64 vcc, -1, 0
    s_xor_b32 s57, s99, 737280
    s_add_u32 m0, s56, 24576
    s_cbranch_vccnz L_w2_282
    s_bitcmp1_b32 s34, 0
    s_cbranch_scc1 L_w1_282
    s_waitcnt vmcnt(3)
L_w1_282:
    s_waitcnt vmcnt(4)
L_w2_282:
    s_waitcnt vmcnt(5)
    buffer_load_dwordx4 v8, s[4:7], s57 offen offset:0 nt lds
    v_exp_f32 v33, v33
    v_exp_f32 v34, v34
    v_exp_f32 v35, v35
    v_exp_f32 v36, v36
    v_exp_f32 v37, v37
    v_exp_f32 v38, v38
    v_exp_f32 v39, v39
    v_exp_f32 v40, v40
    v_exp_f32 v41, v41
    v_exp_f32 v42, v42
    v_exp_f32 v43, v43
    v_exp_f32 v44, v44
    v_exp_f32 v45, v45
    s_cbranch_vccnz L_w2_283
    s_bitcmp1_b32 s34, 0
    s_cbranch_scc1 L_w1_283
    s_waitcnt vmcnt(3)
L_w1_283:
    s_waitcnt vmcnt(4)
L_w2_283:
    s_waitcnt vmcnt(5)
    buffer_load_dwordx4 v9, s[4:7], s57 offen offset:1024 nt lds
    v_exp_f32 v46, v46
    v_exp_f32 v47, v47
    v_pk_add_f32 v[2:3], v[32:33], v[34:35]
    v_pk_add_f32 v[4:5], v[36:37], v[38:39]
    v_pk_add_f32 v[2:3], v[2:3], v[40:41]
    v_pk_add_f32 v[4:5], v[4:5], v[42:43]
    v_pk_add_f32 v[2:3], v[2:3], v[44:45]
    v_pk_add_f32 v[4:5], v[4:5], v[46:47]
    v_pk_add_f32 v[2:3], v[2:3], v[4:5]
    v_add_f32 v2, v2, v3
    v_add_f32 v15, v15, v2
    v_cvt_pk_bf16_f32 v48, v32, v33
    v_cvt_pk_bf16_f32 v49, v34, v35
    v_cvt_pk_bf16_f32 v50, v36, v37
    v_cvt_pk_bf16_f32 v51, v38, v39
    v_cvt_pk_bf16_f32 v52, v40, v41
    v_cvt_pk_bf16_f32 v53, v42, v43
    v_cvt_pk_bf16_f32 v54, v44, v45
    v_cvt_pk_bf16_f32 v55, v46, v47
    v_accvgpr_write_b32 a104, v48
    v_accvgpr_write_b32 a105, v49
    v_accvgpr_write_b32 a106, v50
    v_accvgpr_write_b32 a107, v51
    v_accvgpr_write_b32 a108, v52
    s_cbranch_vccnz L_w2_284
    s_bitcmp1_b32 s34, 0
    s_cbranch_scc1 L_w1_284
    s_waitcnt vmcnt(3)
L_w1_284:
    s_waitcnt vmcnt(4)
L_w2_284:
    s_waitcnt vmcnt(5)
    buffer_load_dwordx4 v10, s[4:7], s57 offen offset:2048 nt lds
    v_accvgpr_write_b32 a109, v53
    v_accvgpr_write_b32 a110, v54
    v_accvgpr_write_b32 a111, v55
    v_mfma_f32_32x32x16_bf16 v[32:47], v[128:131], v[192:195], 0
    v_mfma_f32_32x32x16_bf16 v[32:47], v[132:135], v[196:199], v[32:47]
    v_mfma_f32_32x32x16_bf16 v[32:47], v[136:139], v[200:203], v[32:47]
    s_cbranch_vccnz L_w2_285
    s_bitcmp1_b32 s34, 0
    s_cbranch_scc1 L_w1_285
    s_waitcnt vmcnt(3)
L_w1_285:
    s_waitcnt vmcnt(4)
L_w2_285:
    s_waitcnt vmcnt(5)
    buffer_load_dwordx4 v11, s[4:7], s57 offen offset:3072 nt lds
    v_mfma_f32_32x32x16_bf16 v[32:47], v[140:143], v[204:207], v[32:47]
    v_mfma_f32_32x32x16_bf16 v[32:47], v[144:147], v[208:211], v[32:47]
    v_mfma_f32_32x32x16_bf16 v[32:47], v[148:151], v[212:215], v[32:47]
    v_mfma_f32_32x32x16_bf16 v[32:47], v[152:155], v[216:219], v[32:47]
    s_add_u32 s49, s49, s100
    s_lshr_b32 s34, s49, 4
    s_and_b32 s49, s49, 15
    s_cmp_ge_u32 s34, 2
    s_cselect_b64 vcc, -1, 0
    s_xor_b32 s57, s99, 741376
    s_add_u32 m0, s56, 28672
    s_cbranch_vccnz L_w2_286
    s_bitcmp1_b32 s34, 0
    s_cbranch_scc1 L_w1_286
    s_waitcnt vmcnt(3)
L_w1_286:
    s_waitcnt vmcnt(4)
L_w2_286:
    s_waitcnt vmcnt(5)
    buffer_load_dwordx4 v8, s[4:7], s57 offen offset:0 nt lds
    v_mfma_f32_32x32x16_bf16 v[32:47], v[156:159], v[220:223], v[32:47]
    ds_read_b128 v[128:131], v16 offset:8192
    ds_read_b128 v[132:135], v17 offset:8192
    ds_read_b128 v[136:139], v18 offset:8192
    ds_read_b128 v[140:143], v19 offset:8192
    ds_read_b128 v[144:147], v20 offset:8192
    ds_read_b128 v[148:151], v21 offset:8192
    ds_read_b128 v[152:155], v22 offset:8192
    ds_read_b128 v[156:159], v23 offset:8192
    s_nop 3
    v_max3_f32 v13, v32, v33, v34
    v_max3_f32 v31, v35, v36, v37
    v_max3_f32 v13, v13, v38, v39
    v_max3_f32 v31, v31, v40, v41
    v_max3_f32 v13, v13, v42, v43
    v_max3_f32 v31, v31, v44, v45
    v_max3_f32 v13, v13, v46, v47
    v_max3_f32 v13, v13, v31, v14
    v_mov_b32 v31, v13
    s_nop 1
    v_permlane32_swap_b32 v13, v31
    v_max_f32 v13, v13, v31
    v_sub_f32 v31, v14, v13
    v_mul_f32 v30, s60, v13
    v_mul_f32 v31, s60, v31
    v_mov_b32 v14, v13
    v_exp_f32 v175, v31
    s_waitcnt lgkmcnt(0)
    v_pk_fma_f32 v[32:33], v[32:33], s[60:61], v[30:31] op_sel_hi:[1,0,0] neg_lo:[0,0,1] neg_hi:[0,0,1]
    s_cbranch_vccnz L_w2_287
    s_bitcmp1_b32 s34, 0
    s_cbranch_scc1 L_w1_287
    s_waitcnt vmcnt(3)
L_w1_287:
    s_waitcnt vmcnt(4)
L_w2_287:
    s_waitcnt vmcnt(5)
    buffer_load_dwordx4 v9, s[4:7], s57 offen offset:1024 nt lds
    v_pk_fma_f32 v[34:35], v[34:35], s[60:61], v[30:31] op_sel_hi:[1,0,0] neg_lo:[0,0,1] neg_hi:[0,0,1]
    v_pk_fma_f32 v[36:37], v[36:37], s[60:61], v[30:31] op_sel_hi:[1,0,0] neg_lo:[0,0,1] neg_hi:[0,0,1]
    v_pk_fma_f32 v[38:39], v[38:39], s[60:61], v[30:31] op_sel_hi:[1,0,0] neg_lo:[0,0,1] neg_hi:[0,0,1]
    v_pk_fma_f32 v[40:41], v[40:41], s[60:61], v[30:31] op_sel_hi:[1,0,0] neg_lo:[0,0,1] neg_hi:[0,0,1]
    v_pk_fma_f32 v[42:43], v[42:43], s[60:61], v[30:31] op_sel_hi:[1,0,0] neg_lo:[0,0,1] neg_hi:[0,0,1]
    v_pk_fma_f32 v[44:45], v[44:45], s[60:61], v[30:31] op_sel_hi:[1,0,0] neg_lo:[0,0,1] neg_hi:[0,0,1]
    v_pk_fma_f32 v[46:47], v[46:47], s[60:61], v[30:31] op_sel_hi:[1,0,0] neg_lo:[0,0,1] neg_hi:[0,0,1]
    v_mul_f32 v15, v15, v175
    v_exp_f32 v32, v32
    v_exp_f32 v33, v33
    v_exp_f32 v34, v34
    v_exp_f32 v35, v35
    v_exp_f32 v36, v36
    v_exp_f32 v37, v37
    v_exp_f32 v38, v38
    v_exp_f32 v39, v39
    v_exp_f32 v40, v40
    s_cbranch_vccnz L_w2_288
    s_bitcmp1_b32 s34, 0
    s_cbranch_scc1 L_w1_288
    s_waitcnt vmcnt(3)
L_w1_288:
    s_waitcnt vmcnt(4)
L_w2_288:
    s_waitcnt vmcnt(5)
    buffer_load_dwordx4 v10, s[4:7], s57 offen offset:2048 nt lds
    v_exp_f32 v41, v41
    v_exp_f32 v42, v42
    v_exp_f32 v43, v43
    v_exp_f32 v44, v44
    v_exp_f32 v45, v45
    v_exp_f32 v46, v46
    v_exp_f32 v47, v47
    v_pk_add_f32 v[2:3], v[32:33], v[34:35]
    v_pk_add_f32 v[4:5], v[36:37], v[38:39]
    v_pk_add_f32 v[2:3], v[2:3], v[40:41]
    v_pk_add_f32 v[4:5], v[4:5], v[42:43]
    v_pk_add_f32 v[2:3], v[2:3], v[44:45]
    v_pk_add_f32 v[4:5], v[4:5], v[46:47]
    v_pk_add_f32 v[2:3], v[2:3], v[4:5]
    v_add_f32 v2, v2, v3
    v_add_f32 v15, v15, v2
    v_cvt_pk_bf16_f32 v48, v32, v33
    v_cvt_pk_bf16_f32 v49, v34, v35
    v_cvt_pk_bf16_f32 v50, v36, v37
    s_cbranch_vccnz L_w2_289
    s_bitcmp1_b32 s34, 0
    s_cbranch_scc1 L_w1_289
    s_waitcnt vmcnt(3)
L_w1_289:
    s_waitcnt vmcnt(4)
L_w2_289:
    s_waitcnt vmcnt(5)
    buffer_load_dwordx4 v11, s[4:7], s57 offen offset:3072 nt lds
    v_cvt_pk_bf16_f32 v51, v38, v39
    v_cvt_pk_bf16_f32 v52, v40, v41
    v_cvt_pk_bf16_f32 v53, v42, v43
    v_cvt_pk_bf16_f32 v54, v44, v45
    v_cvt_pk_bf16_f32 v55, v46, v47
    v_accvgpr_write_b32 a112, v48
    v_accvgpr_write_b32 a113, v49
    v_accvgpr_write_b32 a114, v50
    v_accvgpr_write_b32 a115, v51
    v_accvgpr_write_b32 a116, v52
    v_accvgpr_write_b32 a117, v53
    v_accvgpr_write_b32 a118, v54
    v_accvgpr_write_b32 a119, v55
    v_mfma_f32_32x32x16_bf16 v[32:47], v[64:67], v[192:195], 0
    v_mfma_f32_32x32x16_bf16 v[32:47], v[68:71], v[196:199], v[32:47]
    s_add_u32 s49, s49, s100
    s_lshr_b32 s34, s49, 4
    s_and_b32 s49, s49, 15
    s_cmp_ge_u32 s34, 2
    s_cselect_b64 vcc, -1, 0
    s_cmp_lg_u32 s44, 24
    s_cbranch_scc1 L_nr24
    s_mov_b32 s3, 83200
    v_mov_b32 v246, 1
    s_mov_b64 exec, 1
    buffer_atomic_add v246, off, s[24:27], s3 sc0
    s_mov_b64 exec, -1
L_nr24:
    v_add_u32 v0, 1, v0
    s_mov_b64 exec, s[32:33]
    buffer_store_dword v0, v242, s[24:27], s35 offen
    s_mov_b64 exec, -1
    buffer_load_dword v244, v242, s[24:27], s35 offen sc1
    s_xor_b32 s57, s99, 786432
    s_add_u32 m0, s56, 0
    s_cbranch_vccnz L_w2_292
    s_bitcmp1_b32 s34, 0
    s_cbranch_scc1 L_w1_292
    s_waitcnt vmcnt(5)
L_w1_292:
    s_waitcnt vmcnt(6)
L_w2_292:
    s_waitcnt vmcnt(7)
    buffer_load_dwordx4 v8, s[4:7], s57 offen offset:0 nt lds
    v_mfma_f32_32x32x16_bf16 v[32:47], v[72:75], v[200:203], v[32:47]
    v_mfma_f32_32x32x16_bf16 v[32:47], v[76:79], v[204:207], v[32:47]
    v_mfma_f32_32x32x16_bf16 v[32:47], v[80:83], v[208:211], v[32:47]
    v_mfma_f32_32x32x16_bf16 v[32:47], v[84:87], v[212:215], v[32:47]
    s_cbranch_vccnz L_w2_293
    s_bitcmp1_b32 s34, 0
    s_cbranch_scc1 L_w1_293
    s_waitcnt vmcnt(5)
L_w1_293:
    s_waitcnt vmcnt(6)
L_w2_293:
    s_waitcnt vmcnt(7)
    buffer_load_dwordx4 v9, s[4:7], s57 offen offset:1024 nt lds
    v_mfma_f32_32x32x16_bf16 v[32:47], v[88:91], v[216:219], v[32:47]
    v_mfma_f32_32x32x16_bf16 v[32:47], v[92:95], v[220:223], v[32:47]
    s_nop 11
    v_max3_f32 v13, v32, v33, v34
    v_max3_f32 v31, v35, v36, v37
    v_max3_f32 v13, v13, v38, v39
    v_max3_f32 v31, v31, v40, v41
    v_max3_f32 v13, v13, v42, v43
    v_max3_f32 v31, v31, v44, v45
    v_max3_f32 v13, v13, v46, v47
    v_max3_f32 v13, v13, v31, v14
    v_mov_b32 v31, v13
    s_nop 1
    v_permlane32_swap_b32 v13, v31
    s_cbranch_vccnz L_w2_294
    s_bitcmp1_b32 s34, 0
    s_cbranch_scc1 L_w1_294
    s_waitcnt vmcnt(5)
L_w1_294:
    s_waitcnt vmcnt(6)
L_w2_294:
    s_waitcnt vmcnt(7)
    buffer_load_dwordx4 v10, s[4:7], s57 offen offset:2048 nt lds
    v_max_f32 v13, v13, v31
    v_sub_f32 v31, v14, v13
    v_mul_f32 v30, s60, v13
    v_mul_f32 v31, s60, v31
    v_mov_b32 v14, v13
    v_exp_f32 v176, v31
    v_pk_fma_f32 v[32:33], v[32:33], s[60:61], v[30:31] op_sel_hi:[1,0,0] neg_lo:[0,0,1] neg_hi:[0,0,1]
    v_pk_fma_f32 v[34:35], v[34:35], s[60:61], v[30:31] op_sel_hi:[1,0,0] neg_lo:[0,0,1] neg_hi:[0,0,1]
    v_pk_fma_f32 v[36:37], v[36:37], s[60:61], v[30:31] op_sel_hi:[1,0,0] neg_lo:[0,0,1] neg_hi:[0,0,1]
    v_pk_fma_f32 v[38:39], v[38:39], s[60:61], v[30:31] op_sel_hi:[1,0,0] neg_lo:[0,0,1] neg_hi:[0,0,1]
    v_pk_fma_f32 v[40:41], v[40:41], s[60:61], v[30:31] op_sel_hi:[1,0,0] neg_lo:[0,0,1] neg_hi:[0,0,1]
    v_pk_fma_f32 v[42:43], v[42:43], s[60:61], v[30:31] op_sel_hi:[1,0,0] neg_lo:[0,0,1] neg_hi:[0,0,1]
    v_pk_fma_f32 v[44:45], v[44:45], s[60:61], v[30:31] op_sel_hi:[1,0,0] neg_lo:[0,0,1] neg_hi:[0,0,1]
    v_pk_fma_f32 v[46:47], v[46:47], s[60:61], v[30:31] op_sel_hi:[1,0,0] neg_lo:[0,0,1] neg_hi:[0,0,1]
    v_mul_f32 v15, v15, v176
    v_exp_f32 v32, v32
    v_exp_f32 v33, v33
    v_exp_f32 v34, v34
    v_exp_f32 v35, v35
    v_exp_f32 v36, v36
    s_cbranch_vccnz L_w2_295
    s_bitcmp1_b32 s34, 0
    s_cbranch_scc1 L_w1_295
    s_waitcnt vmcnt(5)
L_w1_295:
    s_waitcnt vmcnt(6)
L_w2_295:
    s_waitcnt vmcnt(7)
    buffer_load_dwordx4 v11, s[4:7], s57 offen offset:3072 nt lds
    v_exp_f32 v37, v37
    v_exp_f32 v38, v38
    v_exp_f32 v39, v39
    v_exp_f32 v40, v40
    v_exp_f32 v41, v41
    v_exp_f32 v42, v42
    v_exp_f32 v43, v43
    v_exp_f32 v44, v44
    v_exp_f32 v45, v45
    v_exp_f32 v46, v46
    v_exp_f32 v47, v47
    v_pk_add_f32 v[2:3], v[32:33], v[34:35]
    v_pk_add_f32 v[4:5], v[36:37], v[38:39]
    v_pk_add_f32 v[2:3], v[2:3], v[40:41]
    v_pk_add_f32 v[4:5], v[4:5], v[42:43]
    s_add_u32 s49, s49, s100
    s_lshr_b32 s34, s49, 4
    s_and_b32 s49, s49, 15
    s_cmp_ge_u32 s34, 2
    s_cselect_b64 vcc, -1, 0
    s_xor_b32 s57, s99, 790528
    s_add_u32 m0, s56, 4096
    s_cbranch_vccnz L_w2_296
    s_bitcmp1_b32 s34, 0
    s_cbranch_scc1 L_w1_296
    s_waitcnt vmcnt(3)
L_w1_296:
    s_waitcnt vmcnt(6)
L_w2_296:
    s_waitcnt vmcnt(7)
    buffer_load_dwordx4 v8, s[4:7], s57 offen offset:0 nt lds
    v_pk_add_f32 v[2:3], v[2:3], v[44:45]
    v_pk_add_f32 v[4:5], v[4:5], v[46:47]
    v_pk_add_f32 v[2:3], v[2:3], v[4:5]
    v_add_f32 v2, v2, v3
    v_add_f32 v15, v15, v2
    v_cvt_pk_bf16_f32 v48, v32, v33
    v_cvt_pk_bf16_f32 v49, v34, v35
    v_cvt_pk_bf16_f32 v50, v36, v37
    v_cvt_pk_bf16_f32 v51, v38, v39
    v_cvt_pk_bf16_f32 v52, v40, v41
    v_cvt_pk_bf16_f32 v53, v42, v43
    v_cvt_pk_bf16_f32 v54, v44, v45
    v_cvt_pk_bf16_f32 v55, v46, v47
    v_accvgpr_write_b32 a120, v48
    v_accvgpr_write_b32 a121, v49
    v_accvgpr_write_b32 a122, v50
    v_accvgpr_write_b32 a123, v51
    v_accvgpr_write_b32 a124, v52
    v_accvgpr_write_b32 a125, v53
    v_accvgpr_write_b32 a126, v54
    v_accvgpr_write_b32 a127, v55
    v_mfma_f32_32x32x16_bf16 v[32:47], a[128:131], v[192:195], 0
    s_cbranch_vccnz L_w2_297
    s_bitcmp1_b32 s34, 0
    s_cbranch_scc1 L_w1_297
    s_waitcnt vmcnt(3)
L_w1_297:
    s_waitcnt vmcnt(4)
L_w2_297:
    s_waitcnt vmcnt(7)
    buffer_load_dwordx4 v9, s[4:7], s57 offen offset:1024 nt lds
    v_mfma_f32_32x32x16_bf16 v[32:47], a[132:135], v[196:199], v[32:47]
    v_mfma_f32_32x32x16_bf16 v[32:47], a[136:139], v[200:203], v[32:47]
    v_mfma_f32_32x32x16_bf16 v[32:47], a[140:143], v[204:207], v[32:47]
    v_mfma_f32_32x32x16_bf16 v[32:47], a[144:147], v[208:211], v[32:47]
    s_cbranch_vccnz L_w2_298
    s_bitcmp1_b32 s34, 0
    s_cbranch_scc1 L_w1_298
    s_waitcnt vmcnt(3)
L_w1_298:
    s_waitcnt vmcnt(4)
L_w2_298:
    s_waitcnt vmcnt(5)
    buffer_load_dwordx4 v10, s[4:7], s57 offen offset:2048 nt lds
    v_mfma_f32_32x32x16_bf16 v[32:47], a[148:151], v[212:215], v[32:47]
    v_mfma_f32_32x32x16_bf16 v[32:47], a[152:155], v[216:219], v[32:47]
    v_mfma_f32_32x32x16_bf16 v[32:47], a[156:159], v[220:223], v[32:47]
    s_nop 11
    v_max3_f32 v13, v32, v33, v34
    v_max3_f32 v31, v35, v36, v37
    s_cbranch_vccnz L_w2_299
    s_bitcmp1_b32 s34, 0
    s_cbranch_scc1 L_w1_299
    s_waitcnt vmcnt(3)
L_w1_299:
    s_waitcnt vmcnt(4)
L_w2_299:
    s_waitcnt vmcnt(5)
    buffer_load_dwordx4 v11, s[4:7], s57 offen offset:3072 nt lds
    v_max3_f32 v13, v13, v38, v39
    v_max3_f32 v31, v31, v40, v41
    v_max3_f32 v13, v13, v42, v43
    v_max3_f32 v31, v31, v44, v45
    v_max3_f32 v13, v13, v46, v47
    v_max3_f32 v13, v13, v31, v14
    v_mov_b32 v31, v13
    s_nop 1
    v_permlane32_swap_b32 v13, v31
    v_max_f32 v13, v13, v31
    v_sub_f32 v31, v14, v13
    v_mul_f32 v30, s60, v13
    v_mul_f32 v31, s60, v31
    v_mov_b32 v14, v13
    v_exp_f32 v177, v31
    v_pk_fma_f32 v[32:33], v[32:33], s[60:61], v[30:31] op_sel_hi:[1,0,0] neg_lo:[0,0,1] neg_hi:[0,0,1]
    v_pk_fma_f32 v[34:35], v[34:35], s[60:61], v[30:31] op_sel_hi:[1,0,0] neg_lo:[0,0,1] neg_hi:[0,0,1]
    v_pk_fma_f32 v[36:37], v[36:37], s[60:61], v[30:31] op_sel_hi:[1,0,0] neg_lo:[0,0,1] neg_hi:[0,0,1]
    v_pk_fma_f32 v[38:39], v[38:39], s[60:61], v[30:31] op_sel_hi:[1,0,0] neg_lo:[0,0,1] neg_hi:[0,0,1]
    v_pk_fma_f32 v[40:41], v[40:41], s[60:61], v[30:31] op_sel_hi:[1,0,0] neg_lo:[0,0,1] neg_hi:[0,0,1]
    v_pk_fma_f32 v[42:43], v[42:43], s[60:61], v[30:31] op_sel_hi:[1,0,0] neg_lo:[0,0,1] neg_hi:[0,0,1]
    v_pk_fma_f32 v[44:45], v[44:45], s[60:61], v[30:31] op_sel_hi:[1,0,0] neg_lo:[0,0,1] neg_hi:[0,0,1]
    v_pk_fma_f32 v[46:47], v[46:47], s[60:61], v[30:31] op_sel_hi:[1,0,0] neg_lo:[0,0,1] neg_hi:[0,0,1]
    v_mul_f32 v15, v15, v177
    v_exp_f32 v32, v32
    s_cmp_lg_u32 s44, 24
    s_cbranch_scc1 L_nc24
    v_sub_u32 v247, v246, v245
    v_lshlrev_b32 v246, 8, v254
    v_readfirstlane_b32 s3, v247
    s_nop 0
    s_min_u32 s3, s3, 7
    s_mul_i32 s3, s3, 6
    s_add_u32 s3, s3, s45
    v_mov_b32 v247, s3
    s_and_b32 s3, s35, 0xfffffcff
    s_mov_b64 exec, 15
    buffer_store_dword v247, v246, s[24:27], s3 offen offset:128
    s_mov_b64 exec, -1
L_nc24:
    v_sub_u32 v244, v244, v0
    v_cmp_gt_u32 s[100:101], 64, v244
    v_readlane_b32 s46, v244, 32
    s_bcnt1_i32_b32 s3, s100
    s_mul_i32 s3, s3, 3
    s_add_u32 s46, s46, 6
    s_cmp_lt_u32 s46, 128
    s_cselect_b32 s46, s46, 21
    s_add_u32 s3, s3, s46
    s_ashr_i32 s3, s3, 2
    s_add_i32 s3, s3, 2
    s_max_i32 s3, s3, 8
    s_min_i32 s100, s3, 32
    s_add_u32 s49, s49, s100
    s_lshr_b32 s34, s49, 4
    s_and_b32 s49, s49, 15
    s_cmp_ge_u32 s34, 2
    s_cselect_b64 vcc, -1, 0
    s_xor_b32 s57, s99, 802816
    s_add_u32 m0, s56, 8192
    s_cbranch_vccnz L_w2_300
    s_bitcmp1_b32 s34, 0
    s_cbranch_scc1 L_w1_300
    s_waitcnt vmcnt(3)
L_w1_300:
    s_waitcnt vmcnt(4)
L_w2_300:
    s_waitcnt vmcnt(5)
    buffer_load_dwordx4 v8, s[4:7], s57 offen offset:0 nt lds
    v_exp_f32 v33, v33
    v_exp_f32 v34, v34
    v_exp_f32 v35, v35
    v_exp_f32 v36, v36
    v_exp_f32 v37, v37
    v_exp_f32 v38, v38
    v_exp_f32 v39, v39
    v_exp_f32 v40, v40
    v_exp_f32 v41, v41
    v_exp_f32 v42, v42
    v_exp_f32 v43, v43
    v_exp_f32 v44, v44
    v_exp_f32 v45, v45
    s_cbranch_vccnz L_w2_301
    s_bitcmp1_b32 s34, 0
    s_cbranch_scc1 L_w1_301
    s_waitcnt vmcnt(3)
L_w1_301:
    s_waitcnt vmcnt(4)
L_w2_301:
    s_waitcnt vmcnt(5)
    buffer_load_dwordx4 v9, s[4:7], s57 offen offset:1024 nt lds
    v_exp_f32 v46, v46
    v_exp_f32 v47, v47
    v_pk_add_f32 v[2:3], v[32:33], v[34:35]
    v_pk_add_f32 v[4:5], v[36:37], v[38:39]
    v_pk_add_f32 v[2:3], v[2:3], v[40:41]
    v_pk_add_f32 v[4:5], v[4:5], v[42:43]
    v_pk_add_f32 v[2:3], v[2:3], v[44:45]
    v_pk_add_f32 v[4:5], v[4:5], v[46:47]
    v_pk_add_f32 v[2:3], v[2:3], v[4:5]
    v_add_f32 v2, v2, v3
    v_add_f32 v15, v15, v2
    v_cvt_pk_bf16_f32 v48, v32, v33
    v_cvt_pk_bf16_f32 v49, v34, v35
    v_cvt_pk_bf16_f32 v50, v36, v37
    v_cvt_pk_bf16_f32 v51, v38, v39
    v_cvt_pk_bf16_f32 v52, v40, v41
    v_cvt_pk_bf16_f32 v53, v42, v43
    v_cvt_pk_bf16_f32 v54, v44, v45
    v_cvt_pk_bf16_f32 v55, v46, v47
    v_accvgpr_write_b32 a128, v48
    v_accvgpr_write_b32 a129, v49
    v_accvgpr_write_b32 a130, v50
    v_accvgpr_write_b32 a131, v51
    v_accvgpr_write_b32 a132, v52
    s_cbranch_vccnz L_w2_302
    s_bitcmp1_b32 s34, 0
    s_cbranch_scc1 L_w1_302
    s_waitcnt vmcnt(3)
L_w1_302:
    s_waitcnt vmcnt(4)
L_w2_302:
    s_waitcnt vmcnt(5)
    buffer_load_dwordx4 v10, s[4:7], s57 offen offset:2048 nt lds
    v_accvgpr_write_b32 a133, v53
    v_accvgpr_write_b32 a134, v54
    v_accvgpr_write_b32 a135, v55
    v_mfma_f32_32x32x16_bf16 v[32:47], v[128:131], v[192:195], 0
    v_mfma_f32_32x32x16_bf16 v[32:47], v[132:135], v[196:199], v[32:47]
    v_mfma_f32_32x32x16_bf16 v[32:47], v[136:139], v[200:203], v[32:47]
    s_cbranch_vccnz L_w2_303
    s_bitcmp1_b32 s34, 0
    s_cbranch_scc1 L_w1_303
    s_waitcnt vmcnt(3)
L_w1_303:
    s_waitcnt vmcnt(4)
L_w2_303:
    s_waitcnt vmcnt(5)
    buffer_load_dwordx4 v11, s[4:7], s57 offen offset:3072 nt lds
    v_mfma_f32_32x32x16_bf16 v[32:47], v[140:143], v[204:207], v[32:47]
    v_mfma_f32_32x32x16_bf16 v[32:47], v[144:147], v[208:211], v[32:47]
    v_mfma_f32_32x32x16_bf16 v[32:47], v[148:151], v[212:215], v[32:47]
    v_mfma_f32_32x32x16_bf16 v[32:47], v[152:155], v[216:219], v[32:47]
    s_add_u32 s49, s49, s100
    s_lshr_b32 s34, s49, 4
    s_and_b32 s49, s49, 15
    s_cmp_ge_u32 s34, 2
    s_cselect_b64 vcc, -1, 0
    s_xor_b32 s57, s99, 806912
    s_add_u32 m0, s56, 12288
    s_cbranch_vccnz L_w2_304
    s_bitcmp1_b32 s34, 0
    s_cbranch_scc1 L_w1_304
    s_waitcnt vmcnt(3)
L_w1_304:
    s_waitcnt vmcnt(4)
L_w2_304:
    s_waitcnt vmcnt(5)
    buffer_load_dwordx4 v8, s[4:7], s57 offen offset:0 nt lds
    v_mfma_f32_32x32x16_bf16 v[32:47], v[156:159], v[220:223], v[32:47]
    ds_read_b128 v[128:131], v16 offset:16384
    ds_read_b128 v[132:135], v17 offset:16384
    ds_read_b128 v[136:139], v18 offset:16384
    ds_read_b128 v[140:143], v19 offset:16384
    ds_read_b128 v[144:147], v20 offset:16384
    ds_read_b128 v[148:151], v21 offset:16384
    ds_read_b128 v[152:155], v22 offset:16384
    ds_read_b128 v[156:159], v23 offset:16384
    s_nop 3
    v_max3_f32 v13, v32, v33, v34
    v_max3_f32 v31, v35, v36, v37
    v_max3_f32 v13, v13, v38, v39
    v_max3_f32 v31, v31, v40, v41
    v_max3_f32 v13, v13, v42, v43
    v_max3_f32 v31, v31, v44, v45
    v_max3_f32 v13, v13, v46, v47
    v_max3_f32 v13, v13, v31, v14
    v_mov_b32 v31, v13
    s_nop 1
    v_permlane32_swap_b32 v13, v31
    v_max_f32 v13, v13, v31
    v_sub_f32 v31, v14, v13
    v_mul_f32 v30, s60, v13
    v_mul_f32 v31, s60, v31
    v_mov_b32 v14, v13
    v_exp_f32 v178, v31
    s_waitcnt lgkmcnt(0)
    v_pk_fma_f32 v[32:33], v[32:33], s[60:61], v[30:31] op_sel_hi:[1,0,0] neg_lo:[0,0,1] neg_hi:[0,0,1]
    s_cbranch_vccnz L_w2_305
    s_bitcmp1_b32 s34, 0
    s_cbranch_scc1 L_w1_305
    s_waitcnt vmcnt(3)
L_w1_305:
    s_waitcnt vmcnt(4)
L_w2_305:
    s_waitcnt vmcnt(5)
    buffer_load_dwordx4 v9, s[4:7], s57 offen offset:1024 nt lds
    v_pk_fma_f32 v[34:35], v[34:35], s[60:61], v[30:31] op_sel_hi:[1,0,0] neg_lo:[0,0,1] neg_hi:[0,0,1]
    v_pk_fma_f32 v[36:37], v[36:37], s[60:61], v[30:31] op_sel_hi:[1,0,0] neg_lo:[0,0,1] neg_hi:[0,0,1]
    v_pk_fma_f32 v[38:39], v[38:39], s[60:61], v[30:31] op_sel_hi:[1,0,0] neg_lo:[0,0,1] neg_hi:[0,0,1]
    v_pk_fma_f32 v[40:41], v[40:41], s[60:61], v[30:31] op_sel_hi:[1,0,0] neg_lo:[0,0,1] neg_hi:[0,0,1]
    v_pk_fma_f32 v[42:43], v[42:43], s[60:61], v[30:31] op_sel_hi:[1,0,0] neg_lo:[0,0,1] neg_hi:[0,0,1]
    v_pk_fma_f32 v[44:45], v[44:45], s[60:61], v[30:31] op_sel_hi:[1,0,0] neg_lo:[0,0,1] neg_hi:[0,0,1]
    v_pk_fma_f32 v[46:47], v[46:47], s[60:61], v[30:31] op_sel_hi:[1,0,0] neg_lo:[0,0,1] neg_hi:[0,0,1]
    v_mul_f32 v15, v15, v178
    v_exp_f32 v32, v32
    v_exp_f32 v33, v33
    v_exp_f32 v34, v34
    v_exp_f32 v35, v35
    v_exp_f32 v36, v36
    v_exp_f32 v37, v37
    v_exp_f32 v38, v38
    v_exp_f32 v39, v39
    v_exp_f32 v40, v40
    s_cbranch_vccnz L_w2_306
    s_bitcmp1_b32 s34, 0
    s_cbranch_scc1 L_w1_306
    s_waitcnt vmcnt(3)
L_w1_306:
    s_waitcnt vmcnt(4)
L_w2_306:
    s_waitcnt vmcnt(5)
    buffer_load_dwordx4 v10, s[4:7], s57 offen offset:2048 nt lds
    v_exp_f32 v41, v41
    v_exp_f32 v42, v42
    v_exp_f32 v43, v43
    v_exp_f32 v44, v44
    v_exp_f32 v45, v45
    v_exp_f32 v46, v46
    v_exp_f32 v47, v47
    v_pk_add_f32 v[2:3], v[32:33], v[34:35]
    v_pk_add_f32 v[4:5], v[36:37], v[38:39]
    v_pk_add_f32 v[2:3], v[2:3], v[40:41]
    v_pk_add_f32 v[4:5], v[4:5], v[42:43]
    v_pk_add_f32 v[2:3], v[2:3], v[44:45]
    v_pk_add_f32 v[4:5], v[4:5], v[46:47]
    v_pk_add_f32 v[2:3], v[2:3], v[4:5]
    v_add_f32 v2, v2, v3
    v_add_f32 v15, v15, v2
    v_cvt_pk_bf16_f32 v48, v32, v33
    v_cvt_pk_bf16_f32 v49, v34, v35
    v_cvt_pk_bf16_f32 v50, v36, v37
    s_cbranch_vccnz L_w2_307
    s_bitcmp1_b32 s34, 0
    s_cbranch_scc1 L_w1_307
    s_waitcnt vmcnt(3)
L_w1_307:
    s_waitcnt vmcnt(4)
L_w2_307:
    s_waitcnt vmcnt(5)
    buffer_load_dwordx4 v11, s[4:7], s57 offen offset:3072 nt lds
    v_cvt_pk_bf16_f32 v51, v38, v39
    v_cvt_pk_bf16_f32 v52, v40, v41
    v_cvt_pk_bf16_f32 v53, v42, v43
    v_cvt_pk_bf16_f32 v54, v44, v45
    v_cvt_pk_bf16_f32 v55, v46, v47
    v_accvgpr_write_b32 a136, v48
    v_accvgpr_write_b32 a137, v49
    v_accvgpr_write_b32 a138, v50
    v_accvgpr_write_b32 a139, v51
    v_accvgpr_write_b32 a140, v52
    v_accvgpr_write_b32 a141, v53
    v_accvgpr_write_b32 a142, v54
    v_accvgpr_write_b32 a143, v55
    v_mfma_f32_32x32x16_bf16 v[32:47], v[128:131], v[192:195], 0
    v_mfma_f32_32x32x16_bf16 v[32:47], v[132:135], v[196:199], v[32:47]
    s_add_u32 s49, s49, s100
    s_lshr_b32 s34, s49, 4
    s_and_b32 s49, s49, 15
    s_cmp_ge_u32 s34, 2
    s_cselect_b64 vcc, -1, 0
    s_cmp_lg_u32 s44, 26
    s_cbranch_scc1 L_nr26
    s_mov_b32 s3, 83456
    v_mov_b32 v246, 1
    s_mov_b64 exec, 1
    buffer_atomic_add v246, off, s[24:27], s3 sc0
    s_mov_b64 exec, -1
L_nr26:
    v_add_u32 v0, 1, v0
    s_mov_b64 exec, s[32:33]
    buffer_store_dword v0, v242, s[24:27], s35 offen
    s_mov_b64 exec, -1
    buffer_load_dword v244, v242, s[24:27], s35 offen sc1
    s_xor_b32 s57, s99, 851968
    s_add_u32 m0, s56, 16384
    s_cbranch_vccnz L_w2_310
    s_bitcmp1_b32 s34, 0
    s_cbranch_scc1 L_w1_310
    s_waitcnt vmcnt(5)
L_w1_310:
    s_waitcnt vmcnt(6)
L_w2_310:
    s_waitcnt vmcnt(7)
    buffer_load_dwordx4 v8, s[4:7], s57 offen offset:0 nt lds
    v_mfma_f32_32x32x16_bf16 v[32:47], v[136:139], v[200:203], v[32:47]
    v_mfma_f32_32x32x16_bf16 v[32:47], v[140:143], v[204:207], v[32:47]
    v_mfma_f32_32x32x16_bf16 v[32:47], v[144:147], v[208:211], v[32:47]
    v_mfma_f32_32x32x16_bf16 v[32:47], v[148:151], v[212:215], v[32:47]
    s_cbranch_vccnz L_w2_311
    s_bitcmp1_b32 s34, 0
    s_cbranch_scc1 L_w1_311
    s_waitcnt vmcnt(5)
L_w1_311:
    s_waitcnt vmcnt(6)
L_w2_311:
    s_waitcnt vmcnt(7)
    buffer_load_dwordx4 v9, s[4:7], s57 offen offset:1024 nt lds
    v_mfma_f32_32x32x16_bf16 v[32:47], v[152:155], v[216:219], v[32:47]
    v_mfma_f32_32x32x16_bf16 v[32:47], v[156:159], v[220:223], v[32:47]
    ds_read_b128 v[128:131], v16 offset:24576
    ds_read_b128 v[132:135], v17 offset:24576
    ds_read_b128 v[136:139], v18 offset:24576
    ds_read_b128 v[140:143], v19 offset:24576
    ds_read_b128 v[144:147], v20 offset:24576
    ds_read_b128 v[148:151], v21 offset:24576
    ds_read_b128 v[152:155], v22 offset:24576
    ds_read_b128 v[156:159], v23 offset:24576
    s_nop 3
    v_max3_f32 v13, v32, v33, v34
    v_max3_f32 v31, v35, v36, v37
    v_max3_f32 v13, v13, v38, v39
    v_max3_f32 v31, v31, v40, v41
    v_max3_f32 v13, v13, v42, v43
    v_max3_f32 v31, v31, v44, v45
    v_max3_f32 v13, v13, v46, v47
    v_max3_f32 v13, v13, v31, v14
    v_mov_b32 v31, v13
    s_nop 1
    v_permlane32_swap_b32 v13, v31
    s_cbranch_vccnz L_w2_312
    s_bitcmp1_b32 s34, 0
    s_cbranch_scc1 L_w1_312
    s_waitcnt vmcnt(5)
L_w1_312:
    s_waitcnt vmcnt(6)
L_w2_312:
    s_waitcnt vmcnt(7)
    buffer_load_dwordx4 v10, s[4:7], s57 offen offset:2048 nt lds
    v_max_f32 v13, v13, v31
    v_sub_f32 v31, v14, v13
    v_mul_f32 v30, s60, v13
    v_mul_f32 v31, s60, v31
    v_mov_b32 v14, v13
    v_exp_f32 v179, v31
    s_waitcnt lgkmcnt(0)
    v_pk_fma_f32 v[32:33], v[32:33], s[60:61], v[30:31] op_sel_hi:[1,0,0] neg_lo:[0,0,1] neg_hi:[0,0,1]
    v_pk_fma_f32 v[34:35], v[34:35], s[60:61], v[30:31] op_sel_hi:[1,0,0] neg_lo:[0,0,1] neg_hi:[0,0,1]
    v_pk_fma_f32 v[36:37], v[36:37], s[60:61], v[30:31] op_sel_hi:[1,0,0] neg_lo:[0,0,1] neg_hi:[0,0,1]
    v_pk_fma_f32 v[38:39], v[38:39], s[60:61], v[30:31] op_sel_hi:[1,0,0] neg_lo:[0,0,1] neg_hi:[0,0,1]
    v_pk_fma_f32 v[40:41], v[40:41], s[60:61], v[30:31] op_sel_hi:[1,0,0] neg_lo:[0,0,1] neg_hi:[0,0,1]
    v_pk_fma_f32 v[42:43], v[42:43], s[60:61], v[30:31] op_sel_hi:[1,0,0] neg_lo:[0,0,1] neg_hi:[0,0,1]
    v_pk_fma_f32 v[44:45], v[44:45], s[60:61], v[30:31] op_sel_hi:[1,0,0] neg_lo:[0,0,1] neg_hi:[0,0,1]
    v_pk_fma_f32 v[46:47], v[46:47], s[60:61], v[30:31] op_sel_hi:[1,0,0] neg_lo:[0,0,1] neg_hi:[0,0,1]
    v_mul_f32 v15, v15, v179
    v_exp_f32 v32, v32
    v_exp_f32 v33, v33
    v_exp_f32 v34, v34
    v_exp_f32 v35, v35
    v_exp_f32 v36, v36
    s_cbranch_vccnz L_w2_313
    s_bitcmp1_b32 s34, 0
    s_cbranch_scc1 L_w1_313
    s_waitcnt vmcnt(5)
L_w1_313:
    s_waitcnt vmcnt(6)
L_w2_313:
    s_waitcnt vmcnt(7)
    buffer_load_dwordx4 v11, s[4:7], s57 offen offset:3072 nt lds
    v_exp_f32 v37, v37
    v_exp_f32 v38, v38
    v_exp_f32 v39, v39
    v_exp_f32 v40, v40
    v_exp_f32 v41, v41
    v_exp_f32 v42, v42
    v_exp_f32 v43, v43
    v_exp_f32 v44, v44
    v_exp_f32 v45, v45
    v_exp_f32 v46, v46
    v_exp_f32 v47, v47
    v_pk_add_f32 v[2:3], v[32:33], v[34:35]
    v_pk_add_f32 v[4:5], v[36:37], v[38:39]
    v_pk_add_f32 v[2:3], v[2:3], v[40:41]
    v_pk_add_f32 v[4:5], v[4:5], v[42:43]
    s_add_u32 s49, s49, s100
    s_lshr_b32 s34, s49, 4
    s_and_b32 s49, s49, 15
    s_cmp_ge_u32 s34, 2
    s_cselect_b64 vcc, -1, 0
    s_xor_b32 s57, s99, 856064
    s_add_u32 m0, s56, 20480
    s_cbranch_vccnz L_w2_314
    s_bitcmp1_b32 s34, 0
    s_cbranch_scc1 L_w1_314
    s_waitcnt vmcnt(3)
L_w1_314:
    s_waitcnt vmcnt(6)
L_w2_314:
    s_waitcnt vmcnt(7)
    buffer_load_dwordx4 v8, s[4:7], s57 offen offset:0 nt lds
    v_pk_add_f32 v[2:3], v[2:3], v[44:45]
    v_pk_add_f32 v[4:5], v[4:5], v[46:47]
    v_pk_add_f32 v[2:3], v[2:3], v[4:5]
    v_add_f32 v2, v2, v3
    v_add_f32 v15, v15, v2
    v_cvt_pk_bf16_f32 v48, v32, v33
    v_cvt_pk_bf16_f32 v49, v34, v35
    v_cvt_pk_bf16_f32 v50, v36, v37
    v_cvt_pk_bf16_f32 v51, v38, v39
    v_cvt_pk_bf16_f32 v52, v40, v41
    v_cvt_pk_bf16_f32 v53, v42, v43
    v_cvt_pk_bf16_f32 v54, v44, v45
    v_cvt_pk_bf16_f32 v55, v46, v47
    v_accvgpr_write_b32 a144, v48
    v_accvgpr_write_b32 a145, v49
    v_accvgpr_write_b32 a146, v50
    v_accvgpr_write_b32 a147, v51
    v_accvgpr_write_b32 a148, v52
    v_accvgpr_write_b32 a149, v53
    v_accvgpr_write_b32 a150, v54
    v_accvgpr_write_b32 a151, v55
    v_mfma_f32_32x32x16_bf16 v[32:47], v[128:131], v[192:195], 0
    s_cbranch_vccnz L_w2_315
    s_bitcmp1_b32 s34, 0
    s_cbranch_scc1 L_w1_315
    s_waitcnt vmcnt(3)
L_w1_315:
    s_waitcnt vmcnt(4)
L_w2_315:
    s_waitcnt vmcnt(7)
    buffer_load_dwordx4 v9, s[4:7], s57 offen offset:1024 nt lds
    v_mfma_f32_32x32x16_bf16 v[32:47], v[132:135], v[196:199], v[32:47]
    v_mfma_f32_32x32x16_bf16 v[32:47], v[136:139], v[200:203], v[32:47]
    v_mfma_f32_32x32x16_bf16 v[32:47], v[140:143], v[204:207], v[32:47]
    v_mfma_f32_32x32x16_bf16 v[32:47], v[144:147], v[208:211], v[32:47]
    s_cbranch_vccnz L_w2_316
    s_bitcmp1_b32 s34, 0
    s_cbranch_scc1 L_w1_316
    s_waitcnt vmcnt(3)
L_w1_316:
    s_waitcnt vmcnt(4)
L_w2_316:
    s_waitcnt vmcnt(5)
    buffer_load_dwordx4 v10, s[4:7], s57 offen offset:2048 nt lds
    v_mfma_f32_32x32x16_bf16 v[32:47], v[148:151], v[212:215], v[32:47]
    v_mfma_f32_32x32x16_bf16 v[32:47], v[152:155], v[216:219], v[32:47]
    v_mfma_f32_32x32x16_bf16 v[32:47], v[156:159], v[220:223], v[32:47]
    ds_read_b128 v[128:131], v16 offset:0
    ds_read_b128 v[132:135], v17 offset:0
    ds_read_b128 v[136:139], v18 offset:0
    ds_read_b128 v[140:143], v19 offset:0
    ds_read_b128 v[144:147], v20 offset:0
    ds_read_b128 v[148:151], v21 offset:0
    ds_read_b128 v[152:155], v22 offset:0
    ds_read_b128 v[156:159], v23 offset:0
    s_nop 3
    v_max3_f32 v13, v32, v33, v34
    v_max3_f32 v31, v35, v36, v37
    s_cbranch_vccnz L_w2_317
    s_bitcmp1_b32 s34, 0
    s_cbranch_scc1 L_w1_317
    s_waitcnt vmcnt(3)
L_w1_317:
    s_waitcnt vmcnt(4)
L_w2_317:
    s_waitcnt vmcnt(5)
    buffer_load_dwordx4 v11, s[4:7], s57 offen offset:3072 nt lds
    v_max3_f32 v13, v13, v38, v39
    v_max3_f32 v31, v31, v40, v41
    v_max3_f32 v13, v13, v42, v43
    v_max3_f32 v31, v31, v44, v45
    v_max3_f32 v13, v13, v46, v47
    v_max3_f32 v13, v13, v31, v14
    v_mov_b32 v31, v13
    s_nop 1
    v_permlane32_swap_b32 v13, v31
    v_max_f32 v13, v13, v31
    v_sub_f32 v31, v14, v13
    v_mul_f32 v30, s60, v13
    v_mul_f32 v31, s60, v31
    v_mov_b32 v14, v13
    v_exp_f32 v180, v31
    s_waitcnt lgkmcnt(0)
    v_pk_fma_f32 v[32:33], v[32:33], s[60:61], v[30:31] op_sel_hi:[1,0,0] neg_lo:[0,0,1] neg_hi:[0,0,1]
    v_pk_fma_f32 v[34:35], v[34:35], s[60:61], v[30:31] op_sel_hi:[1,0,0] neg_lo:[0,0,1] neg_hi:[0,0,1]
    v_pk_fma_f32 v[36:37], v[36:37], s[60:61], v[30:31] op_sel_hi:[1,0,0] neg_lo:[0,0,1] neg_hi:[0,0,1]
    v_pk_fma_f32 v[38:39], v[38:39], s[60:61], v[30:31] op_sel_hi:[1,0,0] neg_lo:[0,0,1] neg_hi:[0,0,1]
    v_pk_fma_f32 v[40:41], v[40:41], s[60:61], v[30:31] op_sel_hi:[1,0,0] neg_lo:[0,0,1] neg_hi:[0,0,1]
    v_pk_fma_f32 v[42:43], v[42:43], s[60:61], v[30:31] op_sel_hi:[1,0,0] neg_lo:[0,0,1] neg_hi:[0,0,1]
    v_pk_fma_f32 v[44:45], v[44:45], s[60:61], v[30:31] op_sel_hi:[1,0,0] neg_lo:[0,0,1] neg_hi:[0,0,1]
    v_pk_fma_f32 v[46:47], v[46:47], s[60:61], v[30:31] op_sel_hi:[1,0,0] neg_lo:[0,0,1] neg_hi:[0,0,1]
    v_mul_f32 v15, v15, v180
    v_exp_f32 v32, v32
    s_cmp_lg_u32 s44, 26
    s_cbranch_scc1 L_nc26
    v_sub_u32 v247, v246, v245
    v_lshlrev_b32 v246, 8, v254
    v_readfirstlane_b32 s3, v247
    s_nop 0
    s_min_u32 s3, s3, 7
    s_mul_i32 s3, s3, 6
    s_add_u32 s3, s3, s45
    v_mov_b32 v247, s3
    s_and_b32 s3, s35, 0xfffffcff
    s_mov_b64 exec, 15
    buffer_store_dword v247, v246, s[24:27], s3 offen offset:128
    s_mov_b64 exec, -1
L_nc26:
    v_sub_u32 v244, v244, v0
    v_cmp_gt_u32 s[100:101], 64, v244
    v_readlane_b32 s46, v244, 32
    s_bcnt1_i32_b32 s3, s100
    s_mul_i32 s3, s3, 3
    s_add_u32 s46, s46, 7
    s_cmp_lt_u32 s46, 128
    s_cselect_b32 s46, s46, 21
    s_add_u32 s3, s3, s46
    s_ashr_i32 s3, s3, 2
    s_add_i32 s3, s3, 2
    s_max_i32 s3, s3, 8
    s_min_i32 s100, s3, 32
    s_add_u32 s49, s49, s100
    s_lshr_b32 s34, s49, 4
    s_and_b32 s49, s49, 15
    s_cmp_ge_u32 s34, 2
    s_cselect_b64 vcc, -1, 0
    s_xor_b32 s57, s99, 868352
    s_add_u32 m0, s56, 24576
    s_cbranch_vccnz L_w2_318
    s_bitcmp1_b32 s34, 0
    s_cbranch_scc1 L_w1_318
    s_waitcnt vmcnt(3)
L_w1_318:
    s_waitcnt vmcnt(4)
L_w2_318:
    s_waitcnt vmcnt(5)
    buffer_load_dwordx4 v8, s[4:7], s57 offen offset:0 nt lds
    v_exp_f32 v33, v33
    v_exp_f32 v34, v34
    v_exp_f32 v35, v35
    v_exp_f32 v36, v36
    v_exp_f32 v37, v37
    v_exp_f32 v38, v38
    v_exp_f32 v39, v39
    v_exp_f32 v40, v40
    v_exp_f32 v41, v41
    v_exp_f32 v42, v42
    v_exp_f32 v43, v43
    v_exp_f32 v44, v44
    v_exp_f32 v45, v45
    s_cbranch_vccnz L_w2_319
    s_bitcmp1_b32 s34, 0
    s_cbranch_scc1 L_w1_319
    s_waitcnt vmcnt(3)
L_w1_319:
    s_waitcnt vmcnt(4)
L_w2_319:
    s_waitcnt vmcnt(5)
    buffer_load_dwordx4 v9, s[4:7], s57 offen offset:1024 nt lds
    v_exp_f32 v46, v46
    v_exp_f32 v47, v47
    v_pk_add_f32 v[2:3], v[32:33], v[34:35]
    v_pk_add_f32 v[4:5], v[36:37], v[38:39]
    v_pk_add_f32 v[2:3], v[2:3], v[40:41]
    v_pk_add_f32 v[4:5], v[4:5], v[42:43]
    v_pk_add_f32 v[2:3], v[2:3], v[44:45]
    v_pk_add_f32 v[4:5], v[4:5], v[46:47]
    v_pk_add_f32 v[2:3], v[2:3], v[4:5]
    v_add_f32 v2, v2, v3
    v_add_f32 v15, v15, v2
    v_cvt_pk_bf16_f32 v48, v32, v33
    v_cvt_pk_bf16_f32 v49, v34, v35
    v_cvt_pk_bf16_f32 v50, v36, v37
    v_cvt_pk_bf16_f32 v51, v38, v39
    v_cvt_pk_bf16_f32 v52, v40, v41
    v_cvt_pk_bf16_f32 v53, v42, v43
    v_cvt_pk_bf16_f32 v54, v44, v45
    v_cvt_pk_bf16_f32 v55, v46, v47
    v_accvgpr_write_b32 a152, v48
    v_accvgpr_write_b32 a153, v49
    v_accvgpr_write_b32 a154, v50
    v_accvgpr_write_b32 a155, v51
    v_accvgpr_write_b32 a156, v52
    s_cbranch_vccnz L_w2_320
    s_bitcmp1_b32 s34, 0
    s_cbranch_scc1 L_w1_320
    s_waitcnt vmcnt(3)
L_w1_320:
    s_waitcnt vmcnt(4)
L_w2_320:
    s_waitcnt vmcnt(5)
    buffer_load_dwordx4 v10, s[4:7], s57 offen offset:2048 nt lds
    v_accvgpr_write_b32 a157, v53
    v_accvgpr_write_b32 a158, v54
    v_accvgpr_write_b32 a159, v55
    v_mfma_f32_32x32x16_bf16 v[32:47], a[160:163], v[192:195], 0
    v_mfma_f32_32x32x16_bf16 v[32:47], a[164:167], v[196:199], v[32:47]
    v_mfma_f32_32x32x16_bf16 v[32:47], a[168:171], v[200:203], v[32:47]
    s_cbranch_vccnz L_w2_321
    s_bitcmp1_b32 s34, 0
    s_cbranch_scc1 L_w1_321
    s_waitcnt vmcnt(3)
L_w1_321:
    s_waitcnt vmcnt(4)
L_w2_321:
    s_waitcnt vmcnt(5)
    buffer_load_dwordx4 v11, s[4:7], s57 offen offset:3072 nt lds
    v_mfma_f32_32x32x16_bf16 v[32:47], a[172:175], v[204:207], v[32:47]
    v_mfma_f32_32x32x16_bf16 v[32:47], a[176:179], v[208:211], v[32:47]
    v_mfma_f32_32x32x16_bf16 v[32:47], a[180:183], v[212:215], v[32:47]
    v_mfma_f32_32x32x16_bf16 v[32:47], a[184:187], v[216:219], v[32:47]
    s_add_u32 s49, s49, s100
    s_lshr_b32 s34, s49, 4
    s_and_b32 s49, s49, 15
    s_cmp_ge_u32 s34, 2
    s_cselect_b64 vcc, -1, 0
    s_xor_b32 s57, s99, 872448
    s_add_u32 m0, s56, 28672
    s_cbranch_vccnz L_w2_322
    s_bitcmp1_b32 s34, 0
    s_cbranch_scc1 L_w1_322
    s_waitcnt vmcnt(3)
L_w1_322:
    s_waitcnt vmcnt(4)
L_w2_322:
    s_waitcnt vmcnt(5)
    buffer_load_dwordx4 v8, s[4:7], s57 offen offset:0 nt lds
    v_mfma_f32_32x32x16_bf16 v[32:47], a[188:191], v[220:223], v[32:47]
    s_nop 11
    v_max3_f32 v13, v32, v33, v34
    v_max3_f32 v31, v35, v36, v37
    v_max3_f32 v13, v13, v38, v39
    v_max3_f32 v31, v31, v40, v41
    v_max3_f32 v13, v13, v42, v43
    v_max3_f32 v31, v31, v44, v45
    v_max3_f32 v13, v13, v46, v47
    v_max3_f32 v13, v13, v31, v14
    v_mov_b32 v31, v13
    s_nop 1
    v_permlane32_swap_b32 v13, v31
    v_max_f32 v13, v13, v31
    v_sub_f32 v31, v14, v13
    v_mul_f32 v30, s60, v13
    v_mul_f32 v31, s60, v31
    v_mov_b32 v14, v13
    v_exp_f32 v181, v31
    v_pk_fma_f32 v[32:33], v[32:33], s[60:61], v[30:31] op_sel_hi:[1,0,0] neg_lo:[0,0,1] neg_hi:[0,0,1]
    s_cbranch_vccnz L_w2_323
    s_bitcmp1_b32 s34, 0
    s_cbranch_scc1 L_w1_323
    s_waitcnt vmcnt(3)
L_w1_323:
    s_waitcnt vmcnt(4)
L_w2_323:
    s_waitcnt vmcnt(5)
    buffer_load_dwordx4 v9, s[4:7], s57 offen offset:1024 nt lds
    v_pk_fma_f32 v[34:35], v[34:35], s[60:61], v[30:31] op_sel_hi:[1,0,0] neg_lo:[0,0,1] neg_hi:[0,0,1]
    v_pk_fma_f32 v[36:37], v[36:37], s[60:61], v[30:31] op_sel_hi:[1,0,0] neg_lo:[0,0,1] neg_hi:[0,0,1]
    v_pk_fma_f32 v[38:39], v[38:39], s[60:61], v[30:31] op_sel_hi:[1,0,0] neg_lo:[0,0,1] neg_hi:[0,0,1]
    v_pk_fma_f32 v[40:41], v[40:41], s[60:61], v[30:31] op_sel_hi:[1,0,0] neg_lo:[0,0,1] neg_hi:[0,0,1]
    v_pk_fma_f32 v[42:43], v[42:43], s[60:61], v[30:31] op_sel_hi:[1,0,0] neg_lo:[0,0,1] neg_hi:[0,0,1]
    v_pk_fma_f32 v[44:45], v[44:45], s[60:61], v[30:31] op_sel_hi:[1,0,0] neg_lo:[0,0,1] neg_hi:[0,0,1]
    v_pk_fma_f32 v[46:47], v[46:47], s[60:61], v[30:31] op_sel_hi:[1,0,0] neg_lo:[0,0,1] neg_hi:[0,0,1]
    v_mul_f32 v15, v15, v181
    v_exp_f32 v32, v32
    v_exp_f32 v33, v33
    v_exp_f32 v34, v34
    v_exp_f32 v35, v35
    v_exp_f32 v36, v36
    v_exp_f32 v37, v37
    v_exp_f32 v38, v38
    v_exp_f32 v39, v39
    v_exp_f32 v40, v40
    s_cbranch_vccnz L_w2_324
    s_bitcmp1_b32 s34, 0
    s_cbranch_scc1 L_w1_324
    s_waitcnt vmcnt(3)
L_w1_324:
    s_waitcnt vmcnt(4)
L_w2_324:
    s_waitcnt vmcnt(5)
    buffer_load_dwordx4 v10, s[4:7], s57 offen offset:2048 nt lds
    v_exp_f32 v41, v41
    v_exp_f32 v42, v42
    v_exp_f32 v43, v43
    v_exp_f32 v44, v44
    v_exp_f32 v45, v45
    v_exp_f32 v46, v46
    v_exp_f32 v47, v47
    v_pk_add_f32 v[2:3], v[32:33], v[34:35]
    v_pk_add_f32 v[4:5], v[36:37], v[38:39]
    v_pk_add_f32 v[2:3], v[2:3], v[40:41]
    v_pk_add_f32 v[4:5], v[4:5], v[42:43]
    v_pk_add_f32 v[2:3], v[2:3], v[44:45]
    v_pk_add_f32 v[4:5], v[4:5], v[46:47]
    v_pk_add_f32 v[2:3], v[2:3], v[4:5]
    v_add_f32 v2, v2, v3
    v_add_f32 v15, v15, v2
    v_cvt_pk_bf16_f32 v48, v32, v33
    v_cvt_pk_bf16_f32 v49, v34, v35
    v_cvt_pk_bf16_f32 v50, v36, v37
    s_cbranch_vccnz L_w2_325
    s_bitcmp1_b32 s34, 0
    s_cbranch_scc1 L_w1_325
    s_waitcnt vmcnt(3)
L_w1_325:
    s_waitcnt vmcnt(4)
L_w2_325:
    s_waitcnt vmcnt(5)
    buffer_load_dwordx4 v11, s[4:7], s57 offen offset:3072 nt lds
    v_cvt_pk_bf16_f32 v51, v38, v39
    v_cvt_pk_bf16_f32 v52, v40, v41
    v_cvt_pk_bf16_f32 v53, v42, v43
    v_cvt_pk_bf16_f32 v54, v44, v45
    v_cvt_pk_bf16_f32 v55, v46, v47
    v_accvgpr_write_b32 a160, v48
    v_accvgpr_write_b32 a161, v49
    v_accvgpr_write_b32 a162, v50
    v_accvgpr_write_b32 a163, v51
    v_accvgpr_write_b32 a164, v52
    v_accvgpr_write_b32 a165, v53
    v_accvgpr_write_b32 a166, v54
    v_accvgpr_write_b32 a167, v55
    v_mfma_f32_32x32x16_bf16 v[32:47], v[128:131], v[192:195], 0
    v_mfma_f32_32x32x16_bf16 v[32:47], v[132:135], v[196:199], v[32:47]
    s_add_u32 s49, s49, s100
    s_lshr_b32 s34, s49, 4
    s_and_b32 s49, s49, 15
    s_cmp_ge_u32 s34, 2
    s_cselect_b64 vcc, -1, 0
    s_cmp_lg_u32 s44, 28
    s_cbranch_scc1 L_nr28
    s_mov_b32 s3, 83712
    v_mov_b32 v246, 1
    s_mov_b64 exec, 1
    buffer_atomic_add v246, off, s[24:27], s3 sc0
    s_mov_b64 exec, -1
L_nr28:
    v_add_u32 v0, 1, v0
    s_mov_b64 exec, s[32:33]
    buffer_store_dword v0, v242, s[24:27], s35 offen
    s_mov_b64 exec, -1
    buffer_load_dword v244, v242, s[24:27], s35 offen sc1
    s_xor_b32 s57, s99, 917504
    s_add_u32 m0, s56, 0
    s_cbranch_vccnz L_w2_328
    s_bitcmp1_b32 s34, 0
    s_cbranch_scc1 L_w1_328
    s_waitcnt vmcnt(5)
L_w1_328:
    s_waitcnt vmcnt(6)
L_w2_328:
    s_waitcnt vmcnt(7)
    buffer_load_dwordx4 v8, s[4:7], s57 offen offset:0 nt lds
    v_mfma_f32_32x32x16_bf16 v[32:47], v[136:139], v[200:203], v[32:47]
    v_mfma_f32_32x32x16_bf16 v[32:47], v[140:143], v[204:207], v[32:47]
    v_mfma_f32_32x32x16_bf16 v[32:47], v[144:147], v[208:211], v[32:47]
    v_mfma_f32_32x32x16_bf16 v[32:47], v[148:151], v[212:215], v[32:47]
    s_cbranch_vccnz L_w2_329
    s_bitcmp1_b32 s34, 0
    s_cbranch_scc1 L_w1_329
    s_waitcnt vmcnt(5)
L_w1_329:
    s_waitcnt vmcnt(6)
L_w2_329:
    s_waitcnt vmcnt(7)
    buffer_load_dwordx4 v9, s[4:7], s57 offen offset:1024 nt lds
    v_mfma_f32_32x32x16_bf16 v[32:47], v[152:155], v[216:219], v[32:47]
    v_mfma_f32_32x32x16_bf16 v[32:47], v[156:159], v[220:223], v[32:47]
    ds_read_b128 v[128:131], v16 offset:8192
    ds_read_b128 v[132:135], v17 offset:8192
    ds_read_b128 v[136:139], v18 offset:8192
    ds_read_b128 v[140:143], v19 offset:8192
    ds_read_b128 v[144:147], v20 offset:8192
    ds_read_b128 v[148:151], v21 offset:8192
    ds_read_b128 v[152:155], v22 offset:8192
    ds_read_b128 v[156:159], v23 offset:8192
    s_nop 3
    v_max3_f32 v13, v32, v33, v34
    v_max3_f32 v31, v35, v36, v37
    v_max3_f32 v13, v13, v38, v39
    v_max3_f32 v31, v31, v40, v41
    v_max3_f32 v13, v13, v42, v43
    v_max3_f32 v31, v31, v44, v45
    v_max3_f32 v13, v13, v46, v47
    v_max3_f32 v13, v13, v31, v14
    v_mov_b32 v31, v13
    s_nop 1
    v_permlane32_swap_b32 v13, v31
    s_cbranch_vccnz L_w2_330
    s_bitcmp1_b32 s34, 0
    s_cbranch_scc1 L_w1_330
    s_waitcnt vmcnt(5)
L_w1_330:
    s_waitcnt vmcnt(6)
L_w2_330:
    s_waitcnt vmcnt(7)
    buffer_load_dwordx4 v10, s[4:7], s57 offen offset:2048 nt lds
    v_max_f32 v13, v13, v31
    v_sub_f32 v31, v14, v13
    v_mul_f32 v30, s60, v13
    v_mul_f32 v31, s60, v31
    v_mov_b32 v14, v13
    v_exp_f32 v182, v31
    s_waitcnt lgkmcnt(0)
    v_pk_fma_f32 v[32:33], v[32:33], s[60:61], v[30:31] op_sel_hi:[1,0,0] neg_lo:[0,0,1] neg_hi:[0,0,1]
    v_pk_fma_f32 v[34:35], v[34:35], s[60:61], v[30:31] op_sel_hi:[1,0,0] neg_lo:[0,0,1] neg_hi:[0,0,1]
    v_pk_fma_f32 v[36:37], v[36:37], s[60:61], v[30:31] op_sel_hi:[1,0,0] neg_lo:[0,0,1] neg_hi:[0,0,1]
    v_pk_fma_f32 v[38:39], v[38:39], s[60:61], v[30:31] op_sel_hi:[1,0,0] neg_lo:[0,0,1] neg_hi:[0,0,1]
    v_pk_fma_f32 v[40:41], v[40:41], s[60:61], v[30:31] op_sel_hi:[1,0,0] neg_lo:[0,0,1] neg_hi:[0,0,1]
    v_pk_fma_f32 v[42:43], v[42:43], s[60:61], v[30:31] op_sel_hi:[1,0,0] neg_lo:[0,0,1] neg_hi:[0,0,1]
    v_pk_fma_f32 v[44:45], v[44:45], s[60:61], v[30:31] op_sel_hi:[1,0,0] neg_lo:[0,0,1] neg_hi:[0,0,1]
    v_pk_fma_f32 v[46:47], v[46:47], s[60:61], v[30:31] op_sel_hi:[1,0,0] neg_lo:[0,0,1] neg_hi:[0,0,1]
    v_mul_f32 v15, v15, v182
    v_exp_f32 v32, v32
    v_exp_f32 v33, v33
    v_exp_f32 v34, v34
    v_exp_f32 v35, v35
    v_exp_f32 v36, v36
    s_cbranch_vccnz L_w2_331
    s_bitcmp1_b32 s34, 0
    s_cbranch_scc1 L_w1_331
    s_waitcnt vmcnt(5)
L_w1_331:
    s_waitcnt vmcnt(6)
L_w2_331:
    s_waitcnt vmcnt(7)
    buffer_load_dwordx4 v11, s[4:7], s57 offen offset:3072 nt lds
    v_exp_f32 v37, v37
    v_exp_f32 v38, v38
    v_exp_f32 v39, v39
    v_exp_f32 v40, v40
    v_exp_f32 v41, v41
    v_exp_f32 v42, v42
    v_exp_f32 v43, v43
    v_exp_f32 v44, v44
    v_exp_f32 v45, v45
    v_exp_f32 v46, v46
    v_exp_f32 v47, v47
    v_pk_add_f32 v[2:3], v[32:33], v[34:35]
    v_pk_add_f32 v[4:5], v[36:37], v[38:39]
    v_pk_add_f32 v[2:3], v[2:3], v[40:41]
    v_pk_add_f32 v[4:5], v[4:5], v[42:43]
    s_add_u32 s49, s49, s100
    s_lshr_b32 s34, s49, 4
    s_and_b32 s49, s49, 15
    s_cmp_ge_u32 s34, 2
    s_cselect_b64 vcc, -1, 0
    s_xor_b32 s57, s99, 921600
    s_add_u32 m0, s56, 4096
    s_cbranch_vccnz L_w2_332
    s_bitcmp1_b32 s34, 0
    s_cbranch_scc1 L_w1_332
    s_waitcnt vmcnt(3)
L_w1_332:
    s_waitcnt vmcnt(6)
L_w2_332:
    s_waitcnt vmcnt(7)
    buffer_load_dwordx4 v8, s[4:7], s57 offen offset:0 nt lds
    v_pk_add_f32 v[2:3], v[2:3], v[44:45]
    v_pk_add_f32 v[4:5], v[4:5], v[46:47]
    v_pk_add_f32 v[2:3], v[2:3], v[4:5]
    v_add_f32 v2, v2, v3
    v_add_f32 v15, v15, v2
    v_cvt_pk_bf16_f32 v48, v32, v33
    v_cvt_pk_bf16_f32 v49, v34, v35
    v_cvt_pk_bf16_f32 v50, v36, v37
    v_cvt_pk_bf16_f32 v51, v38, v39
    v_cvt_pk_bf16_f32 v52, v40, v41
    v_cvt_pk_bf16_f32 v53, v42, v43
    v_cvt_pk_bf16_f32 v54, v44, v45
    v_cvt_pk_bf16_f32 v55, v46, v47
    v_accvgpr_write_b32 a168, v48
    v_accvgpr_write_b32 a169, v49
    v_accvgpr_write_b32 a170, v50
    v_accvgpr_write_b32 a171, v51
    v_accvgpr_write_b32 a172, v52
    v_accvgpr_write_b32 a173, v53
    v_accvgpr_write_b32 a174, v54
    v_accvgpr_write_b32 a175, v55
    v_mfma_f32_32x32x16_bf16 v[32:47], v[128:131], v[192:195], 0
    s_cbranch_vccnz L_w2_333
    s_bitcmp1_b32 s34, 0
    s_cbranch_scc1 L_w1_333
    s_waitcnt vmcnt(3)
L_w1_333:
    s_waitcnt vmcnt(4)
L_w2_333:
    s_waitcnt vmcnt(7)
    buffer_load_dwordx4 v9, s[4:7], s57 offen offset:1024 nt lds
    v_mfma_f32_32x32x16_bf16 v[32:47], v[132:135], v[196:199], v[32:47]
    v_mfma_f32_32x32x16_bf16 v[32:47], v[136:139], v[200:203], v[32:47]
    v_mfma_f32_32x32x16_bf16 v[32:47], v[140:143], v[204:207], v[32:47]
    v_mfma_f32_32x32x16_bf16 v[32:47], v[144:147], v[208:211], v[32:47]
    s_cbranch_vccnz L_w2_334
    s_bitcmp1_b32 s34, 0
    s_cbranch_scc1 L_w1_334
    s_waitcnt vmcnt(3)
L_w1_334:
    s_waitcnt vmcnt(4)
L_w2_334:
    s_waitcnt vmcnt(5)
    buffer_load_dwordx4 v10, s[4:7], s57 offen offset:2048 nt lds
    v_mfma_f32_32x32x16_bf16 v[32:47], v[148:151], v[212:215], v[32:47]
    v_mfma_f32_32x32x16_bf16 v[32:47], v[152:155], v[216:219], v[32:47]
    v_mfma_f32_32x32x16_bf16 v[32:47], v[156:159], v[220:223], v[32:47]
    ds_read_b128 v[128:131], v16 offset:16384
    ds_read_b128 v[132:135], v17 offset:16384
    ds_read_b128 v[136:139], v18 offset:16384
    ds_read_b128 v[140:143], v19 offset:16384
    ds_read_b128 v[144:147], v20 offset:16384
    ds_read_b128 v[148:151], v21 offset:16384
    ds_read_b128 v[152:155], v22 offset:16384
    ds_read_b128 v[156:159], v23 offset:16384
    s_nop 3
    v_max3_f32 v13, v32, v33, v34
    v_max3_f32 v31, v35, v36, v37
    s_cbranch_vccnz L_w2_335
    s_bitcmp1_b32 s34, 0
    s_cbranch_scc1 L_w1_335
    s_waitcnt vmcnt(3)
L_w1_335:
    s_waitcnt vmcnt(4)
L_w2_335:
    s_waitcnt vmcnt(5)
    buffer_load_dwordx4 v11, s[4:7], s57 offen offset:3072 nt lds
    v_max3_f32 v13, v13, v38, v39
    v_max3_f32 v31, v31, v40, v41
    v_max3_f32 v13, v13, v42, v43
    v_max3_f32 v31, v31, v44, v45
    v_max3_f32 v13, v13, v46, v47
    v_max3_f32 v13, v13, v31, v14
    v_mov_b32 v31, v13
    s_nop 1
    v_permlane32_swap_b32 v13, v31
    v_max_f32 v13, v13, v31
    v_sub_f32 v31, v14, v13
    v_mul_f32 v30, s60, v13
    v_mul_f32 v31, s60, v31
    v_mov_b32 v14, v13
    v_exp_f32 v183, v31
    s_waitcnt lgkmcnt(0)
    v_pk_fma_f32 v[32:33], v[32:33], s[60:61], v[30:31] op_sel_hi:[1,0,0] neg_lo:[0,0,1] neg_hi:[0,0,1]
    v_pk_fma_f32 v[34:35], v[34:35], s[60:61], v[30:31] op_sel_hi:[1,0,0] neg_lo:[0,0,1] neg_hi:[0,0,1]
    v_pk_fma_f32 v[36:37], v[36:37], s[60:61], v[30:31] op_sel_hi:[1,0,0] neg_lo:[0,0,1] neg_hi:[0,0,1]
    v_pk_fma_f32 v[38:39], v[38:39], s[60:61], v[30:31] op_sel_hi:[1,0,0] neg_lo:[0,0,1] neg_hi:[0,0,1]
    v_pk_fma_f32 v[40:41], v[40:41], s[60:61], v[30:31] op_sel_hi:[1,0,0] neg_lo:[0,0,1] neg_hi:[0,0,1]
    v_pk_fma_f32 v[42:43], v[42:43], s[60:61], v[30:31] op_sel_hi:[1,0,0] neg_lo:[0,0,1] neg_hi:[0,0,1]
    v_pk_fma_f32 v[44:45], v[44:45], s[60:61], v[30:31] op_sel_hi:[1,0,0] neg_lo:[0,0,1] neg_hi:[0,0,1]
    v_pk_fma_f32 v[46:47], v[46:47], s[60:61], v[30:31] op_sel_hi:[1,0,0] neg_lo:[0,0,1] neg_hi:[0,0,1]
    v_mul_f32 v15, v15, v183
    v_exp_f32 v32, v32
    s_cmp_lg_u32 s44, 28
    s_cbranch_scc1 L_nc28
    v_sub_u32 v247, v246, v245
    v_lshlrev_b32 v246, 8, v254
    v_readfirstlane_b32 s3, v247
    s_nop 0
    s_min_u32 s3, s3, 7
    s_mul_i32 s3, s3, 6
    s_add_u32 s3, s3, s45
    v_mov_b32 v247, s3
    s_and_b32 s3, s35, 0xfffffcff
    s_mov_b64 exec, 15
    buffer_store_dword v247, v246, s[24:27], s3 offen offset:128
    s_mov_b64 exec, -1
L_nc28:
    v_sub_u32 v244, v244, v0
    v_cmp_gt_u32 s[100:101], 64, v244
    v_readlane_b32 s46, v244, 32
    s_bcnt1_i32_b32 s3, s100
    s_mul_i32 s3, s3, 3
    s_add_u32 s46, s46, 8
    s_cmp_lt_u32 s46, 128
    s_cselect_b32 s46, s46, 21
    s_add_u32 s3, s3, s46
    s_ashr_i32 s3, s3, 2
    s_add_i32 s3, s3, 2
    s_max_i32 s3, s3, 8
    s_min_i32 s100, s3, 32
    s_add_u32 s49, s49, s100
    s_lshr_b32 s34, s49, 4
    s_and_b32 s49, s49, 15
    s_cmp_ge_u32 s34, 2
    s_cselect_b64 vcc, -1, 0
    s_xor_b32 s57, s99, 933888
    s_add_u32 m0, s56, 8192
    s_cbranch_vccnz L_w2_336
    s_bitcmp1_b32 s34, 0
    s_cbranch_scc1 L_w1_336
    s_waitcnt vmcnt(3)
L_w1_336:
    s_waitcnt vmcnt(4)
L_w2_336:
    s_waitcnt vmcnt(5)
    buffer_load_dwordx4 v8, s[4:7], s57 offen offset:0 nt lds
    v_exp_f32 v33, v33
    v_exp_f32 v34, v34
    v_exp_f32 v35, v35
    v_exp_f32 v36, v36
    v_exp_f32 v37, v37
    v_exp_f32 v38, v38
    v_exp_f32 v39, v39
    v_exp_f32 v40, v40
    v_exp_f32 v41, v41
    v_exp_f32 v42, v42
    v_exp_f32 v43, v43
    v_exp_f32 v44, v44
    v_exp_f32 v45, v45
    s_cbranch_vccnz L_w2_337
    s_bitcmp1_b32 s34, 0
    s_cbranch_scc1 L_w1_337
    s_waitcnt vmcnt(3)
L_w1_337:
    s_waitcnt vmcnt(4)
L_w2_337:
    s_waitcnt vmcnt(5)
    buffer_load_dwordx4 v9, s[4:7], s57 offen offset:1024 nt lds
    v_exp_f32 v46, v46
    v_exp_f32 v47, v47
    v_pk_add_f32 v[2:3], v[32:33], v[34:35]
    v_pk_add_f32 v[4:5], v[36:37], v[38:39]
    v_pk_add_f32 v[2:3], v[2:3], v[40:41]
    v_pk_add_f32 v[4:5], v[4:5], v[42:43]
    v_pk_add_f32 v[2:3], v[2:3], v[44:45]
    v_pk_add_f32 v[4:5], v[4:5], v[46:47]
    v_pk_add_f32 v[2:3], v[2:3], v[4:5]
    v_add_f32 v2, v2, v3
    v_add_f32 v15, v15, v2
    v_cvt_pk_bf16_f32 v48, v32, v33
    v_cvt_pk_bf16_f32 v49, v34, v35
    v_cvt_pk_bf16_f32 v50, v36, v37
    v_cvt_pk_bf16_f32 v51, v38, v39
    v_cvt_pk_bf16_f32 v52, v40, v41
    v_cvt_pk_bf16_f32 v53, v42, v43
    v_cvt_pk_bf16_f32 v54, v44, v45
    v_cvt_pk_bf16_f32 v55, v46, v47
    v_accvgpr_write_b32 a176, v48
    v_accvgpr_write_b32 a177, v49
    v_accvgpr_write_b32 a178, v50
    v_accvgpr_write_b32 a179, v51
    v_accvgpr_write_b32 a180, v52
    s_cbranch_vccnz L_w2_338
    s_bitcmp1_b32 s34, 0
    s_cbranch_scc1 L_w1_338
    s_waitcnt vmcnt(3)
L_w1_338:
    s_waitcnt vmcnt(4)
L_w2_338:
    s_waitcnt vmcnt(5)
    buffer_load_dwordx4 v10, s[4:7], s57 offen offset:2048 nt lds
    v_accvgpr_write_b32 a181, v53
    v_accvgpr_write_b32 a182, v54
    v_accvgpr_write_b32 a183, v55
    v_mfma_f32_32x32x16_bf16 v[32:47], v[128:131], v[192:195], 0
    v_mfma_f32_32x32x16_bf16 v[32:47], v[132:135], v[196:199], v[32:47]
    v_mfma_f32_32x32x16_bf16 v[32:47], v[136:139], v[200:203], v[32:47]
    s_cbranch_vccnz L_w2_339
    s_bitcmp1_b32 s34, 0
    s_cbranch_scc1 L_w1_339
    s_waitcnt vmcnt(3)
L_w1_339:
    s_waitcnt vmcnt(4)
L_w2_339:
    s_waitcnt vmcnt(5)
    buffer_load_dwordx4 v11, s[4:7], s57 offen offset:3072 nt lds
    v_mfma_f32_32x32x16_bf16 v[32:47], v[140:143], v[204:207], v[32:47]
    v_mfma_f32_32x32x16_bf16 v[32:47], v[144:147], v[208:211], v[32:47]
    v_mfma_f32_32x32x16_bf16 v[32:47], v[148:151], v[212:215], v[32:47]
    v_mfma_f32_32x32x16_bf16 v[32:47], v[152:155], v[216:219], v[32:47]
    s_add_u32 s49, s49, s100
    s_lshr_b32 s34, s49, 4
    s_and_b32 s49, s49, 15
    s_cmp_ge_u32 s34, 2
    s_cselect_b64 vcc, -1, 0
    s_xor_b32 s57, s99, 937984
    s_add_u32 m0, s56, 12288
    s_cbranch_vccnz L_w2_340
    s_bitcmp1_b32 s34, 0
    s_cbranch_scc1 L_w1_340
    s_waitcnt vmcnt(3)
L_w1_340:
    s_waitcnt vmcnt(4)
L_w2_340:
    s_waitcnt vmcnt(5)
    buffer_load_dwordx4 v8, s[4:7], s57 offen offset:0 nt lds
    v_mfma_f32_32x32x16_bf16 v[32:47], v[156:159], v[220:223], v[32:47]
    ds_read_b128 v[128:131], v16 offset:24576
    ds_read_b128 v[132:135], v17 offset:24576
    ds_read_b128 v[136:139], v18 offset:24576
    ds_read_b128 v[140:143], v19 offset:24576
    ds_read_b128 v[144:147], v20 offset:24576
    ds_read_b128 v[148:151], v21 offset:24576
    ds_read_b128 v[152:155], v22 offset:24576
    ds_read_b128 v[156:159], v23 offset:24576
    s_nop 3
    v_max3_f32 v13, v32, v33, v34
    v_max3_f32 v31, v35, v36, v37
    v_max3_f32 v13, v13, v38, v39
    v_max3_f32 v31, v31, v40, v41
    v_max3_f32 v13, v13, v42, v43
    v_max3_f32 v31, v31, v44, v45
    v_max3_f32 v13, v13, v46, v47
    v_max3_f32 v13, v13, v31, v14
    v_mov_b32 v31, v13
    s_nop 1
    v_permlane32_swap_b32 v13, v31
    v_max_f32 v13, v13, v31
    v_sub_f32 v31, v14, v13
    v_mul_f32 v30, s60, v13
    v_mul_f32 v31, s60, v31
    v_mov_b32 v14, v13
    v_exp_f32 v184, v31
    s_waitcnt lgkmcnt(0)
    v_pk_fma_f32 v[32:33], v[32:33], s[60:61], v[30:31] op_sel_hi:[1,0,0] neg_lo:[0,0,1] neg_hi:[0,0,1]
    s_cbranch_vccnz L_w2_341
    s_bitcmp1_b32 s34, 0
    s_cbranch_scc1 L_w1_341
    s_waitcnt vmcnt(3)
L_w1_341:
    s_waitcnt vmcnt(4)
L_w2_341:
    s_waitcnt vmcnt(5)
    buffer_load_dwordx4 v9, s[4:7], s57 offen offset:1024 nt lds
    v_pk_fma_f32 v[34:35], v[34:35], s[60:61], v[30:31] op_sel_hi:[1,0,0] neg_lo:[0,0,1] neg_hi:[0,0,1]
    v_pk_fma_f32 v[36:37], v[36:37], s[60:61], v[30:31] op_sel_hi:[1,0,0] neg_lo:[0,0,1] neg_hi:[0,0,1]
    v_pk_fma_f32 v[38:39], v[38:39], s[60:61], v[30:31] op_sel_hi:[1,0,0] neg_lo:[0,0,1] neg_hi:[0,0,1]
    v_pk_fma_f32 v[40:41], v[40:41], s[60:61], v[30:31] op_sel_hi:[1,0,0] neg_lo:[0,0,1] neg_hi:[0,0,1]
    v_pk_fma_f32 v[42:43], v[42:43], s[60:61], v[30:31] op_sel_hi:[1,0,0] neg_lo:[0,0,1] neg_hi:[0,0,1]
    v_pk_fma_f32 v[44:45], v[44:45], s[60:61], v[30:31] op_sel_hi:[1,0,0] neg_lo:[0,0,1] neg_hi:[0,0,1]
    v_pk_fma_f32 v[46:47], v[46:47], s[60:61], v[30:31] op_sel_hi:[1,0,0] neg_lo:[0,0,1] neg_hi:[0,0,1]
    v_mul_f32 v15, v15, v184
    v_exp_f32 v32, v32
    v_exp_f32 v33, v33
    v_exp_f32 v34, v34
    v_exp_f32 v35, v35
    v_exp_f32 v36, v36
    v_exp_f32 v37, v37
    v_exp_f32 v38, v38
    v_exp_f32 v39, v39
    v_exp_f32 v40, v40
    s_cbranch_vccnz L_w2_342
    s_bitcmp1_b32 s34, 0
    s_cbranch_scc1 L_w1_342
    s_waitcnt vmcnt(3)
L_w1_342:
    s_waitcnt vmcnt(4)
L_w2_342:
    s_waitcnt vmcnt(5)
    buffer_load_dwordx4 v10, s[4:7], s57 offen offset:2048 nt lds
    v_exp_f32 v41, v41
    v_exp_f32 v42, v42
    v_exp_f32 v43, v43
    v_exp_f32 v44, v44
    v_exp_f32 v45, v45
    v_exp_f32 v46, v46
    v_exp_f32 v47, v47
    v_pk_add_f32 v[2:3], v[32:33], v[34:35]
    v_pk_add_f32 v[4:5], v[36:37], v[38:39]
    v_pk_add_f32 v[2:3], v[2:3], v[40:41]
    v_pk_add_f32 v[4:5], v[4:5], v[42:43]
    v_pk_add_f32 v[2:3], v[2:3], v[44:45]
    v_pk_add_f32 v[4:5], v[4:5], v[46:47]
    v_pk_add_f32 v[2:3], v[2:3], v[4:5]
    v_add_f32 v2, v2, v3
    v_add_f32 v15, v15, v2
    v_cvt_pk_bf16_f32 v48, v32, v33
    v_cvt_pk_bf16_f32 v49, v34, v35
    v_cvt_pk_bf16_f32 v50, v36, v37
    s_cbranch_vccnz L_w2_343
    s_bitcmp1_b32 s34, 0
    s_cbranch_scc1 L_w1_343
    s_waitcnt vmcnt(3)
L_w1_343:
    s_waitcnt vmcnt(4)
L_w2_343:
    s_waitcnt vmcnt(5)
    buffer_load_dwordx4 v11, s[4:7], s57 offen offset:3072 nt lds
    v_cvt_pk_bf16_f32 v51, v38, v39
    v_cvt_pk_bf16_f32 v52, v40, v41
    v_cvt_pk_bf16_f32 v53, v42, v43
    v_cvt_pk_bf16_f32 v54, v44, v45
    v_cvt_pk_bf16_f32 v55, v46, v47
    v_accvgpr_write_b32 a184, v48
    v_accvgpr_write_b32 a185, v49
    v_accvgpr_write_b32 a186, v50
    v_accvgpr_write_b32 a187, v51
    v_accvgpr_write_b32 a188, v52
    v_accvgpr_write_b32 a189, v53
    v_accvgpr_write_b32 a190, v54
    v_accvgpr_write_b32 a191, v55
    v_mfma_f32_32x32x16_bf16 v[32:47], a[192:195], v[192:195], 0
    v_mfma_f32_32x32x16_bf16 v[32:47], a[196:199], v[196:199], v[32:47]
    s_add_u32 s49, s49, s100
    s_lshr_b32 s34, s49, 4
    s_and_b32 s49, s49, 15
    s_cmp_ge_u32 s34, 2
    s_cselect_b64 vcc, -1, 0
    s_cmp_lg_u32 s44, 30
    s_cbranch_scc1 L_nr30
    s_mov_b32 s3, 83968
    v_mov_b32 v246, 1
    s_mov_b64 exec, 1
    buffer_atomic_add v246, off, s[24:27], s3 sc0
    s_mov_b64 exec, -1
L_nr30:
    v_add_u32 v0, 1, v0
    s_mov_b64 exec, s[32:33]
    buffer_store_dword v0, v242, s[24:27], s35 offen
    s_mov_b64 exec, -1
    buffer_load_dword v244, v242, s[24:27], s35 offen sc1
    s_xor_b32 s57, s99, 983040
    s_add_u32 m0, s56, 16384
    s_cbranch_vccnz L_w2_346
    s_bitcmp1_b32 s34, 0
    s_cbranch_scc1 L_w1_346
    s_waitcnt vmcnt(5)
L_w1_346:
    s_waitcnt vmcnt(6)
L_w2_346:
    s_waitcnt vmcnt(7)
    buffer_load_dwordx4 v8, s[4:7], s57 offen offset:0 nt lds
    v_mfma_f32_32x32x16_bf16 v[32:47], a[200:203], v[200:203], v[32:47]
    v_mfma_f32_32x32x16_bf16 v[32:47], a[204:207], v[204:207], v[32:47]
    v_mfma_f32_32x32x16_bf16 v[32:47], a[208:211], v[208:211], v[32:47]
    v_mfma_f32_32x32x16_bf16 v[32:47], a[212:215], v[212:215], v[32:47]
    s_cbranch_vccnz L_w2_347
    s_bitcmp1_b32 s34, 0
    s_cbranch_scc1 L_w1_347
    s_waitcnt vmcnt(5)
L_w1_347:
    s_waitcnt vmcnt(6)
L_w2_347:
    s_waitcnt vmcnt(7)
    buffer_load_dwordx4 v9, s[4:7], s57 offen offset:1024 nt lds
    v_mfma_f32_32x32x16_bf16 v[32:47], a[216:219], v[216:219], v[32:47]
    v_mfma_f32_32x32x16_bf16 v[32:47], a[220:223], v[220:223], v[32:47]
    s_nop 11
    v_max3_f32 v13, v32, v33, v34
    v_max3_f32 v31, v35, v36, v37
    v_max3_f32 v13, v13, v38, v39
    v_max3_f32 v31, v31, v40, v41
    v_max3_f32 v13, v13, v42, v43
    v_max3_f32 v31, v31, v44, v45
    v_max3_f32 v13, v13, v46, v47
    v_max3_f32 v13, v13, v31, v14
    v_mov_b32 v31, v13
    s_nop 1
    v_permlane32_swap_b32 v13, v31
    s_cbranch_vccnz L_w2_348
    s_bitcmp1_b32 s34, 0
    s_cbranch_scc1 L_w1_348
    s_waitcnt vmcnt(5)
L_w1_348:
    s_waitcnt vmcnt(6)
L_w2_348:
    s_waitcnt vmcnt(7)
    buffer_load_dwordx4 v10, s[4:7], s57 offen offset:2048 nt lds
    v_max_f32 v13, v13, v31
    v_sub_f32 v31, v14, v13
    v_mul_f32 v30, s60, v13
    v_mul_f32 v31, s60, v31
    v_mov_b32 v14, v13
    v_exp_f32 v185, v31
    v_pk_fma_f32 v[32:33], v[32:33], s[60:61], v[30:31] op_sel_hi:[1,0,0] neg_lo:[0,0,1] neg_hi:[0,0,1]
    v_pk_fma_f32 v[34:35], v[34:35], s[60:61], v[30:31] op_sel_hi:[1,0,0] neg_lo:[0,0,1] neg_hi:[0,0,1]
    v_pk_fma_f32 v[36:37], v[36:37], s[60:61], v[30:31] op_sel_hi:[1,0,0] neg_lo:[0,0,1] neg_hi:[0,0,1]
    v_pk_fma_f32 v[38:39], v[38:39], s[60:61], v[30:31] op_sel_hi:[1,0,0] neg_lo:[0,0,1] neg_hi:[0,0,1]
    v_pk_fma_f32 v[40:41], v[40:41], s[60:61], v[30:31] op_sel_hi:[1,0,0] neg_lo:[0,0,1] neg_hi:[0,0,1]
    v_pk_fma_f32 v[42:43], v[42:43], s[60:61], v[30:31] op_sel_hi:[1,0,0] neg_lo:[0,0,1] neg_hi:[0,0,1]
    v_pk_fma_f32 v[44:45], v[44:45], s[60:61], v[30:31] op_sel_hi:[1,0,0] neg_lo:[0,0,1] neg_hi:[0,0,1]
    v_pk_fma_f32 v[46:47], v[46:47], s[60:61], v[30:31] op_sel_hi:[1,0,0] neg_lo:[0,0,1] neg_hi:[0,0,1]
    v_mul_f32 v15, v15, v185
    v_exp_f32 v32, v32
    v_exp_f32 v33, v33
    v_exp_f32 v34, v34
    v_exp_f32 v35, v35
    v_exp_f32 v36, v36
    s_cbranch_vccnz L_w2_349
    s_bitcmp1_b32 s34, 0
    s_cbranch_scc1 L_w1_349
    s_waitcnt vmcnt(5)
L_w1_349:
    s_waitcnt vmcnt(6)
L_w2_349:
    s_waitcnt vmcnt(7)
    buffer_load_dwordx4 v11, s[4:7], s57 offen offset:3072 nt lds
    v_exp_f32 v37, v37
    v_exp_f32 v38, v38
    v_exp_f32 v39, v39
    v_exp_f32 v40, v40
    v_exp_f32 v41, v41
    v_exp_f32 v42, v42
    v_exp_f32 v43, v43
    v_exp_f32 v44, v44
    v_exp_f32 v45, v45
    v_exp_f32 v46, v46
    v_exp_f32 v47, v47
    v_pk_add_f32 v[2:3], v[32:33], v[34:35]
    v_pk_add_f32 v[4:5], v[36:37], v[38:39]
    v_pk_add_f32 v[2:3], v[2:3], v[40:41]
    v_pk_add_f32 v[4:5], v[4:5], v[42:43]
    s_add_u32 s49, s49, s100
    s_lshr_b32 s34, s49, 4
    s_and_b32 s49, s49, 15
    s_cmp_ge_u32 s34, 2
    s_cselect_b64 vcc, -1, 0
    s_xor_b32 s57, s99, 987136
    s_add_u32 m0, s56, 20480
    s_cbranch_vccnz L_w2_350
    s_bitcmp1_b32 s34, 0
    s_cbranch_scc1 L_w1_350
    s_waitcnt vmcnt(3)
L_w1_350:
    s_waitcnt vmcnt(6)
L_w2_350:
    s_waitcnt vmcnt(7)
    buffer_load_dwordx4 v8, s[4:7], s57 offen offset:0 nt lds
    v_pk_add_f32 v[2:3], v[2:3], v[44:45]
    v_pk_add_f32 v[4:5], v[4:5], v[46:47]
    v_pk_add_f32 v[2:3], v[2:3], v[4:5]
    v_add_f32 v2, v2, v3
    v_add_f32 v15, v15, v2
    v_cvt_pk_bf16_f32 v48, v32, v33
    v_cvt_pk_bf16_f32 v49, v34, v35
    v_cvt_pk_bf16_f32 v50, v36, v37
    v_cvt_pk_bf16_f32 v51, v38, v39
    v_cvt_pk_bf16_f32 v52, v40, v41
    v_cvt_pk_bf16_f32 v53, v42, v43
    v_cvt_pk_bf16_f32 v54, v44, v45
    v_cvt_pk_bf16_f32 v55, v46, v47
    v_accvgpr_write_b32 a192, v48
    v_accvgpr_write_b32 a193, v49
    v_accvgpr_write_b32 a194, v50
    v_accvgpr_write_b32 a195, v51
    v_accvgpr_write_b32 a196, v52
    v_accvgpr_write_b32 a197, v53
    v_accvgpr_write_b32 a198, v54
    v_accvgpr_write_b32 a199, v55
    v_mfma_f32_32x32x16_bf16 v[32:47], v[128:131], v[192:195], 0
    s_cbranch_vccnz L_w2_351
    s_bitcmp1_b32 s34, 0
    s_cbranch_scc1 L_w1_351
    s_waitcnt vmcnt(3)
L_w1_351:
    s_waitcnt vmcnt(4)
L_w2_351:
    s_waitcnt vmcnt(7)
    buffer_load_dwordx4 v9, s[4:7], s57 offen offset:1024 nt lds
    v_mfma_f32_32x32x16_bf16 v[32:47], v[132:135], v[196:199], v[32:47]
    v_mfma_f32_32x32x16_bf16 v[32:47], v[136:139], v[200:203], v[32:47]
    v_mfma_f32_32x32x16_bf16 v[32:47], v[140:143], v[204:207], v[32:47]
    v_mfma_f32_32x32x16_bf16 v[32:47], v[144:147], v[208:211], v[32:47]
    s_cbranch_vccnz L_w2_352
    s_bitcmp1_b32 s34, 0
    s_cbranch_scc1 L_w1_352
    s_waitcnt vmcnt(3)
L_w1_352:
    s_waitcnt vmcnt(4)
L_w2_352:
    s_waitcnt vmcnt(5)
    buffer_load_dwordx4 v10, s[4:7], s57 offen offset:2048 nt lds
    v_mfma_f32_32x32x16_bf16 v[32:47], v[148:151], v[212:215], v[32:47]
    v_mfma_f32_32x32x16_bf16 v[32:47], v[152:155], v[216:219], v[32:47]
    v_mfma_f32_32x32x16_bf16 v[32:47], v[156:159], v[220:223], v[32:47]
    ds_read_b128 v[128:131], v16 offset:0
    ds_read_b128 v[132:135], v17 offset:0
    ds_read_b128 v[136:139], v18 offset:0
    ds_read_b128 v[140:143], v19 offset:0
    ds_read_b128 v[144:147], v20 offset:0
    ds_read_b128 v[148:151], v21 offset:0
    ds_read_b128 v[152:155], v22 offset:0
    ds_read_b128 v[156:159], v23 offset:0
    s_nop 3
    v_max3_f32 v13, v32, v33, v34
    v_max3_f32 v31, v35, v36, v37
    s_cbranch_vccnz L_w2_353
    s_bitcmp1_b32 s34, 0
    s_cbranch_scc1 L_w1_353
    s_waitcnt vmcnt(3)
L_w1_353:
    s_waitcnt vmcnt(4)
L_w2_353:
    s_waitcnt vmcnt(5)
    buffer_load_dwordx4 v11, s[4:7], s57 offen offset:3072 nt lds
    v_max3_f32 v13, v13, v38, v39
    v_max3_f32 v31, v31, v40, v41
    v_max3_f32 v13, v13, v42, v43
    v_max3_f32 v31, v31, v44, v45
    v_max3_f32 v13, v13, v46, v47
    v_max3_f32 v13, v13, v31, v14
    v_mov_b32 v31, v13
    s_nop 1
    v_permlane32_swap_b32 v13, v31
    v_max_f32 v13, v13, v31
    v_sub_f32 v31, v14, v13
    v_mul_f32 v30, s60, v13
    v_mul_f32 v31, s60, v31
    v_mov_b32 v14, v13
    v_exp_f32 v186, v31
    s_waitcnt lgkmcnt(0)
    v_pk_fma_f32 v[32:33], v[32:33], s[60:61], v[30:31] op_sel_hi:[1,0,0] neg_lo:[0,0,1] neg_hi:[0,0,1]
    v_pk_fma_f32 v[34:35], v[34:35], s[60:61], v[30:31] op_sel_hi:[1,0,0] neg_lo:[0,0,1] neg_hi:[0,0,1]
    v_pk_fma_f32 v[36:37], v[36:37], s[60:61], v[30:31] op_sel_hi:[1,0,0] neg_lo:[0,0,1] neg_hi:[0,0,1]
    v_pk_fma_f32 v[38:39], v[38:39], s[60:61], v[30:31] op_sel_hi:[1,0,0] neg_lo:[0,0,1] neg_hi:[0,0,1]
    v_pk_fma_f32 v[40:41], v[40:41], s[60:61], v[30:31] op_sel_hi:[1,0,0] neg_lo:[0,0,1] neg_hi:[0,0,1]
    v_pk_fma_f32 v[42:43], v[42:43], s[60:61], v[30:31] op_sel_hi:[1,0,0] neg_lo:[0,0,1] neg_hi:[0,0,1]
    v_pk_fma_f32 v[44:45], v[44:45], s[60:61], v[30:31] op_sel_hi:[1,0,0] neg_lo:[0,0,1] neg_hi:[0,0,1]
    v_pk_fma_f32 v[46:47], v[46:47], s[60:61], v[30:31] op_sel_hi:[1,0,0] neg_lo:[0,0,1] neg_hi:[0,0,1]
    v_mul_f32 v15, v15, v186
    v_exp_f32 v32, v32
    s_cmp_lg_u32 s44, 30
    s_cbranch_scc1 L_nc30
    v_sub_u32 v247, v246, v245
    v_lshlrev_b32 v246, 8, v254
    v_readfirstlane_b32 s3, v247
    s_nop 0
    s_min_u32 s3, s3, 7
    s_mul_i32 s3, s3, 6
    s_add_u32 s3, s3, s45
    v_mov_b32 v247, s3
    s_and_b32 s3, s35, 0xfffffcff
    s_mov_b64 exec, 15
    buffer_store_dword v247, v246, s[24:27], s3 offen offset:128
    s_mov_b64 exec, -1
L_nc30:
    v_sub_u32 v244, v244, v0
    v_cmp_gt_u32 s[100:101], 64, v244
    v_readlane_b32 s46, v244, 32
    s_bcnt1_i32_b32 s3, s100
    s_mul_i32 s3, s3, 3
    s_add_u32 s46, s46, 9
    s_cmp_lt_u32 s46, 128
    s_cselect_b32 s46, s46, 21
    s_add_u32 s3, s3, s46
    s_ashr_i32 s3, s3, 2
    s_add_i32 s3, s3, 2
    s_max_i32 s3, s3, 8
    s_min_i32 s100, s3, 32
    s_add_u32 s49, s49, s100
    s_lshr_b32 s34, s49, 4
    s_and_b32 s49, s49, 15
    s_cmp_ge_u32 s34, 2
    s_cselect_b64 vcc, -1, 0
    s_xor_b32 s57, s99, 999424
    s_add_u32 m0, s56, 24576
    s_cbranch_vccnz L_w2_354
    s_bitcmp1_b32 s34, 0
    s_cbranch_scc1 L_w1_354
    s_waitcnt vmcnt(3)
L_w1_354:
    s_waitcnt vmcnt(4)
L_w2_354:
    s_waitcnt vmcnt(5)
    buffer_load_dwordx4 v8, s[4:7], s57 offen offset:0 nt lds
    v_exp_f32 v33, v33
    v_exp_f32 v34, v34
    v_exp_f32 v35, v35
    v_exp_f32 v36, v36
    v_exp_f32 v37, v37
    v_exp_f32 v38, v38
    v_exp_f32 v39, v39
    v_exp_f32 v40, v40
    v_exp_f32 v41, v41
    v_exp_f32 v42, v42
    v_exp_f32 v43, v43
    v_exp_f32 v44, v44
    v_exp_f32 v45, v45
    s_cbranch_vccnz L_w2_355
    s_bitcmp1_b32 s34, 0
    s_cbranch_scc1 L_w1_355
    s_waitcnt vmcnt(3)
L_w1_355:
    s_waitcnt vmcnt(4)
L_w2_355:
    s_waitcnt vmcnt(5)
    buffer_load_dwordx4 v9, s[4:7], s57 offen offset:1024 nt lds
    v_exp_f32 v46, v46
    v_exp_f32 v47, v47
    v_pk_add_f32 v[2:3], v[32:33], v[34:35]
    v_pk_add_f32 v[4:5], v[36:37], v[38:39]
    v_pk_add_f32 v[2:3], v[2:3], v[40:41]
    v_pk_add_f32 v[4:5], v[4:5], v[42:43]
    v_pk_add_f32 v[2:3], v[2:3], v[44:45]
    v_pk_add_f32 v[4:5], v[4:5], v[46:47]
    v_pk_add_f32 v[2:3], v[2:3], v[4:5]
    v_add_f32 v2, v2, v3
    v_add_f32 v15, v15, v2
    v_cvt_pk_bf16_f32 v48, v32, v33
    v_cvt_pk_bf16_f32 v49, v34, v35
    v_cvt_pk_bf16_f32 v50, v36, v37
    v_cvt_pk_bf16_f32 v51, v38, v39
    v_cvt_pk_bf16_f32 v52, v40, v41
    v_cvt_pk_bf16_f32 v53, v42, v43
    v_cvt_pk_bf16_f32 v54, v44, v45
    v_cvt_pk_bf16_f32 v55, v46, v47
    v_accvgpr_write_b32 a200, v48
    v_accvgpr_write_b32 a201, v49
    v_accvgpr_write_b32 a202, v50
    v_accvgpr_write_b32 a203, v51
    v_accvgpr_write_b32 a204, v52
    s_cbranch_vccnz L_w2_356
    s_bitcmp1_b32 s34, 0
    s_cbranch_scc1 L_w1_356
    s_waitcnt vmcnt(3)
L_w1_356:
    s_waitcnt vmcnt(4)
L_w2_356:
    s_waitcnt vmcnt(5)
    buffer_load_dwordx4 v10, s[4:7], s57 offen offset:2048 nt lds
    v_accvgpr_write_b32 a205, v53
    v_accvgpr_write_b32 a206, v54
    v_accvgpr_write_b32 a207, v55
    v_mfma_f32_32x32x16_bf16 v[32:47], v[128:131], v[192:195], 0
    v_mfma_f32_32x32x16_bf16 v[32:47], v[132:135], v[196:199], v[32:47]
    v_mfma_f32_32x32x16_bf16 v[32:47], v[136:139], v[200:203], v[32:47]
    s_cbranch_vccnz L_w2_357
    s_bitcmp1_b32 s34, 0
    s_cbranch_scc1 L_w1_357
    s_waitcnt vmcnt(3)
L_w1_357:
    s_waitcnt vmcnt(4)
L_w2_357:
    s_waitcnt vmcnt(5)
    buffer_load_dwordx4 v11, s[4:7], s57 offen offset:3072 nt lds
    v_mfma_f32_32x32x16_bf16 v[32:47], v[140:143], v[204:207], v[32:47]
    v_mfma_f32_32x32x16_bf16 v[32:47], v[144:147], v[208:211], v[32:47]
    v_mfma_f32_32x32x16_bf16 v[32:47], v[148:151], v[212:215], v[32:47]
    v_mfma_f32_32x32x16_bf16 v[32:47], v[152:155], v[216:219], v[32:47]
    s_add_u32 s49, s49, s100
    s_lshr_b32 s34, s49, 4
    s_and_b32 s49, s49, 15
    s_cmp_ge_u32 s34, 2
    s_cselect_b64 vcc, -1, 0
    s_xor_b32 s57, s99, 1003520
    s_add_u32 m0, s56, 28672
    s_cbranch_vccnz L_w2_358
    s_bitcmp1_b32 s34, 0
    s_cbranch_scc1 L_w1_358
    s_waitcnt vmcnt(3)
L_w1_358:
    s_waitcnt vmcnt(4)
L_w2_358:
    s_waitcnt vmcnt(5)
    buffer_load_dwordx4 v8, s[4:7], s57 offen offset:0 nt lds
    v_mfma_f32_32x32x16_bf16 v[32:47], v[156:159], v[220:223], v[32:47]
    ds_read_b128 v[128:131], v16 offset:8192
    ds_read_b128 v[132:135], v17 offset:8192
    ds_read_b128 v[136:139], v18 offset:8192
    ds_read_b128 v[140:143], v19 offset:8192
    ds_read_b128 v[144:147], v20 offset:8192
    ds_read_b128 v[148:151], v21 offset:8192
    ds_read_b128 v[152:155], v22 offset:8192
    ds_read_b128 v[156:159], v23 offset:8192
    s_nop 3
    v_max3_f32 v13, v32, v33, v34
    v_max3_f32 v31, v35, v36, v37
    v_max3_f32 v13, v13, v38, v39
    v_max3_f32 v31, v31, v40, v41
    v_max3_f32 v13, v13, v42, v43
    v_max3_f32 v31, v31, v44, v45
    v_max3_f32 v13, v13, v46, v47
    v_max3_f32 v13, v13, v31, v14
    v_mov_b32 v31, v13
    s_nop 1
    v_permlane32_swap_b32 v13, v31
    v_max_f32 v13, v13, v31
    v_sub_f32 v31, v14, v13
    v_mul_f32 v30, s60, v13
    v_mul_f32 v31, s60, v31
    v_mov_b32 v14, v13
    v_exp_f32 v187, v31
    s_waitcnt lgkmcnt(0)
    v_pk_fma_f32 v[32:33], v[32:33], s[60:61], v[30:31] op_sel_hi:[1,0,0] neg_lo:[0,0,1] neg_hi:[0,0,1]
    s_cbranch_vccnz L_w2_359
    s_bitcmp1_b32 s34, 0
    s_cbranch_scc1 L_w1_359
    s_waitcnt vmcnt(3)
L_w1_359:
    s_waitcnt vmcnt(4)
L_w2_359:
    s_waitcnt vmcnt(5)
    buffer_load_dwordx4 v9, s[4:7], s57 offen offset:1024 nt lds
    v_pk_fma_f32 v[34:35], v[34:35], s[60:61], v[30:31] op_sel_hi:[1,0,0] neg_lo:[0,0,1] neg_hi:[0,0,1]
    v_pk_fma_f32 v[36:37], v[36:37], s[60:61], v[30:31] op_sel_hi:[1,0,0] neg_lo:[0,0,1] neg_hi:[0,0,1]
    v_pk_fma_f32 v[38:39], v[38:39], s[60:61], v[30:31] op_sel_hi:[1,0,0] neg_lo:[0,0,1] neg_hi:[0,0,1]
    v_pk_fma_f32 v[40:41], v[40:41], s[60:61], v[30:31] op_sel_hi:[1,0,0] neg_lo:[0,0,1] neg_hi:[0,0,1]
    v_pk_fma_f32 v[42:43], v[42:43], s[60:61], v[30:31] op_sel_hi:[1,0,0] neg_lo:[0,0,1] neg_hi:[0,0,1]
    v_pk_fma_f32 v[44:45], v[44:45], s[60:61], v[30:31] op_sel_hi:[1,0,0] neg_lo:[0,0,1] neg_hi:[0,0,1]
    v_pk_fma_f32 v[46:47], v[46:47], s[60:61], v[30:31] op_sel_hi:[1,0,0] neg_lo:[0,0,1] neg_hi:[0,0,1]
    v_mul_f32 v15, v15, v187
    v_exp_f32 v32, v32
    v_exp_f32 v33, v33
    v_exp_f32 v34, v34
    v_exp_f32 v35, v35
    v_exp_f32 v36, v36
    v_exp_f32 v37, v37
    v_exp_f32 v38, v38
    v_exp_f32 v39, v39
    v_exp_f32 v40, v40
    s_cbranch_vccnz L_w2_360
    s_bitcmp1_b32 s34, 0
    s_cbranch_scc1 L_w1_360
    s_waitcnt vmcnt(3)
L_w1_360:
    s_waitcnt vmcnt(4)
L_w2_360:
    s_waitcnt vmcnt(5)
    buffer_load_dwordx4 v10, s[4:7], s57 offen offset:2048 nt lds
    s_mov_b64 exec, s[76:77]
    buffer_load_dword v234, v249, s[24:27], s65 offen sc1
    s_mov_b64 exec, -1
    v_exp_f32 v41, v41
    v_exp_f32 v42, v42
    v_exp_f32 v43, v43
    v_exp_f32 v44, v44
    v_exp_f32 v45, v45
    v_exp_f32 v46, v46
    v_exp_f32 v47, v47
    v_pk_add_f32 v[2:3], v[32:33], v[34:35]
    v_pk_add_f32 v[4:5], v[36:37], v[38:39]
    v_pk_add_f32 v[2:3], v[2:3], v[40:41]
    v_pk_add_f32 v[4:5], v[4:5], v[42:43]
    v_pk_add_f32 v[2:3], v[2:3], v[44:45]
    v_pk_add_f32 v[4:5], v[4:5], v[46:47]
    v_pk_add_f32 v[2:3], v[2:3], v[4:5]
    v_add_f32 v2, v2, v3
    v_add_f32 v15, v15, v2
    v_cvt_pk_bf16_f32 v48, v32, v33
    v_cvt_pk_bf16_f32 v49, v34, v35
    v_cvt_pk_bf16_f32 v50, v36, v37
    s_cbranch_vccnz L_w2_362
    s_bitcmp1_b32 s34, 0
    s_cbranch_scc1 L_w1_362
    s_waitcnt vmcnt(4)
L_w1_362:
    s_waitcnt vmcnt(5)
L_w2_362:
    s_waitcnt vmcnt(6)
    buffer_load_dwordx4 v11, s[4:7], s57 offen offset:3072 nt lds
    v_cvt_pk_bf16_f32 v51, v38, v39
    v_cvt_pk_bf16_f32 v52, v40, v41
    v_cvt_pk_bf16_f32 v53, v42, v43
    v_cvt_pk_bf16_f32 v54, v44, v45
    v_cvt_pk_bf16_f32 v55, v46, v47
    v_accvgpr_write_b32 a208, v48
    v_accvgpr_write_b32 a209, v49
    v_accvgpr_write_b32 a210, v50
    v_accvgpr_write_b32 a211, v51
    v_accvgpr_write_b32 a212, v52
    v_accvgpr_write_b32 a213, v53
    v_accvgpr_write_b32 a214, v54
    v_accvgpr_write_b32 a215, v55
    v_mfma_f32_32x32x16_bf16 v[32:47], a[224:227], v[192:195], 0
    v_mfma_f32_32x32x16_bf16 v[32:47], a[228:231], v[196:199], v[32:47]
    s_add_u32 s49, s49, s100
    s_lshr_b32 s34, s49, 4
    s_and_b32 s49, s49, 15
    s_cmp_ge_u32 s34, 2
    s_cselect_b64 vcc, -1, 0
    s_cmp_lg_u32 s44, 32
    s_cbranch_scc1 L_nr32
    s_mov_b32 s3, 84224
    v_mov_b32 v246, 1
    s_mov_b64 exec, 1
    buffer_atomic_add v246, off, s[24:27], s3 sc0
    s_mov_b64 exec, -1
L_nr32:
    v_add_u32 v0, 1, v0
    s_mov_b64 exec, s[32:33]
    buffer_store_dword v0, v242, s[24:27], s35 offen
    s_mov_b64 exec, -1
    buffer_load_dword v244, v242, s[24:27], s35 offen sc1
    s_xor_b32 s57, s99, 0
    s_add_u32 m0, s56, 0
    s_cbranch_vccnz L_w2_365
    s_bitcmp1_b32 s34, 0
    s_cbranch_scc1 L_w1_365
    s_waitcnt vmcnt(6)
L_w1_365:
    s_waitcnt vmcnt(7)
L_w2_365:
    s_waitcnt vmcnt(8)
    buffer_load_dwordx4 v12, s[8:11], s57 offen offset:0 nt lds
    v_mfma_f32_32x32x16_bf16 v[32:47], a[232:235], v[200:203], v[32:47]
    v_mfma_f32_32x32x16_bf16 v[32:47], a[236:239], v[204:207], v[32:47]
    v_mfma_f32_32x32x16_bf16 v[32:47], a[240:243], v[208:211], v[32:47]
    v_mfma_f32_32x32x16_bf16 v[32:47], a[244:247], v[212:215], v[32:47]
    s_cbranch_vccnz L_w2_366
    s_bitcmp1_b32 s34, 0
    s_cbranch_scc1 L_w1_366
    s_waitcnt vmcnt(6)
L_w1_366:
    s_waitcnt vmcnt(7)
L_w2_366:
    s_waitcnt vmcnt(8)
    buffer_load_dwordx4 v12, s[8:11], s57 offen offset:1024 nt lds
    v_mfma_f32_32x32x16_bf16 v[32:47], a[248:251], v[216:219], v[32:47]
    v_mfma_f32_32x32x16_bf16 v[32:47], a[252:255], v[220:223], v[32:47]
    s_nop 11
    v_max3_f32 v13, v32, v33, v34
    v_max3_f32 v31, v35, v36, v37
    v_max3_f32 v13, v13, v38, v39
    v_max3_f32 v31, v31, v40, v41
    v_max3_f32 v13, v13, v42, v43
    v_max3_f32 v31, v31, v44, v45
    v_max3_f32 v13, v13, v46, v47
    v_max3_f32 v13, v13, v31, v14
    v_mov_b32 v31, v13
    s_nop 1
    v_permlane32_swap_b32 v13, v31
    s_cbranch_vccnz L_w2_367
    s_bitcmp1_b32 s34, 0
    s_cbranch_scc1 L_w1_367
    s_waitcnt vmcnt(6)
L_w1_367:
    s_waitcnt vmcnt(7)
L_w2_367:
    s_waitcnt vmcnt(8)
    buffer_load_dwordx4 v12, s[8:11], s57 offen offset:2048 nt lds
    v_max_f32 v13, v13, v31
    v_sub_f32 v31, v14, v13
    v_mul_f32 v30, s60, v13
    v_mul_f32 v31, s60, v31
    v_mov_b32 v14, v13
    v_exp_f32 v188, v31
    v_pk_fma_f32 v[32:33], v[32:33], s[60:61], v[30:31] op_sel_hi:[1,0,0] neg_lo:[0,0,1] neg_hi:[0,0,1]
    v_pk_fma_f32 v[34:35], v[34:35], s[60:61], v[30:31] op_sel_hi:[1,0,0] neg_lo:[0,0,1] neg_hi:[0,0,1]
    v_pk_fma_f32 v[36:37], v[36:37], s[60:61], v[30:31] op_sel_hi:[1,0,0] neg_lo:[0,0,1] neg_hi:[0,0,1]
    v_pk_fma_f32 v[38:39], v[38:39], s[60:61], v[30:31] op_sel_hi:[1,0,0] neg_lo:[0,0,1] neg_hi:[0,0,1]
    v_pk_fma_f32 v[40:41], v[40:41], s[60:61], v[30:31] op_sel_hi:[1,0,0] neg_lo:[0,0,1] neg_hi:[0,0,1]
    v_pk_fma_f32 v[42:43], v[42:43], s[60:61], v[30:31] op_sel_hi:[1,0,0] neg_lo:[0,0,1] neg_hi:[0,0,1]
    v_pk_fma_f32 v[44:45], v[44:45], s[60:61], v[30:31] op_sel_hi:[1,0,0] neg_lo:[0,0,1] neg_hi:[0,0,1]
    v_pk_fma_f32 v[46:47], v[46:47], s[60:61], v[30:31] op_sel_hi:[1,0,0] neg_lo:[0,0,1] neg_hi:[0,0,1]
    v_mul_f32 v15, v15, v188
    v_exp_f32 v32, v32
    v_exp_f32 v33, v33
    v_exp_f32 v34, v34
    v_exp_f32 v35, v35
    v_exp_f32 v36, v36
    s_cbranch_vccnz L_w2_368
    s_bitcmp1_b32 s34, 0
    s_cbranch_scc1 L_w1_368
    s_waitcnt vmcnt(5)
L_w1_368:
    s_waitcnt vmcnt(7)
L_w2_368:
    s_waitcnt vmcnt(8)
    buffer_load_dwordx4 v12, s[8:11], s57 offen offset:3072 nt lds
    v_exp_f32 v37, v37
    v_exp_f32 v38, v38
    v_exp_f32 v39, v39
    v_exp_f32 v40, v40
    v_exp_f32 v41, v41
    v_exp_f32 v42, v42
    v_exp_f32 v43, v43
    v_exp_f32 v44, v44
    v_exp_f32 v45, v45
    v_exp_f32 v46, v46
    v_exp_f32 v47, v47
    v_pk_add_f32 v[2:3], v[32:33], v[34:35]
    v_pk_add_f32 v[4:5], v[36:37], v[38:39]
    v_pk_add_f32 v[2:3], v[2:3], v[40:41]
    v_pk_add_f32 v[4:5], v[4:5], v[42:43]
    s_add_u32 s49, s49, s100
    s_lshr_b32 s34, s49, 4
    s_and_b32 s49, s49, 15
    s_cmp_ge_u32 s34, 2
    s_cselect_b64 vcc, -1, 0
    s_xor_b32 s57, s99, 4096
    s_add_u32 m0, s56, 4096
    s_cbranch_vccnz L_w2_369
    s_bitcmp1_b32 s34, 0
    s_cbranch_scc1 L_w1_369
    s_waitcnt vmcnt(3)
L_w1_369:
    s_waitcnt vmcnt(6)
L_w2_369:
    s_waitcnt vmcnt(8)
    buffer_load_dwordx4 v12, s[8:11], s57 offen offset:0 nt lds
    v_pk_add_f32 v[2:3], v[2:3], v[44:45]
    v_pk_add_f32 v[4:5], v[4:5], v[46:47]
    v_pk_add_f32 v[2:3], v[2:3], v[4:5]
    v_add_f32 v2, v2, v3
    v_add_f32 v15, v15, v2
    v_cvt_pk_bf16_f32 v48, v32, v33
    v_cvt_pk_bf16_f32 v49, v34, v35
    v_cvt_pk_bf16_f32 v50, v36, v37
    v_cvt_pk_bf16_f32 v51, v38, v39
    v_cvt_pk_bf16_f32 v52, v40, v41
    v_cvt_pk_bf16_f32 v53, v42, v43
    v_cvt_pk_bf16_f32 v54, v44, v45
    v_cvt_pk_bf16_f32 v55, v46, v47
    v_accvgpr_write_b32 a216, v48
    v_accvgpr_write_b32 a217, v49
    v_accvgpr_write_b32 a218, v50
    v_accvgpr_write_b32 a219, v51
    v_accvgpr_write_b32 a220, v52
    v_accvgpr_write_b32 a221, v53
    v_accvgpr_write_b32 a222, v54
    v_accvgpr_write_b32 a223, v55
    v_mfma_f32_32x32x16_bf16 v[32:47], v[128:131], v[192:195], 0
    s_cbranch_vccnz L_w2_370
    s_bitcmp1_b32 s34, 0
    s_cbranch_scc1 L_w1_370
    s_waitcnt vmcnt(3)
L_w1_370:
    s_waitcnt vmcnt(4)
L_w2_370:
    s_waitcnt vmcnt(7)
    buffer_load_dwordx4 v12, s[8:11], s57 offen offset:1024 nt lds
    v_mfma_f32_32x32x16_bf16 v[32:47], v[132:135], v[196:199], v[32:47]
    v_mfma_f32_32x32x16_bf16 v[32:47], v[136:139], v[200:203], v[32:47]
    v_mfma_f32_32x32x16_bf16 v[32:47], v[140:143], v[204:207], v[32:47]
    v_mfma_f32_32x32x16_bf16 v[32:47], v[144:147], v[208:211], v[32:47]
    s_cbranch_vccnz L_w2_371
    s_bitcmp1_b32 s34, 0
    s_cbranch_scc1 L_w1_371
    s_waitcnt vmcnt(3)
L_w1_371:
    s_waitcnt vmcnt(4)
L_w2_371:
    s_waitcnt vmcnt(5)
    buffer_load_dwordx4 v12, s[8:11], s57 offen offset:2048 nt lds
    v_mfma_f32_32x32x16_bf16 v[32:47], v[148:151], v[212:215], v[32:47]
    v_mfma_f32_32x32x16_bf16 v[32:47], v[152:155], v[216:219], v[32:47]
    v_mfma_f32_32x32x16_bf16 v[32:47], v[156:159], v[220:223], v[32:47]
    ds_read_b128 v[128:131], v16 offset:16384
    ds_read_b128 v[132:135], v17 offset:16384
    ds_read_b128 v[136:139], v18 offset:16384
    ds_read_b128 v[140:143], v19 offset:16384
    ds_read_b128 v[144:147], v20 offset:16384
    ds_read_b128 v[148:151], v21 offset:16384
    ds_read_b128 v[152:155], v22 offset:16384
    ds_read_b128 v[156:159], v23 offset:16384
    s_nop 3
    v_max3_f32 v13, v32, v33, v34
    v_max3_f32 v31, v35, v36, v37
    s_cbranch_vccnz L_w2_372
    s_bitcmp1_b32 s34, 0
    s_cbranch_scc1 L_w1_372
    s_waitcnt vmcnt(3)
L_w1_372:
    s_waitcnt vmcnt(4)
L_w2_372:
    s_waitcnt vmcnt(5)
    buffer_load_dwordx4 v12, s[8:11], s57 offen offset:3072 nt lds
    v_max3_f32 v13, v13, v38, v39
    v_max3_f32 v31, v31, v40, v41
    v_max3_f32 v13, v13, v42, v43
    v_max3_f32 v31, v31, v44, v45
    v_max3_f32 v13, v13, v46, v47
    v_max3_f32 v13, v13, v31, v14
    v_mov_b32 v31, v13
    s_nop 1
    v_permlane32_swap_b32 v13, v31
    v_max_f32 v13, v13, v31
    v_sub_f32 v31, v14, v13
    v_mul_f32 v30, s60, v13
    v_mul_f32 v31, s60, v31
    v_mov_b32 v14, v13
    v_exp_f32 v189, v31
    s_waitcnt lgkmcnt(0)
    v_pk_fma_f32 v[32:33], v[32:33], s[60:61], v[30:31] op_sel_hi:[1,0,0] neg_lo:[0,0,1] neg_hi:[0,0,1]
    v_pk_fma_f32 v[34:35], v[34:35], s[60:61], v[30:31] op_sel_hi:[1,0,0] neg_lo:[0,0,1] neg_hi:[0,0,1]
    v_pk_fma_f32 v[36:37], v[36:37], s[60:61], v[30:31] op_sel_hi:[1,0,0] neg_lo:[0,0,1] neg_hi:[0,0,1]
    v_pk_fma_f32 v[38:39], v[38:39], s[60:61], v[30:31] op_sel_hi:[1,0,0] neg_lo:[0,0,1] neg_hi:[0,0,1]
    v_pk_fma_f32 v[40:41], v[40:41], s[60:61], v[30:31] op_sel_hi:[1,0,0] neg_lo:[0,0,1] neg_hi:[0,0,1]
    v_pk_fma_f32 v[42:43], v[42:43], s[60:61], v[30:31] op_sel_hi:[1,0,0] neg_lo:[0,0,1] neg_hi:[0,0,1]
    v_pk_fma_f32 v[44:45], v[44:45], s[60:61], v[30:31] op_sel_hi:[1,0,0] neg_lo:[0,0,1] neg_hi:[0,0,1]
    v_pk_fma_f32 v[46:47], v[46:47], s[60:61], v[30:31] op_sel_hi:[1,0,0] neg_lo:[0,0,1] neg_hi:[0,0,1]
    v_mul_f32 v15, v15, v189
    v_exp_f32 v32, v32
    s_cmp_lg_u32 s44, 32
    s_cbranch_scc1 L_nc32
    v_sub_u32 v247, v246, v245
    v_lshlrev_b32 v246, 8, v254
    v_readfirstlane_b32 s3, v247
    s_nop 0
    s_min_u32 s3, s3, 7
    s_mul_i32 s3, s3, 6
    s_add_u32 s3, s3, s45
    v_mov_b32 v247, s3
    s_and_b32 s3, s35, 0xfffffcff
    s_mov_b64 exec, 15
    buffer_store_dword v247, v246, s[24:27], s3 offen offset:128
    s_mov_b64 exec, -1
L_nc32:
    v_sub_u32 v244, v244, v0
    v_cmp_gt_u32 s[100:101], 64, v244
    v_readlane_b32 s46, v244, 32
    s_bcnt1_i32_b32 s3, s100
    s_mul_i32 s3, s3, 3
    s_add_u32 s46, s46, 10
    s_cmp_lt_u32 s46, 128
    s_cselect_b32 s46, s46, 21
    s_add_u32 s3, s3, s46
    s_ashr_i32 s3, s3, 2
    s_add_i32 s3, s3, 2
    s_max_i32 s3, s3, 8
    s_min_i32 s100, s3, 32
    s_add_u32 s49, s49, s100
    s_lshr_b32 s34, s49, 4
    s_and_b32 s49, s49, 15
    s_cmp_ge_u32 s34, 2
    s_cselect_b64 vcc, -1, 0
    s_xor_b32 s57, s99, 16384
    s_add_u32 m0, s56, 8192
    s_cbranch_vccnz L_w2_373
    s_bitcmp1_b32 s34, 0
    s_cbranch_scc1 L_w1_373
    s_waitcnt vmcnt(3)
L_w1_373:
    s_waitcnt vmcnt(4)
L_w2_373:
    s_waitcnt vmcnt(5)
    buffer_load_dwordx4 v12, s[8:11], s57 offen offset:0 nt lds
    v_exp_f32 v33, v33
    v_exp_f32 v34, v34
    v_exp_f32 v35, v35
    v_exp_f32 v36, v36
    v_exp_f32 v37, v37
    v_exp_f32 v38, v38
    v_exp_f32 v39, v39
    v_exp_f32 v40, v40
    v_exp_f32 v41, v41
    v_exp_f32 v42, v42
    v_exp_f32 v43, v43
    v_exp_f32 v44, v44
    v_exp_f32 v45, v45
    s_cbranch_vccnz L_w2_374
    s_bitcmp1_b32 s34, 0
    s_cbranch_scc1 L_w1_374
    s_waitcnt vmcnt(3)
L_w1_374:
    s_waitcnt vmcnt(4)
L_w2_374:
    s_waitcnt vmcnt(5)
    buffer_load_dwordx4 v12, s[8:11], s57 offen offset:1024 nt lds
    v_exp_f32 v46, v46
    v_exp_f32 v47, v47
    v_pk_add_f32 v[2:3], v[32:33], v[34:35]
    v_pk_add_f32 v[4:5], v[36:37], v[38:39]
    v_pk_add_f32 v[2:3], v[2:3], v[40:41]
    v_pk_add_f32 v[4:5], v[4:5], v[42:43]
    v_pk_add_f32 v[2:3], v[2:3], v[44:45]
    v_pk_add_f32 v[4:5], v[4:5], v[46:47]
    v_pk_add_f32 v[2:3], v[2:3], v[4:5]
    v_add_f32 v2, v2, v3
    v_add_f32 v15, v15, v2
    v_cvt_pk_bf16_f32 v48, v32, v33
    v_cvt_pk_bf16_f32 v49, v34, v35
    v_cvt_pk_bf16_f32 v50, v36, v37
    v_cvt_pk_bf16_f32 v51, v38, v39
    v_cvt_pk_bf16_f32 v52, v40, v41
    v_cvt_pk_bf16_f32 v53, v42, v43
    v_cvt_pk_bf16_f32 v54, v44, v45
    v_cvt_pk_bf16_f32 v55, v46, v47
    v_accvgpr_write_b32 a224, v48
    v_accvgpr_write_b32 a225, v49
    v_accvgpr_write_b32 a226, v50
    v_accvgpr_write_b32 a227, v51
    v_accvgpr_write_b32 a228, v52
    s_cbranch_vccnz L_w2_375
    s_bitcmp1_b32 s34, 0
    s_cbranch_scc1 L_w1_375
    s_waitcnt vmcnt(3)
L_w1_375:
    s_waitcnt vmcnt(4)
L_w2_375:
    s_waitcnt vmcnt(5)
    buffer_load_dwordx4 v12, s[8:11], s57 offen offset:2048 nt lds
    v_accvgpr_write_b32 a229, v53
    v_accvgpr_write_b32 a230, v54
    v_accvgpr_write_b32 a231, v55
    v_mfma_f32_32x32x16_bf16 v[32:47], v[128:131], v[192:195], 0
    v_mfma_f32_32x32x16_bf16 v[32:47], v[132:135], v[196:199], v[32:47]
    v_mfma_f32_32x32x16_bf16 v[32:47], v[136:139], v[200:203], v[32:47]
    s_cbranch_vccnz L_w2_376
    s_bitcmp1_b32 s34, 0
    s_cbranch_scc1 L_w1_376
    s_waitcnt vmcnt(3)
L_w1_376:
    s_waitcnt vmcnt(4)
L_w2_376:
    s_waitcnt vmcnt(5)
    buffer_load_dwordx4 v12, s[8:11], s57 offen offset:3072 nt lds
    v_mfma_f32_32x32x16_bf16 v[32:47], v[140:143], v[204:207], v[32:47]
    v_mfma_f32_32x32x16_bf16 v[32:47], v[144:147], v[208:211], v[32:47]
    v_mfma_f32_32x32x16_bf16 v[32:47], v[148:151], v[212:215], v[32:47]
    v_mfma_f32_32x32x16_bf16 v[32:47], v[152:155], v[216:219], v[32:47]
    s_add_u32 s49, s49, s100
    s_lshr_b32 s34, s49, 4
    s_and_b32 s49, s49, 15
    s_cmp_ge_u32 s34, 2
    s_cselect_b64 vcc, -1, 0
    s_xor_b32 s57, s99, 20480
    s_add_u32 m0, s56, 12288
    s_cbranch_vccnz L_w2_377
    s_bitcmp1_b32 s34, 0
    s_cbranch_scc1 L_w1_377
    s_waitcnt vmcnt(3)
L_w1_377:
    s_waitcnt vmcnt(4)
L_w2_377:
    s_waitcnt vmcnt(5)
    buffer_load_dwordx4 v12, s[8:11], s57 offen offset:0 nt lds
    v_mfma_f32_32x32x16_bf16 v[32:47], v[156:159], v[220:223], v[32:47]
    ds_read_b128 v[128:131], v16 offset:24576
    ds_read_b128 v[132:135], v17 offset:24576
    ds_read_b128 v[136:139], v18 offset:24576
    ds_read_b128 v[140:143], v19 offset:24576
    ds_read_b128 v[144:147], v20 offset:24576
    ds_read_b128 v[148:151], v21 offset:24576
    ds_read_b128 v[152:155], v22 offset:24576
    ds_read_b128 v[156:159], v23 offset:24576
    s_nop 3
    v_max3_f32 v13, v32, v33, v34
    v_max3_f32 v31, v35, v36, v37
    v_max3_f32 v13, v13, v38, v39
    v_max3_f32 v31, v31, v40, v41
    v_max3_f32 v13, v13, v42, v43
    v_max3_f32 v31, v31, v44, v45
    v_max3_f32 v13, v13, v46, v47
    v_max3_f32 v13, v13, v31, v14
    v_mov_b32 v31, v13
    s_nop 1
    v_permlane32_swap_b32 v13, v31
    v_max_f32 v13, v13, v31
    v_sub_f32 v31, v14, v13
    v_mul_f32 v30, s60, v13
    v_mul_f32 v31, s60, v31
    v_mov_b32 v14, v13
    v_exp_f32 v190, v31
    s_waitcnt lgkmcnt(0)
    v_pk_fma_f32 v[32:33], v[32:33], s[60:61], v[30:31] op_sel_hi:[1,0,0] neg_lo:[0,0,1] neg_hi:[0,0,1]
    s_cbranch_vccnz L_w2_378
    s_bitcmp1_b32 s34, 0
    s_cbranch_scc1 L_w1_378
    s_waitcnt vmcnt(3)
L_w1_378:
    s_waitcnt vmcnt(4)
L_w2_378:
    s_waitcnt vmcnt(5)
    buffer_load_dwordx4 v12, s[8:11], s57 offen offset:1024 nt lds
    v_pk_fma_f32 v[34:35], v[34:35], s[60:61], v[30:31] op_sel_hi:[1,0,0] neg_lo:[0,0,1] neg_hi:[0,0,1]
    v_pk_fma_f32 v[36:37], v[36:37], s[60:61], v[30:31] op_sel_hi:[1,0,0] neg_lo:[0,0,1] neg_hi:[0,0,1]
    v_pk_fma_f32 v[38:39], v[38:39], s[60:61], v[30:31] op_sel_hi:[1,0,0] neg_lo:[0,0,1] neg_hi:[0,0,1]
    v_pk_fma_f32 v[40:41], v[40:41], s[60:61], v[30:31] op_sel_hi:[1,0,0] neg_lo:[0,0,1] neg_hi:[0,0,1]
    v_pk_fma_f32 v[42:43], v[42:43], s[60:61], v[30:31] op_sel_hi:[1,0,0] neg_lo:[0,0,1] neg_hi:[0,0,1]
    v_pk_fma_f32 v[44:45], v[44:45], s[60:61], v[30:31] op_sel_hi:[1,0,0] neg_lo:[0,0,1] neg_hi:[0,0,1]
    v_pk_fma_f32 v[46:47], v[46:47], s[60:61], v[30:31] op_sel_hi:[1,0,0] neg_lo:[0,0,1] neg_hi:[0,0,1]
    v_mul_f32 v15, v15, v190
    v_exp_f32 v32, v32
    v_exp_f32 v33, v33
    v_exp_f32 v34, v34
    v_exp_f32 v35, v35
    v_exp_f32 v36, v36
    v_exp_f32 v37, v37
    v_exp_f32 v38, v38
    v_exp_f32 v39, v39
    v_exp_f32 v40, v40
    s_cbranch_vccnz L_w2_379
    s_bitcmp1_b32 s34, 0
    s_cbranch_scc1 L_w1_379
    s_waitcnt vmcnt(3)
L_w1_379:
    s_waitcnt vmcnt(4)
L_w2_379:
    s_waitcnt vmcnt(5)
    buffer_load_dwordx4 v12, s[8:11], s57 offen offset:2048 nt lds
    v_exp_f32 v41, v41
    v_exp_f32 v42, v42
    v_exp_f32 v43, v43
    v_exp_f32 v44, v44
    v_exp_f32 v45, v45
    v_exp_f32 v46, v46
    v_exp_f32 v47, v47
    v_pk_add_f32 v[2:3], v[32:33], v[34:35]
    v_pk_add_f32 v[4:5], v[36:37], v[38:39]
    v_pk_add_f32 v[2:3], v[2:3], v[40:41]
    v_pk_add_f32 v[4:5], v[4:5], v[42:43]
    v_pk_add_f32 v[2:3], v[2:3], v[44:45]
    v_pk_add_f32 v[4:5], v[4:5], v[46:47]
    v_pk_add_f32 v[2:3], v[2:3], v[4:5]
    v_add_f32 v2, v2, v3
    v_add_f32 v15, v15, v2
    v_accvgpr_write_b32 a240, v32
    v_accvgpr_write_b32 a241, v33
    v_accvgpr_write_b32 a242, v34
    s_cbranch_vccnz L_w2_380
    s_bitcmp1_b32 s34, 0
    s_cbranch_scc1 L_w1_380
    s_waitcnt vmcnt(3)
L_w1_380:
    s_waitcnt vmcnt(4)
L_w2_380:
    s_waitcnt vmcnt(5)
    buffer_load_dwordx4 v12, s[8:11], s57 offen offset:3072 nt lds
    v_accvgpr_write_b32 a243, v35
    v_accvgpr_write_b32 a244, v36
    v_accvgpr_write_b32 a245, v37
    v_accvgpr_write_b32 a246, v38
    v_accvgpr_write_b32 a247, v39
    v_accvgpr_write_b32 a248, v40
    v_accvgpr_write_b32 a249, v41
    v_accvgpr_write_b32 a250, v42
    v_accvgpr_write_b32 a251, v43
    v_accvgpr_write_b32 a252, v44
    v_accvgpr_write_b32 a253, v45
    v_accvgpr_write_b32 a254, v46
    v_accvgpr_write_b32 a255, v47
    v_mfma_f32_32x32x16_bf16 v[32:47], v[128:131], v[192:195], 0
    v_mfma_f32_32x32x16_bf16 v[32:47], v[132:135], v[196:199], v[32:47]
    s_add_u32 s49, s49, s100
    s_lshr_b32 s34, s49, 4
    s_and_b32 s49, s49, 15
    s_cmp_ge_u32 s34, 2
    s_cselect_b64 vcc, -1, 0
    s_cmp_lg_u32 s44, 34
    s_cbranch_scc1 L_nr34
    s_mov_b32 s3, 84480
    v_mov_b32 v246, 1
    s_mov_b64 exec, 1
    buffer_atomic_add v246, off, s[24:27], s3 sc0
    s_mov_b64 exec, -1
L_nr34:
    v_add_u32 v0, 1, v0
    s_mov_b64 exec, s[32:33]
    buffer_store_dword v0, v242, s[24:27], s35 offen
    s_mov_b64 exec, -1
    buffer_load_dword v244, v242, s[24:27], s35 offen sc1
    s_xor_b32 s57, s99, 344064
    s_add_u32 m0, s56, 16384
    s_cbranch_vccnz L_w2_383
    s_bitcmp1_b32 s34, 0
    s_cbranch_scc1 L_w1_383
    s_waitcnt vmcnt(5)
L_w1_383:
    s_waitcnt vmcnt(6)
L_w2_383:
    s_waitcnt vmcnt(7)
    buffer_load_dwordx4 v12, s[8:11], s57 offen offset:0 nt lds
    v_mfma_f32_32x32x16_bf16 v[32:47], v[136:139], v[200:203], v[32:47]
    v_mfma_f32_32x32x16_bf16 v[32:47], v[140:143], v[204:207], v[32:47]
    v_mfma_f32_32x32x16_bf16 v[32:47], v[144:147], v[208:211], v[32:47]
    v_mfma_f32_32x32x16_bf16 v[32:47], v[148:151], v[212:215], v[32:47]
    s_cbranch_vccnz L_w2_384
    s_bitcmp1_b32 s34, 0
    s_cbranch_scc1 L_w1_384
    s_waitcnt vmcnt(5)
L_w1_384:
    s_waitcnt vmcnt(6)
L_w2_384:
    s_waitcnt vmcnt(7)
    buffer_load_dwordx4 v12, s[8:11], s57 offen offset:1024 nt lds
    v_mfma_f32_32x32x16_bf16 v[32:47], v[152:155], v[216:219], v[32:47]
    v_mfma_f32_32x32x16_bf16 v[32:47], v[156:159], v[220:223], v[32:47]
    s_nop 11
    v_max3_f32 v13, v32, v33, v34
    v_max3_f32 v31, v35, v36, v37
    v_max3_f32 v13, v13, v38, v39
    v_max3_f32 v31, v31, v40, v41
    v_max3_f32 v13, v13, v42, v43
    v_max3_f32 v31, v31, v44, v45
    v_max3_f32 v13, v13, v46, v47
    v_max3_f32 v13, v13, v31, v14
    v_mov_b32 v31, v13
    s_nop 1
    v_permlane32_swap_b32 v13, v31
    s_cbranch_vccnz L_w2_385
    s_bitcmp1_b32 s34, 0
    s_cbranch_scc1 L_w1_385
    s_waitcnt vmcnt(5)
L_w1_385:
    s_waitcnt vmcnt(6)
L_w2_385:
    s_waitcnt vmcnt(7)
    buffer_load_dwordx4 v12, s[8:11], s57 offen offset:2048 nt lds
    v_max_f32 v13, v13, v31
    v_sub_f32 v31, v14, v13
    v_mul_f32 v30, s60, v13
    v_mul_f32 v31, s60, v31
    v_mov_b32 v14, v13
    v_exp_f32 v191, v31
    v_pk_fma_f32 v[32:33], v[32:33], s[60:61], v[30:31] op_sel_hi:[1,0,0] neg_lo:[0,0,1] neg_hi:[0,0,1]
    v_pk_fma_f32 v[34:35], v[34:35], s[60:61], v[30:31] op_sel_hi:[1,0,0] neg_lo:[0,0,1] neg_hi:[0,0,1]
    v_pk_fma_f32 v[36:37], v[36:37], s[60:61], v[30:31] op_sel_hi:[1,0,0] neg_lo:[0,0,1] neg_hi:[0,0,1]
    v_pk_fma_f32 v[38:39], v[38:39], s[60:61], v[30:31] op_sel_hi:[1,0,0] neg_lo:[0,0,1] neg_hi:[0,0,1]
    v_pk_fma_f32 v[40:41], v[40:41], s[60:61], v[30:31] op_sel_hi:[1,0,0] neg_lo:[0,0,1] neg_hi:[0,0,1]
    v_pk_fma_f32 v[42:43], v[42:43], s[60:61], v[30:31] op_sel_hi:[1,0,0] neg_lo:[0,0,1] neg_hi:[0,0,1]
    v_pk_fma_f32 v[44:45], v[44:45], s[60:61], v[30:31] op_sel_hi:[1,0,0] neg_lo:[0,0,1] neg_hi:[0,0,1]
    v_pk_fma_f32 v[46:47], v[46:47], s[60:61], v[30:31] op_sel_hi:[1,0,0] neg_lo:[0,0,1] neg_hi:[0,0,1]
    v_mul_f32 v15, v15, v191
    v_exp_f32 v32, v32
    v_exp_f32 v33, v33
    v_exp_f32 v34, v34
    v_exp_f32 v35, v35
    v_exp_f32 v36, v36
    s_cbranch_vccnz L_w2_386
    s_bitcmp1_b32 s34, 0
    s_cbranch_scc1 L_w1_386
    s_waitcnt vmcnt(5)
L_w1_386:
    s_waitcnt vmcnt(6)
L_w2_386:
    s_waitcnt vmcnt(7)
    buffer_load_dwordx4 v12, s[8:11], s57 offen offset:3072 nt lds
    v_exp_f32 v37, v37
    v_exp_f32 v38, v38
    v_exp_f32 v39, v39
    v_exp_f32 v40, v40
    v_exp_f32 v41, v41
    v_exp_f32 v42, v42
    v_exp_f32 v43, v43
    v_exp_f32 v44, v44
    v_exp_f32 v45, v45
    v_exp_f32 v46, v46
    v_exp_f32 v47, v47
    v_pk_add_f32 v[2:3], v[32:33], v[34:35]
    v_pk_add_f32 v[4:5], v[36:37], v[38:39]
    v_pk_add_f32 v[2:3], v[2:3], v[40:41]
    v_pk_add_f32 v[4:5], v[4:5], v[42:43]
    s_add_u32 s49, s49, s100
    s_lshr_b32 s34, s49, 4
    s_and_b32 s49, s49, 15
    s_cmp_ge_u32 s34, 2
    s_cselect_b64 vcc, -1, 0
    s_xor_b32 s57, s99, 348160
    s_add_u32 m0, s56, 20480
    s_cbranch_vccnz L_w2_387
    s_bitcmp1_b32 s34, 0
    s_cbranch_scc1 L_w1_387
    s_waitcnt vmcnt(3)
L_w1_387:
    s_waitcnt vmcnt(6)
L_w2_387:
    s_waitcnt vmcnt(7)
    buffer_load_dwordx4 v12, s[8:11], s57 offen offset:0 nt lds
    v_pk_add_f32 v[2:3], v[2:3], v[44:45]
    v_pk_add_f32 v[4:5], v[4:5], v[46:47]
    v_pk_add_f32 v[2:3], v[2:3], v[4:5]
    v_add_f32 v2, v2, v3
    v_add_f32 v15, v15, v2
    s_mov_b32 s66, 200000
L_chk:
    v_cmp_eq_u32 vcc, v234, v255
    s_nop 0
    s_and_b64 s[76:77], s[76:77], vcc
    s_cbranch_scc0 L_chk_ok
    s_sleep 8
    buffer_load_dword v234, v249, s[24:27], s65 offen sc1
    s_waitcnt vmcnt(0)
    s_sub_u32 s66, s66, 1
    s_cmp_gt_i32 s66, 0
    s_cbranch_scc1 L_chk
L_chk_ok:
    s_mov_b64 vcc, 0
    v_mov_b32 v13, v15
    s_lshl_b32 s3, s52, 8
    s_add_u32 s3, s3, 159744
    v_lshlrev_b32 v3, 3, v252
    v_add_u32 v2, s3, v3
    v_add_u32 v1, 159744, v3
    v_permlane32_swap_b32 v15, v13
    v_add_f32 v15, v15, v13
    ds_write_b64 v2, v[14:15]
    buffer_load_dwordx4 v12, s[8:11], s57 offen offset:1024 nt lds
    s_waitcnt lgkmcnt(0)
    s_barrier
    ds_read_b64 v[192:193], v1 offset:0
    ds_read_b64 v[194:195], v1 offset:256
    ds_read_b64 v[196:197], v1 offset:512
    ds_read_b64 v[198:199], v1 offset:768
    s_waitcnt lgkmcnt(0)
    v_max3_f32 v28, v192, v194, v196
    v_max_f32 v28, v28, v198
    v_sub_f32 v192, v192, v28
    v_sub_f32 v194, v194, v28
    v_sub_f32 v196, v196, v28
    v_sub_f32 v198, v198, v28
    v_mul_f32 v192, s60, v192
    v_mul_f32 v194, s60, v194
    v_mul_f32 v196, s60, v196
    v_mul_f32 v198, s60, v198
    v_exp_f32 v192, v192
    v_exp_f32 v194, v194
    v_exp_f32 v196, v196
    v_exp_f32 v198, v198
    v_mul_f32 v29, v192, v193
    buffer_load_dwordx4 v12, s[8:11], s57 offen offset:2048 nt lds
    v_fmac_f32 v29, v194, v195
    v_fmac_f32 v29, v196, v197
    v_fmac_f32 v29, v198, v199
    s_cmp_lt_u32 s52, 2
    s_cselect_b32 s3, 0, 0x80000000
    v_or_b32 v3, s3, v3
    s_lshl_b32 s3, s52, 4
    s_lshl_b32 exec_lo, 0xffff, s3
    s_mov_b32 exec_hi, 0
    s_lshl_b32 s3, s63, 9
    s_add_u32 s3, s3, 131072
    buffer_store_dwordx2 v[28:29], v3, s[24:27], s3 offen sc1
    s_mov_b64 exec, -1
    ds_read_b64_tr_b16 v[128:129], v24 offset:0
    ds_read_b64_tr_b16 v[130:131], v24 offset:2048
    ds_read_b64_tr_b16 v[132:133], v25 offset:0
    ds_read_b64_tr_b16 v[134:135], v25 offset:2048
    ds_read_b64_tr_b16 v[136:137], v26 offset:0
    ds_read_b64_tr_b16 v[138:139], v26 offset:2048
    ds_read_b64_tr_b16 v[140:141], v27 offset:0
    ds_read_b64_tr_b16 v[142:143], v27 offset:2048
    ds_read_b64_tr_b16 v[144:145], v24 offset:4096
    ds_read_b64_tr_b16 v[146:147], v24 offset:6144
    s_waitcnt lgkmcnt(8)
    v_mfma_f32_32x32x16_bf16 v[64:79], v[128:131], v[224:227], 0
    ds_read_b64_tr_b16 v[148:149], v25 offset:4096
    ds_read_b64_tr_b16 v[150:151], v25 offset:6144
    s_waitcnt lgkmcnt(8)
    v_mfma_f32_32x32x16_bf16 v[80:95], v[132:135], v[224:227], 0
    s_cbranch_vccnz L_w2_391
    s_bitcmp1_b32 s34, 0
    s_cbranch_scc1 L_w1_391
    s_waitcnt vmcnt(4)
L_w1_391:
    s_waitcnt vmcnt(5)
L_w2_391:
    s_waitcnt vmcnt(6)
    buffer_load_dwordx4 v12, s[8:11], s57 offen offset:3072 nt lds
    ds_read_b64_tr_b16 v[152:153], v26 offset:4096
    ds_read_b64_tr_b16 v[154:155], v26 offset:6144
    s_waitcnt lgkmcnt(8)
    v_mfma_f32_32x32x16_bf16 v[96:111], v[136:139], v[224:227], 0
    ds_read_b64_tr_b16 v[156:157], v27 offset:4096
    ds_read_b64_tr_b16 v[158:159], v27 offset:6144
    s_waitcnt lgkmcnt(8)
    v_mfma_f32_32x32x16_bf16 v[112:127], v[140:143], v[224:227], 0
    s_waitcnt lgkmcnt(6)
    v_mfma_f32_32x32x16_bf16 v[64:79], v[144:147], v[228:231], v[64:79]
    s_cmp_lg_u32 s44, 34
    s_cbranch_scc1 L_nc34
    v_sub_u32 v247, v246, v245
    v_lshlrev_b32 v246, 8, v254
    v_readfirstlane_b32 s3, v247
    s_nop 0
    s_min_u32 s3, s3, 7
    s_mul_i32 s3, s3, 6
    s_add_u32 s3, s3, s45
    v_mov_b32 v247, s3
    s_and_b32 s3, s35, 0xfffffcff
    s_mov_b64 exec, 15
    buffer_store_dword v247, v246, s[24:27], s3 offen offset:128
    s_mov_b64 exec, -1
L_nc34:
    v_sub_u32 v244, v244, v0
    v_cmp_gt_u32 s[100:101], 64, v244
    v_readlane_b32 s46, v244, 32
    s_bcnt1_i32_b32 s3, s100
    s_mul_i32 s3, s3, 3
    s_add_u32 s46, s46, 11
    s_cmp_lt_u32 s46, 128
    s_cselect_b32 s46, s46, 21
    s_add_u32 s3, s3, s46
    s_ashr_i32 s3, s3, 2
    s_add_i32 s3, s3, 2
    s_max_i32 s3, s3, 8
    s_min_i32 s100, s3, 32
    s_add_u32 s49, s49, s100
    s_lshr_b32 s34, s49, 4
    s_and_b32 s49, s49, 15
    s_cmp_ge_u32 s34, 2
    s_cselect_b64 vcc, -1, 0
    s_xor_b32 s57, s99, 393216
    s_add_u32 m0, s56, 24576
    s_cbranch_vccnz L_w2_392
    s_bitcmp1_b32 s34, 0
    s_cbranch_scc1 L_w1_392
    s_waitcnt vmcnt(4)
L_w1_392:
    s_waitcnt vmcnt(5)
L_w2_392:
    s_waitcnt vmcnt(6)
    buffer_load_dwordx4 v12, s[8:11], s57 offen offset:0 nt lds
    s_waitcnt lgkmcnt(4)
    v_mfma_f32_32x32x16_bf16 v[80:95], v[148:151], v[228:231], v[80:95]
    s_waitcnt lgkmcnt(2)
    v_mfma_f32_32x32x16_bf16 v[96:111], v[152:155], v[228:231], v[96:111]
    s_waitcnt lgkmcnt(0)
    v_mfma_f32_32x32x16_bf16 v[112:127], v[156:159], v[228:231], v[112:127]
    s_cbranch_vccnz L_w2_393
    s_bitcmp1_b32 s34, 0
    s_cbranch_scc1 L_w1_393
    s_waitcnt vmcnt(4)
L_w1_393:
    s_waitcnt vmcnt(5)
L_w2_393:
    s_waitcnt vmcnt(6)
    buffer_load_dwordx4 v12, s[8:11], s57 offen offset:1024 nt lds
    v_pk_mul_f32 v[64:65], v[64:65], v[160:161] op_sel:[0,1] op_sel_hi:[1,1]
    v_pk_mul_f32 v[66:67], v[66:67], v[160:161] op_sel:[0,1] op_sel_hi:[1,1]
    v_pk_mul_f32 v[68:69], v[68:69], v[160:161] op_sel:[0,1] op_sel_hi:[1,1]
    v_pk_mul_f32 v[70:71], v[70:71], v[160:161] op_sel:[0,1] op_sel_hi:[1,1]
    v_pk_mul_f32 v[72:73], v[72:73], v[160:161] op_sel:[0,1] op_sel_hi:[1,1]
    v_pk_mul_f32 v[74:75], v[74:75], v[160:161] op_sel:[0,1] op_sel_hi:[1,1]
    v_pk_mul_f32 v[76:77], v[76:77], v[160:161] op_sel:[0,1] op_sel_hi:[1,1]
    v_pk_mul_f32 v[78:79], v[78:79], v[160:161] op_sel:[0,1] op_sel_hi:[1,1]
    v_pk_mul_f32 v[80:81], v[80:81], v[160:161] op_sel:[0,1] op_sel_hi:[1,1]
    v_pk_mul_f32 v[82:83], v[82:83], v[160:161] op_sel:[0,1] op_sel_hi:[1,1]
    v_pk_mul_f32 v[84:85], v[84:85], v[160:161] op_sel:[0,1] op_sel_hi:[1,1]
    v_pk_mul_f32 v[86:87], v[86:87], v[160:161] op_sel:[0,1] op_sel_hi:[1,1]
    v_pk_mul_f32 v[88:89], v[88:89], v[160:161] op_sel:[0,1] op_sel_hi:[1,1]
    v_pk_mul_f32 v[90:91], v[90:91], v[160:161] op_sel:[0,1] op_sel_hi:[1,1]
    v_pk_mul_f32 v[92:93], v[92:93], v[160:161] op_sel:[0,1] op_sel_hi:[1,1]
    v_pk_mul_f32 v[94:95], v[94:95], v[160:161] op_sel:[0,1] op_sel_hi:[1,1]
    v_pk_mul_f32 v[96:97], v[96:97], v[160:161] op_sel:[0,1] op_sel_hi:[1,1]
    v_pk_mul_f32 v[98:99], v[98:99], v[160:161] op_sel:[0,1] op_sel_hi:[1,1]
    v_pk_mul_f32 v[100:101], v[100:101], v[160:161] op_sel:[0,1] op_sel_hi:[1,1]
    v_pk_mul_f32 v[102:103], v[102:103], v[160:161] op_sel:[0,1] op_sel_hi:[1,1]
    v_pk_mul_f32 v[104:105], v[104:105], v[160:161] op_sel:[0,1] op_sel_hi:[1,1]
    v_pk_mul_f32 v[106:107], v[106:107], v[160:161] op_sel:[0,1] op_sel_hi:[1,1]
    v_pk_mul_f32 v[108:109], v[108:109], v[160:161] op_sel:[0,1] op_sel_hi:[1,1]
    v_pk_mul_f32 v[110:111], v[110:111], v[160:161] op_sel:[0,1] op_sel_hi:[1,1]
    v_pk_mul_f32 v[112:113], v[112:113], v[160:161] op_sel:[0,1] op_sel_hi:[1,1]
    v_pk_mul_f32 v[114:115], v[114:115], v[160:161] op_sel:[0,1] op_sel_hi:[1,1]
    s_cbranch_vccnz L_w2_394
    s_bitcmp1_b32 s34, 0
    s_cbranch_scc1 L_w1_394
    s_waitcnt vmcnt(4)
L_w1_394:
    s_waitcnt vmcnt(5)
L_w2_394:
    s_waitcnt vmcnt(6)
    buffer_load_dwordx4 v12, s[8:11], s57 offen offset:2048 nt lds
    v_pk_mul_f32 v[116:117], v[116:117], v[160:161] op_sel:[0,1] op_sel_hi:[1,1]
    v_pk_mul_f32 v[118:119], v[118:119], v[160:161] op_sel:[0,1] op_sel_hi:[1,1]
    v_pk_mul_f32 v[120:121], v[120:121], v[160:161] op_sel:[0,1] op_sel_hi:[1,1]
    v_pk_mul_f32 v[122:123], v[122:123], v[160:161] op_sel:[0,1] op_sel_hi:[1,1]
    v_pk_mul_f32 v[124:125], v[124:125], v[160:161] op_sel:[0,1] op_sel_hi:[1,1]
    v_pk_mul_f32 v[126:127], v[126:127], v[160:161] op_sel:[0,1] op_sel_hi:[1,1]
    ds_read_b64_tr_b16 v[128:129], v24 offset:8192
    ds_read_b64_tr_b16 v[130:131], v24 offset:10240
    ds_read_b64_tr_b16 v[132:133], v25 offset:8192
    ds_read_b64_tr_b16 v[134:135], v25 offset:10240
    ds_read_b64_tr_b16 v[136:137], v26 offset:8192
    ds_read_b64_tr_b16 v[138:139], v26 offset:10240
    ds_read_b64_tr_b16 v[140:141], v27 offset:8192
    ds_read_b64_tr_b16 v[142:143], v27 offset:10240
    ds_read_b64_tr_b16 v[144:145], v24 offset:12288
    ds_read_b64_tr_b16 v[146:147], v24 offset:14336
    s_waitcnt lgkmcnt(8)
    v_mfma_f32_32x32x16_bf16 v[64:79], v[128:131], a[0:3], v[64:79]
    ds_read_b64_tr_b16 v[148:149], v25 offset:12288
    s_cbranch_vccnz L_w2_395
    s_bitcmp1_b32 s34, 0
    s_cbranch_scc1 L_w1_395
    s_waitcnt vmcnt(3)
L_w1_395:
    s_waitcnt vmcnt(5)
L_w2_395:
    s_waitcnt vmcnt(6)
    buffer_load_dwordx4 v12, s[8:11], s57 offen offset:3072 nt lds
    ds_read_b64_tr_b16 v[150:151], v25 offset:14336
    s_waitcnt lgkmcnt(8)
    v_mfma_f32_32x32x16_bf16 v[80:95], v[132:135], a[0:3], v[80:95]
    ds_read_b64_tr_b16 v[152:153], v26 offset:12288
    ds_read_b64_tr_b16 v[154:155], v26 offset:14336
    s_waitcnt lgkmcnt(8)
    v_mfma_f32_32x32x16_bf16 v[96:111], v[136:139], a[0:3], v[96:111]
    s_add_u32 s49, s49, s100
    s_lshr_b32 s34, s49, 4
    s_and_b32 s49, s49, 15
    s_cmp_ge_u32 s34, 2
    s_cselect_b64 vcc, -1, 0
    s_xor_b32 s57, s99, 397312
    s_add_u32 m0, s56, 28672
    s_cbranch_vccnz L_w2_396
    s_bitcmp1_b32 s34, 0
    s_cbranch_scc1 L_w1_396
    s_waitcnt vmcnt(3)
L_w1_396:
    s_waitcnt vmcnt(4)
L_w2_396:
    s_waitcnt vmcnt(6)
    buffer_load_dwordx4 v12, s[8:11], s57 offen offset:0 nt lds
    ds_read_b64_tr_b16 v[156:157], v27 offset:12288
    ds_read_b64_tr_b16 v[158:159], v27 offset:14336
    s_waitcnt lgkmcnt(8)
    v_mfma_f32_32x32x16_bf16 v[112:127], v[140:143], a[0:3], v[112:127]
    s_waitcnt lgkmcnt(6)
    v_mfma_f32_32x32x16_bf16 v[64:79], v[144:147], a[4:7], v[64:79]
    s_cbranch_vccnz L_w2_397
    s_bitcmp1_b32 s34, 0
    s_cbranch_scc1 L_w1_397
    s_waitcnt vmcnt(3)
L_w1_397:
    s_waitcnt vmcnt(4)
L_w2_397:
    s_waitcnt vmcnt(5)
    buffer_load_dwordx4 v12, s[8:11], s57 offen offset:1024 nt lds
    s_waitcnt lgkmcnt(4)
    v_mfma_f32_32x32x16_bf16 v[80:95], v[148:151], a[4:7], v[80:95]
    s_waitcnt lgkmcnt(2)
    v_mfma_f32_32x32x16_bf16 v[96:111], v[152:155], a[4:7], v[96:111]
    s_waitcnt lgkmcnt(0)
    v_mfma_f32_32x32x16_bf16 v[112:127], v[156:159], a[4:7], v[112:127]
    s_cbranch_vccnz L_w2_398
    s_bitcmp1_b32 s34, 0
    s_cbranch_scc1 L_w1_398
    s_waitcnt vmcnt(3)
L_w1_398:
    s_waitcnt vmcnt(4)
L_w2_398:
    s_waitcnt vmcnt(5)
    buffer_load_dwordx4 v12, s[8:11], s57 offen offset:2048 nt lds
    v_pk_mul_f32 v[64:65], v[64:65], v[162:163] op_sel_hi:[1,0]
    v_pk_mul_f32 v[66:67], v[66:67], v[162:163] op_sel_hi:[1,0]
    v_pk_mul_f32 v[68:69], v[68:69], v[162:163] op_sel_hi:[1,0]
    v_pk_mul_f32 v[70:71], v[70:71], v[162:163] op_sel_hi:[1,0]
    v_pk_mul_f32 v[72:73], v[72:73], v[162:163] op_sel_hi:[1,0]
    v_pk_mul_f32 v[74:75], v[74:75], v[162:163] op_sel_hi:[1,0]
    v_pk_mul_f32 v[76:77], v[76:77], v[162:163] op_sel_hi:[1,0]
    v_pk_mul_f32 v[78:79], v[78:79], v[162:163] op_sel_hi:[1,0]
    v_pk_mul_f32 v[80:81], v[80:81], v[162:163] op_sel_hi:[1,0]
    v_pk_mul_f32 v[82:83], v[82:83], v[162:163] op_sel_hi:[1,0]
    v_pk_mul_f32 v[84:85], v[84:85], v[162:163] op_sel_hi:[1,0]
    v_pk_mul_f32 v[86:87], v[86:87], v[162:163] op_sel_hi:[1,0]
    v_pk_mul_f32 v[88:89], v[88:89], v[162:163] op_sel_hi:[1,0]
    v_pk_mul_f32 v[90:91], v[90:91], v[162:163] op_sel_hi:[1,0]
    v_pk_mul_f32 v[92:93], v[92:93], v[162:163] op_sel_hi:[1,0]
    v_pk_mul_f32 v[94:95], v[94:95], v[162:163] op_sel_hi:[1,0]
    v_pk_mul_f32 v[96:97], v[96:97], v[162:163] op_sel_hi:[1,0]
    v_pk_mul_f32 v[98:99], v[98:99], v[162:163] op_sel_hi:[1,0]
    v_pk_mul_f32 v[100:101], v[100:101], v[162:163] op_sel_hi:[1,0]
    v_pk_mul_f32 v[102:103], v[102:103], v[162:163] op_sel_hi:[1,0]
    v_pk_mul_f32 v[104:105], v[104:105], v[162:163] op_sel_hi:[1,0]
    v_pk_mul_f32 v[106:107], v[106:107], v[162:163] op_sel_hi:[1,0]
    v_pk_mul_f32 v[108:109], v[108:109], v[162:163] op_sel_hi:[1,0]
    v_pk_mul_f32 v[110:111], v[110:111], v[162:163] op_sel_hi:[1,0]
    v_pk_mul_f32 v[112:113], v[112:113], v[162:163] op_sel_hi:[1,0]
    v_pk_mul_f32 v[114:115], v[114:115], v[162:163] op_sel_hi:[1,0]
    s_cbranch_vccnz L_w2_399
    s_bitcmp1_b32 s34, 0
    s_cbranch_scc1 L_w1_399
    s_waitcnt vmcnt(3)
L_w1_399:
    s_waitcnt vmcnt(4)
L_w2_399:
    s_waitcnt vmcnt(5)
    buffer_load_dwordx4 v12, s[8:11], s57 offen offset:3072 nt lds
    v_pk_mul_f32 v[116:117], v[116:117], v[162:163] op_sel_hi:[1,0]
    v_pk_mul_f32 v[118:119], v[118:119], v[162:163] op_sel_hi:[1,0]
    v_pk_mul_f32 v[120:121], v[120:121], v[162:163] op_sel_hi:[1,0]
    v_pk_mul_f32 v[122:123], v[122:123], v[162:163] op_sel_hi:[1,0]
    v_pk_mul_f32 v[124:125], v[124:125], v[162:163] op_sel_hi:[1,0]
    v_pk_mul_f32 v[126:127], v[126:127], v[162:163] op_sel_hi:[1,0]
    ds_read_b64_tr_b16 v[128:129], v24 offset:16384
    ds_read_b64_tr_b16 v[130:131], v24 offset:18432
    ds_read_b64_tr_b16 v[132:133], v25 offset:16384
    ds_read_b64_tr_b16 v[134:135], v25 offset:18432
    ds_read_b64_tr_b16 v[136:137], v26 offset:16384
    ds_read_b64_tr_b16 v[138:139], v26 offset:18432
    ds_read_b64_tr_b16 v[140:141], v27 offset:16384
    ds_read_b64_tr_b16 v[142:143], v27 offset:18432
    ds_read_b64_tr_b16 v[144:145], v24 offset:20480
    ds_read_b64_tr_b16 v[146:147], v24 offset:22528
    s_waitcnt lgkmcnt(8)
    v_mfma_f32_32x32x16_bf16 v[64:79], v[128:131], a[8:11], v[64:79]
    ds_read_b64_tr_b16 v[148:149], v25 offset:20480
    s_add_u32 s49, s49, s100
    s_lshr_b32 s34, s49, 4
    s_and_b32 s49, s49, 15
    s_cmp_ge_u32 s34, 2
    s_cselect_b64 vcc, -1, 0
    s_cmp_lg_u32 s44, 36
    s_cbranch_scc1 L_nr36
    s_mov_b32 s3, 84736
    v_mov_b32 v246, 1
    s_mov_b64 exec, 1
    buffer_atomic_add v246, off, s[24:27], s3 sc0
    s_mov_b64 exec, -1
L_nr36:
    v_add_u32 v0, 1, v0
    s_mov_b64 exec, s[32:33]
    buffer_store_dword v0, v242, s[24:27], s35 offen
    s_mov_b64 exec, -1
    buffer_load_dword v244, v242, s[24:27], s35 offen sc1
    s_xor_b32 s57, s99, 65536
    s_add_u32 m0, s56, 0
    s_cbranch_vccnz L_w2_402
    s_bitcmp1_b32 s34, 0
    s_cbranch_scc1 L_w1_402
    s_waitcnt vmcnt(5)
L_w1_402:
    s_waitcnt vmcnt(6)
L_w2_402:
    s_waitcnt vmcnt(7)
    buffer_load_dwordx4 v12, s[8:11], s57 offen offset:0 nt lds
    ds_read_b64_tr_b16 v[150:151], v25 offset:22528
    s_waitcnt lgkmcnt(8)
    v_mfma_f32_32x32x16_bf16 v[80:95], v[132:135], a[8:11], v[80:95]
    ds_read_b64_tr_b16 v[152:153], v26 offset:20480
    ds_read_b64_tr_b16 v[154:155], v26 offset:22528
    s_waitcnt lgkmcnt(8)
    v_mfma_f32_32x32x16_bf16 v[96:111], v[136:139], a[8:11], v[96:111]
    s_cbranch_vccnz L_w2_403
    s_bitcmp1_b32 s34, 0
    s_cbranch_scc1 L_w1_403
    s_waitcnt vmcnt(5)
L_w1_403:
    s_waitcnt vmcnt(6)
L_w2_403:
    s_waitcnt vmcnt(7)
    buffer_load_dwordx4 v12, s[8:11], s57 offen offset:1024 nt lds
    ds_read_b64_tr_b16 v[156:157], v27 offset:20480
    ds_read_b64_tr_b16 v[158:159], v27 offset:22528
    s_waitcnt lgkmcnt(8)
    v_mfma_f32_32x32x16_bf16 v[112:127], v[140:143], a[8:11], v[112:127]
    s_waitcnt lgkmcnt(6)
    v_mfma_f32_32x32x16_bf16 v[64:79], v[144:147], a[12:15], v[64:79]
    s_cbranch_vccnz L_w2_404
    s_bitcmp1_b32 s34, 0
    s_cbranch_scc1 L_w1_404
    s_waitcnt vmcnt(5)
L_w1_404:
    s_waitcnt vmcnt(6)
L_w2_404:
    s_waitcnt vmcnt(7)
    buffer_load_dwordx4 v12, s[8:11], s57 offen offset:2048 nt lds
    s_waitcnt lgkmcnt(4)
    v_mfma_f32_32x32x16_bf16 v[80:95], v[148:151], a[12:15], v[80:95]
    s_waitcnt lgkmcnt(2)
    v_mfma_f32_32x32x16_bf16 v[96:111], v[152:155], a[12:15], v[96:111]
    s_waitcnt lgkmcnt(0)
    v_mfma_f32_32x32x16_bf16 v[112:127], v[156:159], a[12:15], v[112:127]
    s_cbranch_vccnz L_w2_405
    s_bitcmp1_b32 s34, 0
    s_cbranch_scc1 L_w1_405
    s_waitcnt vmcnt(5)
L_w1_405:
    s_waitcnt vmcnt(6)
L_w2_405:
    s_waitcnt vmcnt(7)
    buffer_load_dwordx4 v12, s[8:11], s57 offen offset:3072 nt lds
    v_pk_mul_f32 v[64:65], v[64:65], v[162:163] op_sel:[0,1] op_sel_hi:[1,1]
    v_pk_mul_f32 v[66:67], v[66:67], v[162:163] op_sel:[0,1] op_sel_hi:[1,1]
    v_pk_mul_f32 v[68:69], v[68:69], v[162:163] op_sel:[0,1] op_sel_hi:[1,1]
    v_pk_mul_f32 v[70:71], v[70:71], v[162:163] op_sel:[0,1] op_sel_hi:[1,1]
    v_pk_mul_f32 v[72:73], v[72:73], v[162:163] op_sel:[0,1] op_sel_hi:[1,1]
    v_pk_mul_f32 v[74:75], v[74:75], v[162:163] op_sel:[0,1] op_sel_hi:[1,1]
    v_pk_mul_f32 v[76:77], v[76:77], v[162:163] op_sel:[0,1] op_sel_hi:[1,1]
    v_pk_mul_f32 v[78:79], v[78:79], v[162:163] op_sel:[0,1] op_sel_hi:[1,1]
    v_pk_mul_f32 v[80:81], v[80:81], v[162:163] op_sel:[0,1] op_sel_hi:[1,1]
    v_pk_mul_f32 v[82:83], v[82:83], v[162:163] op_sel:[0,1] op_sel_hi:[1,1]
    v_pk_mul_f32 v[84:85], v[84:85], v[162:163] op_sel:[0,1] op_sel_hi:[1,1]
    v_pk_mul_f32 v[86:87], v[86:87], v[162:163] op_sel:[0,1] op_sel_hi:[1,1]
    v_pk_mul_f32 v[88:89], v[88:89], v[162:163] op_sel:[0,1] op_sel_hi:[1,1]
    v_pk_mul_f32 v[90:91], v[90:91], v[162:163] op_sel:[0,1] op_sel_hi:[1,1]
    v_pk_mul_f32 v[92:93], v[92:93], v[162:163] op_sel:[0,1] op_sel_hi:[1,1]
    v_pk_mul_f32 v[94:95], v[94:95], v[162:163] op_sel:[0,1] op_sel_hi:[1,1]
    v_pk_mul_f32 v[96:97], v[96:97], v[162:163] op_sel:[0,1] op_sel_hi:[1,1]
    v_pk_mul_f32 v[98:99], v[98:99], v[162:163] op_sel:[0,1] op_sel_hi:[1,1]
    v_pk_mul_f32 v[100:101], v[100:101], v[162:163] op_sel:[0,1] op_sel_hi:[1,1]
    v_pk_mul_f32 v[102:103], v[102:103], v[162:163] op_sel:[0,1] op_sel_hi:[1,1]
    s_add_u32 s49, s49, s100
    s_lshr_b32 s34, s49, 4
    s_and_b32 s49, s49, 15
    s_cmp_ge_u32 s34, 2
    s_cselect_b64 vcc, -1, 0
    s_xor_b32 s57, s99, 69632
    s_add_u32 m0, s56, 4096
    s_cbranch_vccnz L_w2_406
    s_bitcmp1_b32 s34, 0
    s_cbranch_scc1 L_w1_406
    s_waitcnt vmcnt(3)
L_w1_406:
    s_waitcnt vmcnt(6)
L_w2_406:
    s_waitcnt vmcnt(7)
    buffer_load_dwordx4 v12, s[8:11], s57 offen offset:0 nt lds
    s_add_u32 s79, s72, 0
    s_add_u32 m0, s67, 0
    s_nop 0
    buffer_load_dwordx4 v56, s[20:23], s79 offen lds
    v_pk_mul_f32 v[104:105], v[104:105], v[162:163] op_sel:[0,1] op_sel_hi:[1,1]
    v_pk_mul_f32 v[106:107], v[106:107], v[162:163] op_sel:[0,1] op_sel_hi:[1,1]
    v_pk_mul_f32 v[108:109], v[108:109], v[162:163] op_sel:[0,1] op_sel_hi:[1,1]
    v_pk_mul_f32 v[110:111], v[110:111], v[162:163] op_sel:[0,1] op_sel_hi:[1,1]
    v_pk_mul_f32 v[112:113], v[112:113], v[162:163] op_sel:[0,1] op_sel_hi:[1,1]
    v_pk_mul_f32 v[114:115], v[114:115], v[162:163] op_sel:[0,1] op_sel_hi:[1,1]
    v_pk_mul_f32 v[116:117], v[116:117], v[162:163] op_sel:[0,1] op_sel_hi:[1,1]
    v_pk_mul_f32 v[118:119], v[118:119], v[162:163] op_sel:[0,1] op_sel_hi:[1,1]
    v_pk_mul_f32 v[120:121], v[120:121], v[162:163] op_sel:[0,1] op_sel_hi:[1,1]
    v_pk_mul_f32 v[122:123], v[122:123], v[162:163] op_sel:[0,1] op_sel_hi:[1,1]
    v_pk_mul_f32 v[124:125], v[124:125], v[162:163] op_sel:[0,1] op_sel_hi:[1,1]
    v_pk_mul_f32 v[126:127], v[126:127], v[162:163] op_sel:[0,1] op_sel_hi:[1,1]
    s_add_u32 m0, s56, 4096
    s_cbranch_vccnz L_w2_408
    s_bitcmp1_b32 s34, 0
    s_cbranch_scc1 L_w1_408
    s_waitcnt vmcnt(4)
L_w1_408:
    s_waitcnt vmcnt(5)
L_w2_408:
    s_waitcnt vmcnt(8)
    buffer_load_dwordx4 v12, s[8:11], s57 offen offset:1024 nt lds
    ds_read_b64_tr_b16 v[128:129], v24 offset:24576
    ds_read_b64_tr_b16 v[130:131], v24 offset:26624
    ds_read_b64_tr_b16 v[132:133], v25 offset:24576
    ds_read_b64_tr_b16 v[134:135], v25 offset:26624
    ds_read_b64_tr_b16 v[136:137], v26 offset:24576
    ds_read_b64_tr_b16 v[138:139], v26 offset:26624
    ds_read_b64_tr_b16 v[140:141], v27 offset:24576
    ds_read_b64_tr_b16 v[142:143], v27 offset:26624
    ds_read_b64_tr_b16 v[144:145], v24 offset:28672
    ds_read_b64_tr_b16 v[146:147], v24 offset:30720
    s_waitcnt lgkmcnt(8)
    v_mfma_f32_32x32x16_bf16 v[64:79], v[128:131], a[16:19], v[64:79]
    ds_read_b64_tr_b16 v[148:149], v25 offset:28672
    s_cbranch_vccnz L_w2_409
    s_bitcmp1_b32 s34, 0
    s_cbranch_scc1 L_w1_409
    s_waitcnt vmcnt(4)
L_w1_409:
    s_waitcnt vmcnt(5)
L_w2_409:
    s_waitcnt vmcnt(6)
    buffer_load_dwordx4 v12, s[8:11], s57 offen offset:2048 nt lds
    ds_read_b64_tr_b16 v[150:151], v25 offset:30720
    s_waitcnt lgkmcnt(8)
    v_mfma_f32_32x32x16_bf16 v[80:95], v[132:135], a[16:19], v[80:95]
    ds_read_b64_tr_b16 v[152:153], v26 offset:28672
    ds_read_b64_tr_b16 v[154:155], v26 offset:30720
    s_waitcnt lgkmcnt(8)
    v_mfma_f32_32x32x16_bf16 v[96:111], v[136:139], a[16:19], v[96:111]
    s_cbranch_vccnz L_w2_410
    s_bitcmp1_b32 s34, 0
    s_cbranch_scc1 L_w1_410
    s_waitcnt vmcnt(4)
L_w1_410:
    s_waitcnt vmcnt(5)
L_w2_410:
    s_waitcnt vmcnt(6)
    buffer_load_dwordx4 v12, s[8:11], s57 offen offset:3072 nt lds
    s_add_u32 m0, s67, 1024
    s_nop 0
    buffer_load_dwordx4 v57, s[20:23], s79 offen lds
    ds_read_b64_tr_b16 v[156:157], v27 offset:28672
    ds_read_b64_tr_b16 v[158:159], v27 offset:30720
    s_waitcnt lgkmcnt(8)
    v_mfma_f32_32x32x16_bf16 v[112:127], v[140:143], a[16:19], v[112:127]
    s_waitcnt lgkmcnt(6)
    v_mfma_f32_32x32x16_bf16 v[64:79], v[144:147], a[20:23], v[64:79]
    s_cmp_lg_u32 s44, 36
    s_cbranch_scc1 L_nc36
    v_sub_u32 v247, v246, v245
    v_lshlrev_b32 v246, 8, v254
    v_readfirstlane_b32 s3, v247
    s_nop 0
    s_min_u32 s3, s3, 7
    s_mul_i32 s3, s3, 6
    s_add_u32 s3, s3, s45
    v_mov_b32 v247, s3
    s_and_b32 s3, s35, 0xfffffcff
    s_mov_b64 exec, 15
    buffer_store_dword v247, v246, s[24:27], s3 offen offset:128
    s_mov_b64 exec, -1
L_nc36:
    v_sub_u32 v244, v244, v0
    v_cmp_gt_u32 s[100:101], 64, v244
    v_readlane_b32 s46, v244, 32
    s_bcnt1_i32_b32 s3, s100
    s_mul_i32 s3, s3, 3
    s_add_u32 s46, s46, 12
    s_cmp_lt_u32 s46, 128
    s_cselect_b32 s46, s46, 21
    s_add_u32 s3, s3, s46
    s_ashr_i32 s3, s3, 2
    s_add_i32 s3, s3, 2
    s_max_i32 s3, s3, 8
    s_min_i32 s100, s3, 32
    s_add_u32 s49, s49, s100
    s_lshr_b32 s34, s49, 4
    s_and_b32 s49, s49, 15
    s_cmp_ge_u32 s34, 2
    s_cselect_b64 vcc, -1, 0
    s_xor_b32 s57, s99, 409600
    s_add_u32 m0, s56, 8192
    s_cbranch_vccnz L_w2_412
    s_bitcmp1_b32 s34, 0
    s_cbranch_scc1 L_w1_412
    s_waitcnt vmcnt(5)
L_w1_412:
    s_waitcnt vmcnt(6)
L_w2_412:
    s_waitcnt vmcnt(7)
    buffer_load_dwordx4 v12, s[8:11], s57 offen offset:0 nt lds
    s_waitcnt lgkmcnt(4)
    v_mfma_f32_32x32x16_bf16 v[80:95], v[148:151], a[20:23], v[80:95]
    s_waitcnt lgkmcnt(2)
    v_mfma_f32_32x32x16_bf16 v[96:111], v[152:155], a[20:23], v[96:111]
    s_waitcnt lgkmcnt(0)
    v_mfma_f32_32x32x16_bf16 v[112:127], v[156:159], a[20:23], v[112:127]
    s_cbranch_vccnz L_w2_413
    s_bitcmp1_b32 s34, 0
    s_cbranch_scc1 L_w1_413
    s_waitcnt vmcnt(4)
L_w1_413:
    s_waitcnt vmcnt(6)
L_w2_413:
    s_waitcnt vmcnt(7)
    buffer_load_dwordx4 v12, s[8:11], s57 offen offset:1024 nt lds
    v_pk_mul_f32 v[64:65], v[64:65], v[164:165] op_sel_hi:[1,0]
    v_pk_mul_f32 v[66:67], v[66:67], v[164:165] op_sel_hi:[1,0]
    v_pk_mul_f32 v[68:69], v[68:69], v[164:165] op_sel_hi:[1,0]
    v_pk_mul_f32 v[70:71], v[70:71], v[164:165] op_sel_hi:[1,0]
    v_pk_mul_f32 v[72:73], v[72:73], v[164:165] op_sel_hi:[1,0]
    v_pk_mul_f32 v[74:75], v[74:75], v[164:165] op_sel_hi:[1,0]
    v_pk_mul_f32 v[76:77], v[76:77], v[164:165] op_sel_hi:[1,0]
    v_pk_mul_f32 v[78:79], v[78:79], v[164:165] op_sel_hi:[1,0]
    v_pk_mul_f32 v[80:81], v[80:81], v[164:165] op_sel_hi:[1,0]
    v_pk_mul_f32 v[82:83], v[82:83], v[164:165] op_sel_hi:[1,0]
    v_pk_mul_f32 v[84:85], v[84:85], v[164:165] op_sel_hi:[1,0]
    v_pk_mul_f32 v[86:87], v[86:87], v[164:165] op_sel_hi:[1,0]
    v_pk_mul_f32 v[88:89], v[88:89], v[164:165] op_sel_hi:[1,0]
    v_pk_mul_f32 v[90:91], v[90:91], v[164:165] op_sel_hi:[1,0]
    v_pk_mul_f32 v[92:93], v[92:93], v[164:165] op_sel_hi:[1,0]
    v_pk_mul_f32 v[94:95], v[94:95], v[164:165] op_sel_hi:[1,0]
    v_pk_mul_f32 v[96:97], v[96:97], v[164:165] op_sel_hi:[1,0]
    v_pk_mul_f32 v[98:99], v[98:99], v[164:165] op_sel_hi:[1,0]
    v_pk_mul_f32 v[100:101], v[100:101], v[164:165] op_sel_hi:[1,0]
    v_pk_mul_f32 v[102:103], v[102:103], v[164:165] op_sel_hi:[1,0]
    s_cbranch_vccnz L_w2_414
    s_bitcmp1_b32 s34, 0
    s_cbranch_scc1 L_w1_414
    s_waitcnt vmcnt(4)
L_w1_414:
    s_waitcnt vmcnt(5)
L_w2_414:
    s_waitcnt vmcnt(7)
    buffer_load_dwordx4 v12, s[8:11], s57 offen offset:2048 nt lds
    s_add_u32 m0, s67, 2048
    s_nop 0
    buffer_load_dwordx4 v58, s[20:23], s79 offen lds
    v_pk_mul_f32 v[104:105], v[104:105], v[164:165] op_sel_hi:[1,0]
    v_pk_mul_f32 v[106:107], v[106:107], v[164:165] op_sel_hi:[1,0]
    v_pk_mul_f32 v[108:109], v[108:109], v[164:165] op_sel_hi:[1,0]
    v_pk_mul_f32 v[110:111], v[110:111], v[164:165] op_sel_hi:[1,0]
    v_pk_mul_f32 v[112:113], v[112:113], v[164:165] op_sel_hi:[1,0]
    v_pk_mul_f32 v[114:115], v[114:115], v[164:165] op_sel_hi:[1,0]
    v_pk_mul_f32 v[116:117], v[116:117], v[164:165] op_sel_hi:[1,0]
    v_pk_mul_f32 v[118:119], v[118:119], v[164:165] op_sel_hi:[1,0]
    v_pk_mul_f32 v[120:121], v[120:121], v[164:165] op_sel_hi:[1,0]
    v_pk_mul_f32 v[122:123], v[122:123], v[164:165] op_sel_hi:[1,0]
    v_pk_mul_f32 v[124:125], v[124:125], v[164:165] op_sel_hi:[1,0]
    v_pk_mul_f32 v[126:127], v[126:127], v[164:165] op_sel_hi:[1,0]
    s_add_u32 m0, s56, 8192
    s_cbranch_vccnz L_w2_416
    s_bitcmp1_b32 s34, 0
    s_cbranch_scc1 L_w1_416
    s_waitcnt vmcnt(5)
L_w1_416:
    s_waitcnt vmcnt(6)
L_w2_416:
    s_waitcnt vmcnt(7)
    buffer_load_dwordx4 v12, s[8:11], s57 offen offset:3072 nt lds
    s_add_u32 s49, s49, s100
    s_lshr_b32 s34, s49, 4
    s_and_b32 s49, s49, 15
    s_cmp_ge_u32 s34, 2
    s_cselect_b64 vcc, -1, 0
    s_xor_b32 s57, s99, 413696
    s_add_u32 m0, s56, 12288
    s_cbranch_vccnz L_w2_417
    s_bitcmp1_b32 s34, 0
    s_cbranch_scc1 L_w1_417
    s_waitcnt vmcnt(4)
L_w1_417:
    s_waitcnt vmcnt(6)
L_w2_417:
    s_waitcnt vmcnt(7)
    buffer_load_dwordx4 v12, s[8:11], s57 offen offset:0 nt lds
    s_cbranch_vccnz L_w2_418
    s_bitcmp1_b32 s34, 0
    s_cbranch_scc1 L_w1_418
    s_waitcnt vmcnt(4)
L_w1_418:
    s_waitcnt vmcnt(5)
L_w2_418:
    s_waitcnt vmcnt(7)
    buffer_load_dwordx4 v12, s[8:11], s57 offen offset:1024 nt lds
    s_add_u32 m0, s67, 3072
    s_nop 0
    buffer_load_dwordx4 v59, s[20:23], s79 offen lds
    ds_read_b64_tr_b16 v[128:129], v24 offset:0
    ds_read_b64_tr_b16 v[130:131], v24 offset:2048
    ds_read_b64_tr_b16 v[132:133], v25 offset:0
    ds_read_b64_tr_b16 v[134:135], v25 offset:2048
    ds_read_b64_tr_b16 v[136:137], v26 offset:0
    ds_read_b64_tr_b16 v[138:139], v26 offset:2048
    ds_read_b64_tr_b16 v[140:141], v27 offset:0
    ds_read_b64_tr_b16 v[142:143], v27 offset:2048
    ds_read_b64_tr_b16 v[144:145], v24 offset:4096
    ds_read_b64_tr_b16 v[146:147], v24 offset:6144
    s_waitcnt lgkmcnt(8)
    v_mfma_f32_32x32x16_bf16 v[64:79], v[128:131], a[24:27], v[64:79]
    ds_read_b64_tr_b16 v[148:149], v25 offset:4096
    s_add_u32 m0, s56, 12288
    s_cbranch_vccnz L_w2_420
    s_bitcmp1_b32 s34, 0
    s_cbranch_scc1 L_w1_420
    s_waitcnt vmcnt(5)
L_w1_420:
    s_waitcnt vmcnt(6)
L_w2_420:
    s_waitcnt vmcnt(7)
    buffer_load_dwordx4 v12, s[8:11], s57 offen offset:2048 nt lds
    ds_read_b64_tr_b16 v[150:151], v25 offset:6144
    s_waitcnt lgkmcnt(8)
    v_mfma_f32_32x32x16_bf16 v[80:95], v[132:135], a[24:27], v[80:95]
    ds_read_b64_tr_b16 v[152:153], v26 offset:4096
    ds_read_b64_tr_b16 v[154:155], v26 offset:6144
    s_waitcnt lgkmcnt(8)
    v_mfma_f32_32x32x16_bf16 v[96:111], v[136:139], a[24:27], v[96:111]
    s_cbranch_vccnz L_w2_421
    s_bitcmp1_b32 s34, 0
    s_cbranch_scc1 L_w1_421
    s_waitcnt vmcnt(4)
L_w1_421:
    s_waitcnt vmcnt(6)
L_w2_421:
    s_waitcnt vmcnt(7)
    buffer_load_dwordx4 v12, s[8:11], s57 offen offset:3072 nt lds
    ds_read_b64_tr_b16 v[156:157], v27 offset:4096
    ds_read_b64_tr_b16 v[158:159], v27 offset:6144
    s_waitcnt lgkmcnt(8)
    v_mfma_f32_32x32x16_bf16 v[112:127], v[140:143], a[24:27], v[112:127]
    s_waitcnt lgkmcnt(6)
    v_mfma_f32_32x32x16_bf16 v[64:79], v[144:147], a[28:31], v[64:79]
    s_add_u32 s49, s49, s100
    s_lshr_b32 s34, s49, 4
    s_and_b32 s49, s49, 15
    s_cmp_ge_u32 s34, 2
    s_cselect_b64 vcc, -1, 0
    s_cmp_lg_u32 s44, 38
    s_cbranch_scc1 L_nr38
    s_mov_b32 s3, 84992
    v_mov_b32 v246, 1
    s_mov_b64 exec, 1
    buffer_atomic_add v246, off, s[24:27], s3 sc0
    s_mov_b64 exec, -1
L_nr38:
    v_add_u32 v0, 1, v0
    s_mov_b64 exec, s[32:33]
    buffer_store_dword v0, v242, s[24:27], s35 offen
    s_mov_b64 exec, -1
    buffer_load_dword v244, v242, s[24:27], s35 offen sc1
    s_xor_b32 s57, s99, 458752
    s_add_u32 m0, s56, 16384
    s_cbranch_vccnz L_w2_424
    s_bitcmp1_b32 s34, 0
    s_cbranch_scc1 L_w1_424
    s_waitcnt vmcnt(6)
L_w1_424:
    s_waitcnt vmcnt(7)
L_w2_424:
    s_waitcnt vmcnt(9)
    buffer_load_dwordx4 v12, s[8:11], s57 offen offset:0 nt lds
    s_add_u32 m0, s67, 4096
    s_nop 0
    buffer_load_dwordx4 v60, s[20:23], s79 offen lds
    s_waitcnt lgkmcnt(4)
    v_mfma_f32_32x32x16_bf16 v[80:95], v[148:151], a[28:31], v[80:95]
    s_waitcnt lgkmcnt(2)
    v_mfma_f32_32x32x16_bf16 v[96:111], v[152:155], a[28:31], v[96:111]
    s_waitcnt lgkmcnt(0)
    v_mfma_f32_32x32x16_bf16 v[112:127], v[156:159], a[28:31], v[112:127]
    s_add_u32 m0, s56, 16384
    s_cbranch_vccnz L_w2_426
    s_bitcmp1_b32 s34, 0
    s_cbranch_scc1 L_w1_426
    s_waitcnt vmcnt(7)
L_w1_426:
    s_waitcnt vmcnt(8)
L_w2_426:
    s_waitcnt vmcnt(9)
    buffer_load_dwordx4 v12, s[8:11], s57 offen offset:1024 nt lds
    v_pk_mul_f32 v[64:65], v[64:65], v[164:165] op_sel:[0,1] op_sel_hi:[1,1]
    v_pk_mul_f32 v[66:67], v[66:67], v[164:165] op_sel:[0,1] op_sel_hi:[1,1]
    v_pk_mul_f32 v[68:69], v[68:69], v[164:165] op_sel:[0,1] op_sel_hi:[1,1]
    v_pk_mul_f32 v[70:71], v[70:71], v[164:165] op_sel:[0,1] op_sel_hi:[1,1]
    v_pk_mul_f32 v[72:73], v[72:73], v[164:165] op_sel:[0,1] op_sel_hi:[1,1]
    v_pk_mul_f32 v[74:75], v[74:75], v[164:165] op_sel:[0,1] op_sel_hi:[1,1]
    v_pk_mul_f32 v[76:77], v[76:77], v[164:165] op_sel:[0,1] op_sel_hi:[1,1]
    v_pk_mul_f32 v[78:79], v[78:79], v[164:165] op_sel:[0,1] op_sel_hi:[1,1]
    v_pk_mul_f32 v[80:81], v[80:81], v[164:165] op_sel:[0,1] op_sel_hi:[1,1]
    v_pk_mul_f32 v[82:83], v[82:83], v[164:165] op_sel:[0,1] op_sel_hi:[1,1]
    v_pk_mul_f32 v[84:85], v[84:85], v[164:165] op_sel:[0,1] op_sel_hi:[1,1]
    v_pk_mul_f32 v[86:87], v[86:87], v[164:165] op_sel:[0,1] op_sel_hi:[1,1]
    v_pk_mul_f32 v[88:89], v[88:89], v[164:165] op_sel:[0,1] op_sel_hi:[1,1]
    v_pk_mul_f32 v[90:91], v[90:91], v[164:165] op_sel:[0,1] op_sel_hi:[1,1]
    v_pk_mul_f32 v[92:93], v[92:93], v[164:165] op_sel:[0,1] op_sel_hi:[1,1]
    v_pk_mul_f32 v[94:95], v[94:95], v[164:165] op_sel:[0,1] op_sel_hi:[1,1]
    v_pk_mul_f32 v[96:97], v[96:97], v[164:165] op_sel:[0,1] op_sel_hi:[1,1]
    v_pk_mul_f32 v[98:99], v[98:99], v[164:165] op_sel:[0,1] op_sel_hi:[1,1]
    v_pk_mul_f32 v[100:101], v[100:101], v[164:165] op_sel:[0,1] op_sel_hi:[1,1]
    v_pk_mul_f32 v[102:103], v[102:103], v[164:165] op_sel:[0,1] op_sel_hi:[1,1]
    s_cbranch_vccnz L_w2_427
    s_bitcmp1_b32 s34, 0
    s_cbranch_scc1 L_w1_427
    s_waitcnt vmcnt(6)
L_w1_427:
    s_waitcnt vmcnt(8)
L_w2_427:
    s_waitcnt vmcnt(9)
    buffer_load_dwordx4 v12, s[8:11], s57 offen offset:2048 nt lds
    v_pk_mul_f32 v[104:105], v[104:105], v[164:165] op_sel:[0,1] op_sel_hi:[1,1]
    v_pk_mul_f32 v[106:107], v[106:107], v[164:165] op_sel:[0,1] op_sel_hi:[1,1]
    v_pk_mul_f32 v[108:109], v[108:109], v[164:165] op_sel:[0,1] op_sel_hi:[1,1]
    v_pk_mul_f32 v[110:111], v[110:111], v[164:165] op_sel:[0,1] op_sel_hi:[1,1]
    v_pk_mul_f32 v[112:113], v[112:113], v[164:165] op_sel:[0,1] op_sel_hi:[1,1]
    v_pk_mul_f32 v[114:115], v[114:115], v[164:165] op_sel:[0,1] op_sel_hi:[1,1]
    v_pk_mul_f32 v[116:117], v[116:117], v[164:165] op_sel:[0,1] op_sel_hi:[1,1]
    v_pk_mul_f32 v[118:119], v[118:119], v[164:165] op_sel:[0,1] op_sel_hi:[1,1]
    v_pk_mul_f32 v[120:121], v[120:121], v[164:165] op_sel:[0,1] op_sel_hi:[1,1]
    v_pk_mul_f32 v[122:123], v[122:123], v[164:165] op_sel:[0,1] op_sel_hi:[1,1]
    v_pk_mul_f32 v[124:125], v[124:125], v[164:165] op_sel:[0,1] op_sel_hi:[1,1]
    v_pk_mul_f32 v[126:127], v[126:127], v[164:165] op_sel:[0,1] op_sel_hi:[1,1]
    s_cbranch_vccnz L_w2_428
    s_bitcmp1_b32 s34, 0
    s_cbranch_scc1 L_w1_428
    s_waitcnt vmcnt(6)
L_w1_428:
    s_waitcnt vmcnt(7)
L_w2_428:
    s_waitcnt vmcnt(9)
    buffer_load_dwordx4 v12, s[8:11], s57 offen offset:3072 nt lds
    s_add_u32 s49, s49, s100
    s_lshr_b32 s34, s49, 4
    s_and_b32 s49, s49, 15
    s_cmp_ge_u32 s34, 2
    s_cselect_b64 vcc, -1, 0
    s_xor_b32 s57, s99, 462848
    s_add_u32 m0, s56, 20480
    s_cbranch_vccnz L_w2_429
    s_bitcmp1_b32 s34, 0
    s_cbranch_scc1 L_w1_429
    s_waitcnt vmcnt(4)
L_w1_429:
    s_waitcnt vmcnt(7)
L_w2_429:
    s_waitcnt vmcnt(8)
    buffer_load_dwordx4 v12, s[8:11], s57 offen offset:0 nt lds
    s_cbranch_vccnz L_w2_430
    s_bitcmp1_b32 s34, 0
    s_cbranch_scc1 L_w1_430
    s_waitcnt vmcnt(3)
L_w1_430:
    s_waitcnt vmcnt(5)
L_w2_430:
    s_waitcnt vmcnt(8)
    buffer_load_dwordx4 v12, s[8:11], s57 offen offset:1024 nt lds
    ds_read_b64_tr_b16 v[128:129], v24 offset:8192
    ds_read_b64_tr_b16 v[130:131], v24 offset:10240
    ds_read_b64_tr_b16 v[132:133], v25 offset:8192
    ds_read_b64_tr_b16 v[134:135], v25 offset:10240
    ds_read_b64_tr_b16 v[136:137], v26 offset:8192
    ds_read_b64_tr_b16 v[138:139], v26 offset:10240
    ds_read_b64_tr_b16 v[140:141], v27 offset:8192
    ds_read_b64_tr_b16 v[142:143], v27 offset:10240
    ds_read_b64_tr_b16 v[144:145], v24 offset:12288
    ds_read_b64_tr_b16 v[146:147], v24 offset:14336
    s_waitcnt lgkmcnt(8)
    v_mfma_f32_32x32x16_bf16 v[64:79], v[128:131], a[32:35], v[64:79]
    ds_read_b64_tr_b16 v[148:149], v25 offset:12288
    s_cbranch_vccnz L_w2_431
    s_bitcmp1_b32 s34, 0
    s_cbranch_scc1 L_w1_431
    s_waitcnt vmcnt(3)
L_w1_431:
    s_waitcnt vmcnt(4)
L_w2_431:
    s_waitcnt vmcnt(6)
    buffer_load_dwordx4 v12, s[8:11], s57 offen offset:2048 nt lds
    ds_read_b64_tr_b16 v[150:151], v25 offset:14336
    s_waitcnt lgkmcnt(8)
    v_mfma_f32_32x32x16_bf16 v[80:95], v[132:135], a[32:35], v[80:95]
    ds_read_b64_tr_b16 v[152:153], v26 offset:12288
    ds_read_b64_tr_b16 v[154:155], v26 offset:14336
    s_waitcnt lgkmcnt(8)
    v_mfma_f32_32x32x16_bf16 v[96:111], v[136:139], a[32:35], v[96:111]
    s_cbranch_vccnz L_w2_432
    s_bitcmp1_b32 s34, 0
    s_cbranch_scc1 L_w1_432
    s_waitcnt vmcnt(3)
L_w1_432:
    s_waitcnt vmcnt(4)
L_w2_432:
    s_waitcnt vmcnt(5)
    buffer_load_dwordx4 v12, s[8:11], s57 offen offset:3072 nt lds
    ds_read_b64_tr_b16 v[156:157], v27 offset:12288
    ds_read_b64_tr_b16 v[158:159], v27 offset:14336
    s_waitcnt lgkmcnt(8)
    v_mfma_f32_32x32x16_bf16 v[112:127], v[140:143], a[32:35], v[112:127]
    s_waitcnt lgkmcnt(6)
    v_mfma_f32_32x32x16_bf16 v[64:79], v[144:147], a[36:39], v[64:79]
    s_waitcnt lgkmcnt(4)
    v_mfma_f32_32x32x16_bf16 v[80:95], v[148:151], a[36:39], v[80:95]
    s_cmp_lg_u32 s44, 38
    s_cbranch_scc1 L_nc38
    v_sub_u32 v247, v246, v245
    v_lshlrev_b32 v246, 8, v254
    v_readfirstlane_b32 s3, v247
    s_nop 0
    s_min_u32 s3, s3, 7
    s_mul_i32 s3, s3, 6
    s_add_u32 s3, s3, s45
    v_mov_b32 v247, s3
    s_and_b32 s3, s35, 0xfffffcff
    s_mov_b64 exec, 15
    buffer_store_dword v247, v246, s[24:27], s3 offen offset:128
    s_mov_b64 exec, -1
L_nc38:
    v_sub_u32 v244, v244, v0
    v_cmp_gt_u32 s[100:101], 64, v244
    v_readlane_b32 s46, v244, 32
    s_bcnt1_i32_b32 s3, s100
    s_mul_i32 s3, s3, 3
    s_add_u32 s46, s46, 13
    s_cmp_lt_u32 s46, 128
    s_cselect_b32 s46, s46, 21
    s_add_u32 s3, s3, s46
    s_ashr_i32 s3, s3, 2
    s_add_i32 s3, s3, 2
    s_max_i32 s3, s3, 8
    s_min_i32 s100, s3, 32
    s_add_u32 s49, s49, s100
    s_lshr_b32 s34, s49, 4
    s_and_b32 s49, s49, 15
    s_cmp_ge_u32 s34, 2
    s_cselect_b64 vcc, -1, 0
    s_xor_b32 s57, s99, 81920
    s_add_u32 m0, s56, 24576
    s_cbranch_vccnz L_w2_433
    s_bitcmp1_b32 s34, 0
    s_cbranch_scc1 L_w1_433
    s_waitcnt vmcnt(3)
L_w1_433:
    s_waitcnt vmcnt(4)
L_w2_433:
    s_waitcnt vmcnt(5)
    buffer_load_dwordx4 v12, s[8:11], s57 offen offset:0 nt lds
    s_waitcnt lgkmcnt(2)
    v_mfma_f32_32x32x16_bf16 v[96:111], v[152:155], a[36:39], v[96:111]
    s_waitcnt lgkmcnt(0)
    v_mfma_f32_32x32x16_bf16 v[112:127], v[156:159], a[36:39], v[112:127]
    v_pk_mul_f32 v[64:65], v[64:65], v[166:167] op_sel_hi:[1,0]
    v_pk_mul_f32 v[66:67], v[66:67], v[166:167] op_sel_hi:[1,0]
    v_pk_mul_f32 v[68:69], v[68:69], v[166:167] op_sel_hi:[1,0]
    v_pk_mul_f32 v[70:71], v[70:71], v[166:167] op_sel_hi:[1,0]
    v_pk_mul_f32 v[72:73], v[72:73], v[166:167] op_sel_hi:[1,0]
    v_pk_mul_f32 v[74:75], v[74:75], v[166:167] op_sel_hi:[1,0]
    v_pk_mul_f32 v[76:77], v[76:77], v[166:167] op_sel_hi:[1,0]
    v_pk_mul_f32 v[78:79], v[78:79], v[166:167] op_sel_hi:[1,0]
    s_cbranch_vccnz L_w2_434
    s_bitcmp1_b32 s34, 0
    s_cbranch_scc1 L_w1_434
    s_waitcnt vmcnt(3)
L_w1_434:
    s_waitcnt vmcnt(4)
L_w2_434:
    s_waitcnt vmcnt(5)
    buffer_load_dwordx4 v12, s[8:11], s57 offen offset:1024 nt lds
    v_pk_mul_f32 v[80:81], v[80:81], v[166:167] op_sel_hi:[1,0]
    v_pk_mul_f32 v[82:83], v[82:83], v[166:167] op_sel_hi:[1,0]
    v_pk_mul_f32 v[84:85], v[84:85], v[166:167] op_sel_hi:[1,0]
    v_pk_mul_f32 v[86:87], v[86:87], v[166:167] op_sel_hi:[1,0]
    v_pk_mul_f32 v[88:89], v[88:89], v[166:167] op_sel_hi:[1,0]
    v_pk_mul_f32 v[90:91], v[90:91], v[166:167] op_sel_hi:[1,0]
    v_pk_mul_f32 v[92:93], v[92:93], v[166:167] op_sel_hi:[1,0]
    v_pk_mul_f32 v[94:95], v[94:95], v[166:167] op_sel_hi:[1,0]
    v_pk_mul_f32 v[96:97], v[96:97], v[166:167] op_sel_hi:[1,0]
    v_pk_mul_f32 v[98:99], v[98:99], v[166:167] op_sel_hi:[1,0]
    v_pk_mul_f32 v[100:101], v[100:101], v[166:167] op_sel_hi:[1,0]
    v_pk_mul_f32 v[102:103], v[102:103], v[166:167] op_sel_hi:[1,0]
    v_pk_mul_f32 v[104:105], v[104:105], v[166:167] op_sel_hi:[1,0]
    v_pk_mul_f32 v[106:107], v[106:107], v[166:167] op_sel_hi:[1,0]
    v_pk_mul_f32 v[108:109], v[108:109], v[166:167] op_sel_hi:[1,0]
    v_pk_mul_f32 v[110:111], v[110:111], v[166:167] op_sel_hi:[1,0]
    v_pk_mul_f32 v[112:113], v[112:113], v[166:167] op_sel_hi:[1,0]
    v_pk_mul_f32 v[114:115], v[114:115], v[166:167] op_sel_hi:[1,0]
    v_pk_mul_f32 v[116:117], v[116:117], v[166:167] op_sel_hi:[1,0]
    v_pk_mul_f32 v[118:119], v[118:119], v[166:167] op_sel_hi:[1,0]
    v_pk_mul_f32 v[120:121], v[120:121], v[166:167] op_sel_hi:[1,0]
    v_pk_mul_f32 v[122:123], v[122:123], v[166:167] op_sel_hi:[1,0]
    v_pk_mul_f32 v[124:125], v[124:125], v[166:167] op_sel_hi:[1,0]
    v_pk_mul_f32 v[126:127], v[126:127], v[166:167] op_sel_hi:[1,0]
    ds_read_b64_tr_b16 a[0:1], v61 offset:0
    ds_read_b64_tr_b16 a[4:5], v61 offset:32
    s_cbranch_vccnz L_w2_435
    s_bitcmp1_b32 s34, 0
    s_cbranch_scc1 L_w1_435
    s_waitcnt vmcnt(3)
L_w1_435:
    s_waitcnt vmcnt(4)
L_w2_435:
    s_waitcnt vmcnt(5)
    buffer_load_dwordx4 v12, s[8:11], s57 offen offset:2048 nt lds
    ds_read_b64_tr_b16 a[8:9], v61 offset:64
    ds_read_b64_tr_b16 a[12:13], v61 offset:96
    ds_read_b64_tr_b16 a[16:17], v61 offset:128
    ds_read_b64_tr_b16 a[20:21], v61 offset:160
    ds_read_b64_tr_b16 a[24:25], v61 offset:192
    ds_read_b64_tr_b16 a[28:29], v61 offset:224
    ds_read_b64_tr_b16 a[32:33], v61 offset:256
    s_waitcnt lgkmcnt(0)
    s_cbranch_vccnz L_w2_436
    s_bitcmp1_b32 s34, 0
    s_cbranch_scc1 L_w1_436
    s_waitcnt vmcnt(3)
L_w1_436:
    s_waitcnt vmcnt(4)
L_w2_436:
    s_waitcnt vmcnt(5)
    buffer_load_dwordx4 v12, s[8:11], s57 offen offset:3072 nt lds
    s_add_u32 s49, s49, s100
    s_lshr_b32 s34, s49, 4
    s_and_b32 s49, s49, 15
    s_cmp_ge_u32 s34, 2
    s_cselect_b64 vcc, -1, 0
    s_xor_b32 s57, s99, 86016
    s_add_u32 m0, s56, 28672
    s_cbranch_vccnz L_w2_437
    s_bitcmp1_b32 s34, 0
    s_cbranch_scc1 L_w1_437
    s_waitcnt vmcnt(3)
L_w1_437:
    s_waitcnt vmcnt(4)
L_w2_437:
    s_waitcnt vmcnt(5)
    buffer_load_dwordx4 v12, s[8:11], s57 offen offset:0 nt lds
    s_add_u32 s79, s72, 9216
    s_add_u32 m0, s67, 0
    s_nop 0
    buffer_load_dwordx4 v56, s[20:23], s79 offen lds
    s_add_u32 m0, s56, 28672
    s_cbranch_vccnz L_w2_439
    s_bitcmp1_b32 s34, 0
    s_cbranch_scc1 L_w1_439
    s_waitcnt vmcnt(4)
L_w1_439:
    s_waitcnt vmcnt(5)
L_w2_439:
    s_waitcnt vmcnt(6)
    buffer_load_dwordx4 v12, s[8:11], s57 offen offset:1024 nt lds
    ds_read_b64_tr_b16 v[128:129], v24 offset:16384
    ds_read_b64_tr_b16 v[130:131], v24 offset:18432
    ds_read_b64_tr_b16 v[132:133], v25 offset:16384
    ds_read_b64_tr_b16 v[134:135], v25 offset:18432
    ds_read_b64_tr_b16 v[136:137], v26 offset:16384
    ds_read_b64_tr_b16 v[138:139], v26 offset:18432
    ds_read_b64_tr_b16 v[140:141], v27 offset:16384
    ds_read_b64_tr_b16 v[142:143], v27 offset:18432
    ds_read_b64_tr_b16 v[144:145], v24 offset:20480
    ds_read_b64_tr_b16 v[146:147], v24 offset:22528
    s_waitcnt lgkmcnt(8)
    v_mfma_f32_32x32x16_bf16 v[64:79], v[128:131], a[40:43], v[64:79]
    ds_read_b64_tr_b16 v[148:149], v25 offset:20480
    s_cbranch_vccnz L_w2_440
    s_bitcmp1_b32 s34, 0
    s_cbranch_scc1 L_w1_440
    s_waitcnt vmcnt(4)
L_w1_440:
    s_waitcnt vmcnt(5)
L_w2_440:
    s_waitcnt vmcnt(6)
    buffer_load_dwordx4 v12, s[8:11], s57 offen offset:2048 nt lds
    ds_read_b64_tr_b16 v[150:151], v25 offset:22528
    s_waitcnt lgkmcnt(8)
    v_mfma_f32_32x32x16_bf16 v[80:95], v[132:135], a[40:43], v[80:95]
    ds_read_b64_tr_b16 v[152:153], v26 offset:20480
    ds_read_b64_tr_b16 v[154:155], v26 offset:22528
    s_waitcnt lgkmcnt(8)
    v_mfma_f32_32x32x16_bf16 v[96:111], v[136:139], a[40:43], v[96:111]
    s_cbranch_vccnz L_w2_441
    s_bitcmp1_b32 s34, 0
    s_cbranch_scc1 L_w1_441
    s_waitcnt vmcnt(4)
L_w1_441:
    s_waitcnt vmcnt(5)
L_w2_441:
    s_waitcnt vmcnt(6)
    buffer_load_dwordx4 v12, s[8:11], s57 offen offset:3072 nt lds
    s_add_u32 m0, s67, 1024
    s_nop 0
    buffer_load_dwordx4 v57, s[20:23], s79 offen lds
    ds_read_b64_tr_b16 v[156:157], v27 offset:20480
    ds_read_b64_tr_b16 v[158:159], v27 offset:22528
    s_waitcnt lgkmcnt(8)
    v_mfma_f32_32x32x16_bf16 v[112:127], v[140:143], a[40:43], v[112:127]
    s_waitcnt lgkmcnt(6)
    v_mfma_f32_32x32x16_bf16 v[64:79], v[144:147], a[44:47], v[64:79]
    s_add_u32 s49, s49, s100
    s_lshr_b32 s34, s49, 4
    s_and_b32 s49, s49, 15
    s_cmp_ge_u32 s34, 2
    s_cselect_b64 vcc, -1, 0
    s_cmp_lg_u32 s44, 40
    s_cbranch_scc1 L_nr40
    s_mov_b32 s3, 85248
    v_mov_b32 v246, 1
    s_mov_b64 exec, 1
    buffer_atomic_add v246, off, s[24:27], s3 sc0
    s_mov_b64 exec, -1
L_nr40:
    v_add_u32 v0, 1, v0
    s_mov_b64 exec, s[32:33]
    buffer_store_dword v0, v242, s[24:27], s35 offen
    s_mov_b64 exec, -1
    buffer_load_dword v244, v242, s[24:27], s35 offen sc1
    s_xor_b32 s57, s99, 475136
    s_add_u32 m0, s56, 0
    s_cbranch_vccnz L_w2_445
    s_bitcmp1_b32 s34, 0
    s_cbranch_scc1 L_w1_445
    s_waitcnt vmcnt(7)
L_w1_445:
    s_waitcnt vmcnt(8)
L_w2_445:
    s_waitcnt vmcnt(9)
    buffer_load_dwordx4 v12, s[8:11], s57 offen offset:0 nt lds
    s_waitcnt lgkmcnt(4)
    v_mfma_f32_32x32x16_bf16 v[80:95], v[148:151], a[44:47], v[80:95]
    s_waitcnt lgkmcnt(2)
    v_mfma_f32_32x32x16_bf16 v[96:111], v[152:155], a[44:47], v[96:111]
    s_waitcnt lgkmcnt(0)
    v_mfma_f32_32x32x16_bf16 v[112:127], v[156:159], a[44:47], v[112:127]
    s_cbranch_vccnz L_w2_446
    s_bitcmp1_b32 s34, 0
    s_cbranch_scc1 L_w1_446
    s_waitcnt vmcnt(6)
L_w1_446:
    s_waitcnt vmcnt(8)
L_w2_446:
    s_waitcnt vmcnt(9)
    buffer_load_dwordx4 v12, s[8:11], s57 offen offset:1024 nt lds
    v_pk_mul_f32 v[64:65], v[64:65], v[166:167] op_sel:[0,1] op_sel_hi:[1,1]
    v_pk_mul_f32 v[66:67], v[66:67], v[166:167] op_sel:[0,1] op_sel_hi:[1,1]
    v_pk_mul_f32 v[68:69], v[68:69], v[166:167] op_sel:[0,1] op_sel_hi:[1,1]
    v_pk_mul_f32 v[70:71], v[70:71], v[166:167] op_sel:[0,1] op_sel_hi:[1,1]
    v_pk_mul_f32 v[72:73], v[72:73], v[166:167] op_sel:[0,1] op_sel_hi:[1,1]
    v_pk_mul_f32 v[74:75], v[74:75], v[166:167] op_sel:[0,1] op_sel_hi:[1,1]
    v_pk_mul_f32 v[76:77], v[76:77], v[166:167] op_sel:[0,1] op_sel_hi:[1,1]
    v_pk_mul_f32 v[78:79], v[78:79], v[166:167] op_sel:[0,1] op_sel_hi:[1,1]
    v_pk_mul_f32 v[80:81], v[80:81], v[166:167] op_sel:[0,1] op_sel_hi:[1,1]
    v_pk_mul_f32 v[82:83], v[82:83], v[166:167] op_sel:[0,1] op_sel_hi:[1,1]
    v_pk_mul_f32 v[84:85], v[84:85], v[166:167] op_sel:[0,1] op_sel_hi:[1,1]
    v_pk_mul_f32 v[86:87], v[86:87], v[166:167] op_sel:[0,1] op_sel_hi:[1,1]
    v_pk_mul_f32 v[88:89], v[88:89], v[166:167] op_sel:[0,1] op_sel_hi:[1,1]
    v_pk_mul_f32 v[90:91], v[90:91], v[166:167] op_sel:[0,1] op_sel_hi:[1,1]
    v_pk_mul_f32 v[92:93], v[92:93], v[166:167] op_sel:[0,1] op_sel_hi:[1,1]
    v_pk_mul_f32 v[94:95], v[94:95], v[166:167] op_sel:[0,1] op_sel_hi:[1,1]
    v_pk_mul_f32 v[96:97], v[96:97], v[166:167] op_sel:[0,1] op_sel_hi:[1,1]
    v_pk_mul_f32 v[98:99], v[98:99], v[166:167] op_sel:[0,1] op_sel_hi:[1,1]
    v_pk_mul_f32 v[100:101], v[100:101], v[166:167] op_sel:[0,1] op_sel_hi:[1,1]
    v_pk_mul_f32 v[102:103], v[102:103], v[166:167] op_sel:[0,1] op_sel_hi:[1,1]
    s_cbranch_vccnz L_w2_447
    s_bitcmp1_b32 s34, 0
    s_cbranch_scc1 L_w1_447
    s_waitcnt vmcnt(6)
L_w1_447:
    s_waitcnt vmcnt(7)
L_w2_447:
    s_waitcnt vmcnt(9)
    buffer_load_dwordx4 v12, s[8:11], s57 offen offset:2048 nt lds
    s_add_u32 m0, s67, 2048
    s_nop 0
    buffer_load_dwordx4 v58, s[20:23], s79 offen lds
    v_pk_mul_f32 v[104:105], v[104:105], v[166:167] op_sel:[0,1] op_sel_hi:[1,1]
    v_pk_mul_f32 v[106:107], v[106:107], v[166:167] op_sel:[0,1] op_sel_hi:[1,1]
    v_pk_mul_f32 v[108:109], v[108:109], v[166:167] op_sel:[0,1] op_sel_hi:[1,1]
    v_pk_mul_f32 v[110:111], v[110:111], v[166:167] op_sel:[0,1] op_sel_hi:[1,1]
    v_pk_mul_f32 v[112:113], v[112:113], v[166:167] op_sel:[0,1] op_sel_hi:[1,1]
    v_pk_mul_f32 v[114:115], v[114:115], v[166:167] op_sel:[0,1] op_sel_hi:[1,1]
    v_pk_mul_f32 v[116:117], v[116:117], v[166:167] op_sel:[0,1] op_sel_hi:[1,1]
    v_pk_mul_f32 v[118:119], v[118:119], v[166:167] op_sel:[0,1] op_sel_hi:[1,1]
    v_pk_mul_f32 v[120:121], v[120:121], v[166:167] op_sel:[0,1] op_sel_hi:[1,1]
    v_pk_mul_f32 v[122:123], v[122:123], v[166:167] op_sel:[0,1] op_sel_hi:[1,1]
    v_pk_mul_f32 v[124:125], v[124:125], v[166:167] op_sel:[0,1] op_sel_hi:[1,1]
    v_pk_mul_f32 v[126:127], v[126:127], v[166:167] op_sel:[0,1] op_sel_hi:[1,1]
    s_add_u32 m0, s56, 0
    s_cbranch_vccnz L_w2_449
    s_bitcmp1_b32 s34, 0
    s_cbranch_scc1 L_w1_449
    s_waitcnt vmcnt(7)
L_w1_449:
    s_waitcnt vmcnt(8)
L_w2_449:
    s_waitcnt vmcnt(9)
    buffer_load_dwordx4 v12, s[8:11], s57 offen offset:3072 nt lds
    s_add_u32 s49, s49, s100
    s_lshr_b32 s34, s49, 4
    s_and_b32 s49, s49, 15
    s_cmp_ge_u32 s34, 2
    s_cselect_b64 vcc, -1, 0
    s_xor_b32 s57, s99, 479232
    s_add_u32 m0, s56, 4096
    s_cbranch_vccnz L_w2_450
    s_bitcmp1_b32 s34, 0
    s_cbranch_scc1 L_w1_450
    s_waitcnt vmcnt(4)
L_w1_450:
    s_waitcnt vmcnt(8)
L_w2_450:
    s_waitcnt vmcnt(9)
    buffer_load_dwordx4 v12, s[8:11], s57 offen offset:0 nt lds
    s_cbranch_vccnz L_w2_451
    s_bitcmp1_b32 s34, 0
    s_cbranch_scc1 L_w1_451
    s_waitcnt vmcnt(4)
L_w1_451:
    s_waitcnt vmcnt(5)
L_w2_451:
    s_waitcnt vmcnt(9)
    buffer_load_dwordx4 v12, s[8:11], s57 offen offset:1024 nt lds
    s_add_u32 m0, s67, 3072
    s_nop 0
    buffer_load_dwordx4 v59, s[20:23], s79 offen lds
    ds_read_b64_tr_b16 v[128:129], v24 offset:24576
    ds_read_b64_tr_b16 v[130:131], v24 offset:26624
    ds_read_b64_tr_b16 v[132:133], v25 offset:24576
    ds_read_b64_tr_b16 v[134:135], v25 offset:26624
    ds_read_b64_tr_b16 v[136:137], v26 offset:24576
    ds_read_b64_tr_b16 v[138:139], v26 offset:26624
    ds_read_b64_tr_b16 v[140:141], v27 offset:24576
    ds_read_b64_tr_b16 v[142:143], v27 offset:26624
    ds_read_b64_tr_b16 v[144:145], v24 offset:28672
    ds_read_b64_tr_b16 v[146:147], v24 offset:30720
    s_waitcnt lgkmcnt(8)
    v_mfma_f32_32x32x16_bf16 v[64:79], v[128:131], a[48:51], v[64:79]
    ds_read_b64_tr_b16 v[148:149], v25 offset:28672
    s_add_u32 m0, s56, 4096
    s_cbranch_vccnz L_w2_453
    s_bitcmp1_b32 s34, 0
    s_cbranch_scc1 L_w1_453
    s_waitcnt vmcnt(5)
L_w1_453:
    s_waitcnt vmcnt(6)
L_w2_453:
    s_waitcnt vmcnt(7)
    buffer_load_dwordx4 v12, s[8:11], s57 offen offset:2048 nt lds
    ds_read_b64_tr_b16 v[150:151], v25 offset:30720
    s_waitcnt lgkmcnt(8)
    v_mfma_f32_32x32x16_bf16 v[80:95], v[132:135], a[48:51], v[80:95]
    ds_read_b64_tr_b16 v[152:153], v26 offset:28672
    ds_read_b64_tr_b16 v[154:155], v26 offset:30720
    s_waitcnt lgkmcnt(8)
    v_mfma_f32_32x32x16_bf16 v[96:111], v[136:139], a[48:51], v[96:111]
    s_cbranch_vccnz L_w2_454
    s_bitcmp1_b32 s34, 0
    s_cbranch_scc1 L_w1_454
    s_waitcnt vmcnt(4)
L_w1_454:
    s_waitcnt vmcnt(6)
L_w2_454:
    s_waitcnt vmcnt(7)
    buffer_load_dwordx4 v12, s[8:11], s57 offen offset:3072 nt lds
    ds_read_b64_tr_b16 v[156:157], v27 offset:28672
    ds_read_b64_tr_b16 v[158:159], v27 offset:30720
    s_waitcnt lgkmcnt(8)
    v_mfma_f32_32x32x16_bf16 v[112:127], v[140:143], a[48:51], v[112:127]
    s_waitcnt lgkmcnt(6)
    v_mfma_f32_32x32x16_bf16 v[64:79], v[144:147], a[52:55], v[64:79]
    s_cmp_lg_u32 s44, 40
    s_cbranch_scc1 L_nc40
    v_sub_u32 v247, v246, v245
    v_lshlrev_b32 v246, 8, v254
    v_readfirstlane_b32 s3, v247
    s_nop 0
    s_min_u32 s3, s3, 7
    s_mul_i32 s3, s3, 6
    s_add_u32 s3, s3, s45
    v_mov_b32 v247, s3
    s_and_b32 s3, s35, 0xfffffcff
    s_mov_b64 exec, 15
    buffer_store_dword v247, v246, s[24:27], s3 offen offset:128
    s_mov_b64 exec, -1
L_nc40:
    v_sub_u32 v244, v244, v0
    v_cmp_gt_u32 s[100:101], 64, v244
    v_readlane_b32 s46, v244, 32
    s_bcnt1_i32_b32 s3, s100
    s_mul_i32 s3, s3, 3
    s_add_u32 s46, s46, 14
    s_cmp_lt_u32 s46, 128
    s_cselect_b32 s46, s46, 21
    s_add_u32 s3, s3, s46
    s_ashr_i32 s3, s3, 2
    s_add_i32 s3, s3, 2
    s_max_i32 s3, s3, 8
    s_min_i32 s100, s3, 32
    s_add_u32 s49, s49, s100
    s_lshr_b32 s34, s49, 4
    s_and_b32 s49, s49, 15
    s_cmp_ge_u32 s34, 2
    s_cselect_b64 vcc, -1, 0
    s_xor_b32 s57, s99, 524288
    s_add_u32 m0, s56, 8192
    s_cbranch_vccnz L_w2_455
    s_bitcmp1_b32 s34, 0
    s_cbranch_scc1 L_w1_455
    s_waitcnt vmcnt(4)
L_w1_455:
    s_waitcnt vmcnt(5)
L_w2_455:
    s_waitcnt vmcnt(7)
    buffer_load_dwordx4 v12, s[8:11], s57 offen offset:0 nt lds
    s_add_u32 m0, s67, 4096
    s_nop 0
    buffer_load_dwordx4 v60, s[20:23], s79 offen lds
    s_waitcnt lgkmcnt(4)
    v_mfma_f32_32x32x16_bf16 v[80:95], v[148:151], a[52:55], v[80:95]
    s_waitcnt lgkmcnt(2)
    v_mfma_f32_32x32x16_bf16 v[96:111], v[152:155], a[52:55], v[96:111]
    s_waitcnt lgkmcnt(0)
    v_mfma_f32_32x32x16_bf16 v[112:127], v[156:159], a[52:55], v[112:127]
    s_add_u32 m0, s56, 8192
    s_cbranch_vccnz L_w2_457
    s_bitcmp1_b32 s34, 0
    s_cbranch_scc1 L_w1_457
    s_waitcnt vmcnt(5)
L_w1_457:
    s_waitcnt vmcnt(6)
L_w2_457:
    s_waitcnt vmcnt(7)
    buffer_load_dwordx4 v12, s[8:11], s57 offen offset:1024 nt lds
    v_pk_mul_f32 v[64:65], v[64:65], v[168:169] op_sel_hi:[1,0]
    v_pk_mul_f32 v[66:67], v[66:67], v[168:169] op_sel_hi:[1,0]
    v_pk_mul_f32 v[68:69], v[68:69], v[168:169] op_sel_hi:[1,0]
    v_pk_mul_f32 v[70:71], v[70:71], v[168:169] op_sel_hi:[1,0]
    v_pk_mul_f32 v[72:73], v[72:73], v[168:169] op_sel_hi:[1,0]
    v_pk_mul_f32 v[74:75], v[74:75], v[168:169] op_sel_hi:[1,0]
    v_pk_mul_f32 v[76:77], v[76:77], v[168:169] op_sel_hi:[1,0]
    v_pk_mul_f32 v[78:79], v[78:79], v[168:169] op_sel_hi:[1,0]
    v_pk_mul_f32 v[80:81], v[80:81], v[168:169] op_sel_hi:[1,0]
    v_pk_mul_f32 v[82:83], v[82:83], v[168:169] op_sel_hi:[1,0]
    v_pk_mul_f32 v[84:85], v[84:85], v[168:169] op_sel_hi:[1,0]
    v_pk_mul_f32 v[86:87], v[86:87], v[168:169] op_sel_hi:[1,0]
    v_pk_mul_f32 v[88:89], v[88:89], v[168:169] op_sel_hi:[1,0]
    v_pk_mul_f32 v[90:91], v[90:91], v[168:169] op_sel_hi:[1,0]
    v_pk_mul_f32 v[92:93], v[92:93], v[168:169] op_sel_hi:[1,0]
    v_pk_mul_f32 v[94:95], v[94:95], v[168:169] op_sel_hi:[1,0]
    v_pk_mul_f32 v[96:97], v[96:97], v[168:169] op_sel_hi:[1,0]
    v_pk_mul_f32 v[98:99], v[98:99], v[168:169] op_sel_hi:[1,0]
    v_pk_mul_f32 v[100:101], v[100:101], v[168:169] op_sel_hi:[1,0]
    v_pk_mul_f32 v[102:103], v[102:103], v[168:169] op_sel_hi:[1,0]
    s_cbranch_vccnz L_w2_458
    s_bitcmp1_b32 s34, 0
    s_cbranch_scc1 L_w1_458
    s_waitcnt vmcnt(4)
L_w1_458:
    s_waitcnt vmcnt(6)
L_w2_458:
    s_waitcnt vmcnt(7)
    buffer_load_dwordx4 v12, s[8:11], s57 offen offset:2048 nt lds
    v_pk_mul_f32 v[104:105], v[104:105], v[168:169] op_sel_hi:[1,0]
    v_pk_mul_f32 v[106:107], v[106:107], v[168:169] op_sel_hi:[1,0]
    v_pk_mul_f32 v[108:109], v[108:109], v[168:169] op_sel_hi:[1,0]
    v_pk_mul_f32 v[110:111], v[110:111], v[168:169] op_sel_hi:[1,0]
    v_pk_mul_f32 v[112:113], v[112:113], v[168:169] op_sel_hi:[1,0]
    v_pk_mul_f32 v[114:115], v[114:115], v[168:169] op_sel_hi:[1,0]
    v_pk_mul_f32 v[116:117], v[116:117], v[168:169] op_sel_hi:[1,0]
    v_pk_mul_f32 v[118:119], v[118:119], v[168:169] op_sel_hi:[1,0]
    v_pk_mul_f32 v[120:121], v[120:121], v[168:169] op_sel_hi:[1,0]
    v_pk_mul_f32 v[122:123], v[122:123], v[168:169] op_sel_hi:[1,0]
    v_pk_mul_f32 v[124:125], v[124:125], v[168:169] op_sel_hi:[1,0]
    v_pk_mul_f32 v[126:127], v[126:127], v[168:169] op_sel_hi:[1,0]
    s_cbranch_vccnz L_w2_459
    s_bitcmp1_b32 s34, 0
    s_cbranch_scc1 L_w1_459
    s_waitcnt vmcnt(4)
L_w1_459:
    s_waitcnt vmcnt(5)
L_w2_459:
    s_waitcnt vmcnt(7)
    buffer_load_dwordx4 v12, s[8:11], s57 offen offset:3072 nt lds
    s_add_u32 s49, s49, s100
    s_lshr_b32 s34, s49, 4
    s_and_b32 s49, s49, 15
    s_cmp_ge_u32 s34, 2
    s_cselect_b64 vcc, -1, 0
    s_xor_b32 s57, s99, 528384
    s_add_u32 m0, s56, 12288
    s_cbranch_vccnz L_w2_460
    s_bitcmp1_b32 s34, 0
    s_cbranch_scc1 L_w1_460
    s_waitcnt vmcnt(4)
L_w1_460:
    s_waitcnt vmcnt(5)
L_w2_460:
    s_waitcnt vmcnt(6)
    buffer_load_dwordx4 v12, s[8:11], s57 offen offset:0 nt lds
    s_cbranch_vccnz L_w2_461
    s_bitcmp1_b32 s34, 0
    s_cbranch_scc1 L_w1_461
    s_waitcnt vmcnt(3)
L_w1_461:
    s_waitcnt vmcnt(5)
L_w2_461:
    s_waitcnt vmcnt(6)
    buffer_load_dwordx4 v12, s[8:11], s57 offen offset:1024 nt lds
    ds_read_b64_tr_b16 v[128:129], v24 offset:0
    ds_read_b64_tr_b16 v[130:131], v24 offset:2048
    ds_read_b64_tr_b16 v[132:133], v25 offset:0
    ds_read_b64_tr_b16 v[134:135], v25 offset:2048
    ds_read_b64_tr_b16 v[136:137], v26 offset:0
    ds_read_b64_tr_b16 v[138:139], v26 offset:2048
    ds_read_b64_tr_b16 v[140:141], v27 offset:0
    ds_read_b64_tr_b16 v[142:143], v27 offset:2048
    ds_read_b64_tr_b16 v[144:145], v24 offset:4096
    ds_read_b64_tr_b16 v[146:147], v24 offset:6144
    s_waitcnt lgkmcnt(8)
    v_mfma_f32_32x32x16_bf16 v[64:79], v[128:131], a[56:59], v[64:79]
    ds_read_b64_tr_b16 v[148:149], v25 offset:4096
    s_cbranch_vccnz L_w2_462
    s_bitcmp1_b32 s34, 0
    s_cbranch_scc1 L_w1_462
    s_waitcnt vmcnt(3)
L_w1_462:
    s_waitcnt vmcnt(4)
L_w2_462:
    s_waitcnt vmcnt(6)
    buffer_load_dwordx4 v12, s[8:11], s57 offen offset:2048 nt lds
    ds_read_b64_tr_b16 v[150:151], v25 offset:6144
    s_waitcnt lgkmcnt(8)
    v_mfma_f32_32x32x16_bf16 v[80:95], v[132:135], a[56:59], v[80:95]
    ds_read_b64_tr_b16 v[152:153], v26 offset:4096
    ds_read_b64_tr_b16 v[154:155], v26 offset:6144
    s_waitcnt lgkmcnt(8)
    v_mfma_f32_32x32x16_bf16 v[96:111], v[136:139], a[56:59], v[96:111]
    s_cbranch_vccnz L_w2_463
    s_bitcmp1_b32 s34, 0
    s_cbranch_scc1 L_w1_463
    s_waitcnt vmcnt(3)
L_w1_463:
    s_waitcnt vmcnt(4)
L_w2_463:
    s_waitcnt vmcnt(5)
    buffer_load_dwordx4 v12, s[8:11], s57 offen offset:3072 nt lds
    ds_read_b64_tr_b16 v[156:157], v27 offset:4096
    ds_read_b64_tr_b16 v[158:159], v27 offset:6144
    s_waitcnt lgkmcnt(8)
    v_mfma_f32_32x32x16_bf16 v[112:127], v[140:143], a[56:59], v[112:127]
    s_waitcnt lgkmcnt(6)
    v_mfma_f32_32x32x16_bf16 v[64:79], v[144:147], a[60:63], v[64:79]
    s_waitcnt lgkmcnt(4)
    v_mfma_f32_32x32x16_bf16 v[80:95], v[148:151], a[60:63], v[80:95]
    s_add_u32 s49, s49, s100
    s_lshr_b32 s34, s49, 4
    s_and_b32 s49, s49, 15
    s_cmp_ge_u32 s34, 2
    s_cselect_b64 vcc, -1, 0
    s_cmp_lg_u32 s44, 42
    s_cbranch_scc1 L_nr42
    s_mov_b32 s3, 85504
    v_mov_b32 v246, 1
    s_mov_b64 exec, 1
    buffer_atomic_add v246, off, s[24:27], s3 sc0
    s_mov_b64 exec, -1
L_nr42:
    v_add_u32 v0, 1, v0
    s_mov_b64 exec, s[32:33]
    buffer_store_dword v0, v242, s[24:27], s35 offen
    s_mov_b64 exec, -1
    buffer_load_dword v244, v242, s[24:27], s35 offen sc1
    s_xor_b32 s57, s99, 278528
    s_add_u32 m0, s56, 16384
    s_cbranch_vccnz L_w2_466
    s_bitcmp1_b32 s34, 0
    s_cbranch_scc1 L_w1_466
    s_waitcnt vmcnt(5)
L_w1_466:
    s_waitcnt vmcnt(6)
L_w2_466:
    s_waitcnt vmcnt(7)
    buffer_load_dwordx4 v12, s[8:11], s57 offen offset:0 nt lds
    s_waitcnt lgkmcnt(2)
    v_mfma_f32_32x32x16_bf16 v[96:111], v[152:155], a[60:63], v[96:111]
    s_waitcnt lgkmcnt(0)
    v_mfma_f32_32x32x16_bf16 v[112:127], v[156:159], a[60:63], v[112:127]
    v_pk_mul_f32 v[64:65], v[64:65], v[168:169] op_sel:[0,1] op_sel_hi:[1,1]
    v_pk_mul_f32 v[66:67], v[66:67], v[168:169] op_sel:[0,1] op_sel_hi:[1,1]
    v_pk_mul_f32 v[68:69], v[68:69], v[168:169] op_sel:[0,1] op_sel_hi:[1,1]
    v_pk_mul_f32 v[70:71], v[70:71], v[168:169] op_sel:[0,1] op_sel_hi:[1,1]
    v_pk_mul_f32 v[72:73], v[72:73], v[168:169] op_sel:[0,1] op_sel_hi:[1,1]
    v_pk_mul_f32 v[74:75], v[74:75], v[168:169] op_sel:[0,1] op_sel_hi:[1,1]
    v_pk_mul_f32 v[76:77], v[76:77], v[168:169] op_sel:[0,1] op_sel_hi:[1,1]
    v_pk_mul_f32 v[78:79], v[78:79], v[168:169] op_sel:[0,1] op_sel_hi:[1,1]
    s_cbranch_vccnz L_w2_467
    s_bitcmp1_b32 s34, 0
    s_cbranch_scc1 L_w1_467
    s_waitcnt vmcnt(5)
L_w1_467:
    s_waitcnt vmcnt(6)
L_w2_467:
    s_waitcnt vmcnt(7)
    buffer_load_dwordx4 v12, s[8:11], s57 offen offset:1024 nt lds
    v_pk_mul_f32 v[80:81], v[80:81], v[168:169] op_sel:[0,1] op_sel_hi:[1,1]
    v_pk_mul_f32 v[82:83], v[82:83], v[168:169] op_sel:[0,1] op_sel_hi:[1,1]
    v_pk_mul_f32 v[84:85], v[84:85], v[168:169] op_sel:[0,1] op_sel_hi:[1,1]
    v_pk_mul_f32 v[86:87], v[86:87], v[168:169] op_sel:[0,1] op_sel_hi:[1,1]
    v_pk_mul_f32 v[88:89], v[88:89], v[168:169] op_sel:[0,1] op_sel_hi:[1,1]
    v_pk_mul_f32 v[90:91], v[90:91], v[168:169] op_sel:[0,1] op_sel_hi:[1,1]
    v_pk_mul_f32 v[92:93], v[92:93], v[168:169] op_sel:[0,1] op_sel_hi:[1,1]
    v_pk_mul_f32 v[94:95], v[94:95], v[168:169] op_sel:[0,1] op_sel_hi:[1,1]
    v_pk_mul_f32 v[96:97], v[96:97], v[168:169] op_sel:[0,1] op_sel_hi:[1,1]
    v_pk_mul_f32 v[98:99], v[98:99], v[168:169] op_sel:[0,1] op_sel_hi:[1,1]
    v_pk_mul_f32 v[100:101], v[100:101], v[168:169] op_sel:[0,1] op_sel_hi:[1,1]
    v_pk_mul_f32 v[102:103], v[102:103], v[168:169] op_sel:[0,1] op_sel_hi:[1,1]
    v_pk_mul_f32 v[104:105], v[104:105], v[168:169] op_sel:[0,1] op_sel_hi:[1,1]
    v_pk_mul_f32 v[106:107], v[106:107], v[168:169] op_sel:[0,1] op_sel_hi:[1,1]
    v_pk_mul_f32 v[108:109], v[108:109], v[168:169] op_sel:[0,1] op_sel_hi:[1,1]
    v_pk_mul_f32 v[110:111], v[110:111], v[168:169] op_sel:[0,1] op_sel_hi:[1,1]
    v_pk_mul_f32 v[112:113], v[112:113], v[168:169] op_sel:[0,1] op_sel_hi:[1,1]
    v_pk_mul_f32 v[114:115], v[114:115], v[168:169] op_sel:[0,1] op_sel_hi:[1,1]
    v_pk_mul_f32 v[116:117], v[116:117], v[168:169] op_sel:[0,1] op_sel_hi:[1,1]
    v_pk_mul_f32 v[118:119], v[118:119], v[168:169] op_sel:[0,1] op_sel_hi:[1,1]
    v_pk_mul_f32 v[120:121], v[120:121], v[168:169] op_sel:[0,1] op_sel_hi:[1,1]
    v_pk_mul_f32 v[122:123], v[122:123], v[168:169] op_sel:[0,1] op_sel_hi:[1,1]
    v_pk_mul_f32 v[124:125], v[124:125], v[168:169] op_sel:[0,1] op_sel_hi:[1,1]
    v_pk_mul_f32 v[126:127], v[126:127], v[168:169] op_sel:[0,1] op_sel_hi:[1,1]
    ds_read_b64_tr_b16 a[2:3], v61 offset:0
    ds_read_b64_tr_b16 a[6:7], v61 offset:32
    s_cbranch_vccnz L_w2_468
    s_bitcmp1_b32 s34, 0
    s_cbranch_scc1 L_w1_468
    s_waitcnt vmcnt(5)
L_w1_468:
    s_waitcnt vmcnt(6)
L_w2_468:
    s_waitcnt vmcnt(7)
    buffer_load_dwordx4 v12, s[8:11], s57 offen offset:2048 nt lds
    ds_read_b64_tr_b16 a[10:11], v61 offset:64
    ds_read_b64_tr_b16 a[14:15], v61 offset:96
    ds_read_b64_tr_b16 a[18:19], v61 offset:128
    ds_read_b64_tr_b16 a[22:23], v61 offset:160
    ds_read_b64_tr_b16 a[26:27], v61 offset:192
    ds_read_b64_tr_b16 a[30:31], v61 offset:224
    ds_read_b64_tr_b16 a[34:35], v61 offset:256
    s_waitcnt lgkmcnt(0)
    s_cbranch_vccnz L_w2_469
    s_bitcmp1_b32 s34, 0
    s_cbranch_scc1 L_w1_469
    s_waitcnt vmcnt(5)
L_w1_469:
    s_waitcnt vmcnt(6)
L_w2_469:
    s_waitcnt vmcnt(7)
    buffer_load_dwordx4 v12, s[8:11], s57 offen offset:3072 nt lds
    s_add_u32 s49, s49, s100
    s_lshr_b32 s34, s49, 4
    s_and_b32 s49, s49, 15
    s_cmp_ge_u32 s34, 2
    s_cselect_b64 vcc, -1, 0
    s_xor_b32 s57, s99, 282624
    s_add_u32 m0, s56, 20480
    s_cbranch_vccnz L_w2_470
    s_bitcmp1_b32 s34, 0
    s_cbranch_scc1 L_w1_470
    s_waitcnt vmcnt(3)
L_w1_470:
    s_waitcnt vmcnt(6)
L_w2_470:
    s_waitcnt vmcnt(7)
    buffer_load_dwordx4 v12, s[8:11], s57 offen offset:0 nt lds
    s_add_u32 s79, s72, 147456
    s_add_u32 m0, s67, 0
    s_nop 0
    buffer_load_dwordx4 v56, s[20:23], s79 offen lds
    s_add_u32 m0, s56, 20480
    s_cbranch_vccnz L_w2_472
    s_bitcmp1_b32 s34, 0
    s_cbranch_scc1 L_w1_472
    s_waitcnt vmcnt(4)
L_w1_472:
    s_waitcnt vmcnt(5)
L_w2_472:
    s_waitcnt vmcnt(8)
    buffer_load_dwordx4 v12, s[8:11], s57 offen offset:1024 nt lds
    ds_read_b64_tr_b16 v[128:129], v24 offset:8192
    ds_read_b64_tr_b16 v[130:131], v24 offset:10240
    ds_read_b64_tr_b16 v[132:133], v25 offset:8192
    ds_read_b64_tr_b16 v[134:135], v25 offset:10240
    ds_read_b64_tr_b16 v[136:137], v26 offset:8192
    ds_read_b64_tr_b16 v[138:139], v26 offset:10240
    ds_read_b64_tr_b16 v[140:141], v27 offset:8192
    ds_read_b64_tr_b16 v[142:143], v27 offset:10240
    ds_read_b64_tr_b16 v[144:145], v24 offset:12288
    ds_read_b64_tr_b16 v[146:147], v24 offset:14336
    s_waitcnt lgkmcnt(8)
    v_mfma_f32_32x32x16_bf16 v[64:79], v[128:131], a[64:67], v[64:79]
    ds_read_b64_tr_b16 v[148:149], v25 offset:12288
    s_cbranch_vccnz L_w2_473
    s_bitcmp1_b32 s34, 0
    s_cbranch_scc1 L_w1_473
    s_waitcnt vmcnt(4)
L_w1_473:
    s_waitcnt vmcnt(5)
L_w2_473:
    s_waitcnt vmcnt(6)
    buffer_load_dwordx4 v12, s[8:11], s57 offen offset:2048 nt lds
    ds_read_b64_tr_b16 v[150:151], v25 offset:14336
    s_waitcnt lgkmcnt(8)
    v_mfma_f32_32x32x16_bf16 v[80:95], v[132:135], a[64:67], v[80:95]
    ds_read_b64_tr_b16 v[152:153], v26 offset:12288
    ds_read_b64_tr_b16 v[154:155], v26 offset:14336
    s_waitcnt lgkmcnt(8)
    v_mfma_f32_32x32x16_bf16 v[96:111], v[136:139], a[64:67], v[96:111]
    s_cbranch_vccnz L_w2_474
    s_bitcmp1_b32 s34, 0
    s_cbranch_scc1 L_w1_474
    s_waitcnt vmcnt(4)
L_w1_474:
    s_waitcnt vmcnt(5)
L_w2_474:
    s_waitcnt vmcnt(6)
    buffer_load_dwordx4 v12, s[8:11], s57 offen offset:3072 nt lds
    s_add_u32 m0, s67, 1024
    s_nop 0
    buffer_load_dwordx4 v57, s[20:23], s79 offen lds
    ds_read_b64_tr_b16 v[156:157], v27 offset:12288
    ds_read_b64_tr_b16 v[158:159], v27 offset:14336
    s_waitcnt lgkmcnt(8)
    v_mfma_f32_32x32x16_bf16 v[112:127], v[140:143], a[64:67], v[112:127]
    s_waitcnt lgkmcnt(6)
    v_mfma_f32_32x32x16_bf16 v[64:79], v[144:147], a[68:71], v[64:79]
    s_cmp_lg_u32 s44, 42
    s_cbranch_scc1 L_nc42
    v_sub_u32 v247, v246, v245
    v_lshlrev_b32 v246, 8, v254
    v_readfirstlane_b32 s3, v247
    s_nop 0
    s_min_u32 s3, s3, 7
    s_mul_i32 s3, s3, 6
    s_add_u32 s3, s3, s45
    v_mov_b32 v247, s3
    s_and_b32 s3, s35, 0xfffffcff
    s_mov_b64 exec, 15
    buffer_store_dword v247, v246, s[24:27], s3 offen offset:128
    s_mov_b64 exec, -1
L_nc42:
    v_sub_u32 v244, v244, v0
    v_cmp_gt_u32 s[100:101], 64, v244
    v_readlane_b32 s46, v244, 32
    s_bcnt1_i32_b32 s3, s100
    s_mul_i32 s3, s3, 3
    s_add_u32 s46, s46, 15
    s_cmp_lt_u32 s46, 128
    s_cselect_b32 s46, s46, 21
    s_add_u32 s3, s3, s46
    s_ashr_i32 s3, s3, 2
    s_add_i32 s3, s3, 2
    s_max_i32 s3, s3, 8
    s_min_i32 s100, s3, 32
    s_add_u32 s49, s49, s100
    s_lshr_b32 s34, s49, 4
    s_and_b32 s49, s49, 15
    s_cmp_ge_u32 s34, 2
    s_cselect_b64 vcc, -1, 0
    s_xor_b32 s57, s99, 540672
    s_add_u32 m0, s56, 24576
    s_cbranch_vccnz L_w2_476
    s_bitcmp1_b32 s34, 0
    s_cbranch_scc1 L_w1_476
    s_waitcnt vmcnt(5)
L_w1_476:
    s_waitcnt vmcnt(6)
L_w2_476:
    s_waitcnt vmcnt(7)
    buffer_load_dwordx4 v12, s[8:11], s57 offen offset:0 nt lds
    s_waitcnt lgkmcnt(4)
    v_mfma_f32_32x32x16_bf16 v[80:95], v[148:151], a[68:71], v[80:95]
    s_waitcnt lgkmcnt(2)
    v_mfma_f32_32x32x16_bf16 v[96:111], v[152:155], a[68:71], v[96:111]
    s_waitcnt lgkmcnt(0)
    v_mfma_f32_32x32x16_bf16 v[112:127], v[156:159], a[68:71], v[112:127]
    s_cbranch_vccnz L_w2_477
    s_bitcmp1_b32 s34, 0
    s_cbranch_scc1 L_w1_477
    s_waitcnt vmcnt(4)
L_w1_477:
    s_waitcnt vmcnt(6)
L_w2_477:
    s_waitcnt vmcnt(7)
    buffer_load_dwordx4 v12, s[8:11], s57 offen offset:1024 nt lds
    v_pk_mul_f32 v[64:65], v[64:65], v[170:171] op_sel_hi:[1,0]
    v_pk_mul_f32 v[66:67], v[66:67], v[170:171] op_sel_hi:[1,0]
    v_pk_mul_f32 v[68:69], v[68:69], v[170:171] op_sel_hi:[1,0]
    v_pk_mul_f32 v[70:71], v[70:71], v[170:171] op_sel_hi:[1,0]
    v_pk_mul_f32 v[72:73], v[72:73], v[170:171] op_sel_hi:[1,0]
    v_pk_mul_f32 v[74:75], v[74:75], v[170:171] op_sel_hi:[1,0]
    v_pk_mul_f32 v[76:77], v[76:77], v[170:171] op_sel_hi:[1,0]
    v_pk_mul_f32 v[78:79], v[78:79], v[170:171] op_sel_hi:[1,0]
    v_pk_mul_f32 v[80:81], v[80:81], v[170:171] op_sel_hi:[1,0]
    v_pk_mul_f32 v[82:83], v[82:83], v[170:171] op_sel_hi:[1,0]
    v_pk_mul_f32 v[84:85], v[84:85], v[170:171] op_sel_hi:[1,0]
    v_pk_mul_f32 v[86:87], v[86:87], v[170:171] op_sel_hi:[1,0]
    v_pk_mul_f32 v[88:89], v[88:89], v[170:171] op_sel_hi:[1,0]
    v_pk_mul_f32 v[90:91], v[90:91], v[170:171] op_sel_hi:[1,0]
    v_pk_mul_f32 v[92:93], v[92:93], v[170:171] op_sel_hi:[1,0]
    v_pk_mul_f32 v[94:95], v[94:95], v[170:171] op_sel_hi:[1,0]
    v_pk_mul_f32 v[96:97], v[96:97], v[170:171] op_sel_hi:[1,0]
    v_pk_mul_f32 v[98:99], v[98:99], v[170:171] op_sel_hi:[1,0]
    v_pk_mul_f32 v[100:101], v[100:101], v[170:171] op_sel_hi:[1,0]
    v_pk_mul_f32 v[102:103], v[102:103], v[170:171] op_sel_hi:[1,0]
    s_cbranch_vccnz L_w2_478
    s_bitcmp1_b32 s34, 0
    s_cbranch_scc1 L_w1_478
    s_waitcnt vmcnt(4)
L_w1_478:
    s_waitcnt vmcnt(5)
L_w2_478:
    s_waitcnt vmcnt(7)
    buffer_load_dwordx4 v12, s[8:11], s57 offen offset:2048 nt lds
    s_add_u32 m0, s67, 2048
    s_nop 0
    buffer_load_dwordx4 v58, s[20:23], s79 offen lds
    v_pk_mul_f32 v[104:105], v[104:105], v[170:171] op_sel_hi:[1,0]
    v_pk_mul_f32 v[106:107], v[106:107], v[170:171] op_sel_hi:[1,0]
    v_pk_mul_f32 v[108:109], v[108:109], v[170:171] op_sel_hi:[1,0]
    v_pk_mul_f32 v[110:111], v[110:111], v[170:171] op_sel_hi:[1,0]
    v_pk_mul_f32 v[112:113], v[112:113], v[170:171] op_sel_hi:[1,0]
    v_pk_mul_f32 v[114:115], v[114:115], v[170:171] op_sel_hi:[1,0]
    v_pk_mul_f32 v[116:117], v[116:117], v[170:171] op_sel_hi:[1,0]
    v_pk_mul_f32 v[118:119], v[118:119], v[170:171] op_sel_hi:[1,0]
    v_pk_mul_f32 v[120:121], v[120:121], v[170:171] op_sel_hi:[1,0]
    v_pk_mul_f32 v[122:123], v[122:123], v[170:171] op_sel_hi:[1,0]
    v_pk_mul_f32 v[124:125], v[124:125], v[170:171] op_sel_hi:[1,0]
    v_pk_mul_f32 v[126:127], v[126:127], v[170:171] op_sel_hi:[1,0]
    s_add_u32 m0, s56, 24576
    s_cbranch_vccnz L_w2_480
    s_bitcmp1_b32 s34, 0
    s_cbranch_scc1 L_w1_480
    s_waitcnt vmcnt(5)
L_w1_480:
    s_waitcnt vmcnt(6)
L_w2_480:
    s_waitcnt vmcnt(7)
    buffer_load_dwordx4 v12, s[8:11], s57 offen offset:3072 nt lds
    s_add_u32 s49, s49, s100
    s_lshr_b32 s34, s49, 4
    s_and_b32 s49, s49, 15
    s_cmp_ge_u32 s34, 2
    s_cselect_b64 vcc, -1, 0
    s_xor_b32 s57, s99, 544768
    s_add_u32 m0, s56, 28672
    s_cbranch_vccnz L_w2_481
    s_bitcmp1_b32 s34, 0
    s_cbranch_scc1 L_w1_481
    s_waitcnt vmcnt(4)
L_w1_481:
    s_waitcnt vmcnt(6)
L_w2_481:
    s_waitcnt vmcnt(7)
    buffer_load_dwordx4 v12, s[8:11], s57 offen offset:0 nt lds
    s_cbranch_vccnz L_w2_482
    s_bitcmp1_b32 s34, 0
    s_cbranch_scc1 L_w1_482
    s_waitcnt vmcnt(4)
L_w1_482:
    s_waitcnt vmcnt(5)
L_w2_482:
    s_waitcnt vmcnt(7)
    buffer_load_dwordx4 v12, s[8:11], s57 offen offset:1024 nt lds
    s_add_u32 m0, s67, 3072
    s_nop 0
    buffer_load_dwordx4 v59, s[20:23], s79 offen lds
    ds_read_b64_tr_b16 v[128:129], v24 offset:16384
    ds_read_b64_tr_b16 v[130:131], v24 offset:18432
    ds_read_b64_tr_b16 v[132:133], v25 offset:16384
    ds_read_b64_tr_b16 v[134:135], v25 offset:18432
    ds_read_b64_tr_b16 v[136:137], v26 offset:16384
    ds_read_b64_tr_b16 v[138:139], v26 offset:18432
    ds_read_b64_tr_b16 v[140:141], v27 offset:16384
    ds_read_b64_tr_b16 v[142:143], v27 offset:18432
    ds_read_b64_tr_b16 v[144:145], v24 offset:20480
    ds_read_b64_tr_b16 v[146:147], v24 offset:22528
    s_waitcnt lgkmcnt(8)
    v_mfma_f32_32x32x16_bf16 v[64:79], v[128:131], a[72:75], v[64:79]
    ds_read_b64_tr_b16 v[148:149], v25 offset:20480
    s_add_u32 m0, s56, 28672
    s_cbranch_vccnz L_w2_484
    s_bitcmp1_b32 s34, 0
    s_cbranch_scc1 L_w1_484
    s_waitcnt vmcnt(5)
L_w1_484:
    s_waitcnt vmcnt(6)
L_w2_484:
    s_waitcnt vmcnt(7)
    buffer_load_dwordx4 v12, s[8:11], s57 offen offset:2048 nt lds
    ds_read_b64_tr_b16 v[150:151], v25 offset:22528
    s_waitcnt lgkmcnt(8)
    v_mfma_f32_32x32x16_bf16 v[80:95], v[132:135], a[72:75], v[80:95]
    ds_read_b64_tr_b16 v[152:153], v26 offset:20480
    ds_read_b64_tr_b16 v[154:155], v26 offset:22528
    s_waitcnt lgkmcnt(8)
    v_mfma_f32_32x32x16_bf16 v[96:111], v[136:139], a[72:75], v[96:111]
    s_cbranch_vccnz L_w2_485
    s_bitcmp1_b32 s34, 0
    s_cbranch_scc1 L_w1_485
    s_waitcnt vmcnt(4)
L_w1_485:
    s_waitcnt vmcnt(6)
L_w2_485:
    s_waitcnt vmcnt(7)
    buffer_load_dwordx4 v12, s[8:11], s57 offen offset:3072 nt lds
    ds_read_b64_tr_b16 v[156:157], v27 offset:20480
    ds_read_b64_tr_b16 v[158:159], v27 offset:22528
    s_waitcnt lgkmcnt(8)
    v_mfma_f32_32x32x16_bf16 v[112:127], v[140:143], a[72:75], v[112:127]
    s_waitcnt lgkmcnt(6)
    v_mfma_f32_32x32x16_bf16 v[64:79], v[144:147], a[76:79], v[64:79]
    s_add_u32 s49, s49, s100
    s_lshr_b32 s34, s49, 4
    s_and_b32 s49, s49, 15
    s_cmp_ge_u32 s34, 2
    s_cselect_b64 vcc, -1, 0
    s_cmp_lg_u32 s44, 44
    s_cbranch_scc1 L_nr44
    s_mov_b32 s3, 85760
    v_mov_b32 v246, 1
    s_mov_b64 exec, 1
    buffer_atomic_add v246, off, s[24:27], s3 sc0
    s_mov_b64 exec, -1
L_nr44:
    v_add_u32 v0, 1, v0
    s_mov_b64 exec, s[32:33]
    buffer_store_dword v0, v242, s[24:27], s35 offen
    s_mov_b64 exec, -1
    buffer_load_dword v244, v242, s[24:27], s35 offen sc1
    s_xor_b32 s57, s99, 589824
    s_add_u32 m0, s56, 0
    s_cbranch_vccnz L_w2_488
    s_bitcmp1_b32 s34, 0
    s_cbranch_scc1 L_w1_488
    s_waitcnt vmcnt(6)
L_w1_488:
    s_waitcnt vmcnt(7)
L_w2_488:
    s_waitcnt vmcnt(9)
    buffer_load_dwordx4 v12, s[8:11], s57 offen offset:0 nt lds
    s_add_u32 m0, s67, 4096
    s_nop 0
    buffer_load_dwordx4 v60, s[20:23], s79 offen lds
    s_waitcnt lgkmcnt(4)
    v_mfma_f32_32x32x16_bf16 v[80:95], v[148:151], a[76:79], v[80:95]
    s_waitcnt lgkmcnt(2)
    v_mfma_f32_32x32x16_bf16 v[96:111], v[152:155], a[76:79], v[96:111]
    s_waitcnt lgkmcnt(0)
    v_mfma_f32_32x32x16_bf16 v[112:127], v[156:159], a[76:79], v[112:127]
    s_add_u32 m0, s56, 0
    s_cbranch_vccnz L_w2_490
    s_bitcmp1_b32 s34, 0
    s_cbranch_scc1 L_w1_490
    s_waitcnt vmcnt(7)
L_w1_490:
    s_waitcnt vmcnt(8)
L_w2_490:
    s_waitcnt vmcnt(9)
    buffer_load_dwordx4 v12, s[8:11], s57 offen offset:1024 nt lds
    v_pk_mul_f32 v[64:65], v[64:65], v[170:171] op_sel:[0,1] op_sel_hi:[1,1]
    v_pk_mul_f32 v[66:67], v[66:67], v[170:171] op_sel:[0,1] op_sel_hi:[1,1]
    v_pk_mul_f32 v[68:69], v[68:69], v[170:171] op_sel:[0,1] op_sel_hi:[1,1]
    v_pk_mul_f32 v[70:71], v[70:71], v[170:171] op_sel:[0,1] op_sel_hi:[1,1]
    v_pk_mul_f32 v[72:73], v[72:73], v[170:171] op_sel:[0,1] op_sel_hi:[1,1]
    v_pk_mul_f32 v[74:75], v[74:75], v[170:171] op_sel:[0,1] op_sel_hi:[1,1]
    v_pk_mul_f32 v[76:77], v[76:77], v[170:171] op_sel:[0,1] op_sel_hi:[1,1]
    v_pk_mul_f32 v[78:79], v[78:79], v[170:171] op_sel:[0,1] op_sel_hi:[1,1]
    v_pk_mul_f32 v[80:81], v[80:81], v[170:171] op_sel:[0,1] op_sel_hi:[1,1]
    v_pk_mul_f32 v[82:83], v[82:83], v[170:171] op_sel:[0,1] op_sel_hi:[1,1]
    v_pk_mul_f32 v[84:85], v[84:85], v[170:171] op_sel:[0,1] op_sel_hi:[1,1]
    v_pk_mul_f32 v[86:87], v[86:87], v[170:171] op_sel:[0,1] op_sel_hi:[1,1]
    v_pk_mul_f32 v[88:89], v[88:89], v[170:171] op_sel:[0,1] op_sel_hi:[1,1]
    v_pk_mul_f32 v[90:91], v[90:91], v[170:171] op_sel:[0,1] op_sel_hi:[1,1]
    v_pk_mul_f32 v[92:93], v[92:93], v[170:171] op_sel:[0,1] op_sel_hi:[1,1]
    v_pk_mul_f32 v[94:95], v[94:95], v[170:171] op_sel:[0,1] op_sel_hi:[1,1]
    v_pk_mul_f32 v[96:97], v[96:97], v[170:171] op_sel:[0,1] op_sel_hi:[1,1]
    v_pk_mul_f32 v[98:99], v[98:99], v[170:171] op_sel:[0,1] op_sel_hi:[1,1]
    v_pk_mul_f32 v[100:101], v[100:101], v[170:171] op_sel:[0,1] op_sel_hi:[1,1]
    v_pk_mul_f32 v[102:103], v[102:103], v[170:171] op_sel:[0,1] op_sel_hi:[1,1]
    s_cbranch_vccnz L_w2_491
    s_bitcmp1_b32 s34, 0
    s_cbranch_scc1 L_w1_491
    s_waitcnt vmcnt(6)
L_w1_491:
    s_waitcnt vmcnt(8)
L_w2_491:
    s_waitcnt vmcnt(9)
    buffer_load_dwordx4 v12, s[8:11], s57 offen offset:2048 nt lds
    v_pk_mul_f32 v[104:105], v[104:105], v[170:171] op_sel:[0,1] op_sel_hi:[1,1]
    v_pk_mul_f32 v[106:107], v[106:107], v[170:171] op_sel:[0,1] op_sel_hi:[1,1]
    v_pk_mul_f32 v[108:109], v[108:109], v[170:171] op_sel:[0,1] op_sel_hi:[1,1]
    v_pk_mul_f32 v[110:111], v[110:111], v[170:171] op_sel:[0,1] op_sel_hi:[1,1]
    v_pk_mul_f32 v[112:113], v[112:113], v[170:171] op_sel:[0,1] op_sel_hi:[1,1]
    v_pk_mul_f32 v[114:115], v[114:115], v[170:171] op_sel:[0,1] op_sel_hi:[1,1]
    v_pk_mul_f32 v[116:117], v[116:117], v[170:171] op_sel:[0,1] op_sel_hi:[1,1]
    v_pk_mul_f32 v[118:119], v[118:119], v[170:171] op_sel:[0,1] op_sel_hi:[1,1]
    v_pk_mul_f32 v[120:121], v[120:121], v[170:171] op_sel:[0,1] op_sel_hi:[1,1]
    v_pk_mul_f32 v[122:123], v[122:123], v[170:171] op_sel:[0,1] op_sel_hi:[1,1]
    v_pk_mul_f32 v[124:125], v[124:125], v[170:171] op_sel:[0,1] op_sel_hi:[1,1]
    v_pk_mul_f32 v[126:127], v[126:127], v[170:171] op_sel:[0,1] op_sel_hi:[1,1]
    s_cbranch_vccnz L_w2_492
    s_bitcmp1_b32 s34, 0
    s_cbranch_scc1 L_w1_492
    s_waitcnt vmcnt(6)
L_w1_492:
    s_waitcnt vmcnt(7)
L_w2_492:
    s_waitcnt vmcnt(9)
    buffer_load_dwordx4 v12, s[8:11], s57 offen offset:3072 nt lds
    s_add_u32 s49, s49, s100
    s_lshr_b32 s34, s49, 4
    s_and_b32 s49, s49, 15
    s_cmp_ge_u32 s34, 2
    s_cselect_b64 vcc, -1, 0
    s_xor_b32 s57, s99, 593920
    s_add_u32 m0, s56, 4096
    s_cbranch_vccnz L_w2_493
    s_bitcmp1_b32 s34, 0
    s_cbranch_scc1 L_w1_493
    s_waitcnt vmcnt(4)
L_w1_493:
    s_waitcnt vmcnt(7)
L_w2_493:
    s_waitcnt vmcnt(8)
    buffer_load_dwordx4 v12, s[8:11], s57 offen offset:0 nt lds
    s_cbranch_vccnz L_w2_494
    s_bitcmp1_b32 s34, 0
    s_cbranch_scc1 L_w1_494
    s_waitcnt vmcnt(3)
L_w1_494:
    s_waitcnt vmcnt(5)
L_w2_494:
    s_waitcnt vmcnt(8)
    buffer_load_dwordx4 v12, s[8:11], s57 offen offset:1024 nt lds
    ds_read_b64_tr_b16 v[128:129], v24 offset:24576
    ds_read_b64_tr_b16 v[130:131], v24 offset:26624
    ds_read_b64_tr_b16 v[132:133], v25 offset:24576
    ds_read_b64_tr_b16 v[134:135], v25 offset:26624
    ds_read_b64_tr_b16 v[136:137], v26 offset:24576
    ds_read_b64_tr_b16 v[138:139], v26 offset:26624
    ds_read_b64_tr_b16 v[140:141], v27 offset:24576
    ds_read_b64_tr_b16 v[142:143], v27 offset:26624
    ds_read_b64_tr_b16 v[144:145], v24 offset:28672
    ds_read_b64_tr_b16 v[146:147], v24 offset:30720
    s_waitcnt lgkmcnt(8)
    v_mfma_f32_32x32x16_bf16 v[64:79], v[128:131], a[80:83], v[64:79]
    ds_read_b64_tr_b16 v[148:149], v25 offset:28672
    s_cbranch_vccnz L_w2_495
    s_bitcmp1_b32 s34, 0
    s_cbranch_scc1 L_w1_495
    s_waitcnt vmcnt(3)
L_w1_495:
    s_waitcnt vmcnt(4)
L_w2_495:
    s_waitcnt vmcnt(6)
    buffer_load_dwordx4 v12, s[8:11], s57 offen offset:2048 nt lds
    ds_read_b64_tr_b16 v[150:151], v25 offset:30720
    s_waitcnt lgkmcnt(8)
    v_mfma_f32_32x32x16_bf16 v[80:95], v[132:135], a[80:83], v[80:95]
    ds_read_b64_tr_b16 v[152:153], v26 offset:28672
    ds_read_b64_tr_b16 v[154:155], v26 offset:30720
    s_waitcnt lgkmcnt(8)
    v_mfma_f32_32x32x16_bf16 v[96:111], v[136:139], a[80:83], v[96:111]
    s_cbranch_vccnz L_w2_496
    s_bitcmp1_b32 s34, 0
    s_cbranch_scc1 L_w1_496
    s_waitcnt vmcnt(3)
L_w1_496:
    s_waitcnt vmcnt(4)
L_w2_496:
    s_waitcnt vmcnt(5)
    buffer_load_dwordx4 v12, s[8:11], s57 offen offset:3072 nt lds
    ds_read_b64_tr_b16 v[156:157], v27 offset:28672
    ds_read_b64_tr_b16 v[158:159], v27 offset:30720
    s_waitcnt lgkmcnt(8)
    v_mfma_f32_32x32x16_bf16 v[112:127], v[140:143], a[80:83], v[112:127]
    s_waitcnt lgkmcnt(6)
    v_mfma_f32_32x32x16_bf16 v[64:79], v[144:147], a[84:87], v[64:79]
    s_waitcnt lgkmcnt(4)
    v_mfma_f32_32x32x16_bf16 v[80:95], v[148:151], a[84:87], v[80:95]
    s_cmp_lg_u32 s44, 44
    s_cbranch_scc1 L_nc44
    v_sub_u32 v247, v246, v245
    v_lshlrev_b32 v246, 8, v254
    v_readfirstlane_b32 s3, v247
    s_nop 0
    s_min_u32 s3, s3, 7
    s_mul_i32 s3, s3, 6
    s_add_u32 s3, s3, s45
    v_mov_b32 v247, s3
    s_and_b32 s3, s35, 0xfffffcff
    s_mov_b64 exec, 15
    buffer_store_dword v247, v246, s[24:27], s3 offen offset:128
    s_mov_b64 exec, -1
L_nc44:
    v_sub_u32 v244, v244, v0
    v_cmp_gt_u32 s[100:101], 64, v244
    v_readlane_b32 s46, v244, 32
    s_bcnt1_i32_b32 s3, s100
    s_mul_i32 s3, s3, 3
    s_add_u32 s46, s46, 16
    s_cmp_lt_u32 s46, 128
    s_cselect_b32 s46, s46, 21
    s_add_u32 s3, s3, s46
    s_ashr_i32 s3, s3, 2
    s_add_i32 s3, s3, 2
    s_max_i32 s3, s3, 8
    s_min_i32 s100, s3, 32
    s_add_u32 s49, s49, s100
    s_lshr_b32 s34, s49, 4
    s_and_b32 s49, s49, 15
    s_cmp_ge_u32 s34, 2
    s_cselect_b64 vcc, -1, 0
    s_xor_b32 s57, s99, 131072
    s_add_u32 m0, s56, 8192
    s_cbranch_vccnz L_w2_497
    s_bitcmp1_b32 s34, 0
    s_cbranch_scc1 L_w1_497
    s_waitcnt vmcnt(3)
L_w1_497:
    s_waitcnt vmcnt(4)
L_w2_497:
    s_waitcnt vmcnt(5)
    buffer_load_dwordx4 v12, s[8:11], s57 offen offset:0 nt lds
    s_waitcnt lgkmcnt(2)
    v_mfma_f32_32x32x16_bf16 v[96:111], v[152:155], a[84:87], v[96:111]
    s_waitcnt lgkmcnt(0)
    v_mfma_f32_32x32x16_bf16 v[112:127], v[156:159], a[84:87], v[112:127]
    v_pk_mul_f32 v[64:65], v[64:65], v[172:173] op_sel_hi:[1,0]
    v_pk_mul_f32 v[66:67], v[66:67], v[172:173] op_sel_hi:[1,0]
    v_pk_mul_f32 v[68:69], v[68:69], v[172:173] op_sel_hi:[1,0]
    v_pk_mul_f32 v[70:71], v[70:71], v[172:173] op_sel_hi:[1,0]
    v_pk_mul_f32 v[72:73], v[72:73], v[172:173] op_sel_hi:[1,0]
    v_pk_mul_f32 v[74:75], v[74:75], v[172:173] op_sel_hi:[1,0]
    v_pk_mul_f32 v[76:77], v[76:77], v[172:173] op_sel_hi:[1,0]
    v_pk_mul_f32 v[78:79], v[78:79], v[172:173] op_sel_hi:[1,0]
    s_cbranch_vccnz L_w2_498
    s_bitcmp1_b32 s34, 0
    s_cbranch_scc1 L_w1_498
    s_waitcnt vmcnt(3)
L_w1_498:
    s_waitcnt vmcnt(4)
L_w2_498:
    s_waitcnt vmcnt(5)
    buffer_load_dwordx4 v12, s[8:11], s57 offen offset:1024 nt lds
    v_pk_mul_f32 v[80:81], v[80:81], v[172:173] op_sel_hi:[1,0]
    v_pk_mul_f32 v[82:83], v[82:83], v[172:173] op_sel_hi:[1,0]
    v_pk_mul_f32 v[84:85], v[84:85], v[172:173] op_sel_hi:[1,0]
    v_pk_mul_f32 v[86:87], v[86:87], v[172:173] op_sel_hi:[1,0]
    v_pk_mul_f32 v[88:89], v[88:89], v[172:173] op_sel_hi:[1,0]
    v_pk_mul_f32 v[90:91], v[90:91], v[172:173] op_sel_hi:[1,0]
    v_pk_mul_f32 v[92:93], v[92:93], v[172:173] op_sel_hi:[1,0]
    v_pk_mul_f32 v[94:95], v[94:95], v[172:173] op_sel_hi:[1,0]
    v_pk_mul_f32 v[96:97], v[96:97], v[172:173] op_sel_hi:[1,0]
    v_pk_mul_f32 v[98:99], v[98:99], v[172:173] op_sel_hi:[1,0]
    v_pk_mul_f32 v[100:101], v[100:101], v[172:173] op_sel_hi:[1,0]
    v_pk_mul_f32 v[102:103], v[102:103], v[172:173] op_sel_hi:[1,0]
    v_pk_mul_f32 v[104:105], v[104:105], v[172:173] op_sel_hi:[1,0]
    v_pk_mul_f32 v[106:107], v[106:107], v[172:173] op_sel_hi:[1,0]
    v_pk_mul_f32 v[108:109], v[108:109], v[172:173] op_sel_hi:[1,0]
    v_pk_mul_f32 v[110:111], v[110:111], v[172:173] op_sel_hi:[1,0]
    v_pk_mul_f32 v[112:113], v[112:113], v[172:173] op_sel_hi:[1,0]
    v_pk_mul_f32 v[114:115], v[114:115], v[172:173] op_sel_hi:[1,0]
    v_pk_mul_f32 v[116:117], v[116:117], v[172:173] op_sel_hi:[1,0]
    v_pk_mul_f32 v[118:119], v[118:119], v[172:173] op_sel_hi:[1,0]
    v_pk_mul_f32 v[120:121], v[120:121], v[172:173] op_sel_hi:[1,0]
    v_pk_mul_f32 v[122:123], v[122:123], v[172:173] op_sel_hi:[1,0]
    v_pk_mul_f32 v[124:125], v[124:125], v[172:173] op_sel_hi:[1,0]
    v_pk_mul_f32 v[126:127], v[126:127], v[172:173] op_sel_hi:[1,0]
    ds_read_b64_tr_b16 a[36:37], v61 offset:0
    ds_read_b64_tr_b16 a[40:41], v61 offset:32
    s_cbranch_vccnz L_w2_499
    s_bitcmp1_b32 s34, 0
    s_cbranch_scc1 L_w1_499
    s_waitcnt vmcnt(3)
L_w1_499:
    s_waitcnt vmcnt(4)
L_w2_499:
    s_waitcnt vmcnt(5)
    buffer_load_dwordx4 v12, s[8:11], s57 offen offset:2048 nt lds
    ds_read_b64_tr_b16 a[44:45], v61 offset:64
    ds_read_b64_tr_b16 a[48:49], v61 offset:96
    ds_read_b64_tr_b16 a[52:53], v61 offset:128
    ds_read_b64_tr_b16 a[56:57], v61 offset:160
    ds_read_b64_tr_b16 a[60:61], v61 offset:192
    ds_read_b64_tr_b16 a[64:65], v61 offset:224
    ds_read_b64_tr_b16 a[68:69], v61 offset:256
    s_waitcnt lgkmcnt(0)
    s_cbranch_vccnz L_w2_500
    s_bitcmp1_b32 s34, 0
    s_cbranch_scc1 L_w1_500
    s_waitcnt vmcnt(3)
L_w1_500:
    s_waitcnt vmcnt(4)
L_w2_500:
    s_waitcnt vmcnt(5)
    buffer_load_dwordx4 v12, s[8:11], s57 offen offset:3072 nt lds
    s_add_u32 s49, s49, s100
    s_lshr_b32 s34, s49, 4
    s_and_b32 s49, s49, 15
    s_cmp_ge_u32 s34, 2
    s_cselect_b64 vcc, -1, 0
    s_xor_b32 s57, s99, 135168
    s_add_u32 m0, s56, 12288
    s_cbranch_vccnz L_w2_501
    s_bitcmp1_b32 s34, 0
    s_cbranch_scc1 L_w1_501
    s_waitcnt vmcnt(3)
L_w1_501:
    s_waitcnt vmcnt(4)
L_w2_501:
    s_waitcnt vmcnt(5)
    buffer_load_dwordx4 v12, s[8:11], s57 offen offset:0 nt lds
    s_add_u32 s79, s72, 156672
    s_add_u32 m0, s67, 0
    s_nop 0
    buffer_load_dwordx4 v56, s[20:23], s79 offen lds
    s_add_u32 m0, s56, 12288
    s_cbranch_vccnz L_w2_503
    s_bitcmp1_b32 s34, 0
    s_cbranch_scc1 L_w1_503
    s_waitcnt vmcnt(4)
L_w1_503:
    s_waitcnt vmcnt(5)
L_w2_503:
    s_waitcnt vmcnt(6)
    buffer_load_dwordx4 v12, s[8:11], s57 offen offset:1024 nt lds
    ds_read_b64_tr_b16 v[128:129], v24 offset:0
    ds_read_b64_tr_b16 v[130:131], v24 offset:2048
    ds_read_b64_tr_b16 v[132:133], v25 offset:0
    ds_read_b64_tr_b16 v[134:135], v25 offset:2048
    ds_read_b64_tr_b16 v[136:137], v26 offset:0
    ds_read_b64_tr_b16 v[138:139], v26 offset:2048
    ds_read_b64_tr_b16 v[140:141], v27 offset:0
    ds_read_b64_tr_b16 v[142:143], v27 offset:2048
    ds_read_b64_tr_b16 v[144:145], v24 offset:4096
    ds_read_b64_tr_b16 v[146:147], v24 offset:6144
    s_waitcnt lgkmcnt(8)
    v_mfma_f32_32x32x16_bf16 v[64:79], v[128:131], a[88:91], v[64:79]
    ds_read_b64_tr_b16 v[148:149], v25 offset:4096
    s_cbranch_vccnz L_w2_504
    s_bitcmp1_b32 s34, 0
    s_cbranch_scc1 L_w1_504
    s_waitcnt vmcnt(4)
L_w1_504:
    s_waitcnt vmcnt(5)
L_w2_504:
    s_waitcnt vmcnt(6)
    buffer_load_dwordx4 v12, s[8:11], s57 offen offset:2048 nt lds
    ds_read_b64_tr_b16 v[150:151], v25 offset:6144
    s_waitcnt lgkmcnt(8)
    v_mfma_f32_32x32x16_bf16 v[80:95], v[132:135], a[88:91], v[80:95]
    ds_read_b64_tr_b16 v[152:153], v26 offset:4096
    ds_read_b64_tr_b16 v[154:155], v26 offset:6144
    s_waitcnt lgkmcnt(8)
    v_mfma_f32_32x32x16_bf16 v[96:111], v[136:139], a[88:91], v[96:111]
    s_cbranch_vccnz L_w2_505
    s_bitcmp1_b32 s34, 0
    s_cbranch_scc1 L_w1_505
    s_waitcnt vmcnt(4)
L_w1_505:
    s_waitcnt vmcnt(5)
L_w2_505:
    s_waitcnt vmcnt(6)
    buffer_load_dwordx4 v12, s[8:11], s57 offen offset:3072 nt lds
    s_add_u32 m0, s67, 1024
    s_nop 0
    buffer_load_dwordx4 v57, s[20:23], s79 offen lds
    ds_read_b64_tr_b16 v[156:157], v27 offset:4096
    ds_read_b64_tr_b16 v[158:159], v27 offset:6144
    s_waitcnt lgkmcnt(8)
    v_mfma_f32_32x32x16_bf16 v[112:127], v[140:143], a[88:91], v[112:127]
    s_waitcnt lgkmcnt(6)
    v_mfma_f32_32x32x16_bf16 v[64:79], v[144:147], a[92:95], v[64:79]
    s_add_u32 s49, s49, s100
    s_lshr_b32 s34, s49, 4
    s_and_b32 s49, s49, 15
    s_cmp_ge_u32 s34, 2
    s_cselect_b64 vcc, -1, 0
    s_cmp_lg_u32 s44, 46
    s_cbranch_scc1 L_nr46
    s_mov_b32 s3, 86016
    v_mov_b32 v246, 1
    s_mov_b64 exec, 1
    buffer_atomic_add v246, off, s[24:27], s3 sc0
    s_mov_b64 exec, -1
L_nr46:
    v_add_u32 v0, 1, v0
    s_mov_b64 exec, s[32:33]
    buffer_store_dword v0, v242, s[24:27], s35 offen
    s_mov_b64 exec, -1
    buffer_load_dword v244, v242, s[24:27], s35 offen sc1
    s_xor_b32 s57, s99, 606208
    s_add_u32 m0, s56, 16384
    s_cbranch_vccnz L_w2_509
    s_bitcmp1_b32 s34, 0
    s_cbranch_scc1 L_w1_509
    s_waitcnt vmcnt(7)
L_w1_509:
    s_waitcnt vmcnt(8)
L_w2_509:
    s_waitcnt vmcnt(9)
    buffer_load_dwordx4 v12, s[8:11], s57 offen offset:0 nt lds
    s_waitcnt lgkmcnt(4)
    v_mfma_f32_32x32x16_bf16 v[80:95], v[148:151], a[92:95], v[80:95]
    s_waitcnt lgkmcnt(2)
    v_mfma_f32_32x32x16_bf16 v[96:111], v[152:155], a[92:95], v[96:111]
    s_waitcnt lgkmcnt(0)
    v_mfma_f32_32x32x16_bf16 v[112:127], v[156:159], a[92:95], v[112:127]
    s_cbranch_vccnz L_w2_510
    s_bitcmp1_b32 s34, 0
    s_cbranch_scc1 L_w1_510
    s_waitcnt vmcnt(6)
L_w1_510:
    s_waitcnt vmcnt(8)
L_w2_510:
    s_waitcnt vmcnt(9)
    buffer_load_dwordx4 v12, s[8:11], s57 offen offset:1024 nt lds
    v_pk_mul_f32 v[64:65], v[64:65], v[172:173] op_sel:[0,1] op_sel_hi:[1,1]
    v_pk_mul_f32 v[66:67], v[66:67], v[172:173] op_sel:[0,1] op_sel_hi:[1,1]
    v_pk_mul_f32 v[68:69], v[68:69], v[172:173] op_sel:[0,1] op_sel_hi:[1,1]
    v_pk_mul_f32 v[70:71], v[70:71], v[172:173] op_sel:[0,1] op_sel_hi:[1,1]
    v_pk_mul_f32 v[72:73], v[72:73], v[172:173] op_sel:[0,1] op_sel_hi:[1,1]
    v_pk_mul_f32 v[74:75], v[74:75], v[172:173] op_sel:[0,1] op_sel_hi:[1,1]
    v_pk_mul_f32 v[76:77], v[76:77], v[172:173] op_sel:[0,1] op_sel_hi:[1,1]
    v_pk_mul_f32 v[78:79], v[78:79], v[172:173] op_sel:[0,1] op_sel_hi:[1,1]
    v_pk_mul_f32 v[80:81], v[80:81], v[172:173] op_sel:[0,1] op_sel_hi:[1,1]
    v_pk_mul_f32 v[82:83], v[82:83], v[172:173] op_sel:[0,1] op_sel_hi:[1,1]
    v_pk_mul_f32 v[84:85], v[84:85], v[172:173] op_sel:[0,1] op_sel_hi:[1,1]
    v_pk_mul_f32 v[86:87], v[86:87], v[172:173] op_sel:[0,1] op_sel_hi:[1,1]
    v_pk_mul_f32 v[88:89], v[88:89], v[172:173] op_sel:[0,1] op_sel_hi:[1,1]
    v_pk_mul_f32 v[90:91], v[90:91], v[172:173] op_sel:[0,1] op_sel_hi:[1,1]
    v_pk_mul_f32 v[92:93], v[92:93], v[172:173] op_sel:[0,1] op_sel_hi:[1,1]
    v_pk_mul_f32 v[94:95], v[94:95], v[172:173] op_sel:[0,1] op_sel_hi:[1,1]
    v_pk_mul_f32 v[96:97], v[96:97], v[172:173] op_sel:[0,1] op_sel_hi:[1,1]
    v_pk_mul_f32 v[98:99], v[98:99], v[172:173] op_sel:[0,1] op_sel_hi:[1,1]
    v_pk_mul_f32 v[100:101], v[100:101], v[172:173] op_sel:[0,1] op_sel_hi:[1,1]
    v_pk_mul_f32 v[102:103], v[102:103], v[172:173] op_sel:[0,1] op_sel_hi:[1,1]
    s_cbranch_vccnz L_w2_511
    s_bitcmp1_b32 s34, 0
    s_cbranch_scc1 L_w1_511
    s_waitcnt vmcnt(6)
L_w1_511:
    s_waitcnt vmcnt(7)
L_w2_511:
    s_waitcnt vmcnt(9)
    buffer_load_dwordx4 v12, s[8:11], s57 offen offset:2048 nt lds
    s_add_u32 m0, s67, 2048
    s_nop 0
    buffer_load_dwordx4 v58, s[20:23], s79 offen lds
    v_pk_mul_f32 v[104:105], v[104:105], v[172:173] op_sel:[0,1] op_sel_hi:[1,1]
    v_pk_mul_f32 v[106:107], v[106:107], v[172:173] op_sel:[0,1] op_sel_hi:[1,1]
    v_pk_mul_f32 v[108:109], v[108:109], v[172:173] op_sel:[0,1] op_sel_hi:[1,1]
    v_pk_mul_f32 v[110:111], v[110:111], v[172:173] op_sel:[0,1] op_sel_hi:[1,1]
    v_pk_mul_f32 v[112:113], v[112:113], v[172:173] op_sel:[0,1] op_sel_hi:[1,1]
    v_pk_mul_f32 v[114:115], v[114:115], v[172:173] op_sel:[0,1] op_sel_hi:[1,1]
    v_pk_mul_f32 v[116:117], v[116:117], v[172:173] op_sel:[0,1] op_sel_hi:[1,1]
    v_pk_mul_f32 v[118:119], v[118:119], v[172:173] op_sel:[0,1] op_sel_hi:[1,1]
    v_pk_mul_f32 v[120:121], v[120:121], v[172:173] op_sel:[0,1] op_sel_hi:[1,1]
    v_pk_mul_f32 v[122:123], v[122:123], v[172:173] op_sel:[0,1] op_sel_hi:[1,1]
    v_pk_mul_f32 v[124:125], v[124:125], v[172:173] op_sel:[0,1] op_sel_hi:[1,1]
    v_pk_mul_f32 v[126:127], v[126:127], v[172:173] op_sel:[0,1] op_sel_hi:[1,1]
    s_add_u32 m0, s56, 16384
    s_cbranch_vccnz L_w2_513
    s_bitcmp1_b32 s34, 0
    s_cbranch_scc1 L_w1_513
    s_waitcnt vmcnt(7)
L_w1_513:
    s_waitcnt vmcnt(8)
L_w2_513:
    s_waitcnt vmcnt(9)
    buffer_load_dwordx4 v12, s[8:11], s57 offen offset:3072 nt lds
    s_add_u32 s49, s49, s100
    s_lshr_b32 s34, s49, 4
    s_and_b32 s49, s49, 15
    s_cmp_ge_u32 s34, 2
    s_cselect_b64 vcc, -1, 0
    s_xor_b32 s57, s99, 610304
    s_add_u32 m0, s56, 20480
    s_cbranch_vccnz L_w2_514
    s_bitcmp1_b32 s34, 0
    s_cbranch_scc1 L_w1_514
    s_waitcnt vmcnt(4)
L_w1_514:
    s_waitcnt vmcnt(8)
L_w2_514:
    s_waitcnt vmcnt(9)
    buffer_load_dwordx4 v12, s[8:11], s57 offen offset:0 nt lds
    s_cbranch_vccnz L_w2_515
    s_bitcmp1_b32 s34, 0
    s_cbranch_scc1 L_w1_515
    s_waitcnt vmcnt(4)
L_w1_515:
    s_waitcnt vmcnt(5)
L_w2_515:
    s_waitcnt vmcnt(9)
    buffer_load_dwordx4 v12, s[8:11], s57 offen offset:1024 nt lds
    s_add_u32 m0, s67, 3072
    s_nop 0
    buffer_load_dwordx4 v59, s[20:23], s79 offen lds
    ds_read_b64_tr_b16 v[128:129], v24 offset:8192
    ds_read_b64_tr_b16 v[130:131], v24 offset:10240
    ds_read_b64_tr_b16 v[132:133], v25 offset:8192
    ds_read_b64_tr_b16 v[134:135], v25 offset:10240
    ds_read_b64_tr_b16 v[136:137], v26 offset:8192
    ds_read_b64_tr_b16 v[138:139], v26 offset:10240
    ds_read_b64_tr_b16 v[140:141], v27 offset:8192
    ds_read_b64_tr_b16 v[142:143], v27 offset:10240
    ds_read_b64_tr_b16 v[144:145], v24 offset:12288
    ds_read_b64_tr_b16 v[146:147], v24 offset:14336
    s_waitcnt lgkmcnt(8)
    v_mfma_f32_32x32x16_bf16 v[64:79], v[128:131], a[96:99], v[64:79]
    ds_read_b64_tr_b16 v[148:149], v25 offset:12288
    s_add_u32 m0, s56, 20480
    s_cbranch_vccnz L_w2_517
    s_bitcmp1_b32 s34, 0
    s_cbranch_scc1 L_w1_517
    s_waitcnt vmcnt(5)
L_w1_517:
    s_waitcnt vmcnt(6)
L_w2_517:
    s_waitcnt vmcnt(7)
    buffer_load_dwordx4 v12, s[8:11], s57 offen offset:2048 nt lds
    ds_read_b64_tr_b16 v[150:151], v25 offset:14336
    s_waitcnt lgkmcnt(8)
    v_mfma_f32_32x32x16_bf16 v[80:95], v[132:135], a[96:99], v[80:95]
    ds_read_b64_tr_b16 v[152:153], v26 offset:12288
    ds_read_b64_tr_b16 v[154:155], v26 offset:14336
    s_waitcnt lgkmcnt(8)
    v_mfma_f32_32x32x16_bf16 v[96:111], v[136:139], a[96:99], v[96:111]
    s_cbranch_vccnz L_w2_518
    s_bitcmp1_b32 s34, 0
    s_cbranch_scc1 L_w1_518
    s_waitcnt vmcnt(4)
L_w1_518:
    s_waitcnt vmcnt(6)
L_w2_518:
    s_waitcnt vmcnt(7)
    buffer_load_dwordx4 v12, s[8:11], s57 offen offset:3072 nt lds
    ds_read_b64_tr_b16 v[156:157], v27 offset:12288
    ds_read_b64_tr_b16 v[158:159], v27 offset:14336
    s_waitcnt lgkmcnt(8)
    v_mfma_f32_32x32x16_bf16 v[112:127], v[140:143], a[96:99], v[112:127]
    s_waitcnt lgkmcnt(6)
    v_mfma_f32_32x32x16_bf16 v[64:79], v[144:147], a[100:103], v[64:79]
    s_cmp_lg_u32 s44, 46
    s_cbranch_scc1 L_nc46
    v_sub_u32 v247, v246, v245
    v_lshlrev_b32 v246, 8, v254
    v_readfirstlane_b32 s3, v247
    s_nop 0
    s_min_u32 s3, s3, 7
    s_mul_i32 s3, s3, 6
    s_add_u32 s3, s3, s45
    v_mov_b32 v247, s3
    s_and_b32 s3, s35, 0xfffffcff
    s_mov_b64 exec, 15
    buffer_store_dword v247, v246, s[24:27], s3 offen offset:128
    s_mov_b64 exec, -1
L_nc46:
    v_sub_u32 v244, v244, v0
    v_cmp_gt_u32 s[100:101], 64, v244
    v_readlane_b32 s46, v244, 32
    s_bcnt1_i32_b32 s3, s100
    s_mul_i32 s3, s3, 3
    s_add_u32 s46, s46, 17
    s_cmp_lt_u32 s46, 128
    s_cselect_b32 s46, s46, 21
    s_add_u32 s3, s3, s46
    s_ashr_i32 s3, s3, 2
    s_add_i32 s3, s3, 2
    s_max_i32 s3, s3, 8
    s_min_i32 s100, s3, 32
    s_add_u32 s49, s49, s100
    s_lshr_b32 s34, s49, 4
    s_and_b32 s49, s49, 15
    s_cmp_ge_u32 s34, 2
    s_cselect_b64 vcc, -1, 0
    s_xor_b32 s57, s99, 655360
    s_add_u32 m0, s56, 24576
    s_cbranch_vccnz L_w2_519
    s_bitcmp1_b32 s34, 0
    s_cbranch_scc1 L_w1_519
    s_waitcnt vmcnt(4)
L_w1_519:
    s_waitcnt vmcnt(5)
L_w2_519:
    s_waitcnt vmcnt(7)
    buffer_load_dwordx4 v12, s[8:11], s57 offen offset:0 nt lds
    s_add_u32 m0, s67, 4096
    s_nop 0
    buffer_load_dwordx4 v60, s[20:23], s79 offen lds
    s_waitcnt lgkmcnt(4)
    v_mfma_f32_32x32x16_bf16 v[80:95], v[148:151], a[100:103], v[80:95]
    s_waitcnt lgkmcnt(2)
    v_mfma_f32_32x32x16_bf16 v[96:111], v[152:155], a[100:103], v[96:111]
    s_waitcnt lgkmcnt(0)
    v_mfma_f32_32x32x16_bf16 v[112:127], v[156:159], a[100:103], v[112:127]
    s_add_u32 m0, s56, 24576
    s_cbranch_vccnz L_w2_521
    s_bitcmp1_b32 s34, 0
    s_cbranch_scc1 L_w1_521
    s_waitcnt vmcnt(5)
L_w1_521:
    s_waitcnt vmcnt(6)
L_w2_521:
    s_waitcnt vmcnt(7)
    buffer_load_dwordx4 v12, s[8:11], s57 offen offset:1024 nt lds
    v_pk_mul_f32 v[64:65], v[64:65], v[174:175] op_sel_hi:[1,0]
    v_pk_mul_f32 v[66:67], v[66:67], v[174:175] op_sel_hi:[1,0]
    v_pk_mul_f32 v[68:69], v[68:69], v[174:175] op_sel_hi:[1,0]
    v_pk_mul_f32 v[70:71], v[70:71], v[174:175] op_sel_hi:[1,0]
    v_pk_mul_f32 v[72:73], v[72:73], v[174:175] op_sel_hi:[1,0]
    v_pk_mul_f32 v[74:75], v[74:75], v[174:175] op_sel_hi:[1,0]
    v_pk_mul_f32 v[76:77], v[76:77], v[174:175] op_sel_hi:[1,0]
    v_pk_mul_f32 v[78:79], v[78:79], v[174:175] op_sel_hi:[1,0]
    v_pk_mul_f32 v[80:81], v[80:81], v[174:175] op_sel_hi:[1,0]
    v_pk_mul_f32 v[82:83], v[82:83], v[174:175] op_sel_hi:[1,0]
    v_pk_mul_f32 v[84:85], v[84:85], v[174:175] op_sel_hi:[1,0]
    v_pk_mul_f32 v[86:87], v[86:87], v[174:175] op_sel_hi:[1,0]
    v_pk_mul_f32 v[88:89], v[88:89], v[174:175] op_sel_hi:[1,0]
    v_pk_mul_f32 v[90:91], v[90:91], v[174:175] op_sel_hi:[1,0]
    v_pk_mul_f32 v[92:93], v[92:93], v[174:175] op_sel_hi:[1,0]
    v_pk_mul_f32 v[94:95], v[94:95], v[174:175] op_sel_hi:[1,0]
    v_pk_mul_f32 v[96:97], v[96:97], v[174:175] op_sel_hi:[1,0]
    v_pk_mul_f32 v[98:99], v[98:99], v[174:175] op_sel_hi:[1,0]
    v_pk_mul_f32 v[100:101], v[100:101], v[174:175] op_sel_hi:[1,0]
    v_pk_mul_f32 v[102:103], v[102:103], v[174:175] op_sel_hi:[1,0]
    s_cbranch_vccnz L_w2_522
    s_bitcmp1_b32 s34, 0
    s_cbranch_scc1 L_w1_522
    s_waitcnt vmcnt(4)
L_w1_522:
    s_waitcnt vmcnt(6)
L_w2_522:
    s_waitcnt vmcnt(7)
    buffer_load_dwordx4 v12, s[8:11], s57 offen offset:2048 nt lds
    v_pk_mul_f32 v[104:105], v[104:105], v[174:175] op_sel_hi:[1,0]
    v_pk_mul_f32 v[106:107], v[106:107], v[174:175] op_sel_hi:[1,0]
    v_pk_mul_f32 v[108:109], v[108:109], v[174:175] op_sel_hi:[1,0]
    v_pk_mul_f32 v[110:111], v[110:111], v[174:175] op_sel_hi:[1,0]
    v_pk_mul_f32 v[112:113], v[112:113], v[174:175] op_sel_hi:[1,0]
    v_pk_mul_f32 v[114:115], v[114:115], v[174:175] op_sel_hi:[1,0]
    v_pk_mul_f32 v[116:117], v[116:117], v[174:175] op_sel_hi:[1,0]
    v_pk_mul_f32 v[118:119], v[118:119], v[174:175] op_sel_hi:[1,0]
    v_pk_mul_f32 v[120:121], v[120:121], v[174:175] op_sel_hi:[1,0]
    v_pk_mul_f32 v[122:123], v[122:123], v[174:175] op_sel_hi:[1,0]
    v_pk_mul_f32 v[124:125], v[124:125], v[174:175] op_sel_hi:[1,0]
    v_pk_mul_f32 v[126:127], v[126:127], v[174:175] op_sel_hi:[1,0]
    s_cbranch_vccnz L_w2_523
    s_bitcmp1_b32 s34, 0
    s_cbranch_scc1 L_w1_523
    s_waitcnt vmcnt(4)
L_w1_523:
    s_waitcnt vmcnt(5)
L_w2_523:
    s_waitcnt vmcnt(7)
    buffer_load_dwordx4 v12, s[8:11], s57 offen offset:3072 nt lds
    s_add_u32 s49, s49, s100
    s_lshr_b32 s34, s49, 4
    s_and_b32 s49, s49, 15
    s_cmp_ge_u32 s34, 2
    s_cselect_b64 vcc, -1, 0
    s_xor_b32 s57, s99, 659456
    s_add_u32 m0, s56, 28672
    s_cbranch_vccnz L_w2_524
    s_bitcmp1_b32 s34, 0
    s_cbranch_scc1 L_w1_524
    s_waitcnt vmcnt(4)
L_w1_524:
    s_waitcnt vmcnt(5)
L_w2_524:
    s_waitcnt vmcnt(6)
    buffer_load_dwordx4 v12, s[8:11], s57 offen offset:0 nt lds
    s_cbranch_vccnz L_w2_525
    s_bitcmp1_b32 s34, 0
    s_cbranch_scc1 L_w1_525
    s_waitcnt vmcnt(3)
L_w1_525:
    s_waitcnt vmcnt(5)
L_w2_525:
    s_waitcnt vmcnt(6)
    buffer_load_dwordx4 v12, s[8:11], s57 offen offset:1024 nt lds
    ds_read_b64_tr_b16 v[128:129], v24 offset:16384
    ds_read_b64_tr_b16 v[130:131], v24 offset:18432
    ds_read_b64_tr_b16 v[132:133], v25 offset:16384
    ds_read_b64_tr_b16 v[134:135], v25 offset:18432
    ds_read_b64_tr_b16 v[136:137], v26 offset:16384
    ds_read_b64_tr_b16 v[138:139], v26 offset:18432
    ds_read_b64_tr_b16 v[140:141], v27 offset:16384
    ds_read_b64_tr_b16 v[142:143], v27 offset:18432
    ds_read_b64_tr_b16 v[144:145], v24 offset:20480
    ds_read_b64_tr_b16 v[146:147], v24 offset:22528
    s_waitcnt lgkmcnt(8)
    v_mfma_f32_32x32x16_bf16 v[64:79], v[128:131], a[104:107], v[64:79]
    ds_read_b64_tr_b16 v[148:149], v25 offset:20480
    s_cbranch_vccnz L_w2_526
    s_bitcmp1_b32 s34, 0
    s_cbranch_scc1 L_w1_526
    s_waitcnt vmcnt(3)
L_w1_526:
    s_waitcnt vmcnt(4)
L_w2_526:
    s_waitcnt vmcnt(6)
    buffer_load_dwordx4 v12, s[8:11], s57 offen offset:2048 nt lds
    ds_read_b64_tr_b16 v[150:151], v25 offset:22528
    s_waitcnt lgkmcnt(8)
    v_mfma_f32_32x32x16_bf16 v[80:95], v[132:135], a[104:107], v[80:95]
    ds_read_b64_tr_b16 v[152:153], v26 offset:20480
    ds_read_b64_tr_b16 v[154:155], v26 offset:22528
    s_waitcnt lgkmcnt(8)
    v_mfma_f32_32x32x16_bf16 v[96:111], v[136:139], a[104:107], v[96:111]
    s_cbranch_vccnz L_w2_527
    s_bitcmp1_b32 s34, 0
    s_cbranch_scc1 L_w1_527
    s_waitcnt vmcnt(3)
L_w1_527:
    s_waitcnt vmcnt(4)
L_w2_527:
    s_waitcnt vmcnt(5)
    buffer_load_dwordx4 v12, s[8:11], s57 offen offset:3072 nt lds
    ds_read_b64_tr_b16 v[156:157], v27 offset:20480
    ds_read_b64_tr_b16 v[158:159], v27 offset:22528
    s_waitcnt lgkmcnt(8)
    v_mfma_f32_32x32x16_bf16 v[112:127], v[140:143], a[104:107], v[112:127]
    s_waitcnt lgkmcnt(6)
    v_mfma_f32_32x32x16_bf16 v[64:79], v[144:147], a[108:111], v[64:79]
    s_waitcnt lgkmcnt(4)
    v_mfma_f32_32x32x16_bf16 v[80:95], v[148:151], a[108:111], v[80:95]
    s_add_u32 s49, s49, s100
    s_lshr_b32 s34, s49, 4
    s_and_b32 s49, s49, 15
    s_cmp_ge_u32 s34, 2
    s_cselect_b64 vcc, -1, 0
    s_cmp_lg_u32 s44, 48
    s_cbranch_scc1 L_nr48
    s_mov_b32 s3, 86272
    v_mov_b32 v246, 1
    s_mov_b64 exec, 1
    buffer_atomic_add v246, off, s[24:27], s3 sc0
    s_mov_b64 exec, -1
L_nr48:
    v_add_u32 v0, 1, v0
    s_mov_b64 exec, s[32:33]
    buffer_store_dword v0, v242, s[24:27], s35 offen
    s_mov_b64 exec, -1
    buffer_load_dword v244, v242, s[24:27], s35 offen sc1
    s_xor_b32 s57, s99, 327680
    s_add_u32 m0, s56, 0
    s_cbranch_vccnz L_w2_530
    s_bitcmp1_b32 s34, 0
    s_cbranch_scc1 L_w1_530
    s_waitcnt vmcnt(5)
L_w1_530:
    s_waitcnt vmcnt(6)
L_w2_530:
    s_waitcnt vmcnt(7)
    buffer_load_dwordx4 v12, s[8:11], s57 offen offset:0 nt lds
    s_waitcnt lgkmcnt(2)
    v_mfma_f32_32x32x16_bf16 v[96:111], v[152:155], a[108:111], v[96:111]
    s_waitcnt lgkmcnt(0)
    v_mfma_f32_32x32x16_bf16 v[112:127], v[156:159], a[108:111], v[112:127]
    v_pk_mul_f32 v[64:65], v[64:65], v[174:175] op_sel:[0,1] op_sel_hi:[1,1]
    v_pk_mul_f32 v[66:67], v[66:67], v[174:175] op_sel:[0,1] op_sel_hi:[1,1]
    v_pk_mul_f32 v[68:69], v[68:69], v[174:175] op_sel:[0,1] op_sel_hi:[1,1]
    v_pk_mul_f32 v[70:71], v[70:71], v[174:175] op_sel:[0,1] op_sel_hi:[1,1]
    v_pk_mul_f32 v[72:73], v[72:73], v[174:175] op_sel:[0,1] op_sel_hi:[1,1]
    v_pk_mul_f32 v[74:75], v[74:75], v[174:175] op_sel:[0,1] op_sel_hi:[1,1]
    v_pk_mul_f32 v[76:77], v[76:77], v[174:175] op_sel:[0,1] op_sel_hi:[1,1]
    v_pk_mul_f32 v[78:79], v[78:79], v[174:175] op_sel:[0,1] op_sel_hi:[1,1]
    s_cbranch_vccnz L_w2_531
    s_bitcmp1_b32 s34, 0
    s_cbranch_scc1 L_w1_531
    s_waitcnt vmcnt(5)
L_w1_531:
    s_waitcnt vmcnt(6)
L_w2_531:
    s_waitcnt vmcnt(7)
    buffer_load_dwordx4 v12, s[8:11], s57 offen offset:1024 nt lds
    v_pk_mul_f32 v[80:81], v[80:81], v[174:175] op_sel:[0,1] op_sel_hi:[1,1]
    v_pk_mul_f32 v[82:83], v[82:83], v[174:175] op_sel:[0,1] op_sel_hi:[1,1]
    v_pk_mul_f32 v[84:85], v[84:85], v[174:175] op_sel:[0,1] op_sel_hi:[1,1]
    v_pk_mul_f32 v[86:87], v[86:87], v[174:175] op_sel:[0,1] op_sel_hi:[1,1]
    v_pk_mul_f32 v[88:89], v[88:89], v[174:175] op_sel:[0,1] op_sel_hi:[1,1]
    v_pk_mul_f32 v[90:91], v[90:91], v[174:175] op_sel:[0,1] op_sel_hi:[1,1]
    v_pk_mul_f32 v[92:93], v[92:93], v[174:175] op_sel:[0,1] op_sel_hi:[1,1]
    v_pk_mul_f32 v[94:95], v[94:95], v[174:175] op_sel:[0,1] op_sel_hi:[1,1]
    v_pk_mul_f32 v[96:97], v[96:97], v[174:175] op_sel:[0,1] op_sel_hi:[1,1]
    v_pk_mul_f32 v[98:99], v[98:99], v[174:175] op_sel:[0,1] op_sel_hi:[1,1]
    v_pk_mul_f32 v[100:101], v[100:101], v[174:175] op_sel:[0,1] op_sel_hi:[1,1]
    v_pk_mul_f32 v[102:103], v[102:103], v[174:175] op_sel:[0,1] op_sel_hi:[1,1]
    v_pk_mul_f32 v[104:105], v[104:105], v[174:175] op_sel:[0,1] op_sel_hi:[1,1]
    v_pk_mul_f32 v[106:107], v[106:107], v[174:175] op_sel:[0,1] op_sel_hi:[1,1]
    v_pk_mul_f32 v[108:109], v[108:109], v[174:175] op_sel:[0,1] op_sel_hi:[1,1]
    v_pk_mul_f32 v[110:111], v[110:111], v[174:175] op_sel:[0,1] op_sel_hi:[1,1]
    v_pk_mul_f32 v[112:113], v[112:113], v[174:175] op_sel:[0,1] op_sel_hi:[1,1]
    v_pk_mul_f32 v[114:115], v[114:115], v[174:175] op_sel:[0,1] op_sel_hi:[1,1]
    v_pk_mul_f32 v[116:117], v[116:117], v[174:175] op_sel:[0,1] op_sel_hi:[1,1]
    v_pk_mul_f32 v[118:119], v[118:119], v[174:175] op_sel:[0,1] op_sel_hi:[1,1]
    v_pk_mul_f32 v[120:121], v[120:121], v[174:175] op_sel:[0,1] op_sel_hi:[1,1]
    v_pk_mul_f32 v[122:123], v[122:123], v[174:175] op_sel:[0,1] op_sel_hi:[1,1]
    v_pk_mul_f32 v[124:125], v[124:125], v[174:175] op_sel:[0,1] op_sel_hi:[1,1]
    v_pk_mul_f32 v[126:127], v[126:127], v[174:175] op_sel:[0,1] op_sel_hi:[1,1]
    ds_read_b64_tr_b16 a[38:39], v61 offset:0
    ds_read_b64_tr_b16 a[42:43], v61 offset:32
    s_cbranch_vccnz L_w2_532
    s_bitcmp1_b32 s34, 0
    s_cbranch_scc1 L_w1_532
    s_waitcnt vmcnt(5)
L_w1_532:
    s_waitcnt vmcnt(6)
L_w2_532:
    s_waitcnt vmcnt(7)
    buffer_load_dwordx4 v12, s[8:11], s57 offen offset:2048 nt lds
    ds_read_b64_tr_b16 a[46:47], v61 offset:64
    ds_read_b64_tr_b16 a[50:51], v61 offset:96
    ds_read_b64_tr_b16 a[54:55], v61 offset:128
    ds_read_b64_tr_b16 a[58:59], v61 offset:160
    ds_read_b64_tr_b16 a[62:63], v61 offset:192
    ds_read_b64_tr_b16 a[66:67], v61 offset:224
    ds_read_b64_tr_b16 a[70:71], v61 offset:256
    s_waitcnt lgkmcnt(0)
    s_cbranch_vccnz L_w2_533
    s_bitcmp1_b32 s34, 0
    s_cbranch_scc1 L_w1_533
    s_waitcnt vmcnt(5)
L_w1_533:
    s_waitcnt vmcnt(6)
L_w2_533:
    s_waitcnt vmcnt(7)
    buffer_load_dwordx4 v12, s[8:11], s57 offen offset:3072 nt lds
    s_add_u32 s49, s49, s100
    s_lshr_b32 s34, s49, 4
    s_and_b32 s49, s49, 15
    s_cmp_ge_u32 s34, 2
    s_cselect_b64 vcc, -1, 0
    s_xor_b32 s57, s99, 331776
    s_add_u32 m0, s56, 4096
    s_cbranch_vccnz L_w2_534
    s_bitcmp1_b32 s34, 0
    s_cbranch_scc1 L_w1_534
    s_waitcnt vmcnt(3)
L_w1_534:
    s_waitcnt vmcnt(6)
L_w2_534:
    s_waitcnt vmcnt(7)
    buffer_load_dwordx4 v12, s[8:11], s57 offen offset:0 nt lds
    s_add_u32 s79, s58, 0
    s_add_u32 m0, s67, 0
    s_nop 0
    buffer_load_dwordx4 v56, s[20:23], s79 offen lds
    s_add_u32 m0, s56, 4096
    s_cbranch_vccnz L_w2_536
    s_bitcmp1_b32 s34, 0
    s_cbranch_scc1 L_w1_536
    s_waitcnt vmcnt(4)
L_w1_536:
    s_waitcnt vmcnt(5)
L_w2_536:
    s_waitcnt vmcnt(8)
    buffer_load_dwordx4 v12, s[8:11], s57 offen offset:1024 nt lds
    ds_read_b64_tr_b16 v[128:129], v24 offset:24576
    ds_read_b64_tr_b16 v[130:131], v24 offset:26624
    ds_read_b64_tr_b16 v[132:133], v25 offset:24576
    ds_read_b64_tr_b16 v[134:135], v25 offset:26624
    ds_read_b64_tr_b16 v[136:137], v26 offset:24576
    ds_read_b64_tr_b16 v[138:139], v26 offset:26624
    ds_read_b64_tr_b16 v[140:141], v27 offset:24576
    ds_read_b64_tr_b16 v[142:143], v27 offset:26624
    ds_read_b64_tr_b16 v[144:145], v24 offset:28672
    ds_read_b64_tr_b16 v[146:147], v24 offset:30720
    s_waitcnt lgkmcnt(8)
    v_mfma_f32_32x32x16_bf16 v[64:79], v[128:131], a[112:115], v[64:79]
    ds_read_b64_tr_b16 v[148:149], v25 offset:28672
    s_cbranch_vccnz L_w2_537
    s_bitcmp1_b32 s34, 0
    s_cbranch_scc1 L_w1_537
    s_waitcnt vmcnt(4)
L_w1_537:
    s_waitcnt vmcnt(5)
L_w2_537:
    s_waitcnt vmcnt(6)
    buffer_load_dwordx4 v12, s[8:11], s57 offen offset:2048 nt lds
    ds_read_b64_tr_b16 v[150:151], v25 offset:30720
    s_waitcnt lgkmcnt(8)
    v_mfma_f32_32x32x16_bf16 v[80:95], v[132:135], a[112:115], v[80:95]
    ds_read_b64_tr_b16 v[152:153], v26 offset:28672
    ds_read_b64_tr_b16 v[154:155], v26 offset:30720
    s_waitcnt lgkmcnt(8)
    v_mfma_f32_32x32x16_bf16 v[96:111], v[136:139], a[112:115], v[96:111]
    s_cbranch_vccnz L_w2_538
    s_bitcmp1_b32 s34, 0
    s_cbranch_scc1 L_w1_538
    s_waitcnt vmcnt(4)
L_w1_538:
    s_waitcnt vmcnt(5)
L_w2_538:
    s_waitcnt vmcnt(6)
    buffer_load_dwordx4 v12, s[8:11], s57 offen offset:3072 nt lds
    s_add_u32 m0, s67, 1024
    s_nop 0
    buffer_load_dwordx4 v57, s[20:23], s79 offen lds
    ds_read_b64_tr_b16 v[156:157], v27 offset:28672
    ds_read_b64_tr_b16 v[158:159], v27 offset:30720
    s_waitcnt lgkmcnt(8)
    v_mfma_f32_32x32x16_bf16 v[112:127], v[140:143], a[112:115], v[112:127]
    s_waitcnt lgkmcnt(6)
    v_mfma_f32_32x32x16_bf16 v[64:79], v[144:147], a[116:119], v[64:79]
    s_cmp_lg_u32 s44, 48
    s_cbranch_scc1 L_nc48
    v_sub_u32 v247, v246, v245
    v_lshlrev_b32 v246, 8, v254
    v_readfirstlane_b32 s3, v247
    s_nop 0
    s_min_u32 s3, s3, 7
    s_mul_i32 s3, s3, 6
    s_add_u32 s3, s3, s45
    v_mov_b32 v247, s3
    s_and_b32 s3, s35, 0xfffffcff
    s_mov_b64 exec, 15
    buffer_store_dword v247, v246, s[24:27], s3 offen offset:128
    s_mov_b64 exec, -1
L_nc48:
    v_sub_u32 v244, v244, v0
    v_cmp_gt_u32 s[100:101], 64, v244
    v_readlane_b32 s46, v244, 32
    s_bcnt1_i32_b32 s3, s100
    s_mul_i32 s3, s3, 3
    s_add_u32 s46, s46, 18
    s_cmp_lt_u32 s46, 128
    s_cselect_b32 s46, s46, 21
    s_add_u32 s3, s3, s46
    s_ashr_i32 s3, s3, 2
    s_add_i32 s3, s3, 2
    s_max_i32 s3, s3, 8
    s_min_i32 s100, s3, 32
    s_add_u32 s49, s49, s100
    s_lshr_b32 s34, s49, 4
    s_and_b32 s49, s49, 15
    s_cmp_ge_u32 s34, 2
    s_cselect_b64 vcc, -1, 0
    s_xor_b32 s57, s99, 147456
    s_add_u32 m0, s56, 8192
    s_cbranch_vccnz L_w2_540
    s_bitcmp1_b32 s34, 0
    s_cbranch_scc1 L_w1_540
    s_waitcnt vmcnt(5)
L_w1_540:
    s_waitcnt vmcnt(6)
L_w2_540:
    s_waitcnt vmcnt(7)
    buffer_load_dwordx4 v12, s[8:11], s57 offen offset:0 nt lds
    s_waitcnt lgkmcnt(4)
    v_mfma_f32_32x32x16_bf16 v[80:95], v[148:151], a[116:119], v[80:95]
    s_waitcnt lgkmcnt(2)
    v_mfma_f32_32x32x16_bf16 v[96:111], v[152:155], a[116:119], v[96:111]
    s_waitcnt lgkmcnt(0)
    v_mfma_f32_32x32x16_bf16 v[112:127], v[156:159], a[116:119], v[112:127]
    s_cbranch_vccnz L_w2_541
    s_bitcmp1_b32 s34, 0
    s_cbranch_scc1 L_w1_541
    s_waitcnt vmcnt(4)
L_w1_541:
    s_waitcnt vmcnt(6)
L_w2_541:
    s_waitcnt vmcnt(7)
    buffer_load_dwordx4 v12, s[8:11], s57 offen offset:1024 nt lds
    v_pk_mul_f32 v[64:65], v[64:65], v[176:177] op_sel_hi:[1,0]
    v_pk_mul_f32 v[66:67], v[66:67], v[176:177] op_sel_hi:[1,0]
    v_pk_mul_f32 v[68:69], v[68:69], v[176:177] op_sel_hi:[1,0]
    v_pk_mul_f32 v[70:71], v[70:71], v[176:177] op_sel_hi:[1,0]
    v_pk_mul_f32 v[72:73], v[72:73], v[176:177] op_sel_hi:[1,0]
    v_pk_mul_f32 v[74:75], v[74:75], v[176:177] op_sel_hi:[1,0]
    v_pk_mul_f32 v[76:77], v[76:77], v[176:177] op_sel_hi:[1,0]
    v_pk_mul_f32 v[78:79], v[78:79], v[176:177] op_sel_hi:[1,0]
    v_pk_mul_f32 v[80:81], v[80:81], v[176:177] op_sel_hi:[1,0]
    v_pk_mul_f32 v[82:83], v[82:83], v[176:177] op_sel_hi:[1,0]
    v_pk_mul_f32 v[84:85], v[84:85], v[176:177] op_sel_hi:[1,0]
    v_pk_mul_f32 v[86:87], v[86:87], v[176:177] op_sel_hi:[1,0]
    v_pk_mul_f32 v[88:89], v[88:89], v[176:177] op_sel_hi:[1,0]
    v_pk_mul_f32 v[90:91], v[90:91], v[176:177] op_sel_hi:[1,0]
    v_pk_mul_f32 v[92:93], v[92:93], v[176:177] op_sel_hi:[1,0]
    v_pk_mul_f32 v[94:95], v[94:95], v[176:177] op_sel_hi:[1,0]
    v_pk_mul_f32 v[96:97], v[96:97], v[176:177] op_sel_hi:[1,0]
    v_pk_mul_f32 v[98:99], v[98:99], v[176:177] op_sel_hi:[1,0]
    v_pk_mul_f32 v[100:101], v[100:101], v[176:177] op_sel_hi:[1,0]
    v_pk_mul_f32 v[102:103], v[102:103], v[176:177] op_sel_hi:[1,0]
    s_cbranch_vccnz L_w2_542
    s_bitcmp1_b32 s34, 0
    s_cbranch_scc1 L_w1_542
    s_waitcnt vmcnt(4)
L_w1_542:
    s_waitcnt vmcnt(5)
L_w2_542:
    s_waitcnt vmcnt(7)
    buffer_load_dwordx4 v12, s[8:11], s57 offen offset:2048 nt lds
    s_add_u32 m0, s67, 2048
    s_nop 0
    buffer_load_dwordx4 v58, s[20:23], s79 offen lds
    v_pk_mul_f32 v[104:105], v[104:105], v[176:177] op_sel_hi:[1,0]
    v_pk_mul_f32 v[106:107], v[106:107], v[176:177] op_sel_hi:[1,0]
    v_pk_mul_f32 v[108:109], v[108:109], v[176:177] op_sel_hi:[1,0]
    v_pk_mul_f32 v[110:111], v[110:111], v[176:177] op_sel_hi:[1,0]
    v_pk_mul_f32 v[112:113], v[112:113], v[176:177] op_sel_hi:[1,0]
    v_pk_mul_f32 v[114:115], v[114:115], v[176:177] op_sel_hi:[1,0]
    v_pk_mul_f32 v[116:117], v[116:117], v[176:177] op_sel_hi:[1,0]
    v_pk_mul_f32 v[118:119], v[118:119], v[176:177] op_sel_hi:[1,0]
    v_pk_mul_f32 v[120:121], v[120:121], v[176:177] op_sel_hi:[1,0]
    v_pk_mul_f32 v[122:123], v[122:123], v[176:177] op_sel_hi:[1,0]
    v_pk_mul_f32 v[124:125], v[124:125], v[176:177] op_sel_hi:[1,0]
    v_pk_mul_f32 v[126:127], v[126:127], v[176:177] op_sel_hi:[1,0]
    s_add_u32 m0, s56, 8192
    s_cbranch_vccnz L_w2_544
    s_bitcmp1_b32 s34, 0
    s_cbranch_scc1 L_w1_544
    s_waitcnt vmcnt(5)
L_w1_544:
    s_waitcnt vmcnt(6)
L_w2_544:
    s_waitcnt vmcnt(7)
    buffer_load_dwordx4 v12, s[8:11], s57 offen offset:3072 nt lds
    s_add_u32 s49, s49, s100
    s_lshr_b32 s34, s49, 4
    s_and_b32 s49, s49, 15
    s_cmp_ge_u32 s34, 2
    s_cselect_b64 vcc, -1, 0
    s_xor_b32 s57, s99, 151552
    s_add_u32 m0, s56, 12288
    s_cbranch_vccnz L_w2_545
    s_bitcmp1_b32 s34, 0
    s_cbranch_scc1 L_w1_545
    s_waitcnt vmcnt(4)
L_w1_545:
    s_waitcnt vmcnt(6)
L_w2_545:
    s_waitcnt vmcnt(7)
    buffer_load_dwordx4 v12, s[8:11], s57 offen offset:0 nt lds
    s_cbranch_vccnz L_w2_546
    s_bitcmp1_b32 s34, 0
    s_cbranch_scc1 L_w1_546
    s_waitcnt vmcnt(4)
L_w1_546:
    s_waitcnt vmcnt(5)
L_w2_546:
    s_waitcnt vmcnt(7)
    buffer_load_dwordx4 v12, s[8:11], s57 offen offset:1024 nt lds
    s_add_u32 m0, s67, 3072
    s_nop 0
    buffer_load_dwordx4 v59, s[20:23], s79 offen lds
    ds_read_b64_tr_b16 v[128:129], v24 offset:0
    ds_read_b64_tr_b16 v[130:131], v24 offset:2048
    ds_read_b64_tr_b16 v[132:133], v25 offset:0
    ds_read_b64_tr_b16 v[134:135], v25 offset:2048
    ds_read_b64_tr_b16 v[136:137], v26 offset:0
    ds_read_b64_tr_b16 v[138:139], v26 offset:2048
    ds_read_b64_tr_b16 v[140:141], v27 offset:0
    ds_read_b64_tr_b16 v[142:143], v27 offset:2048
    ds_read_b64_tr_b16 v[144:145], v24 offset:4096
    ds_read_b64_tr_b16 v[146:147], v24 offset:6144
    s_waitcnt lgkmcnt(8)
    v_mfma_f32_32x32x16_bf16 v[64:79], v[128:131], a[120:123], v[64:79]
    ds_read_b64_tr_b16 v[148:149], v25 offset:4096
    s_add_u32 m0, s56, 12288
    s_cbranch_vccnz L_w2_548
    s_bitcmp1_b32 s34, 0
    s_cbranch_scc1 L_w1_548
    s_waitcnt vmcnt(5)
L_w1_548:
    s_waitcnt vmcnt(6)
L_w2_548:
    s_waitcnt vmcnt(7)
    buffer_load_dwordx4 v12, s[8:11], s57 offen offset:2048 nt lds
    ds_read_b64_tr_b16 v[150:151], v25 offset:6144
    s_waitcnt lgkmcnt(8)
    v_mfma_f32_32x32x16_bf16 v[80:95], v[132:135], a[120:123], v[80:95]
    ds_read_b64_tr_b16 v[152:153], v26 offset:4096
    ds_read_b64_tr_b16 v[154:155], v26 offset:6144
    s_waitcnt lgkmcnt(8)
    v_mfma_f32_32x32x16_bf16 v[96:111], v[136:139], a[120:123], v[96:111]
    s_cbranch_vccnz L_w2_549
    s_bitcmp1_b32 s34, 0
    s_cbranch_scc1 L_w1_549
    s_waitcnt vmcnt(4)
L_w1_549:
    s_waitcnt vmcnt(6)
L_w2_549:
    s_waitcnt vmcnt(7)
    buffer_load_dwordx4 v12, s[8:11], s57 offen offset:3072 nt lds
    ds_read_b64_tr_b16 v[156:157], v27 offset:4096
    ds_read_b64_tr_b16 v[158:159], v27 offset:6144
    s_waitcnt lgkmcnt(8)
    v_mfma_f32_32x32x16_bf16 v[112:127], v[140:143], a[120:123], v[112:127]
    s_waitcnt lgkmcnt(6)
    v_mfma_f32_32x32x16_bf16 v[64:79], v[144:147], a[124:127], v[64:79]
    s_add_u32 s49, s49, s100
    s_lshr_b32 s34, s49, 4
    s_and_b32 s49, s49, 15
    s_cmp_ge_u32 s34, 2
    s_cselect_b64 vcc, -1, 0
    s_cmp_lg_u32 s44, 50
    s_cbranch_scc1 L_nr50
    s_mov_b32 s3, 86528
    v_mov_b32 v246, 1
    s_mov_b64 exec, 1
    buffer_atomic_add v246, off, s[24:27], s3 sc0
    s_mov_b64 exec, -1
L_nr50:
    v_add_u32 v0, 1, v0
    s_mov_b64 exec, s[32:33]
    buffer_store_dword v0, v242, s[24:27], s35 offen
    s_mov_b64 exec, -1
    buffer_load_dword v244, v242, s[24:27], s35 offen sc1
    s_xor_b32 s57, s99, 671744
    s_add_u32 m0, s56, 16384
    s_cbranch_vccnz L_w2_552
    s_bitcmp1_b32 s34, 0
    s_cbranch_scc1 L_w1_552
    s_waitcnt vmcnt(6)
L_w1_552:
    s_waitcnt vmcnt(7)
L_w2_552:
    s_waitcnt vmcnt(9)
    buffer_load_dwordx4 v12, s[8:11], s57 offen offset:0 nt lds
    s_add_u32 m0, s67, 4096
    s_nop 0
    buffer_load_dwordx4 v60, s[20:23], s79 offen lds
    s_waitcnt lgkmcnt(4)
    v_mfma_f32_32x32x16_bf16 v[80:95], v[148:151], a[124:127], v[80:95]
    s_waitcnt lgkmcnt(2)
    v_mfma_f32_32x32x16_bf16 v[96:111], v[152:155], a[124:127], v[96:111]
    s_waitcnt lgkmcnt(0)
    v_mfma_f32_32x32x16_bf16 v[112:127], v[156:159], a[124:127], v[112:127]
    s_add_u32 m0, s56, 16384
    s_cbranch_vccnz L_w2_554
    s_bitcmp1_b32 s34, 0
    s_cbranch_scc1 L_w1_554
    s_waitcnt vmcnt(7)
L_w1_554:
    s_waitcnt vmcnt(8)
L_w2_554:
    s_waitcnt vmcnt(9)
    buffer_load_dwordx4 v12, s[8:11], s57 offen offset:1024 nt lds
    v_pk_mul_f32 v[64:65], v[64:65], v[176:177] op_sel:[0,1] op_sel_hi:[1,1]
    v_pk_mul_f32 v[66:67], v[66:67], v[176:177] op_sel:[0,1] op_sel_hi:[1,1]
    v_pk_mul_f32 v[68:69], v[68:69], v[176:177] op_sel:[0,1] op_sel_hi:[1,1]
    v_pk_mul_f32 v[70:71], v[70:71], v[176:177] op_sel:[0,1] op_sel_hi:[1,1]
    v_pk_mul_f32 v[72:73], v[72:73], v[176:177] op_sel:[0,1] op_sel_hi:[1,1]
    v_pk_mul_f32 v[74:75], v[74:75], v[176:177] op_sel:[0,1] op_sel_hi:[1,1]
    v_pk_mul_f32 v[76:77], v[76:77], v[176:177] op_sel:[0,1] op_sel_hi:[1,1]
    v_pk_mul_f32 v[78:79], v[78:79], v[176:177] op_sel:[0,1] op_sel_hi:[1,1]
    v_pk_mul_f32 v[80:81], v[80:81], v[176:177] op_sel:[0,1] op_sel_hi:[1,1]
    v_pk_mul_f32 v[82:83], v[82:83], v[176:177] op_sel:[0,1] op_sel_hi:[1,1]
    v_pk_mul_f32 v[84:85], v[84:85], v[176:177] op_sel:[0,1] op_sel_hi:[1,1]
    v_pk_mul_f32 v[86:87], v[86:87], v[176:177] op_sel:[0,1] op_sel_hi:[1,1]
    v_pk_mul_f32 v[88:89], v[88:89], v[176:177] op_sel:[0,1] op_sel_hi:[1,1]
    v_pk_mul_f32 v[90:91], v[90:91], v[176:177] op_sel:[0,1] op_sel_hi:[1,1]
    v_pk_mul_f32 v[92:93], v[92:93], v[176:177] op_sel:[0,1] op_sel_hi:[1,1]
    v_pk_mul_f32 v[94:95], v[94:95], v[176:177] op_sel:[0,1] op_sel_hi:[1,1]
    v_pk_mul_f32 v[96:97], v[96:97], v[176:177] op_sel:[0,1] op_sel_hi:[1,1]
    v_pk_mul_f32 v[98:99], v[98:99], v[176:177] op_sel:[0,1] op_sel_hi:[1,1]
    v_pk_mul_f32 v[100:101], v[100:101], v[176:177] op_sel:[0,1] op_sel_hi:[1,1]
    v_pk_mul_f32 v[102:103], v[102:103], v[176:177] op_sel:[0,1] op_sel_hi:[1,1]
    s_cbranch_vccnz L_w2_555
    s_bitcmp1_b32 s34, 0
    s_cbranch_scc1 L_w1_555
    s_waitcnt vmcnt(6)
L_w1_555:
    s_waitcnt vmcnt(8)
L_w2_555:
    s_waitcnt vmcnt(9)
    buffer_load_dwordx4 v12, s[8:11], s57 offen offset:2048 nt lds
    v_pk_mul_f32 v[104:105], v[104:105], v[176:177] op_sel:[0,1] op_sel_hi:[1,1]
    v_pk_mul_f32 v[106:107], v[106:107], v[176:177] op_sel:[0,1] op_sel_hi:[1,1]
    v_pk_mul_f32 v[108:109], v[108:109], v[176:177] op_sel:[0,1] op_sel_hi:[1,1]
    v_pk_mul_f32 v[110:111], v[110:111], v[176:177] op_sel:[0,1] op_sel_hi:[1,1]
    v_pk_mul_f32 v[112:113], v[112:113], v[176:177] op_sel:[0,1] op_sel_hi:[1,1]
    v_pk_mul_f32 v[114:115], v[114:115], v[176:177] op_sel:[0,1] op_sel_hi:[1,1]
    v_pk_mul_f32 v[116:117], v[116:117], v[176:177] op_sel:[0,1] op_sel_hi:[1,1]
    v_pk_mul_f32 v[118:119], v[118:119], v[176:177] op_sel:[0,1] op_sel_hi:[1,1]
    v_pk_mul_f32 v[120:121], v[120:121], v[176:177] op_sel:[0,1] op_sel_hi:[1,1]
    v_pk_mul_f32 v[122:123], v[122:123], v[176:177] op_sel:[0,1] op_sel_hi:[1,1]
    v_pk_mul_f32 v[124:125], v[124:125], v[176:177] op_sel:[0,1] op_sel_hi:[1,1]
    v_pk_mul_f32 v[126:127], v[126:127], v[176:177] op_sel:[0,1] op_sel_hi:[1,1]
    s_cbranch_vccnz L_w2_556
    s_bitcmp1_b32 s34, 0
    s_cbranch_scc1 L_w1_556
    s_waitcnt vmcnt(6)
L_w1_556:
    s_waitcnt vmcnt(7)
L_w2_556:
    s_waitcnt vmcnt(9)
    buffer_load_dwordx4 v12, s[8:11], s57 offen offset:3072 nt lds
    s_add_u32 s49, s49, s100
    s_lshr_b32 s34, s49, 4
    s_and_b32 s49, s49, 15
    s_cmp_ge_u32 s34, 2
    s_cselect_b64 vcc, -1, 0
    s_xor_b32 s57, s99, 675840
    s_add_u32 m0, s56, 20480
    s_cbranch_vccnz L_w2_557
    s_bitcmp1_b32 s34, 0
    s_cbranch_scc1 L_w1_557
    s_waitcnt vmcnt(4)
L_w1_557:
    s_waitcnt vmcnt(7)
L_w2_557:
    s_waitcnt vmcnt(8)
    buffer_load_dwordx4 v12, s[8:11], s57 offen offset:0 nt lds
    s_cbranch_vccnz L_w2_558
    s_bitcmp1_b32 s34, 0
    s_cbranch_scc1 L_w1_558
    s_waitcnt vmcnt(3)
L_w1_558:
    s_waitcnt vmcnt(5)
L_w2_558:
    s_waitcnt vmcnt(8)
    buffer_load_dwordx4 v12, s[8:11], s57 offen offset:1024 nt lds
    ds_read_b64_tr_b16 v[128:129], v24 offset:8192
    ds_read_b64_tr_b16 v[130:131], v24 offset:10240
    ds_read_b64_tr_b16 v[132:133], v25 offset:8192
    ds_read_b64_tr_b16 v[134:135], v25 offset:10240
    ds_read_b64_tr_b16 v[136:137], v26 offset:8192
    ds_read_b64_tr_b16 v[138:139], v26 offset:10240
    ds_read_b64_tr_b16 v[140:141], v27 offset:8192
    ds_read_b64_tr_b16 v[142:143], v27 offset:10240
    ds_read_b64_tr_b16 v[144:145], v24 offset:12288
    ds_read_b64_tr_b16 v[146:147], v24 offset:14336
    s_waitcnt lgkmcnt(8)
    v_mfma_f32_32x32x16_bf16 v[64:79], v[128:131], a[128:131], v[64:79]
    ds_read_b64_tr_b16 v[148:149], v25 offset:12288
    s_cbranch_vccnz L_w2_559
    s_bitcmp1_b32 s34, 0
    s_cbranch_scc1 L_w1_559
    s_waitcnt vmcnt(3)
L_w1_559:
    s_waitcnt vmcnt(4)
L_w2_559:
    s_waitcnt vmcnt(6)
    buffer_load_dwordx4 v12, s[8:11], s57 offen offset:2048 nt lds
    ds_read_b64_tr_b16 v[150:151], v25 offset:14336
    s_waitcnt lgkmcnt(8)
    v_mfma_f32_32x32x16_bf16 v[80:95], v[132:135], a[128:131], v[80:95]
    ds_read_b64_tr_b16 v[152:153], v26 offset:12288
    ds_read_b64_tr_b16 v[154:155], v26 offset:14336
    s_waitcnt lgkmcnt(8)
    v_mfma_f32_32x32x16_bf16 v[96:111], v[136:139], a[128:131], v[96:111]
    s_cbranch_vccnz L_w2_560
    s_bitcmp1_b32 s34, 0
    s_cbranch_scc1 L_w1_560
    s_waitcnt vmcnt(3)
L_w1_560:
    s_waitcnt vmcnt(4)
L_w2_560:
    s_waitcnt vmcnt(5)
    buffer_load_dwordx4 v12, s[8:11], s57 offen offset:3072 nt lds
    ds_read_b64_tr_b16 v[156:157], v27 offset:12288
    ds_read_b64_tr_b16 v[158:159], v27 offset:14336
    s_waitcnt lgkmcnt(8)
    v_mfma_f32_32x32x16_bf16 v[112:127], v[140:143], a[128:131], v[112:127]
    s_waitcnt lgkmcnt(6)
    v_mfma_f32_32x32x16_bf16 v[64:79], v[144:147], a[132:135], v[64:79]
    s_waitcnt lgkmcnt(4)
    v_mfma_f32_32x32x16_bf16 v[80:95], v[148:151], a[132:135], v[80:95]
    s_cmp_lg_u32 s44, 50
    s_cbranch_scc1 L_nc50
    v_sub_u32 v247, v246, v245
    v_lshlrev_b32 v246, 8, v254
    v_readfirstlane_b32 s3, v247
    s_nop 0
    s_min_u32 s3, s3, 7
    s_mul_i32 s3, s3, 6
    s_add_u32 s3, s3, s45
    v_mov_b32 v247, s3
    s_and_b32 s3, s35, 0xfffffcff
    s_mov_b64 exec, 15
    buffer_store_dword v247, v246, s[24:27], s3 offen offset:128
    s_mov_b64 exec, -1
L_nc50:
    v_sub_u32 v244, v244, v0
    v_cmp_gt_u32 s[100:101], 64, v244
    v_readlane_b32 s46, v244, 32
    s_bcnt1_i32_b32 s3, s100
    s_mul_i32 s3, s3, 3
    s_add_u32 s46, s46, 19
    s_cmp_lt_u32 s46, 128
    s_cselect_b32 s46, s46, 21
    s_add_u32 s3, s3, s46
    s_ashr_i32 s3, s3, 2
    s_add_i32 s3, s3, 2
    s_max_i32 s3, s3, 8
    s_min_i32 s100, s3, 32
    s_add_u32 s49, s49, s100
    s_lshr_b32 s34, s49, 4
    s_and_b32 s49, s49, 15
    s_cmp_ge_u32 s34, 2
    s_cselect_b64 vcc, -1, 0
    s_xor_b32 s57, s99, 720896
    s_add_u32 m0, s56, 24576
    s_cbranch_vccnz L_w2_561
    s_bitcmp1_b32 s34, 0
    s_cbranch_scc1 L_w1_561
    s_waitcnt vmcnt(3)
L_w1_561:
    s_waitcnt vmcnt(4)
L_w2_561:
    s_waitcnt vmcnt(5)
    buffer_load_dwordx4 v12, s[8:11], s57 offen offset:0 nt lds
    s_waitcnt lgkmcnt(2)
    v_mfma_f32_32x32x16_bf16 v[96:111], v[152:155], a[132:135], v[96:111]
    s_waitcnt lgkmcnt(0)
    v_mfma_f32_32x32x16_bf16 v[112:127], v[156:159], a[132:135], v[112:127]
    v_pk_mul_f32 v[64:65], v[64:65], v[178:179] op_sel_hi:[1,0]
    v_pk_mul_f32 v[66:67], v[66:67], v[178:179] op_sel_hi:[1,0]
    v_pk_mul_f32 v[68:69], v[68:69], v[178:179] op_sel_hi:[1,0]
    v_pk_mul_f32 v[70:71], v[70:71], v[178:179] op_sel_hi:[1,0]
    v_pk_mul_f32 v[72:73], v[72:73], v[178:179] op_sel_hi:[1,0]
    v_pk_mul_f32 v[74:75], v[74:75], v[178:179] op_sel_hi:[1,0]
    v_pk_mul_f32 v[76:77], v[76:77], v[178:179] op_sel_hi:[1,0]
    v_pk_mul_f32 v[78:79], v[78:79], v[178:179] op_sel_hi:[1,0]
    s_cbranch_vccnz L_w2_562
    s_bitcmp1_b32 s34, 0
    s_cbranch_scc1 L_w1_562
    s_waitcnt vmcnt(3)
L_w1_562:
    s_waitcnt vmcnt(4)
L_w2_562:
    s_waitcnt vmcnt(5)
    buffer_load_dwordx4 v12, s[8:11], s57 offen offset:1024 nt lds
    v_pk_mul_f32 v[80:81], v[80:81], v[178:179] op_sel_hi:[1,0]
    v_pk_mul_f32 v[82:83], v[82:83], v[178:179] op_sel_hi:[1,0]
    v_pk_mul_f32 v[84:85], v[84:85], v[178:179] op_sel_hi:[1,0]
    v_pk_mul_f32 v[86:87], v[86:87], v[178:179] op_sel_hi:[1,0]
    v_pk_mul_f32 v[88:89], v[88:89], v[178:179] op_sel_hi:[1,0]
    v_pk_mul_f32 v[90:91], v[90:91], v[178:179] op_sel_hi:[1,0]
    v_pk_mul_f32 v[92:93], v[92:93], v[178:179] op_sel_hi:[1,0]
    v_pk_mul_f32 v[94:95], v[94:95], v[178:179] op_sel_hi:[1,0]
    v_pk_mul_f32 v[96:97], v[96:97], v[178:179] op_sel_hi:[1,0]
    v_pk_mul_f32 v[98:99], v[98:99], v[178:179] op_sel_hi:[1,0]
    v_pk_mul_f32 v[100:101], v[100:101], v[178:179] op_sel_hi:[1,0]
    v_pk_mul_f32 v[102:103], v[102:103], v[178:179] op_sel_hi:[1,0]
    v_pk_mul_f32 v[104:105], v[104:105], v[178:179] op_sel_hi:[1,0]
    v_pk_mul_f32 v[106:107], v[106:107], v[178:179] op_sel_hi:[1,0]
    v_pk_mul_f32 v[108:109], v[108:109], v[178:179] op_sel_hi:[1,0]
    v_pk_mul_f32 v[110:111], v[110:111], v[178:179] op_sel_hi:[1,0]
    v_pk_mul_f32 v[112:113], v[112:113], v[178:179] op_sel_hi:[1,0]
    v_pk_mul_f32 v[114:115], v[114:115], v[178:179] op_sel_hi:[1,0]
    v_pk_mul_f32 v[116:117], v[116:117], v[178:179] op_sel_hi:[1,0]
    v_pk_mul_f32 v[118:119], v[118:119], v[178:179] op_sel_hi:[1,0]
    v_pk_mul_f32 v[120:121], v[120:121], v[178:179] op_sel_hi:[1,0]
    v_pk_mul_f32 v[122:123], v[122:123], v[178:179] op_sel_hi:[1,0]
    v_pk_mul_f32 v[124:125], v[124:125], v[178:179] op_sel_hi:[1,0]
    v_pk_mul_f32 v[126:127], v[126:127], v[178:179] op_sel_hi:[1,0]
    ds_read_b64_tr_b16 a[72:73], v61 offset:0
    ds_read_b64_tr_b16 a[76:77], v61 offset:32
    s_cbranch_vccnz L_w2_563
    s_bitcmp1_b32 s34, 0
    s_cbranch_scc1 L_w1_563
    s_waitcnt vmcnt(3)
L_w1_563:
    s_waitcnt vmcnt(4)
L_w2_563:
    s_waitcnt vmcnt(5)
    buffer_load_dwordx4 v12, s[8:11], s57 offen offset:2048 nt lds
    ds_read_b64_tr_b16 a[80:81], v61 offset:64
    ds_read_b64_tr_b16 a[84:85], v61 offset:96
    ds_read_b64_tr_b16 a[88:89], v61 offset:128
    ds_read_b64_tr_b16 a[92:93], v61 offset:160
    ds_read_b64_tr_b16 a[96:97], v61 offset:192
    ds_read_b64_tr_b16 a[100:101], v61 offset:224
    ds_read_b64_tr_b16 a[104:105], v61 offset:256
    s_waitcnt lgkmcnt(0)
    s_cbranch_vccnz L_w2_564
    s_bitcmp1_b32 s34, 0
    s_cbranch_scc1 L_w1_564
    s_waitcnt vmcnt(3)
L_w1_564:
    s_waitcnt vmcnt(4)
L_w2_564:
    s_waitcnt vmcnt(5)
    buffer_load_dwordx4 v12, s[8:11], s57 offen offset:3072 nt lds
    s_add_u32 s49, s49, s100
    s_lshr_b32 s34, s49, 4
    s_and_b32 s49, s49, 15
    s_cmp_ge_u32 s34, 2
    s_cselect_b64 vcc, -1, 0
    s_xor_b32 s57, s99, 724992
    s_add_u32 m0, s56, 28672
    s_cbranch_vccnz L_w2_565
    s_bitcmp1_b32 s34, 0
    s_cbranch_scc1 L_w1_565
    s_waitcnt vmcnt(3)
L_w1_565:
    s_waitcnt vmcnt(4)
L_w2_565:
    s_waitcnt vmcnt(5)
    buffer_load_dwordx4 v12, s[8:11], s57 offen offset:0 nt lds
    s_add_u32 s79, s58, 9216
    s_add_u32 m0, s67, 0
    s_nop 0
    buffer_load_dwordx4 v56, s[20:23], s79 offen lds
    s_add_u32 m0, s56, 28672
    s_cbranch_vccnz L_w2_567
    s_bitcmp1_b32 s34, 0
    s_cbranch_scc1 L_w1_567
    s_waitcnt vmcnt(4)
L_w1_567:
    s_waitcnt vmcnt(5)
L_w2_567:
    s_waitcnt vmcnt(6)
    buffer_load_dwordx4 v12, s[8:11], s57 offen offset:1024 nt lds
    ds_read_b64_tr_b16 v[128:129], v24 offset:16384
    ds_read_b64_tr_b16 v[130:131], v24 offset:18432
    ds_read_b64_tr_b16 v[132:133], v25 offset:16384
    ds_read_b64_tr_b16 v[134:135], v25 offset:18432
    ds_read_b64_tr_b16 v[136:137], v26 offset:16384
    ds_read_b64_tr_b16 v[138:139], v26 offset:18432
    ds_read_b64_tr_b16 v[140:141], v27 offset:16384
    ds_read_b64_tr_b16 v[142:143], v27 offset:18432
    ds_read_b64_tr_b16 v[144:145], v24 offset:20480
    ds_read_b64_tr_b16 v[146:147], v24 offset:22528
    s_waitcnt lgkmcnt(8)
    v_mfma_f32_32x32x16_bf16 v[64:79], v[128:131], a[136:139], v[64:79]
    ds_read_b64_tr_b16 v[148:149], v25 offset:20480
    s_cbranch_vccnz L_w2_568
    s_bitcmp1_b32 s34, 0
    s_cbranch_scc1 L_w1_568
    s_waitcnt vmcnt(4)
L_w1_568:
    s_waitcnt vmcnt(5)
L_w2_568:
    s_waitcnt vmcnt(6)
    buffer_load_dwordx4 v12, s[8:11], s57 offen offset:2048 nt lds
    ds_read_b64_tr_b16 v[150:151], v25 offset:22528
    s_waitcnt lgkmcnt(8)
    v_mfma_f32_32x32x16_bf16 v[80:95], v[132:135], a[136:139], v[80:95]
    ds_read_b64_tr_b16 v[152:153], v26 offset:20480
    ds_read_b64_tr_b16 v[154:155], v26 offset:22528
    s_waitcnt lgkmcnt(8)
    v_mfma_f32_32x32x16_bf16 v[96:111], v[136:139], a[136:139], v[96:111]
    s_cbranch_vccnz L_w2_569
    s_bitcmp1_b32 s34, 0
    s_cbranch_scc1 L_w1_569
    s_waitcnt vmcnt(4)
L_w1_569:
    s_waitcnt vmcnt(5)
L_w2_569:
    s_waitcnt vmcnt(6)
    buffer_load_dwordx4 v12, s[8:11], s57 offen offset:3072 nt lds
    s_add_u32 m0, s67, 1024
    s_nop 0
    buffer_load_dwordx4 v57, s[20:23], s79 offen lds
    ds_read_b64_tr_b16 v[156:157], v27 offset:20480
    ds_read_b64_tr_b16 v[158:159], v27 offset:22528
    s_waitcnt lgkmcnt(8)
    v_mfma_f32_32x32x16_bf16 v[112:127], v[140:143], a[136:139], v[112:127]
    s_waitcnt lgkmcnt(6)
    v_mfma_f32_32x32x16_bf16 v[64:79], v[144:147], a[140:143], v[64:79]
    s_add_u32 s49, s49, s100
    s_lshr_b32 s34, s49, 4
    s_and_b32 s49, s49, 15
    s_cmp_ge_u32 s34, 2
    s_cselect_b64 vcc, -1, 0
    s_cmp_lg_u32 s44, 52
    s_cbranch_scc1 L_nr52
    s_mov_b32 s3, 86784
    v_mov_b32 v246, 1
    s_mov_b64 exec, 1
    buffer_atomic_add v246, off, s[24:27], s3 sc0
    s_mov_b64 exec, -1
L_nr52:
    v_add_u32 v0, 1, v0
    s_mov_b64 exec, s[32:33]
    buffer_store_dword v0, v242, s[24:27], s35 offen
    s_mov_b64 exec, -1
    buffer_load_dword v244, v242, s[24:27], s35 offen sc1
    s_xor_b32 s57, s99, 737280
    s_add_u32 m0, s56, 0
    s_cbranch_vccnz L_w2_573
    s_bitcmp1_b32 s34, 0
    s_cbranch_scc1 L_w1_573
    s_waitcnt vmcnt(7)
L_w1_573:
    s_waitcnt vmcnt(8)
L_w2_573:
    s_waitcnt vmcnt(9)
    buffer_load_dwordx4 v12, s[8:11], s57 offen offset:0 nt lds
    s_waitcnt lgkmcnt(4)
    v_mfma_f32_32x32x16_bf16 v[80:95], v[148:151], a[140:143], v[80:95]
    s_waitcnt lgkmcnt(2)
    v_mfma_f32_32x32x16_bf16 v[96:111], v[152:155], a[140:143], v[96:111]
    s_waitcnt lgkmcnt(0)
    v_mfma_f32_32x32x16_bf16 v[112:127], v[156:159], a[140:143], v[112:127]
    s_cbranch_vccnz L_w2_574
    s_bitcmp1_b32 s34, 0
    s_cbranch_scc1 L_w1_574
    s_waitcnt vmcnt(6)
L_w1_574:
    s_waitcnt vmcnt(8)
L_w2_574:
    s_waitcnt vmcnt(9)
    buffer_load_dwordx4 v12, s[8:11], s57 offen offset:1024 nt lds
    v_pk_mul_f32 v[64:65], v[64:65], v[178:179] op_sel:[0,1] op_sel_hi:[1,1]
    v_pk_mul_f32 v[66:67], v[66:67], v[178:179] op_sel:[0,1] op_sel_hi:[1,1]
    v_pk_mul_f32 v[68:69], v[68:69], v[178:179] op_sel:[0,1] op_sel_hi:[1,1]
    v_pk_mul_f32 v[70:71], v[70:71], v[178:179] op_sel:[0,1] op_sel_hi:[1,1]
    v_pk_mul_f32 v[72:73], v[72:73], v[178:179] op_sel:[0,1] op_sel_hi:[1,1]
    v_pk_mul_f32 v[74:75], v[74:75], v[178:179] op_sel:[0,1] op_sel_hi:[1,1]
    v_pk_mul_f32 v[76:77], v[76:77], v[178:179] op_sel:[0,1] op_sel_hi:[1,1]
    v_pk_mul_f32 v[78:79], v[78:79], v[178:179] op_sel:[0,1] op_sel_hi:[1,1]
    v_pk_mul_f32 v[80:81], v[80:81], v[178:179] op_sel:[0,1] op_sel_hi:[1,1]
    v_pk_mul_f32 v[82:83], v[82:83], v[178:179] op_sel:[0,1] op_sel_hi:[1,1]
    v_pk_mul_f32 v[84:85], v[84:85], v[178:179] op_sel:[0,1] op_sel_hi:[1,1]
    v_pk_mul_f32 v[86:87], v[86:87], v[178:179] op_sel:[0,1] op_sel_hi:[1,1]
    v_pk_mul_f32 v[88:89], v[88:89], v[178:179] op_sel:[0,1] op_sel_hi:[1,1]
    v_pk_mul_f32 v[90:91], v[90:91], v[178:179] op_sel:[0,1] op_sel_hi:[1,1]
    v_pk_mul_f32 v[92:93], v[92:93], v[178:179] op_sel:[0,1] op_sel_hi:[1,1]
    v_pk_mul_f32 v[94:95], v[94:95], v[178:179] op_sel:[0,1] op_sel_hi:[1,1]
    v_pk_mul_f32 v[96:97], v[96:97], v[178:179] op_sel:[0,1] op_sel_hi:[1,1]
    v_pk_mul_f32 v[98:99], v[98:99], v[178:179] op_sel:[0,1] op_sel_hi:[1,1]
    v_pk_mul_f32 v[100:101], v[100:101], v[178:179] op_sel:[0,1] op_sel_hi:[1,1]
    v_pk_mul_f32 v[102:103], v[102:103], v[178:179] op_sel:[0,1] op_sel_hi:[1,1]
    s_cbranch_vccnz L_w2_575
    s_bitcmp1_b32 s34, 0
    s_cbranch_scc1 L_w1_575
    s_waitcnt vmcnt(6)
L_w1_575:
    s_waitcnt vmcnt(7)
L_w2_575:
    s_waitcnt vmcnt(9)
    buffer_load_dwordx4 v12, s[8:11], s57 offen offset:2048 nt lds
    s_add_u32 m0, s67, 2048
    s_nop 0
    buffer_load_dwordx4 v58, s[20:23], s79 offen lds
    v_pk_mul_f32 v[104:105], v[104:105], v[178:179] op_sel:[0,1] op_sel_hi:[1,1]
    v_pk_mul_f32 v[106:107], v[106:107], v[178:179] op_sel:[0,1] op_sel_hi:[1,1]
    v_pk_mul_f32 v[108:109], v[108:109], v[178:179] op_sel:[0,1] op_sel_hi:[1,1]
    v_pk_mul_f32 v[110:111], v[110:111], v[178:179] op_sel:[0,1] op_sel_hi:[1,1]
    v_pk_mul_f32 v[112:113], v[112:113], v[178:179] op_sel:[0,1] op_sel_hi:[1,1]
    v_pk_mul_f32 v[114:115], v[114:115], v[178:179] op_sel:[0,1] op_sel_hi:[1,1]
    v_pk_mul_f32 v[116:117], v[116:117], v[178:179] op_sel:[0,1] op_sel_hi:[1,1]
    v_pk_mul_f32 v[118:119], v[118:119], v[178:179] op_sel:[0,1] op_sel_hi:[1,1]
    v_pk_mul_f32 v[120:121], v[120:121], v[178:179] op_sel:[0,1] op_sel_hi:[1,1]
    v_pk_mul_f32 v[122:123], v[122:123], v[178:179] op_sel:[0,1] op_sel_hi:[1,1]
    v_pk_mul_f32 v[124:125], v[124:125], v[178:179] op_sel:[0,1] op_sel_hi:[1,1]
    v_pk_mul_f32 v[126:127], v[126:127], v[178:179] op_sel:[0,1] op_sel_hi:[1,1]
    s_add_u32 m0, s56, 0
    s_cbranch_vccnz L_w2_577
    s_bitcmp1_b32 s34, 0
    s_cbranch_scc1 L_w1_577
    s_waitcnt vmcnt(7)
L_w1_577:
    s_waitcnt vmcnt(8)
L_w2_577:
    s_waitcnt vmcnt(9)
    buffer_load_dwordx4 v12, s[8:11], s57 offen offset:3072 nt lds
    s_add_u32 s49, s49, s100
    s_lshr_b32 s34, s49, 4
    s_and_b32 s49, s49, 15
    s_cmp_ge_u32 s34, 2
    s_cselect_b64 vcc, -1, 0
    s_xor_b32 s57, s99, 741376
    s_add_u32 m0, s56, 4096
    s_cbranch_vccnz L_w2_578
    s_bitcmp1_b32 s34, 0
    s_cbranch_scc1 L_w1_578
    s_waitcnt vmcnt(4)
L_w1_578:
    s_waitcnt vmcnt(8)
L_w2_578:
    s_waitcnt vmcnt(9)
    buffer_load_dwordx4 v12, s[8:11], s57 offen offset:0 nt lds
    s_and_b32 s3, s63, -4
    s_lshl_b32 s3, s3, 9
    s_add_u32 s3, s3, 131328
    v_and_b32 v255, 3, v254
    v_lshlrev_b32 v255, 9, v255
    buffer_load_dword v234, v255, s[24:27], s3 offen sc1
    s_xor_b32 s68, s63, 1
    s_lshl_b32 s68, s68, 9
    s_add_u32 s68, s68, 131072
    v_lshlrev_b32 v235, 3, v252
    buffer_load_dwordx2 v[232:233], v235, s[24:27], s68 offen sc1
    s_cbranch_vccnz L_w2_581
    s_bitcmp1_b32 s34, 0
    s_cbranch_scc1 L_w1_581
    s_waitcnt vmcnt(6)
L_w1_581:
    s_waitcnt vmcnt(7)
L_w2_581:
    s_waitcnt vmcnt(11)
    buffer_load_dwordx4 v12, s[8:11], s57 offen offset:1024 nt lds
    s_add_u32 m0, s67, 3072
    s_nop 0
    buffer_load_dwordx4 v59, s[20:23], s79 offen lds
    ds_read_b64_tr_b16 v[128:129], v24 offset:24576
    ds_read_b64_tr_b16 v[130:131], v24 offset:26624
    ds_read_b64_tr_b16 v[132:133], v25 offset:24576
    ds_read_b64_tr_b16 v[134:135], v25 offset:26624
    ds_read_b64_tr_b16 v[136:137], v26 offset:24576
    ds_read_b64_tr_b16 v[138:139], v26 offset:26624
    ds_read_b64_tr_b16 v[140:141], v27 offset:24576
    ds_read_b64_tr_b16 v[142:143], v27 offset:26624
    ds_read_b64_tr_b16 v[144:145], v24 offset:28672
    ds_read_b64_tr_b16 v[146:147], v24 offset:30720
    s_waitcnt lgkmcnt(8)
    v_mfma_f32_32x32x16_bf16 v[64:79], v[128:131], a[144:147], v[64:79]
    ds_read_b64_tr_b16 v[148:149], v25 offset:28672
    s_add_u32 m0, s56, 4096
    s_cbranch_vccnz L_w2_583
    s_bitcmp1_b32 s34, 0
    s_cbranch_scc1 L_w1_583
    s_waitcnt vmcnt(7)
L_w1_583:
    s_waitcnt vmcnt(8)
L_w2_583:
    s_waitcnt vmcnt(9)
    buffer_load_dwordx4 v12, s[8:11], s57 offen offset:2048 nt lds
    ds_read_b64_tr_b16 v[150:151], v25 offset:30720
    s_waitcnt lgkmcnt(8)
    v_mfma_f32_32x32x16_bf16 v[80:95], v[132:135], a[144:147], v[80:95]
    ds_read_b64_tr_b16 v[152:153], v26 offset:28672
    ds_read_b64_tr_b16 v[154:155], v26 offset:30720
    s_waitcnt lgkmcnt(8)
    v_mfma_f32_32x32x16_bf16 v[96:111], v[136:139], a[144:147], v[96:111]
    s_cbranch_vccnz L_w2_584
    s_bitcmp1_b32 s34, 0
    s_cbranch_scc1 L_w1_584
    s_waitcnt vmcnt(6)
L_w1_584:
    s_waitcnt vmcnt(8)
L_w2_584:
    s_waitcnt vmcnt(9)
    buffer_load_dwordx4 v12, s[8:11], s57 offen offset:3072 nt lds
    ds_read_b64_tr_b16 v[156:157], v27 offset:28672
    ds_read_b64_tr_b16 v[158:159], v27 offset:30720
    s_waitcnt lgkmcnt(8)
    v_mfma_f32_32x32x16_bf16 v[112:127], v[140:143], a[144:147], v[112:127]
    s_waitcnt lgkmcnt(6)
    v_mfma_f32_32x32x16_bf16 v[64:79], v[144:147], a[148:151], v[64:79]
    s_cmp_lg_u32 s44, 52
    s_cbranch_scc1 L_nc52
    v_sub_u32 v247, v246, v245
    v_lshlrev_b32 v246, 8, v254
    v_readfirstlane_b32 s3, v247
    s_nop 0
    s_min_u32 s3, s3, 7
    s_mul_i32 s3, s3, 6
    s_add_u32 s3, s3, s45
    v_mov_b32 v247, s3
    s_and_b32 s3, s35, 0xfffffcff
    s_mov_b64 exec, 15
    buffer_store_dword v247, v246, s[24:27], s3 offen offset:128
    s_mov_b64 exec, -1
L_nc52:
    v_sub_u32 v244, v244, v0
    v_cmp_gt_u32 s[100:101], 64, v244
    v_readlane_b32 s46, v244, 32
    s_bcnt1_i32_b32 s3, s100
    s_mul_i32 s3, s3, 3
    s_add_u32 s46, s46, 20
    s_cmp_lt_u32 s46, 128
    s_cselect_b32 s46, s46, 21
    s_add_u32 s3, s3, s46
    s_ashr_i32 s3, s3, 2
    s_add_i32 s3, s3, 2
    s_max_i32 s3, s3, 8
    s_min_i32 s100, s3, 32
    s_add_u32 s49, s49, s100
    s_lshr_b32 s34, s49, 4
    s_and_b32 s49, s49, 15
    s_cmp_ge_u32 s34, 2
    s_cselect_b64 vcc, -1, 0
    s_xor_b32 s57, s99, 196608
    s_add_u32 m0, s56, 8192
    s_cbranch_vccnz L_w2_585
    s_bitcmp1_b32 s34, 0
    s_cbranch_scc1 L_w1_585
    s_waitcnt vmcnt(6)
L_w1_585:
    s_waitcnt vmcnt(7)
L_w2_585:
    s_waitcnt vmcnt(9)
    buffer_load_dwordx4 v12, s[8:11], s57 offen offset:0 nt lds
    s_add_u32 m0, s67, 4096
    s_nop 0
    buffer_load_dwordx4 v60, s[20:23], s79 offen lds
    s_waitcnt lgkmcnt(4)
    v_mfma_f32_32x32x16_bf16 v[80:95], v[148:151], a[148:151], v[80:95]
    s_waitcnt lgkmcnt(2)
    v_mfma_f32_32x32x16_bf16 v[96:111], v[152:155], a[148:151], v[96:111]
    s_waitcnt lgkmcnt(0)
    v_mfma_f32_32x32x16_bf16 v[112:127], v[156:159], a[148:151], v[112:127]
    s_add_u32 m0, s56, 8192
    s_cbranch_vccnz L_w2_587
    s_bitcmp1_b32 s34, 0
    s_cbranch_scc1 L_w1_587
    s_waitcnt vmcnt(5)
L_w1_587:
    s_waitcnt vmcnt(8)
L_w2_587:
    s_waitcnt vmcnt(9)
    buffer_load_dwordx4 v12, s[8:11], s57 offen offset:1024 nt lds
    v_pk_mul_f32 v[64:65], v[64:65], v[180:181] op_sel_hi:[1,0]
    v_pk_mul_f32 v[66:67], v[66:67], v[180:181] op_sel_hi:[1,0]
    v_pk_mul_f32 v[68:69], v[68:69], v[180:181] op_sel_hi:[1,0]
    v_pk_mul_f32 v[70:71], v[70:71], v[180:181] op_sel_hi:[1,0]
    v_pk_mul_f32 v[72:73], v[72:73], v[180:181] op_sel_hi:[1,0]
    v_pk_mul_f32 v[74:75], v[74:75], v[180:181] op_sel_hi:[1,0]
    v_pk_mul_f32 v[76:77], v[76:77], v[180:181] op_sel_hi:[1,0]
    v_pk_mul_f32 v[78:79], v[78:79], v[180:181] op_sel_hi:[1,0]
    v_pk_mul_f32 v[80:81], v[80:81], v[180:181] op_sel_hi:[1,0]
    v_pk_mul_f32 v[82:83], v[82:83], v[180:181] op_sel_hi:[1,0]
    v_pk_mul_f32 v[84:85], v[84:85], v[180:181] op_sel_hi:[1,0]
    v_pk_mul_f32 v[86:87], v[86:87], v[180:181] op_sel_hi:[1,0]
    v_pk_mul_f32 v[88:89], v[88:89], v[180:181] op_sel_hi:[1,0]
    v_pk_mul_f32 v[90:91], v[90:91], v[180:181] op_sel_hi:[1,0]
    v_pk_mul_f32 v[92:93], v[92:93], v[180:181] op_sel_hi:[1,0]
    v_pk_mul_f32 v[94:95], v[94:95], v[180:181] op_sel_hi:[1,0]
    v_pk_mul_f32 v[96:97], v[96:97], v[180:181] op_sel_hi:[1,0]
    v_pk_mul_f32 v[98:99], v[98:99], v[180:181] op_sel_hi:[1,0]
    v_pk_mul_f32 v[100:101], v[100:101], v[180:181] op_sel_hi:[1,0]
    v_pk_mul_f32 v[102:103], v[102:103], v[180:181] op_sel_hi:[1,0]
    s_cbranch_vccnz L_w2_588
    s_bitcmp1_b32 s34, 0
    s_cbranch_scc1 L_w1_588
    s_waitcnt vmcnt(4)
L_w1_588:
    s_waitcnt vmcnt(6)
L_w2_588:
    s_waitcnt vmcnt(9)
    buffer_load_dwordx4 v12, s[8:11], s57 offen offset:2048 nt lds
    v_pk_mul_f32 v[104:105], v[104:105], v[180:181] op_sel_hi:[1,0]
    v_pk_mul_f32 v[106:107], v[106:107], v[180:181] op_sel_hi:[1,0]
    v_pk_mul_f32 v[108:109], v[108:109], v[180:181] op_sel_hi:[1,0]
    v_pk_mul_f32 v[110:111], v[110:111], v[180:181] op_sel_hi:[1,0]
    v_pk_mul_f32 v[112:113], v[112:113], v[180:181] op_sel_hi:[1,0]
    v_pk_mul_f32 v[114:115], v[114:115], v[180:181] op_sel_hi:[1,0]
    v_pk_mul_f32 v[116:117], v[116:117], v[180:181] op_sel_hi:[1,0]
    v_pk_mul_f32 v[118:119], v[118:119], v[180:181] op_sel_hi:[1,0]
    v_pk_mul_f32 v[120:121], v[120:121], v[180:181] op_sel_hi:[1,0]
    v_pk_mul_f32 v[122:123], v[122:123], v[180:181] op_sel_hi:[1,0]
    v_pk_mul_f32 v[124:125], v[124:125], v[180:181] op_sel_hi:[1,0]
    v_pk_mul_f32 v[126:127], v[126:127], v[180:181] op_sel_hi:[1,0]
    s_cbranch_vccnz L_w2_589
    s_bitcmp1_b32 s34, 0
    s_cbranch_scc1 L_w1_589
    s_waitcnt vmcnt(4)
L_w1_589:
    s_waitcnt vmcnt(5)
L_w2_589:
    s_waitcnt vmcnt(7)
    buffer_load_dwordx4 v12, s[8:11], s57 offen offset:3072 nt lds
    v_cmp_ne_u32 s[70:71], s48, v234
    s_nop 0
    s_and_b32 s48, s70, 15
L_ps:
    v_max_u32 v1, v232, v233
    v_cmp_eq_u32 vcc, -1, v1
    s_cbranch_vccz L_ps_ok
    s_sleep 4
    buffer_load_dwordx2 v[232:233], v235, s[24:27], s68 offen sc1
    s_waitcnt vmcnt(0)
    s_sub_u32 s66, s66, 1
    s_and_b32 s3, s66, 63
    s_cbranch_scc1 L_ps
    s_mov_b64 exec, 1
    buffer_atomic_add v243, off, s[24:27], s78
    s_mov_b64 exec, -1
    s_cmp_gt_i32 s66, 0
    s_cbranch_scc1 L_ps
L_ps_ok:
    v_max_f32 v1, v28, v232
    v_sub_f32 v2, v28, v1
    s_add_u32 s49, s49, s100
    s_lshr_b32 s34, s49, 4
    s_and_b32 s49, s49, 15
    s_cmp_ge_u32 s34, 2
    s_cselect_b64 vcc, -1, 0
    s_xor_b32 s57, s99, 200704
    s_add_u32 m0, s56, 12288
    s_cbranch_vccnz L_w2_590
    s_bitcmp1_b32 s34, 0
    s_cbranch_scc1 L_w1_590
    s_waitcnt vmcnt(4)
L_w1_590:
    s_waitcnt vmcnt(5)
L_w2_590:
    s_waitcnt vmcnt(6)
    buffer_load_dwordx4 v12, s[8:11], s57 offen offset:0 nt lds
    v_sub_f32 v3, v232, v1
    v_sub_f32 v4, v14, v1
    v_mul_f32 v2, s60, v2
    v_mul_f32 v3, s60, v3
    v_mul_f32 v4, s60, v4
    v_exp_f32 v2, v2
    v_exp_f32 v3, v3
    v_exp_f32 v4, v4
    v_mul_f32 v2, v2, v29
    v_fmac_f32 v2, v3, v233
    v_rcp_f32 v2, v2
    s_nop 0
    v_mul_f32 v30, v4, v2
    v_mul_f32 v4, v191, v30
    v_mul_f32 v190, v190, v4
    v_pk_mul_f32 v[32:33], v[32:33], v[30:31] op_sel_hi:[1,0]
    v_pk_mul_f32 v[34:35], v[34:35], v[30:31] op_sel_hi:[1,0]
    v_pk_mul_f32 v[36:37], v[36:37], v[30:31] op_sel_hi:[1,0]
    s_cbranch_vccnz L_w2_591
    s_bitcmp1_b32 s34, 0
    s_cbranch_scc1 L_w1_591
    s_waitcnt vmcnt(3)
L_w1_591:
    s_waitcnt vmcnt(5)
L_w2_591:
    s_waitcnt vmcnt(6)
    buffer_load_dwordx4 v12, s[8:11], s57 offen offset:1024 nt lds
    v_pk_mul_f32 v[38:39], v[38:39], v[30:31] op_sel_hi:[1,0]
    v_pk_mul_f32 v[40:41], v[40:41], v[30:31] op_sel_hi:[1,0]
    v_pk_mul_f32 v[42:43], v[42:43], v[30:31] op_sel_hi:[1,0]
    v_pk_mul_f32 v[44:45], v[44:45], v[30:31] op_sel_hi:[1,0]
    v_pk_mul_f32 v[46:47], v[46:47], v[30:31] op_sel_hi:[1,0]
    v_cvt_pk_bf16_f32 v48, v32, v33
    v_cvt_pk_bf16_f32 v49, v34, v35
    v_cvt_pk_bf16_f32 v50, v36, v37
    v_cvt_pk_bf16_f32 v51, v38, v39
    v_cvt_pk_bf16_f32 v52, v40, v41
    v_cvt_pk_bf16_f32 v53, v42, v43
    v_cvt_pk_bf16_f32 v54, v44, v45
    v_cvt_pk_bf16_f32 v55, v46, v47
    v_accvgpr_read_b32 v32, a240
    v_accvgpr_read_b32 v33, a241
    v_accvgpr_read_b32 v34, a242
    v_accvgpr_read_b32 v35, a243
    v_accvgpr_read_b32 v36, a244
    v_accvgpr_read_b32 v37, a245
    v_accvgpr_read_b32 v38, a246
    v_accvgpr_read_b32 v39, a247
    v_accvgpr_read_b32 v40, a248
    v_accvgpr_read_b32 v41, a249
    v_accvgpr_read_b32 v42, a250
    v_accvgpr_read_b32 v43, a251
    v_accvgpr_read_b32 v44, a252
    s_cbranch_vccnz L_w2_592
    s_bitcmp1_b32 s34, 0
    s_cbranch_scc1 L_w1_592
    s_waitcnt vmcnt(3)
L_w1_592:
    s_waitcnt vmcnt(4)
L_w2_592:
    s_waitcnt vmcnt(6)
    buffer_load_dwordx4 v12, s[8:11], s57 offen offset:2048 nt lds
    v_accvgpr_read_b32 v45, a253
    v_accvgpr_read_b32 v46, a254
    v_accvgpr_read_b32 v47, a255
    v_pk_mul_f32 v[32:33], v[32:33], v[4:5] op_sel_hi:[1,0]
    v_pk_mul_f32 v[34:35], v[34:35], v[4:5] op_sel_hi:[1,0]
    v_pk_mul_f32 v[36:37], v[36:37], v[4:5] op_sel_hi:[1,0]
    v_pk_mul_f32 v[38:39], v[38:39], v[4:5] op_sel_hi:[1,0]
    v_pk_mul_f32 v[40:41], v[40:41], v[4:5] op_sel_hi:[1,0]
    v_pk_mul_f32 v[42:43], v[42:43], v[4:5] op_sel_hi:[1,0]
    v_pk_mul_f32 v[44:45], v[44:45], v[4:5] op_sel_hi:[1,0]
    v_pk_mul_f32 v[46:47], v[46:47], v[4:5] op_sel_hi:[1,0]
    v_cvt_pk_bf16_f32 v32, v32, v33
    v_cvt_pk_bf16_f32 v33, v34, v35
    v_cvt_pk_bf16_f32 v34, v36, v37
    v_cvt_pk_bf16_f32 v35, v38, v39
    v_cvt_pk_bf16_f32 v36, v40, v41
    v_cvt_pk_bf16_f32 v37, v42, v43
    v_cvt_pk_bf16_f32 v38, v44, v45
    v_cvt_pk_bf16_f32 v39, v46, v47
    ds_read_b64_tr_b16 v[128:129], v24 offset:0
    ds_read_b64_tr_b16 v[130:131], v24 offset:2048
    ds_read_b64_tr_b16 v[132:133], v25 offset:0
    ds_read_b64_tr_b16 v[134:135], v25 offset:2048
    ds_read_b64_tr_b16 v[136:137], v26 offset:0
    ds_read_b64_tr_b16 v[138:139], v26 offset:2048
    ds_read_b64_tr_b16 v[140:141], v27 offset:0
    s_cbranch_vccnz L_w2_593
    s_bitcmp1_b32 s34, 0
    s_cbranch_scc1 L_w1_593
    s_waitcnt vmcnt(3)
L_w1_593:
    s_waitcnt vmcnt(4)
L_w2_593:
    s_waitcnt vmcnt(5)
    buffer_load_dwordx4 v12, s[8:11], s57 offen offset:3072 nt lds
    ds_read_b64_tr_b16 v[142:143], v27 offset:2048
    ds_read_b64_tr_b16 v[144:145], v24 offset:4096
    ds_read_b64_tr_b16 v[146:147], v24 offset:6144
    s_waitcnt lgkmcnt(8)
    v_mfma_f32_32x32x16_bf16 v[64:79], v[128:131], a[152:155], v[64:79]
    ds_read_b64_tr_b16 v[148:149], v25 offset:4096
    ds_read_b64_tr_b16 v[150:151], v25 offset:6144
    s_waitcnt lgkmcnt(8)
    v_mfma_f32_32x32x16_bf16 v[80:95], v[132:135], a[152:155], v[80:95]
    ds_read_b64_tr_b16 v[152:153], v26 offset:4096
    ds_read_b64_tr_b16 v[154:155], v26 offset:6144
    s_waitcnt lgkmcnt(8)
    v_mfma_f32_32x32x16_bf16 v[96:111], v[136:139], a[152:155], v[96:111]
    s_add_u32 s49, s49, s100
    s_lshr_b32 s34, s49, 4
    s_and_b32 s49, s49, 15
    s_cmp_ge_u32 s34, 2
    s_cselect_b64 vcc, -1, 0
    s_cmp_lg_u32 s44, 54
    s_cbranch_scc1 L_nr54
    s_mov_b32 s3, 87040
    v_mov_b32 v246, 1
    s_mov_b64 exec, 1
    buffer_atomic_add v246, off, s[24:27], s3 sc0
    s_mov_b64 exec, -1
L_nr54:
    v_add_u32 v0, 1, v0
    s_mov_b64 exec, s[32:33]
    buffer_store_dword v0, v242, s[24:27], s35 offen
    s_mov_b64 exec, -1
    buffer_load_dword v244, v242, s[24:27], s35 offen sc1
    s_xor_b32 s57, s99, 786432
    s_add_u32 m0, s56, 16384
    s_cbranch_vccnz L_w2_596
    s_bitcmp1_b32 s34, 0
    s_cbranch_scc1 L_w1_596
    s_waitcnt vmcnt(5)
L_w1_596:
    s_waitcnt vmcnt(6)
L_w2_596:
    s_waitcnt vmcnt(7)
    buffer_load_dwordx4 v12, s[8:11], s57 offen offset:0 nt lds
    ds_read_b64_tr_b16 v[156:157], v27 offset:4096
    ds_read_b64_tr_b16 v[158:159], v27 offset:6144
    s_waitcnt lgkmcnt(8)
    v_mfma_f32_32x32x16_bf16 v[112:127], v[140:143], a[152:155], v[112:127]
    s_waitcnt lgkmcnt(6)
    v_mfma_f32_32x32x16_bf16 v[64:79], v[144:147], a[156:159], v[64:79]
    s_waitcnt lgkmcnt(4)
    v_mfma_f32_32x32x16_bf16 v[80:95], v[148:151], a[156:159], v[80:95]
    s_nop 2
    s_cbranch_vccnz L_w2_597
    s_bitcmp1_b32 s34, 0
    s_cbranch_scc1 L_w1_597
    s_waitcnt vmcnt(5)
L_w1_597:
    s_waitcnt vmcnt(6)
L_w2_597:
    s_waitcnt vmcnt(7)
    buffer_load_dwordx4 v12, s[8:11], s57 offen offset:1024 nt lds
    s_waitcnt lgkmcnt(2)
    v_mfma_f32_32x32x16_bf16 v[96:111], v[152:155], a[156:159], v[96:111]
    s_waitcnt lgkmcnt(0)
    v_mfma_f32_32x32x16_bf16 v[112:127], v[156:159], a[156:159], v[112:127]
    v_pk_mul_f32 v[64:65], v[64:65], v[180:181] op_sel:[0,1] op_sel_hi:[1,1]
    v_pk_mul_f32 v[66:67], v[66:67], v[180:181] op_sel:[0,1] op_sel_hi:[1,1]
    v_pk_mul_f32 v[68:69], v[68:69], v[180:181] op_sel:[0,1] op_sel_hi:[1,1]
    v_pk_mul_f32 v[70:71], v[70:71], v[180:181] op_sel:[0,1] op_sel_hi:[1,1]
    v_pk_mul_f32 v[72:73], v[72:73], v[180:181] op_sel:[0,1] op_sel_hi:[1,1]
    v_pk_mul_f32 v[74:75], v[74:75], v[180:181] op_sel:[0,1] op_sel_hi:[1,1]
    v_pk_mul_f32 v[76:77], v[76:77], v[180:181] op_sel:[0,1] op_sel_hi:[1,1]
    v_pk_mul_f32 v[78:79], v[78:79], v[180:181] op_sel:[0,1] op_sel_hi:[1,1]
    s_cbranch_vccnz L_w2_598
    s_bitcmp1_b32 s34, 0
    s_cbranch_scc1 L_w1_598
    s_waitcnt vmcnt(5)
L_w1_598:
    s_waitcnt vmcnt(6)
L_w2_598:
    s_waitcnt vmcnt(7)
    buffer_load_dwordx4 v12, s[8:11], s57 offen offset:2048 nt lds
    v_pk_mul_f32 v[80:81], v[80:81], v[180:181] op_sel:[0,1] op_sel_hi:[1,1]
    v_pk_mul_f32 v[82:83], v[82:83], v[180:181] op_sel:[0,1] op_sel_hi:[1,1]
    v_pk_mul_f32 v[84:85], v[84:85], v[180:181] op_sel:[0,1] op_sel_hi:[1,1]
    v_pk_mul_f32 v[86:87], v[86:87], v[180:181] op_sel:[0,1] op_sel_hi:[1,1]
    v_pk_mul_f32 v[88:89], v[88:89], v[180:181] op_sel:[0,1] op_sel_hi:[1,1]
    v_pk_mul_f32 v[90:91], v[90:91], v[180:181] op_sel:[0,1] op_sel_hi:[1,1]
    v_pk_mul_f32 v[92:93], v[92:93], v[180:181] op_sel:[0,1] op_sel_hi:[1,1]
    v_pk_mul_f32 v[94:95], v[94:95], v[180:181] op_sel:[0,1] op_sel_hi:[1,1]
    v_pk_mul_f32 v[96:97], v[96:97], v[180:181] op_sel:[0,1] op_sel_hi:[1,1]
    v_pk_mul_f32 v[98:99], v[98:99], v[180:181] op_sel:[0,1] op_sel_hi:[1,1]
    v_pk_mul_f32 v[100:101], v[100:101], v[180:181] op_sel:[0,1] op_sel_hi:[1,1]
    v_pk_mul_f32 v[102:103], v[102:103], v[180:181] op_sel:[0,1] op_sel_hi:[1,1]
    v_pk_mul_f32 v[104:105], v[104:105], v[180:181] op_sel:[0,1] op_sel_hi:[1,1]
    v_pk_mul_f32 v[106:107], v[106:107], v[180:181] op_sel:[0,1] op_sel_hi:[1,1]
    v_pk_mul_f32 v[108:109], v[108:109], v[180:181] op_sel:[0,1] op_sel_hi:[1,1]
    v_pk_mul_f32 v[110:111], v[110:111], v[180:181] op_sel:[0,1] op_sel_hi:[1,1]
    v_pk_mul_f32 v[112:113], v[112:113], v[180:181] op_sel:[0,1] op_sel_hi:[1,1]
    v_pk_mul_f32 v[114:115], v[114:115], v[180:181] op_sel:[0,1] op_sel_hi:[1,1]
    v_pk_mul_f32 v[116:117], v[116:117], v[180:181] op_sel:[0,1] op_sel_hi:[1,1]
    v_pk_mul_f32 v[118:119], v[118:119], v[180:181] op_sel:[0,1] op_sel_hi:[1,1]
    v_pk_mul_f32 v[120:121], v[120:121], v[180:181] op_sel:[0,1] op_sel_hi:[1,1]
    v_pk_mul_f32 v[122:123], v[122:123], v[180:181] op_sel:[0,1] op_sel_hi:[1,1]
    v_pk_mul_f32 v[124:125], v[124:125], v[180:181] op_sel:[0,1] op_sel_hi:[1,1]
    v_pk_mul_f32 v[126:127], v[126:127], v[180:181] op_sel:[0,1] op_sel_hi:[1,1]
    ds_read_b64_tr_b16 a[74:75], v61 offset:0
    ds_read_b64_tr_b16 a[78:79], v61 offset:32
    s_cbranch_vccnz L_w2_599
    s_bitcmp1_b32 s34, 0
    s_cbranch_scc1 L_w1_599
    s_waitcnt vmcnt(5)
L_w1_599:
    s_waitcnt vmcnt(6)
L_w2_599:
    s_waitcnt vmcnt(7)
    buffer_load_dwordx4 v12, s[8:11], s57 offen offset:3072 nt lds
    ds_read_b64_tr_b16 a[82:83], v61 offset:64
    ds_read_b64_tr_b16 a[86:87], v61 offset:96
    ds_read_b64_tr_b16 a[90:91], v61 offset:128
    ds_read_b64_tr_b16 a[94:95], v61 offset:160
    ds_read_b64_tr_b16 a[98:99], v61 offset:192
    ds_read_b64_tr_b16 a[102:103], v61 offset:224
    ds_read_b64_tr_b16 a[106:107], v61 offset:256
    s_waitcnt lgkmcnt(0)
    s_add_u32 s49, s49, s100
    s_lshr_b32 s34, s49, 4
    s_and_b32 s49, s49, 15
    s_cmp_ge_u32 s34, 2
    s_cselect_b64 vcc, -1, 0
    s_xor_b32 s57, s99, 790528
    s_add_u32 m0, s56, 20480
    s_cbranch_vccnz L_w2_600
    s_bitcmp1_b32 s34, 0
    s_cbranch_scc1 L_w1_600
    s_waitcnt vmcnt(3)
L_w1_600:
    s_waitcnt vmcnt(6)
L_w2_600:
    s_waitcnt vmcnt(7)
    buffer_load_dwordx4 v12, s[8:11], s57 offen offset:0 nt lds
    s_add_u32 s79, s58, 147456
    s_add_u32 m0, s67, 0
    s_nop 0
    buffer_load_dwordx4 v56, s[20:23], s79 offen lds
    s_add_u32 m0, s56, 20480
    s_cbranch_vccnz L_w2_602
    s_bitcmp1_b32 s34, 0
    s_cbranch_scc1 L_w1_602
    s_waitcnt vmcnt(4)
L_w1_602:
    s_waitcnt vmcnt(5)
L_w2_602:
    s_waitcnt vmcnt(8)
    buffer_load_dwordx4 v12, s[8:11], s57 offen offset:1024 nt lds
    ds_read_b64_tr_b16 v[128:129], v24 offset:8192
    ds_read_b64_tr_b16 v[130:131], v24 offset:10240
    ds_read_b64_tr_b16 v[132:133], v25 offset:8192
    ds_read_b64_tr_b16 v[134:135], v25 offset:10240
    ds_read_b64_tr_b16 v[136:137], v26 offset:8192
    ds_read_b64_tr_b16 v[138:139], v26 offset:10240
    ds_read_b64_tr_b16 v[140:141], v27 offset:8192
    ds_read_b64_tr_b16 v[142:143], v27 offset:10240
    ds_read_b64_tr_b16 v[144:145], v24 offset:12288
    ds_read_b64_tr_b16 v[146:147], v24 offset:14336
    s_waitcnt lgkmcnt(8)
    v_mfma_f32_32x32x16_bf16 v[64:79], v[128:131], a[160:163], v[64:79]
    ds_read_b64_tr_b16 v[148:149], v25 offset:12288
    s_cbranch_vccnz L_w2_603
    s_bitcmp1_b32 s34, 0
    s_cbranch_scc1 L_w1_603
    s_waitcnt vmcnt(4)
L_w1_603:
    s_waitcnt vmcnt(5)
L_w2_603:
    s_waitcnt vmcnt(6)
    buffer_load_dwordx4 v12, s[8:11], s57 offen offset:2048 nt lds
    ds_read_b64_tr_b16 v[150:151], v25 offset:14336
    s_waitcnt lgkmcnt(8)
    v_mfma_f32_32x32x16_bf16 v[80:95], v[132:135], a[160:163], v[80:95]
    ds_read_b64_tr_b16 v[152:153], v26 offset:12288
    ds_read_b64_tr_b16 v[154:155], v26 offset:14336
    s_waitcnt lgkmcnt(8)
    v_mfma_f32_32x32x16_bf16 v[96:111], v[136:139], a[160:163], v[96:111]
    s_cbranch_vccnz L_w2_604
    s_bitcmp1_b32 s34, 0
    s_cbranch_scc1 L_w1_604
    s_waitcnt vmcnt(4)
L_w1_604:
    s_waitcnt vmcnt(5)
L_w2_604:
    s_waitcnt vmcnt(6)
    buffer_load_dwordx4 v12, s[8:11], s57 offen offset:3072 nt lds
    s_add_u32 m0, s67, 1024
    s_nop 0
    buffer_load_dwordx4 v57, s[20:23], s79 offen lds
    ds_read_b64_tr_b16 v[156:157], v27 offset:12288
    ds_read_b64_tr_b16 v[158:159], v27 offset:14336
    s_waitcnt lgkmcnt(8)
    v_mfma_f32_32x32x16_bf16 v[112:127], v[140:143], a[160:163], v[112:127]
    s_waitcnt lgkmcnt(6)
    v_mfma_f32_32x32x16_bf16 v[64:79], v[144:147], a[164:167], v[64:79]
    s_cmp_lg_u32 s44, 54
    s_cbranch_scc1 L_nc54
    v_sub_u32 v247, v246, v245
    v_lshlrev_b32 v246, 8, v254
    v_readfirstlane_b32 s3, v247
    s_nop 0
    s_min_u32 s3, s3, 7
    s_mul_i32 s3, s3, 6
    s_add_u32 s3, s3, s45
    v_mov_b32 v247, s3
    s_and_b32 s3, s35, 0xfffffcff
    s_mov_b64 exec, 15
    buffer_store_dword v247, v246, s[24:27], s3 offen offset:128
    s_mov_b64 exec, -1
L_nc54:
    v_sub_u32 v244, v244, v0
    v_cmp_gt_u32 s[100:101], 64, v244
    v_readlane_b32 s46, v244, 32
    s_bcnt1_i32_b32 s3, s100
    s_mul_i32 s3, s3, 3
    s_add_u32 s46, s46, 21
    s_cmp_lt_u32 s46, 128
    s_cselect_b32 s46, s46, 21
    s_add_u32 s3, s3, s46
    s_ashr_i32 s3, s3, 2
    s_add_i32 s3, s3, 2
    s_max_i32 s3, s3, 8
    s_min_i32 s100, s3, 32
    s_add_u32 s49, s49, s100
    s_lshr_b32 s34, s49, 4
    s_and_b32 s49, s49, 15
    s_cmp_ge_u32 s34, 2
    s_cselect_b64 vcc, -1, 0
    s_xor_b32 s57, s99, 802816
    s_add_u32 m0, s56, 24576
    s_cbranch_vccnz L_w2_606
    s_bitcmp1_b32 s34, 0
    s_cbranch_scc1 L_w1_606
    s_waitcnt vmcnt(5)
L_w1_606:
    s_waitcnt vmcnt(6)
L_w2_606:
    s_waitcnt vmcnt(7)
    buffer_load_dwordx4 v12, s[8:11], s57 offen offset:0 nt lds
    s_waitcnt lgkmcnt(4)
    v_mfma_f32_32x32x16_bf16 v[80:95], v[148:151], a[164:167], v[80:95]
    s_waitcnt lgkmcnt(2)
    v_mfma_f32_32x32x16_bf16 v[96:111], v[152:155], a[164:167], v[96:111]
    s_waitcnt lgkmcnt(0)
    v_mfma_f32_32x32x16_bf16 v[112:127], v[156:159], a[164:167], v[112:127]
    s_cbranch_vccnz L_w2_607
    s_bitcmp1_b32 s34, 0
    s_cbranch_scc1 L_w1_607
    s_waitcnt vmcnt(4)
L_w1_607:
    s_waitcnt vmcnt(6)
L_w2_607:
    s_waitcnt vmcnt(7)
    buffer_load_dwordx4 v12, s[8:11], s57 offen offset:1024 nt lds
    v_pk_mul_f32 v[64:65], v[64:65], v[182:183] op_sel_hi:[1,0]
    v_pk_mul_f32 v[66:67], v[66:67], v[182:183] op_sel_hi:[1,0]
    v_pk_mul_f32 v[68:69], v[68:69], v[182:183] op_sel_hi:[1,0]
    v_pk_mul_f32 v[70:71], v[70:71], v[182:183] op_sel_hi:[1,0]
    v_pk_mul_f32 v[72:73], v[72:73], v[182:183] op_sel_hi:[1,0]
    v_pk_mul_f32 v[74:75], v[74:75], v[182:183] op_sel_hi:[1,0]
    v_pk_mul_f32 v[76:77], v[76:77], v[182:183] op_sel_hi:[1,0]
    v_pk_mul_f32 v[78:79], v[78:79], v[182:183] op_sel_hi:[1,0]
    v_pk_mul_f32 v[80:81], v[80:81], v[182:183] op_sel_hi:[1,0]
    v_pk_mul_f32 v[82:83], v[82:83], v[182:183] op_sel_hi:[1,0]
    v_pk_mul_f32 v[84:85], v[84:85], v[182:183] op_sel_hi:[1,0]
    v_pk_mul_f32 v[86:87], v[86:87], v[182:183] op_sel_hi:[1,0]
    v_pk_mul_f32 v[88:89], v[88:89], v[182:183] op_sel_hi:[1,0]
    v_pk_mul_f32 v[90:91], v[90:91], v[182:183] op_sel_hi:[1,0]
    v_pk_mul_f32 v[92:93], v[92:93], v[182:183] op_sel_hi:[1,0]
    v_pk_mul_f32 v[94:95], v[94:95], v[182:183] op_sel_hi:[1,0]
    v_pk_mul_f32 v[96:97], v[96:97], v[182:183] op_sel_hi:[1,0]
    v_pk_mul_f32 v[98:99], v[98:99], v[182:183] op_sel_hi:[1,0]
    v_pk_mul_f32 v[100:101], v[100:101], v[182:183] op_sel_hi:[1,0]
    v_pk_mul_f32 v[102:103], v[102:103], v[182:183] op_sel_hi:[1,0]
    s_cbranch_vccnz L_w2_608
    s_bitcmp1_b32 s34, 0
    s_cbranch_scc1 L_w1_608
    s_waitcnt vmcnt(4)
L_w1_608:
    s_waitcnt vmcnt(5)
L_w2_608:
    s_waitcnt vmcnt(7)
    buffer_load_dwordx4 v12, s[8:11], s57 offen offset:2048 nt lds
    s_add_u32 m0, s67, 2048
    s_nop 0
    buffer_load_dwordx4 v58, s[20:23], s79 offen lds
    v_pk_mul_f32 v[104:105], v[104:105], v[182:183] op_sel_hi:[1,0]
    v_pk_mul_f32 v[106:107], v[106:107], v[182:183] op_sel_hi:[1,0]
    v_pk_mul_f32 v[108:109], v[108:109], v[182:183] op_sel_hi:[1,0]
    v_pk_mul_f32 v[110:111], v[110:111], v[182:183] op_sel_hi:[1,0]
    v_pk_mul_f32 v[112:113], v[112:113], v[182:183] op_sel_hi:[1,0]
    v_pk_mul_f32 v[114:115], v[114:115], v[182:183] op_sel_hi:[1,0]
    v_pk_mul_f32 v[116:117], v[116:117], v[182:183] op_sel_hi:[1,0]
    v_pk_mul_f32 v[118:119], v[118:119], v[182:183] op_sel_hi:[1,0]
    v_pk_mul_f32 v[120:121], v[120:121], v[182:183] op_sel_hi:[1,0]
    v_pk_mul_f32 v[122:123], v[122:123], v[182:183] op_sel_hi:[1,0]
    v_pk_mul_f32 v[124:125], v[124:125], v[182:183] op_sel_hi:[1,0]
    v_pk_mul_f32 v[126:127], v[126:127], v[182:183] op_sel_hi:[1,0]
    s_add_u32 m0, s56, 24576
    s_cbranch_vccnz L_w2_610
    s_bitcmp1_b32 s34, 0
    s_cbranch_scc1 L_w1_610
    s_waitcnt vmcnt(5)
L_w1_610:
    s_waitcnt vmcnt(6)
L_w2_610:
    s_waitcnt vmcnt(7)
    buffer_load_dwordx4 v12, s[8:11], s57 offen offset:3072 nt lds
    s_add_u32 s49, s49, s100
    s_lshr_b32 s34, s49, 4
    s_and_b32 s49, s49, 15
    s_cmp_ge_u32 s34, 2
    s_cselect_b64 vcc, -1, 0
    s_xor_b32 s57, s99, 806912
    s_add_u32 m0, s56, 28672
    s_cbranch_vccnz L_w2_611
    s_bitcmp1_b32 s34, 0
    s_cbranch_scc1 L_w1_611
    s_waitcnt vmcnt(4)
L_w1_611:
    s_waitcnt vmcnt(6)
L_w2_611:
    s_waitcnt vmcnt(7)
    buffer_load_dwordx4 v12, s[8:11], s57 offen offset:0 nt lds
    s_cbranch_vccnz L_w2_612
    s_bitcmp1_b32 s34, 0
    s_cbranch_scc1 L_w1_612
    s_waitcnt vmcnt(4)
L_w1_612:
    s_waitcnt vmcnt(5)
L_w2_612:
    s_waitcnt vmcnt(7)
    buffer_load_dwordx4 v12, s[8:11], s57 offen offset:1024 nt lds
    s_add_u32 m0, s67, 3072
    s_nop 0
    buffer_load_dwordx4 v59, s[20:23], s79 offen lds
    ds_read_b64_tr_b16 v[128:129], v24 offset:16384
    ds_read_b64_tr_b16 v[130:131], v24 offset:18432
    ds_read_b64_tr_b16 v[132:133], v25 offset:16384
    ds_read_b64_tr_b16 v[134:135], v25 offset:18432
    ds_read_b64_tr_b16 v[136:137], v26 offset:16384
    ds_read_b64_tr_b16 v[138:139], v26 offset:18432
    ds_read_b64_tr_b16 v[140:141], v27 offset:16384
    ds_read_b64_tr_b16 v[142:143], v27 offset:18432
    ds_read_b64_tr_b16 v[144:145], v24 offset:20480
    ds_read_b64_tr_b16 v[146:147], v24 offset:22528
    s_waitcnt lgkmcnt(8)
    v_mfma_f32_32x32x16_bf16 v[64:79], v[128:131], a[168:171], v[64:79]
    ds_read_b64_tr_b16 v[148:149], v25 offset:20480
    s_add_u32 m0, s56, 28672
    s_cbranch_vccnz L_w2_614
    s_bitcmp1_b32 s34, 0
    s_cbranch_scc1 L_w1_614
    s_waitcnt vmcnt(5)
L_w1_614:
    s_waitcnt vmcnt(6)
L_w2_614:
    s_waitcnt vmcnt(7)
    buffer_load_dwordx4 v12, s[8:11], s57 offen offset:2048 nt lds
    ds_read_b64_tr_b16 v[150:151], v25 offset:22528
    s_waitcnt lgkmcnt(8)
    v_mfma_f32_32x32x16_bf16 v[80:95], v[132:135], a[168:171], v[80:95]
    ds_read_b64_tr_b16 v[152:153], v26 offset:20480
    ds_read_b64_tr_b16 v[154:155], v26 offset:22528
    s_waitcnt lgkmcnt(8)
    v_mfma_f32_32x32x16_bf16 v[96:111], v[136:139], a[168:171], v[96:111]
    s_cbranch_vccnz L_w2_615
    s_bitcmp1_b32 s34, 0
    s_cbranch_scc1 L_w1_615
    s_waitcnt vmcnt(4)
L_w1_615:
    s_waitcnt vmcnt(6)
L_w2_615:
    s_waitcnt vmcnt(7)
    buffer_load_dwordx4 v12, s[8:11], s57 offen offset:3072 nt lds
    ds_read_b64_tr_b16 v[156:157], v27 offset:20480
    ds_read_b64_tr_b16 v[158:159], v27 offset:22528
    s_waitcnt lgkmcnt(8)
    v_mfma_f32_32x32x16_bf16 v[112:127], v[140:143], a[168:171], v[112:127]
    s_waitcnt lgkmcnt(6)
    v_mfma_f32_32x32x16_bf16 v[64:79], v[144:147], a[172:175], v[64:79]
    s_add_u32 s49, s49, s100
    s_lshr_b32 s34, s49, 4
    s_and_b32 s49, s49, 15
    s_cmp_ge_u32 s34, 2
    s_cselect_b64 vcc, -1, 0
    v_add_u32 v0, 1, v0
    s_mov_b64 exec, s[32:33]
    buffer_store_dword v0, v242, s[24:27], s35 offen
    s_mov_b64 exec, -1
    buffer_load_dword v244, v242, s[24:27], s35 offen sc1
    s_xor_b32 s57, s99, 851968
    s_add_u32 m0, s56, 0
    s_cbranch_vccnz L_w2_618
    s_bitcmp1_b32 s34, 0
    s_cbranch_scc1 L_w1_618
    s_waitcnt vmcnt(6)
L_w1_618:
    s_waitcnt vmcnt(7)
L_w2_618:
    s_waitcnt vmcnt(9)
    buffer_load_dwordx4 v12, s[8:11], s57 offen offset:0 nt lds
    s_add_u32 m0, s67, 4096
    s_nop 0
    buffer_load_dwordx4 v60, s[20:23], s79 offen lds
    s_waitcnt lgkmcnt(4)
    v_mfma_f32_32x32x16_bf16 v[80:95], v[148:151], a[172:175], v[80:95]
    s_waitcnt lgkmcnt(2)
    v_mfma_f32_32x32x16_bf16 v[96:111], v[152:155], a[172:175], v[96:111]
    s_waitcnt lgkmcnt(0)
    v_mfma_f32_32x32x16_bf16 v[112:127], v[156:159], a[172:175], v[112:127]
    s_add_u32 m0, s56, 0
    s_cbranch_vccnz L_w2_620
    s_bitcmp1_b32 s34, 0
    s_cbranch_scc1 L_w1_620
    s_waitcnt vmcnt(7)
L_w1_620:
    s_waitcnt vmcnt(8)
L_w2_620:
    s_waitcnt vmcnt(9)
    buffer_load_dwordx4 v12, s[8:11], s57 offen offset:1024 nt lds
    v_pk_mul_f32 v[64:65], v[64:65], v[182:183] op_sel:[0,1] op_sel_hi:[1,1]
    v_pk_mul_f32 v[66:67], v[66:67], v[182:183] op_sel:[0,1] op_sel_hi:[1,1]
    v_pk_mul_f32 v[68:69], v[68:69], v[182:183] op_sel:[0,1] op_sel_hi:[1,1]
    v_pk_mul_f32 v[70:71], v[70:71], v[182:183] op_sel:[0,1] op_sel_hi:[1,1]
    v_pk_mul_f32 v[72:73], v[72:73], v[182:183] op_sel:[0,1] op_sel_hi:[1,1]
    v_pk_mul_f32 v[74:75], v[74:75], v[182:183] op_sel:[0,1] op_sel_hi:[1,1]
    v_pk_mul_f32 v[76:77], v[76:77], v[182:183] op_sel:[0,1] op_sel_hi:[1,1]
    v_pk_mul_f32 v[78:79], v[78:79], v[182:183] op_sel:[0,1] op_sel_hi:[1,1]
    v_pk_mul_f32 v[80:81], v[80:81], v[182:183] op_sel:[0,1] op_sel_hi:[1,1]
    v_pk_mul_f32 v[82:83], v[82:83], v[182:183] op_sel:[0,1] op_sel_hi:[1,1]
    v_pk_mul_f32 v[84:85], v[84:85], v[182:183] op_sel:[0,1] op_sel_hi:[1,1]
    v_pk_mul_f32 v[86:87], v[86:87], v[182:183] op_sel:[0,1] op_sel_hi:[1,1]
    v_pk_mul_f32 v[88:89], v[88:89], v[182:183] op_sel:[0,1] op_sel_hi:[1,1]
    v_pk_mul_f32 v[90:91], v[90:91], v[182:183] op_sel:[0,1] op_sel_hi:[1,1]
    v_pk_mul_f32 v[92:93], v[92:93], v[182:183] op_sel:[0,1] op_sel_hi:[1,1]
    v_pk_mul_f32 v[94:95], v[94:95], v[182:183] op_sel:[0,1] op_sel_hi:[1,1]
    v_pk_mul_f32 v[96:97], v[96:97], v[182:183] op_sel:[0,1] op_sel_hi:[1,1]
    v_pk_mul_f32 v[98:99], v[98:99], v[182:183] op_sel:[0,1] op_sel_hi:[1,1]
    v_pk_mul_f32 v[100:101], v[100:101], v[182:183] op_sel:[0,1] op_sel_hi:[1,1]
    v_pk_mul_f32 v[102:103], v[102:103], v[182:183] op_sel:[0,1] op_sel_hi:[1,1]
    s_cbranch_vccnz L_w2_621
    s_bitcmp1_b32 s34, 0
    s_cbranch_scc1 L_w1_621
    s_waitcnt vmcnt(6)
L_w1_621:
    s_waitcnt vmcnt(8)
L_w2_621:
    s_waitcnt vmcnt(9)
    buffer_load_dwordx4 v12, s[8:11], s57 offen offset:2048 nt lds
    v_pk_mul_f32 v[104:105], v[104:105], v[182:183] op_sel:[0,1] op_sel_hi:[1,1]
    v_pk_mul_f32 v[106:107], v[106:107], v[182:183] op_sel:[0,1] op_sel_hi:[1,1]
    v_pk_mul_f32 v[108:109], v[108:109], v[182:183] op_sel:[0,1] op_sel_hi:[1,1]
    v_pk_mul_f32 v[110:111], v[110:111], v[182:183] op_sel:[0,1] op_sel_hi:[1,1]
    v_pk_mul_f32 v[112:113], v[112:113], v[182:183] op_sel:[0,1] op_sel_hi:[1,1]
    v_pk_mul_f32 v[114:115], v[114:115], v[182:183] op_sel:[0,1] op_sel_hi:[1,1]
    v_pk_mul_f32 v[116:117], v[116:117], v[182:183] op_sel:[0,1] op_sel_hi:[1,1]
    v_pk_mul_f32 v[118:119], v[118:119], v[182:183] op_sel:[0,1] op_sel_hi:[1,1]
    v_pk_mul_f32 v[120:121], v[120:121], v[182:183] op_sel:[0,1] op_sel_hi:[1,1]
    v_pk_mul_f32 v[122:123], v[122:123], v[182:183] op_sel:[0,1] op_sel_hi:[1,1]
    v_pk_mul_f32 v[124:125], v[124:125], v[182:183] op_sel:[0,1] op_sel_hi:[1,1]
    v_pk_mul_f32 v[126:127], v[126:127], v[182:183] op_sel:[0,1] op_sel_hi:[1,1]
    s_cbranch_vccnz L_w2_622
    s_bitcmp1_b32 s34, 0
    s_cbranch_scc1 L_w1_622
    s_waitcnt vmcnt(6)
L_w1_622:
    s_waitcnt vmcnt(7)
L_w2_622:
    s_waitcnt vmcnt(9)
    buffer_load_dwordx4 v12, s[8:11], s57 offen offset:3072 nt lds
    s_add_u32 s49, s49, s100
    s_lshr_b32 s34, s49, 4
    s_and_b32 s49, s49, 15
    s_cmp_ge_u32 s34, 2
    s_cselect_b64 vcc, -1, 0
    s_xor_b32 s57, s99, 856064
    s_add_u32 m0, s56, 4096
    s_cbranch_vccnz L_w2_623
    s_bitcmp1_b32 s34, 0
    s_cbranch_scc1 L_w1_623
    s_waitcnt vmcnt(4)
L_w1_623:
    s_waitcnt vmcnt(7)
L_w2_623:
    s_waitcnt vmcnt(8)
    buffer_load_dwordx4 v12, s[8:11], s57 offen offset:0 nt lds
    s_cbranch_vccnz L_w2_624
    s_bitcmp1_b32 s34, 0
    s_cbranch_scc1 L_w1_624
    s_waitcnt vmcnt(3)
L_w1_624:
    s_waitcnt vmcnt(5)
L_w2_624:
    s_waitcnt vmcnt(8)
    buffer_load_dwordx4 v12, s[8:11], s57 offen offset:1024 nt lds
    ds_read_b64_tr_b16 v[128:129], v24 offset:24576
    ds_read_b64_tr_b16 v[130:131], v24 offset:26624
    ds_read_b64_tr_b16 v[132:133], v25 offset:24576
    ds_read_b64_tr_b16 v[134:135], v25 offset:26624
    ds_read_b64_tr_b16 v[136:137], v26 offset:24576
    ds_read_b64_tr_b16 v[138:139], v26 offset:26624
    ds_read_b64_tr_b16 v[140:141], v27 offset:24576
    ds_read_b64_tr_b16 v[142:143], v27 offset:26624
    ds_read_b64_tr_b16 v[144:145], v24 offset:28672
    ds_read_b64_tr_b16 v[146:147], v24 offset:30720
    s_waitcnt lgkmcnt(8)
    v_mfma_f32_32x32x16_bf16 v[64:79], v[128:131], a[176:179], v[64:79]
    ds_read_b64_tr_b16 v[148:149], v25 offset:28672
    s_cbranch_vccnz L_w2_625
    s_bitcmp1_b32 s34, 0
    s_cbranch_scc1 L_w1_625
    s_waitcnt vmcnt(3)
L_w1_625:
    s_waitcnt vmcnt(4)
L_w2_625:
    s_waitcnt vmcnt(6)
    buffer_load_dwordx4 v12, s[8:11], s57 offen offset:2048 nt lds
    ds_read_b64_tr_b16 v[150:151], v25 offset:30720
    s_waitcnt lgkmcnt(8)
    v_mfma_f32_32x32x16_bf16 v[80:95], v[132:135], a[176:179], v[80:95]
    ds_read_b64_tr_b16 v[152:153], v26 offset:28672
    ds_read_b64_tr_b16 v[154:155], v26 offset:30720
    s_waitcnt lgkmcnt(8)
    v_mfma_f32_32x32x16_bf16 v[96:111], v[136:139], a[176:179], v[96:111]
    s_cbranch_vccnz L_w2_626
    s_bitcmp1_b32 s34, 0
    s_cbranch_scc1 L_w1_626
    s_waitcnt vmcnt(3)
L_w1_626:
    s_waitcnt vmcnt(4)
L_w2_626:
    s_waitcnt vmcnt(5)
    buffer_load_dwordx4 v12, s[8:11], s57 offen offset:3072 nt lds
    ds_read_b64_tr_b16 v[156:157], v27 offset:28672
    ds_read_b64_tr_b16 v[158:159], v27 offset:30720
    s_waitcnt lgkmcnt(8)
    v_mfma_f32_32x32x16_bf16 v[112:127], v[140:143], a[176:179], v[112:127]
    s_waitcnt lgkmcnt(6)
    v_mfma_f32_32x32x16_bf16 v[64:79], v[144:147], a[180:183], v[64:79]
    s_waitcnt lgkmcnt(4)
    v_mfma_f32_32x32x16_bf16 v[80:95], v[148:151], a[180:183], v[80:95]
    v_sub_u32 v244, v244, v0
    v_cmp_gt_u32 s[100:101], 64, v244
    v_readlane_b32 s46, v244, 32
    s_bcnt1_i32_b32 s3, s100
    s_mul_i32 s3, s3, 3
    s_add_u32 s46, s46, 22
    s_cmp_lt_u32 s46, 128
    s_cselect_b32 s46, s46, 21
    s_add_u32 s3, s3, s46
    s_ashr_i32 s3, s3, 2
    s_add_i32 s3, s3, 2
    s_max_i32 s3, s3, 8
    s_min_i32 s100, s3, 32
    s_add_u32 s49, s49, s100
    s_lshr_b32 s34, s49, 4
    s_and_b32 s49, s49, 15
    s_cmp_ge_u32 s34, 2
    s_cselect_b64 vcc, -1, 0
    s_xor_b32 s57, s99, 212992
    s_add_u32 m0, s56, 8192
    s_cbranch_vccnz L_w2_627
    s_bitcmp1_b32 s34, 0
    s_cbranch_scc1 L_w1_627
    s_waitcnt vmcnt(3)
L_w1_627:
    s_waitcnt vmcnt(4)
L_w2_627:
    s_waitcnt vmcnt(5)
    buffer_load_dwordx4 v12, s[8:11], s57 offen offset:0 nt lds
    s_waitcnt lgkmcnt(2)
    v_mfma_f32_32x32x16_bf16 v[96:111], v[152:155], a[180:183], v[96:111]
    s_waitcnt lgkmcnt(0)
    v_mfma_f32_32x32x16_bf16 v[112:127], v[156:159], a[180:183], v[112:127]
    v_pk_mul_f32 v[64:65], v[64:65], v[184:185] op_sel_hi:[1,0]
    v_pk_mul_f32 v[66:67], v[66:67], v[184:185] op_sel_hi:[1,0]
    v_pk_mul_f32 v[68:69], v[68:69], v[184:185] op_sel_hi:[1,0]
    v_pk_mul_f32 v[70:71], v[70:71], v[184:185] op_sel_hi:[1,0]
    v_pk_mul_f32 v[72:73], v[72:73], v[184:185] op_sel_hi:[1,0]
    v_pk_mul_f32 v[74:75], v[74:75], v[184:185] op_sel_hi:[1,0]
    v_pk_mul_f32 v[76:77], v[76:77], v[184:185] op_sel_hi:[1,0]
    v_pk_mul_f32 v[78:79], v[78:79], v[184:185] op_sel_hi:[1,0]
    s_cbranch_vccnz L_w2_628
    s_bitcmp1_b32 s34, 0
    s_cbranch_scc1 L_w1_628
    s_waitcnt vmcnt(3)
L_w1_628:
    s_waitcnt vmcnt(4)
L_w2_628:
    s_waitcnt vmcnt(5)
    buffer_load_dwordx4 v12, s[8:11], s57 offen offset:1024 nt lds
    v_pk_mul_f32 v[80:81], v[80:81], v[184:185] op_sel_hi:[1,0]
    v_pk_mul_f32 v[82:83], v[82:83], v[184:185] op_sel_hi:[1,0]
    v_pk_mul_f32 v[84:85], v[84:85], v[184:185] op_sel_hi:[1,0]
    v_pk_mul_f32 v[86:87], v[86:87], v[184:185] op_sel_hi:[1,0]
    v_pk_mul_f32 v[88:89], v[88:89], v[184:185] op_sel_hi:[1,0]
    v_pk_mul_f32 v[90:91], v[90:91], v[184:185] op_sel_hi:[1,0]
    v_pk_mul_f32 v[92:93], v[92:93], v[184:185] op_sel_hi:[1,0]
    v_pk_mul_f32 v[94:95], v[94:95], v[184:185] op_sel_hi:[1,0]
    v_pk_mul_f32 v[96:97], v[96:97], v[184:185] op_sel_hi:[1,0]
    v_pk_mul_f32 v[98:99], v[98:99], v[184:185] op_sel_hi:[1,0]
    v_pk_mul_f32 v[100:101], v[100:101], v[184:185] op_sel_hi:[1,0]
    v_pk_mul_f32 v[102:103], v[102:103], v[184:185] op_sel_hi:[1,0]
    v_pk_mul_f32 v[104:105], v[104:105], v[184:185] op_sel_hi:[1,0]
    v_pk_mul_f32 v[106:107], v[106:107], v[184:185] op_sel_hi:[1,0]
    v_pk_mul_f32 v[108:109], v[108:109], v[184:185] op_sel_hi:[1,0]
    v_pk_mul_f32 v[110:111], v[110:111], v[184:185] op_sel_hi:[1,0]
    v_pk_mul_f32 v[112:113], v[112:113], v[184:185] op_sel_hi:[1,0]
    v_pk_mul_f32 v[114:115], v[114:115], v[184:185] op_sel_hi:[1,0]
    v_pk_mul_f32 v[116:117], v[116:117], v[184:185] op_sel_hi:[1,0]
    v_pk_mul_f32 v[118:119], v[118:119], v[184:185] op_sel_hi:[1,0]
    v_pk_mul_f32 v[120:121], v[120:121], v[184:185] op_sel_hi:[1,0]
    v_pk_mul_f32 v[122:123], v[122:123], v[184:185] op_sel_hi:[1,0]
    v_pk_mul_f32 v[124:125], v[124:125], v[184:185] op_sel_hi:[1,0]
    v_pk_mul_f32 v[126:127], v[126:127], v[184:185] op_sel_hi:[1,0]
    ds_read_b64_tr_b16 a[108:109], v61 offset:0
    ds_read_b64_tr_b16 a[112:113], v61 offset:32
    s_cbranch_vccnz L_w2_629
    s_bitcmp1_b32 s34, 0
    s_cbranch_scc1 L_w1_629
    s_waitcnt vmcnt(3)
L_w1_629:
    s_waitcnt vmcnt(4)
L_w2_629:
    s_waitcnt vmcnt(5)
    buffer_load_dwordx4 v12, s[8:11], s57 offen offset:2048 nt lds
    ds_read_b64_tr_b16 a[116:117], v61 offset:64
    ds_read_b64_tr_b16 a[120:121], v61 offset:96
    ds_read_b64_tr_b16 a[124:125], v61 offset:128
    ds_read_b64_tr_b16 a[128:129], v61 offset:160
    ds_read_b64_tr_b16 a[132:133], v61 offset:192
    ds_read_b64_tr_b16 a[136:137], v61 offset:224
    ds_read_b64_tr_b16 a[140:141], v61 offset:256
    s_waitcnt lgkmcnt(0)
    s_cbranch_vccnz L_w2_630
    s_bitcmp1_b32 s34, 0
    s_cbranch_scc1 L_w1_630
    s_waitcnt vmcnt(3)
L_w1_630:
    s_waitcnt vmcnt(4)
L_w2_630:
    s_waitcnt vmcnt(5)
    buffer_load_dwordx4 v12, s[8:11], s57 offen offset:3072 nt lds
    s_add_u32 s49, s49, s100
    s_lshr_b32 s34, s49, 4
    s_and_b32 s49, s49, 15
    s_cmp_ge_u32 s34, 2
    s_cselect_b64 vcc, -1, 0
    s_xor_b32 s57, s99, 217088
    s_add_u32 m0, s56, 12288
    s_cbranch_vccnz L_w2_631
    s_bitcmp1_b32 s34, 0
    s_cbranch_scc1 L_w1_631
    s_waitcnt vmcnt(3)
L_w1_631:
    s_waitcnt vmcnt(4)
L_w2_631:
    s_waitcnt vmcnt(5)
    buffer_load_dwordx4 v12, s[8:11], s57 offen offset:0 nt lds
    s_add_u32 s79, s58, 156672
    s_add_u32 m0, s67, 0
    s_nop 0
    buffer_load_dwordx4 v56, s[20:23], s79 offen lds
    s_add_u32 m0, s56, 12288
    s_cbranch_vccnz L_w2_633
    s_bitcmp1_b32 s34, 0
    s_cbranch_scc1 L_w1_633
    s_waitcnt vmcnt(4)
L_w1_633:
    s_waitcnt vmcnt(5)
L_w2_633:
    s_waitcnt vmcnt(6)
    buffer_load_dwordx4 v12, s[8:11], s57 offen offset:1024 nt lds
    ds_read_b64_tr_b16 v[128:129], v24 offset:0
    ds_read_b64_tr_b16 v[130:131], v24 offset:2048
    ds_read_b64_tr_b16 v[132:133], v25 offset:0
    ds_read_b64_tr_b16 v[134:135], v25 offset:2048
    ds_read_b64_tr_b16 v[136:137], v26 offset:0
    ds_read_b64_tr_b16 v[138:139], v26 offset:2048
    ds_read_b64_tr_b16 v[140:141], v27 offset:0
    ds_read_b64_tr_b16 v[142:143], v27 offset:2048
    ds_read_b64_tr_b16 v[144:145], v24 offset:4096
    ds_read_b64_tr_b16 v[146:147], v24 offset:6144
    s_waitcnt lgkmcnt(8)
    v_mfma_f32_32x32x16_bf16 v[64:79], v[128:131], a[184:187], v[64:79]
    ds_read_b64_tr_b16 v[148:149], v25 offset:4096
    s_cbranch_vccnz L_w2_634
    s_bitcmp1_b32 s34, 0
    s_cbranch_scc1 L_w1_634
    s_waitcnt vmcnt(4)
L_w1_634:
    s_waitcnt vmcnt(5)
L_w2_634:
    s_waitcnt vmcnt(6)
    buffer_load_dwordx4 v12, s[8:11], s57 offen offset:2048 nt lds
    ds_read_b64_tr_b16 v[150:151], v25 offset:6144
    s_waitcnt lgkmcnt(8)
    v_mfma_f32_32x32x16_bf16 v[80:95], v[132:135], a[184:187], v[80:95]
    ds_read_b64_tr_b16 v[152:153], v26 offset:4096
    ds_read_b64_tr_b16 v[154:155], v26 offset:6144
    s_waitcnt lgkmcnt(8)
    v_mfma_f32_32x32x16_bf16 v[96:111], v[136:139], a[184:187], v[96:111]
    s_cbranch_vccnz L_w2_635
    s_bitcmp1_b32 s34, 0
    s_cbranch_scc1 L_w1_635
    s_waitcnt vmcnt(4)
L_w1_635:
    s_waitcnt vmcnt(5)
L_w2_635:
    s_waitcnt vmcnt(6)
    buffer_load_dwordx4 v12, s[8:11], s57 offen offset:3072 nt lds
    s_add_u32 m0, s67, 1024
    s_nop 0
    buffer_load_dwordx4 v57, s[20:23], s79 offen lds
    ds_read_b64_tr_b16 v[156:157], v27 offset:4096
    ds_read_b64_tr_b16 v[158:159], v27 offset:6144
    s_waitcnt lgkmcnt(8)
    v_mfma_f32_32x32x16_bf16 v[112:127], v[140:143], a[184:187], v[112:127]
    s_waitcnt lgkmcnt(6)
    v_mfma_f32_32x32x16_bf16 v[64:79], v[144:147], a[188:191], v[64:79]
    s_add_u32 s49, s49, s100
    s_lshr_b32 s34, s49, 4
    s_and_b32 s49, s49, 15
    s_cmp_ge_u32 s34, 2
    s_cselect_b64 vcc, -1, 0
    v_add_u32 v0, 1, v0
    s_mov_b64 exec, s[32:33]
    buffer_store_dword v0, v242, s[24:27], s35 offen
    s_mov_b64 exec, -1
    buffer_load_dword v244, v242, s[24:27], s35 offen sc1
    s_xor_b32 s57, s99, 868352
    s_add_u32 m0, s56, 16384
    s_cbranch_vccnz L_w2_639
    s_bitcmp1_b32 s34, 0
    s_cbranch_scc1 L_w1_639
    s_waitcnt vmcnt(7)
L_w1_639:
    s_waitcnt vmcnt(8)
L_w2_639:
    s_waitcnt vmcnt(9)
    buffer_load_dwordx4 v12, s[8:11], s57 offen offset:0 nt lds
    s_waitcnt lgkmcnt(4)
    v_mfma_f32_32x32x16_bf16 v[80:95], v[148:151], a[188:191], v[80:95]
    s_waitcnt lgkmcnt(2)
    v_mfma_f32_32x32x16_bf16 v[96:111], v[152:155], a[188:191], v[96:111]
    s_waitcnt lgkmcnt(0)
    v_mfma_f32_32x32x16_bf16 v[112:127], v[156:159], a[188:191], v[112:127]
    s_cbranch_vccnz L_w2_640
    s_bitcmp1_b32 s34, 0
    s_cbranch_scc1 L_w1_640
    s_waitcnt vmcnt(6)
L_w1_640:
    s_waitcnt vmcnt(8)
L_w2_640:
    s_waitcnt vmcnt(9)
    buffer_load_dwordx4 v12, s[8:11], s57 offen offset:1024 nt lds
    v_pk_mul_f32 v[64:65], v[64:65], v[184:185] op_sel:[0,1] op_sel_hi:[1,1]
    v_pk_mul_f32 v[66:67], v[66:67], v[184:185] op_sel:[0,1] op_sel_hi:[1,1]
    v_pk_mul_f32 v[68:69], v[68:69], v[184:185] op_sel:[0,1] op_sel_hi:[1,1]
    v_pk_mul_f32 v[70:71], v[70:71], v[184:185] op_sel:[0,1] op_sel_hi:[1,1]
    v_pk_mul_f32 v[72:73], v[72:73], v[184:185] op_sel:[0,1] op_sel_hi:[1,1]
    v_pk_mul_f32 v[74:75], v[74:75], v[184:185] op_sel:[0,1] op_sel_hi:[1,1]
    v_pk_mul_f32 v[76:77], v[76:77], v[184:185] op_sel:[0,1] op_sel_hi:[1,1]
    v_pk_mul_f32 v[78:79], v[78:79], v[184:185] op_sel:[0,1] op_sel_hi:[1,1]
    v_pk_mul_f32 v[80:81], v[80:81], v[184:185] op_sel:[0,1] op_sel_hi:[1,1]
    v_pk_mul_f32 v[82:83], v[82:83], v[184:185] op_sel:[0,1] op_sel_hi:[1,1]
    v_pk_mul_f32 v[84:85], v[84:85], v[184:185] op_sel:[0,1] op_sel_hi:[1,1]
    v_pk_mul_f32 v[86:87], v[86:87], v[184:185] op_sel:[0,1] op_sel_hi:[1,1]
    v_pk_mul_f32 v[88:89], v[88:89], v[184:185] op_sel:[0,1] op_sel_hi:[1,1]
    v_pk_mul_f32 v[90:91], v[90:91], v[184:185] op_sel:[0,1] op_sel_hi:[1,1]
    v_pk_mul_f32 v[92:93], v[92:93], v[184:185] op_sel:[0,1] op_sel_hi:[1,1]
    v_pk_mul_f32 v[94:95], v[94:95], v[184:185] op_sel:[0,1] op_sel_hi:[1,1]
    v_pk_mul_f32 v[96:97], v[96:97], v[184:185] op_sel:[0,1] op_sel_hi:[1,1]
    v_pk_mul_f32 v[98:99], v[98:99], v[184:185] op_sel:[0,1] op_sel_hi:[1,1]
    v_pk_mul_f32 v[100:101], v[100:101], v[184:185] op_sel:[0,1] op_sel_hi:[1,1]
    v_pk_mul_f32 v[102:103], v[102:103], v[184:185] op_sel:[0,1] op_sel_hi:[1,1]
    s_cbranch_vccnz L_w2_641
    s_bitcmp1_b32 s34, 0
    s_cbranch_scc1 L_w1_641
    s_waitcnt vmcnt(6)
L_w1_641:
    s_waitcnt vmcnt(7)
L_w2_641:
    s_waitcnt vmcnt(9)
    buffer_load_dwordx4 v12, s[8:11], s57 offen offset:2048 nt lds
    s_add_u32 m0, s67, 2048
    s_nop 0
    buffer_load_dwordx4 v58, s[20:23], s79 offen lds
    v_pk_mul_f32 v[104:105], v[104:105], v[184:185] op_sel:[0,1] op_sel_hi:[1,1]
    v_pk_mul_f32 v[106:107], v[106:107], v[184:185] op_sel:[0,1] op_sel_hi:[1,1]
    v_pk_mul_f32 v[108:109], v[108:109], v[184:185] op_sel:[0,1] op_sel_hi:[1,1]
    v_pk_mul_f32 v[110:111], v[110:111], v[184:185] op_sel:[0,1] op_sel_hi:[1,1]
    v_pk_mul_f32 v[112:113], v[112:113], v[184:185] op_sel:[0,1] op_sel_hi:[1,1]
    v_pk_mul_f32 v[114:115], v[114:115], v[184:185] op_sel:[0,1] op_sel_hi:[1,1]
    v_pk_mul_f32 v[116:117], v[116:117], v[184:185] op_sel:[0,1] op_sel_hi:[1,1]
    v_pk_mul_f32 v[118:119], v[118:119], v[184:185] op_sel:[0,1] op_sel_hi:[1,1]
    v_pk_mul_f32 v[120:121], v[120:121], v[184:185] op_sel:[0,1] op_sel_hi:[1,1]
    v_pk_mul_f32 v[122:123], v[122:123], v[184:185] op_sel:[0,1] op_sel_hi:[1,1]
    v_pk_mul_f32 v[124:125], v[124:125], v[184:185] op_sel:[0,1] op_sel_hi:[1,1]
    v_pk_mul_f32 v[126:127], v[126:127], v[184:185] op_sel:[0,1] op_sel_hi:[1,1]
    s_add_u32 m0, s56, 16384
    s_cbranch_vccnz L_w2_643
    s_bitcmp1_b32 s34, 0
    s_cbranch_scc1 L_w1_643
    s_waitcnt vmcnt(7)
L_w1_643:
    s_waitcnt vmcnt(8)
L_w2_643:
    s_waitcnt vmcnt(9)
    buffer_load_dwordx4 v12, s[8:11], s57 offen offset:3072 nt lds
    s_add_u32 s49, s49, s100
    s_lshr_b32 s34, s49, 4
    s_and_b32 s49, s49, 15
    s_cmp_ge_u32 s34, 2
    s_cselect_b64 vcc, -1, 0
    s_xor_b32 s57, s99, 872448
    s_add_u32 m0, s56, 20480
    s_cbranch_vccnz L_w2_644
    s_bitcmp1_b32 s34, 0
    s_cbranch_scc1 L_w1_644
    s_waitcnt vmcnt(4)
L_w1_644:
    s_waitcnt vmcnt(8)
L_w2_644:
    s_waitcnt vmcnt(9)
    buffer_load_dwordx4 v12, s[8:11], s57 offen offset:0 nt lds
    s_cbranch_vccnz L_w2_645
    s_bitcmp1_b32 s34, 0
    s_cbranch_scc1 L_w1_645
    s_waitcnt vmcnt(4)
L_w1_645:
    s_waitcnt vmcnt(5)
L_w2_645:
    s_waitcnt vmcnt(9)
    buffer_load_dwordx4 v12, s[8:11], s57 offen offset:1024 nt lds
    s_add_u32 m0, s67, 3072
    s_nop 0
    buffer_load_dwordx4 v59, s[20:23], s79 offen lds
    ds_read_b64_tr_b16 v[128:129], v24 offset:8192
    ds_read_b64_tr_b16 v[130:131], v24 offset:10240
    ds_read_b64_tr_b16 v[132:133], v25 offset:8192
    ds_read_b64_tr_b16 v[134:135], v25 offset:10240
    ds_read_b64_tr_b16 v[136:137], v26 offset:8192
    ds_read_b64_tr_b16 v[138:139], v26 offset:10240
    ds_read_b64_tr_b16 v[140:141], v27 offset:8192
    ds_read_b64_tr_b16 v[142:143], v27 offset:10240
    ds_read_b64_tr_b16 v[144:145], v24 offset:12288
    ds_read_b64_tr_b16 v[146:147], v24 offset:14336
    s_waitcnt lgkmcnt(8)
    v_mfma_f32_32x32x16_bf16 v[64:79], v[128:131], a[192:195], v[64:79]
    ds_read_b64_tr_b16 v[148:149], v25 offset:12288
    s_add_u32 m0, s56, 20480
    s_cbranch_vccnz L_w2_647
    s_bitcmp1_b32 s34, 0
    s_cbranch_scc1 L_w1_647
    s_waitcnt vmcnt(5)
L_w1_647:
    s_waitcnt vmcnt(6)
L_w2_647:
    s_waitcnt vmcnt(7)
    buffer_load_dwordx4 v12, s[8:11], s57 offen offset:2048 nt lds
    ds_read_b64_tr_b16 v[150:151], v25 offset:14336
    s_waitcnt lgkmcnt(8)
    v_mfma_f32_32x32x16_bf16 v[80:95], v[132:135], a[192:195], v[80:95]
    ds_read_b64_tr_b16 v[152:153], v26 offset:12288
    ds_read_b64_tr_b16 v[154:155], v26 offset:14336
    s_waitcnt lgkmcnt(8)
    v_mfma_f32_32x32x16_bf16 v[96:111], v[136:139], a[192:195], v[96:111]
    s_cbranch_vccnz L_w2_648
    s_bitcmp1_b32 s34, 0
    s_cbranch_scc1 L_w1_648
    s_waitcnt vmcnt(4)
L_w1_648:
    s_waitcnt vmcnt(6)
L_w2_648:
    s_waitcnt vmcnt(7)
    buffer_load_dwordx4 v12, s[8:11], s57 offen offset:3072 nt lds
    ds_read_b64_tr_b16 v[156:157], v27 offset:12288
    ds_read_b64_tr_b16 v[158:159], v27 offset:14336
    s_waitcnt lgkmcnt(8)
    v_mfma_f32_32x32x16_bf16 v[112:127], v[140:143], a[192:195], v[112:127]
    s_waitcnt lgkmcnt(6)
    v_mfma_f32_32x32x16_bf16 v[64:79], v[144:147], a[196:199], v[64:79]
    v_sub_u32 v244, v244, v0
    v_cmp_gt_u32 s[100:101], 64, v244
    v_readlane_b32 s46, v244, 32
    s_bcnt1_i32_b32 s3, s100
    s_mul_i32 s3, s3, 3
    s_add_u32 s46, s46, 23
    s_cmp_lt_u32 s46, 128
    s_cselect_b32 s46, s46, 21
    s_add_u32 s3, s3, s46
    s_ashr_i32 s3, s3, 2
    s_add_i32 s3, s3, 2
    s_max_i32 s3, s3, 8
    s_min_i32 s100, s3, 32
    s_add_u32 s49, s49, s100
    s_lshr_b32 s34, s49, 4
    s_and_b32 s49, s49, 15
    s_cmp_ge_u32 s34, 2
    s_cselect_b64 vcc, -1, 0
    s_xor_b32 s57, s99, 917504
    s_add_u32 m0, s56, 24576
    s_cbranch_vccnz L_w2_649
    s_bitcmp1_b32 s34, 0
    s_cbranch_scc1 L_w1_649
    s_waitcnt vmcnt(4)
L_w1_649:
    s_waitcnt vmcnt(5)
L_w2_649:
    s_waitcnt vmcnt(7)
    buffer_load_dwordx4 v12, s[8:11], s57 offen offset:0 nt lds
    s_add_u32 m0, s67, 4096
    s_nop 0
    buffer_load_dwordx4 v60, s[20:23], s79 offen lds
    s_waitcnt lgkmcnt(4)
    v_mfma_f32_32x32x16_bf16 v[80:95], v[148:151], a[196:199], v[80:95]
    s_waitcnt lgkmcnt(2)
    v_mfma_f32_32x32x16_bf16 v[96:111], v[152:155], a[196:199], v[96:111]
    s_waitcnt lgkmcnt(0)
    v_mfma_f32_32x32x16_bf16 v[112:127], v[156:159], a[196:199], v[112:127]
    s_add_u32 m0, s56, 24576
    s_cbranch_vccnz L_w2_651
    s_bitcmp1_b32 s34, 0
    s_cbranch_scc1 L_w1_651
    s_waitcnt vmcnt(5)
L_w1_651:
    s_waitcnt vmcnt(6)
L_w2_651:
    s_waitcnt vmcnt(7)
    buffer_load_dwordx4 v12, s[8:11], s57 offen offset:1024 nt lds
    v_pk_mul_f32 v[64:65], v[64:65], v[186:187] op_sel_hi:[1,0]
    v_pk_mul_f32 v[66:67], v[66:67], v[186:187] op_sel_hi:[1,0]
    v_pk_mul_f32 v[68:69], v[68:69], v[186:187] op_sel_hi:[1,0]
    v_pk_mul_f32 v[70:71], v[70:71], v[186:187] op_sel_hi:[1,0]
    v_pk_mul_f32 v[72:73], v[72:73], v[186:187] op_sel_hi:[1,0]
    v_pk_mul_f32 v[74:75], v[74:75], v[186:187] op_sel_hi:[1,0]
    v_pk_mul_f32 v[76:77], v[76:77], v[186:187] op_sel_hi:[1,0]
    v_pk_mul_f32 v[78:79], v[78:79], v[186:187] op_sel_hi:[1,0]
    v_pk_mul_f32 v[80:81], v[80:81], v[186:187] op_sel_hi:[1,0]
    v_pk_mul_f32 v[82:83], v[82:83], v[186:187] op_sel_hi:[1,0]
    v_pk_mul_f32 v[84:85], v[84:85], v[186:187] op_sel_hi:[1,0]
    v_pk_mul_f32 v[86:87], v[86:87], v[186:187] op_sel_hi:[1,0]
    v_pk_mul_f32 v[88:89], v[88:89], v[186:187] op_sel_hi:[1,0]
    v_pk_mul_f32 v[90:91], v[90:91], v[186:187] op_sel_hi:[1,0]
    v_pk_mul_f32 v[92:93], v[92:93], v[186:187] op_sel_hi:[1,0]
    v_pk_mul_f32 v[94:95], v[94:95], v[186:187] op_sel_hi:[1,0]
    v_pk_mul_f32 v[96:97], v[96:97], v[186:187] op_sel_hi:[1,0]
    v_pk_mul_f32 v[98:99], v[98:99], v[186:187] op_sel_hi:[1,0]
    v_pk_mul_f32 v[100:101], v[100:101], v[186:187] op_sel_hi:[1,0]
    v_pk_mul_f32 v[102:103], v[102:103], v[186:187] op_sel_hi:[1,0]
    s_cbranch_vccnz L_w2_652
    s_bitcmp1_b32 s34, 0
    s_cbranch_scc1 L_w1_652
    s_waitcnt vmcnt(4)
L_w1_652:
    s_waitcnt vmcnt(6)
L_w2_652:
    s_waitcnt vmcnt(7)
    buffer_load_dwordx4 v12, s[8:11], s57 offen offset:2048 nt lds
    v_pk_mul_f32 v[104:105], v[104:105], v[186:187] op_sel_hi:[1,0]
    v_pk_mul_f32 v[106:107], v[106:107], v[186:187] op_sel_hi:[1,0]
    v_pk_mul_f32 v[108:109], v[108:109], v[186:187] op_sel_hi:[1,0]
    v_pk_mul_f32 v[110:111], v[110:111], v[186:187] op_sel_hi:[1,0]
    v_pk_mul_f32 v[112:113], v[112:113], v[186:187] op_sel_hi:[1,0]
    v_pk_mul_f32 v[114:115], v[114:115], v[186:187] op_sel_hi:[1,0]
    v_pk_mul_f32 v[116:117], v[116:117], v[186:187] op_sel_hi:[1,0]
    v_pk_mul_f32 v[118:119], v[118:119], v[186:187] op_sel_hi:[1,0]
    v_pk_mul_f32 v[120:121], v[120:121], v[186:187] op_sel_hi:[1,0]
    v_pk_mul_f32 v[122:123], v[122:123], v[186:187] op_sel_hi:[1,0]
    v_pk_mul_f32 v[124:125], v[124:125], v[186:187] op_sel_hi:[1,0]
    v_pk_mul_f32 v[126:127], v[126:127], v[186:187] op_sel_hi:[1,0]
    s_cbranch_vccnz L_w2_653
    s_bitcmp1_b32 s34, 0
    s_cbranch_scc1 L_w1_653
    s_waitcnt vmcnt(4)
L_w1_653:
    s_waitcnt vmcnt(5)
L_w2_653:
    s_waitcnt vmcnt(7)
    buffer_load_dwordx4 v12, s[8:11], s57 offen offset:3072 nt lds
    s_add_u32 s49, s49, s100
    s_lshr_b32 s34, s49, 4
    s_and_b32 s49, s49, 15
    s_cmp_ge_u32 s34, 2
    s_cselect_b64 vcc, -1, 0
    s_xor_b32 s57, s99, 921600
    s_add_u32 m0, s56, 28672
    s_cbranch_vccnz L_w2_654
    s_bitcmp1_b32 s34, 0
    s_cbranch_scc1 L_w1_654
    s_waitcnt vmcnt(4)
L_w1_654:
    s_waitcnt vmcnt(5)
L_w2_654:
    s_waitcnt vmcnt(6)
    buffer_load_dwordx4 v12, s[8:11], s57 offen offset:0 nt lds
    s_cbranch_vccnz L_w2_655
    s_bitcmp1_b32 s34, 0
    s_cbranch_scc1 L_w1_655
    s_waitcnt vmcnt(3)
L_w1_655:
    s_waitcnt vmcnt(5)
L_w2_655:
    s_waitcnt vmcnt(6)
    buffer_load_dwordx4 v12, s[8:11], s57 offen offset:1024 nt lds
    ds_read_b64_tr_b16 v[128:129], v24 offset:16384
    ds_read_b64_tr_b16 v[130:131], v24 offset:18432
    ds_read_b64_tr_b16 v[132:133], v25 offset:16384
    ds_read_b64_tr_b16 v[134:135], v25 offset:18432
    ds_read_b64_tr_b16 v[136:137], v26 offset:16384
    ds_read_b64_tr_b16 v[138:139], v26 offset:18432
    ds_read_b64_tr_b16 v[140:141], v27 offset:16384
    ds_read_b64_tr_b16 v[142:143], v27 offset:18432
    ds_read_b64_tr_b16 v[144:145], v24 offset:20480
    ds_read_b64_tr_b16 v[146:147], v24 offset:22528
    s_waitcnt lgkmcnt(8)
    v_mfma_f32_32x32x16_bf16 v[64:79], v[128:131], a[200:203], v[64:79]
    ds_read_b64_tr_b16 v[148:149], v25 offset:20480
    s_cbranch_vccnz L_w2_656
    s_bitcmp1_b32 s34, 0
    s_cbranch_scc1 L_w1_656
    s_waitcnt vmcnt(3)
L_w1_656:
    s_waitcnt vmcnt(4)
L_w2_656:
    s_waitcnt vmcnt(6)
    buffer_load_dwordx4 v12, s[8:11], s57 offen offset:2048 nt lds
    ds_read_b64_tr_b16 v[150:151], v25 offset:22528
    s_waitcnt lgkmcnt(8)
    v_mfma_f32_32x32x16_bf16 v[80:95], v[132:135], a[200:203], v[80:95]
    ds_read_b64_tr_b16 v[152:153], v26 offset:20480
    ds_read_b64_tr_b16 v[154:155], v26 offset:22528
    s_waitcnt lgkmcnt(8)
    v_mfma_f32_32x32x16_bf16 v[96:111], v[136:139], a[200:203], v[96:111]
    s_cbranch_vccnz L_w2_657
    s_bitcmp1_b32 s34, 0
    s_cbranch_scc1 L_w1_657
    s_waitcnt vmcnt(3)
L_w1_657:
    s_waitcnt vmcnt(4)
L_w2_657:
    s_waitcnt vmcnt(5)
    buffer_load_dwordx4 v12, s[8:11], s57 offen offset:3072 nt lds
    ds_read_b64_tr_b16 v[156:157], v27 offset:20480
    ds_read_b64_tr_b16 v[158:159], v27 offset:22528
    s_waitcnt lgkmcnt(8)
    v_mfma_f32_32x32x16_bf16 v[112:127], v[140:143], a[200:203], v[112:127]
    s_waitcnt lgkmcnt(6)
    v_mfma_f32_32x32x16_bf16 v[64:79], v[144:147], a[204:207], v[64:79]
    s_waitcnt lgkmcnt(4)
    v_mfma_f32_32x32x16_bf16 v[80:95], v[148:151], a[204:207], v[80:95]
    s_add_u32 s49, s49, s100
    s_lshr_b32 s34, s49, 4
    s_and_b32 s49, s49, 15
    s_cmp_ge_u32 s34, 2
    s_cselect_b64 vcc, -1, 0
    v_add_u32 v0, 1, v0
    s_mov_b64 exec, s[32:33]
    buffer_store_dword v0, v242, s[24:27], s35 offen
    s_mov_b64 exec, -1
    buffer_load_dword v244, v242, s[24:27], s35 offen sc1
    s_xor_b32 s57, s99, 262144
    s_add_u32 m0, s56, 0
    s_cbranch_vccnz L_w2_660
    s_bitcmp1_b32 s34, 0
    s_cbranch_scc1 L_w1_660
    s_waitcnt vmcnt(5)
L_w1_660:
    s_waitcnt vmcnt(6)
L_w2_660:
    s_waitcnt vmcnt(7)
    buffer_load_dwordx4 v12, s[8:11], s57 offen offset:0 nt lds
    s_waitcnt lgkmcnt(2)
    v_mfma_f32_32x32x16_bf16 v[96:111], v[152:155], a[204:207], v[96:111]
    s_waitcnt lgkmcnt(0)
    v_mfma_f32_32x32x16_bf16 v[112:127], v[156:159], a[204:207], v[112:127]
    v_pk_mul_f32 v[64:65], v[64:65], v[186:187] op_sel:[0,1] op_sel_hi:[1,1]
    v_pk_mul_f32 v[66:67], v[66:67], v[186:187] op_sel:[0,1] op_sel_hi:[1,1]
    v_pk_mul_f32 v[68:69], v[68:69], v[186:187] op_sel:[0,1] op_sel_hi:[1,1]
    v_pk_mul_f32 v[70:71], v[70:71], v[186:187] op_sel:[0,1] op_sel_hi:[1,1]
    v_pk_mul_f32 v[72:73], v[72:73], v[186:187] op_sel:[0,1] op_sel_hi:[1,1]
    v_pk_mul_f32 v[74:75], v[74:75], v[186:187] op_sel:[0,1] op_sel_hi:[1,1]
    v_pk_mul_f32 v[76:77], v[76:77], v[186:187] op_sel:[0,1] op_sel_hi:[1,1]
    v_pk_mul_f32 v[78:79], v[78:79], v[186:187] op_sel:[0,1] op_sel_hi:[1,1]
    s_cbranch_vccnz L_w2_661
    s_bitcmp1_b32 s34, 0
    s_cbranch_scc1 L_w1_661
    s_waitcnt vmcnt(5)
L_w1_661:
    s_waitcnt vmcnt(6)
L_w2_661:
    s_waitcnt vmcnt(7)
    buffer_load_dwordx4 v12, s[8:11], s57 offen offset:1024 nt lds
    v_pk_mul_f32 v[80:81], v[80:81], v[186:187] op_sel:[0,1] op_sel_hi:[1,1]
    v_pk_mul_f32 v[82:83], v[82:83], v[186:187] op_sel:[0,1] op_sel_hi:[1,1]
    v_pk_mul_f32 v[84:85], v[84:85], v[186:187] op_sel:[0,1] op_sel_hi:[1,1]
    v_pk_mul_f32 v[86:87], v[86:87], v[186:187] op_sel:[0,1] op_sel_hi:[1,1]
    v_pk_mul_f32 v[88:89], v[88:89], v[186:187] op_sel:[0,1] op_sel_hi:[1,1]
    v_pk_mul_f32 v[90:91], v[90:91], v[186:187] op_sel:[0,1] op_sel_hi:[1,1]
    v_pk_mul_f32 v[92:93], v[92:93], v[186:187] op_sel:[0,1] op_sel_hi:[1,1]
    v_pk_mul_f32 v[94:95], v[94:95], v[186:187] op_sel:[0,1] op_sel_hi:[1,1]
    v_pk_mul_f32 v[96:97], v[96:97], v[186:187] op_sel:[0,1] op_sel_hi:[1,1]
    v_pk_mul_f32 v[98:99], v[98:99], v[186:187] op_sel:[0,1] op_sel_hi:[1,1]
    v_pk_mul_f32 v[100:101], v[100:101], v[186:187] op_sel:[0,1] op_sel_hi:[1,1]
    v_pk_mul_f32 v[102:103], v[102:103], v[186:187] op_sel:[0,1] op_sel_hi:[1,1]
    v_pk_mul_f32 v[104:105], v[104:105], v[186:187] op_sel:[0,1] op_sel_hi:[1,1]
    v_pk_mul_f32 v[106:107], v[106:107], v[186:187] op_sel:[0,1] op_sel_hi:[1,1]
    v_pk_mul_f32 v[108:109], v[108:109], v[186:187] op_sel:[0,1] op_sel_hi:[1,1]
    v_pk_mul_f32 v[110:111], v[110:111], v[186:187] op_sel:[0,1] op_sel_hi:[1,1]
    v_pk_mul_f32 v[112:113], v[112:113], v[186:187] op_sel:[0,1] op_sel_hi:[1,1]
    v_pk_mul_f32 v[114:115], v[114:115], v[186:187] op_sel:[0,1] op_sel_hi:[1,1]
    v_pk_mul_f32 v[116:117], v[116:117], v[186:187] op_sel:[0,1] op_sel_hi:[1,1]
    v_pk_mul_f32 v[118:119], v[118:119], v[186:187] op_sel:[0,1] op_sel_hi:[1,1]
    v_pk_mul_f32 v[120:121], v[120:121], v[186:187] op_sel:[0,1] op_sel_hi:[1,1]
    v_pk_mul_f32 v[122:123], v[122:123], v[186:187] op_sel:[0,1] op_sel_hi:[1,1]
    v_pk_mul_f32 v[124:125], v[124:125], v[186:187] op_sel:[0,1] op_sel_hi:[1,1]
    v_pk_mul_f32 v[126:127], v[126:127], v[186:187] op_sel:[0,1] op_sel_hi:[1,1]
    ds_read_b64_tr_b16 a[110:111], v61 offset:0
    ds_read_b64_tr_b16 a[114:115], v61 offset:32
    s_cbranch_vccnz L_w2_662
    s_bitcmp1_b32 s34, 0
    s_cbranch_scc1 L_w1_662
    s_waitcnt vmcnt(5)
L_w1_662:
    s_waitcnt vmcnt(6)
L_w2_662:
    s_waitcnt vmcnt(7)
    buffer_load_dwordx4 v12, s[8:11], s57 offen offset:2048 nt lds
    ds_read_b64_tr_b16 a[118:119], v61 offset:64
    ds_read_b64_tr_b16 a[122:123], v61 offset:96
    ds_read_b64_tr_b16 a[126:127], v61 offset:128
    ds_read_b64_tr_b16 a[130:131], v61 offset:160
    ds_read_b64_tr_b16 a[134:135], v61 offset:192
    ds_read_b64_tr_b16 a[138:139], v61 offset:224
    ds_read_b64_tr_b16 a[142:143], v61 offset:256
    s_waitcnt lgkmcnt(0)
    s_cbranch_vccnz L_w2_663
    s_bitcmp1_b32 s34, 0
    s_cbranch_scc1 L_w1_663
    s_waitcnt vmcnt(5)
L_w1_663:
    s_waitcnt vmcnt(6)
L_w2_663:
    s_waitcnt vmcnt(7)
    buffer_load_dwordx4 v12, s[8:11], s57 offen offset:3072 nt lds
    s_add_u32 s49, s49, s100
    s_lshr_b32 s34, s49, 4
    s_and_b32 s49, s49, 15
    s_cmp_ge_u32 s34, 2
    s_cselect_b64 vcc, -1, 0
    s_xor_b32 s57, s99, 266240
    s_add_u32 m0, s56, 4096
    s_cbranch_vccnz L_w2_664
    s_bitcmp1_b32 s34, 0
    s_cbranch_scc1 L_w1_664
    s_waitcnt vmcnt(3)
L_w1_664:
    s_waitcnt vmcnt(6)
L_w2_664:
    s_waitcnt vmcnt(7)
    buffer_load_dwordx4 v12, s[8:11], s57 offen offset:0 nt lds
    s_cbranch_vccnz L_w2_665
    s_bitcmp1_b32 s34, 0
    s_cbranch_scc1 L_w1_665
    s_waitcnt vmcnt(3)
L_w1_665:
    s_waitcnt vmcnt(4)
L_w2_665:
    s_waitcnt vmcnt(7)
    buffer_load_dwordx4 v12, s[8:11], s57 offen offset:1024 nt lds
    ds_read_b64_tr_b16 v[128:129], v24 offset:24576
    ds_read_b64_tr_b16 v[130:131], v24 offset:26624
    ds_read_b64_tr_b16 v[132:133], v25 offset:24576
    ds_read_b64_tr_b16 v[134:135], v25 offset:26624
    ds_read_b64_tr_b16 v[136:137], v26 offset:24576
    ds_read_b64_tr_b16 v[138:139], v26 offset:26624
    ds_read_b64_tr_b16 v[140:141], v27 offset:24576
    ds_read_b64_tr_b16 v[142:143], v27 offset:26624
    ds_read_b64_tr_b16 v[144:145], v24 offset:28672
    ds_read_b64_tr_b16 v[146:147], v24 offset:30720
    s_waitcnt lgkmcnt(8)
    v_mfma_f32_32x32x16_bf16 v[64:79], v[128:131], a[208:211], v[64:79]
    ds_read_b64_tr_b16 v[148:149], v25 offset:28672
    s_cbranch_vccnz L_w2_666
    s_bitcmp1_b32 s34, 0
    s_cbranch_scc1 L_w1_666
    s_waitcnt vmcnt(3)
L_w1_666:
    s_waitcnt vmcnt(4)
L_w2_666:
    s_waitcnt vmcnt(5)
    buffer_load_dwordx4 v12, s[8:11], s57 offen offset:2048 nt lds
    ds_read_b64_tr_b16 v[150:151], v25 offset:30720
    s_waitcnt lgkmcnt(8)
    v_mfma_f32_32x32x16_bf16 v[80:95], v[132:135], a[208:211], v[80:95]
    ds_read_b64_tr_b16 v[152:153], v26 offset:28672
    ds_read_b64_tr_b16 v[154:155], v26 offset:30720
    s_waitcnt lgkmcnt(8)
    v_mfma_f32_32x32x16_bf16 v[96:111], v[136:139], a[208:211], v[96:111]
    s_cbranch_vccnz L_w2_667
    s_bitcmp1_b32 s34, 0
    s_cbranch_scc1 L_w1_667
    s_waitcnt vmcnt(3)
L_w1_667:
    s_waitcnt vmcnt(4)
L_w2_667:
    s_waitcnt vmcnt(5)
    buffer_load_dwordx4 v12, s[8:11], s57 offen offset:3072 nt lds
    ds_read_b64_tr_b16 v[156:157], v27 offset:28672
    ds_read_b64_tr_b16 v[158:159], v27 offset:30720
    s_waitcnt lgkmcnt(8)
    v_mfma_f32_32x32x16_bf16 v[112:127], v[140:143], a[208:211], v[112:127]
    s_waitcnt lgkmcnt(6)
    v_mfma_f32_32x32x16_bf16 v[64:79], v[144:147], a[212:215], v[64:79]
    v_sub_u32 v244, v244, v0
    v_cmp_gt_u32 s[100:101], 64, v244
    s_nop 0
    s_bcnt1_i32_b32 s3, s100
    s_mul_i32 s3, s3, 3
    s_ashr_i32 s3, s3, 2
    s_add_i32 s3, s3, 8
    s_max_i32 s3, s3, 8
    s_min_i32 s100, s3, 32
    s_add_u32 s49, s49, s100
    s_lshr_b32 s34, s49, 4
    s_and_b32 s49, s49, 15
    s_cmp_ge_u32 s34, 2
    s_cselect_b64 vcc, -1, 0
    s_xor_b32 s57, s99, 933888
    s_add_u32 m0, s56, 8192
    s_cbranch_vccnz L_w2_668
    s_bitcmp1_b32 s34, 0
    s_cbranch_scc1 L_w1_668
    s_waitcnt vmcnt(3)
L_w1_668:
    s_waitcnt vmcnt(4)
L_w2_668:
    s_waitcnt vmcnt(5)
    buffer_load_dwordx4 v12, s[8:11], s57 offen offset:0 nt lds
    s_waitcnt lgkmcnt(4)
    v_mfma_f32_32x32x16_bf16 v[80:95], v[148:151], a[212:215], v[80:95]
    s_waitcnt lgkmcnt(2)
    v_mfma_f32_32x32x16_bf16 v[96:111], v[152:155], a[212:215], v[96:111]
    s_waitcnt lgkmcnt(0)
    v_mfma_f32_32x32x16_bf16 v[112:127], v[156:159], a[212:215], v[112:127]
    s_cbranch_vccnz L_w2_669
    s_bitcmp1_b32 s34, 0
    s_cbranch_scc1 L_w1_669
    s_waitcnt vmcnt(3)
L_w1_669:
    s_waitcnt vmcnt(4)
L_w2_669:
    s_waitcnt vmcnt(5)
    buffer_load_dwordx4 v12, s[8:11], s57 offen offset:1024 nt lds
    v_pk_mul_f32 v[64:65], v[64:65], v[188:189] op_sel_hi:[1,0]
    v_pk_mul_f32 v[66:67], v[66:67], v[188:189] op_sel_hi:[1,0]
    v_pk_mul_f32 v[68:69], v[68:69], v[188:189] op_sel_hi:[1,0]
    v_pk_mul_f32 v[70:71], v[70:71], v[188:189] op_sel_hi:[1,0]
    v_pk_mul_f32 v[72:73], v[72:73], v[188:189] op_sel_hi:[1,0]
    v_pk_mul_f32 v[74:75], v[74:75], v[188:189] op_sel_hi:[1,0]
    v_pk_mul_f32 v[76:77], v[76:77], v[188:189] op_sel_hi:[1,0]
    v_pk_mul_f32 v[78:79], v[78:79], v[188:189] op_sel_hi:[1,0]
    v_pk_mul_f32 v[80:81], v[80:81], v[188:189] op_sel_hi:[1,0]
    v_pk_mul_f32 v[82:83], v[82:83], v[188:189] op_sel_hi:[1,0]
    v_pk_mul_f32 v[84:85], v[84:85], v[188:189] op_sel_hi:[1,0]
    v_pk_mul_f32 v[86:87], v[86:87], v[188:189] op_sel_hi:[1,0]
    v_pk_mul_f32 v[88:89], v[88:89], v[188:189] op_sel_hi:[1,0]
    v_pk_mul_f32 v[90:91], v[90:91], v[188:189] op_sel_hi:[1,0]
    v_pk_mul_f32 v[92:93], v[92:93], v[188:189] op_sel_hi:[1,0]
    v_pk_mul_f32 v[94:95], v[94:95], v[188:189] op_sel_hi:[1,0]
    v_pk_mul_f32 v[96:97], v[96:97], v[188:189] op_sel_hi:[1,0]
    v_pk_mul_f32 v[98:99], v[98:99], v[188:189] op_sel_hi:[1,0]
    v_pk_mul_f32 v[100:101], v[100:101], v[188:189] op_sel_hi:[1,0]
    v_pk_mul_f32 v[102:103], v[102:103], v[188:189] op_sel_hi:[1,0]
    s_cbranch_vccnz L_w2_670
    s_bitcmp1_b32 s34, 0
    s_cbranch_scc1 L_w1_670
    s_waitcnt vmcnt(3)
L_w1_670:
    s_waitcnt vmcnt(4)
L_w2_670:
    s_waitcnt vmcnt(5)
    buffer_load_dwordx4 v12, s[8:11], s57 offen offset:2048 nt lds
    v_pk_mul_f32 v[104:105], v[104:105], v[188:189] op_sel_hi:[1,0]
    v_pk_mul_f32 v[106:107], v[106:107], v[188:189] op_sel_hi:[1,0]
    v_pk_mul_f32 v[108:109], v[108:109], v[188:189] op_sel_hi:[1,0]
    v_pk_mul_f32 v[110:111], v[110:111], v[188:189] op_sel_hi:[1,0]
    v_pk_mul_f32 v[112:113], v[112:113], v[188:189] op_sel_hi:[1,0]
    v_pk_mul_f32 v[114:115], v[114:115], v[188:189] op_sel_hi:[1,0]
    v_pk_mul_f32 v[116:117], v[116:117], v[188:189] op_sel_hi:[1,0]
    v_pk_mul_f32 v[118:119], v[118:119], v[188:189] op_sel_hi:[1,0]
    v_pk_mul_f32 v[120:121], v[120:121], v[188:189] op_sel_hi:[1,0]
    v_pk_mul_f32 v[122:123], v[122:123], v[188:189] op_sel_hi:[1,0]
    v_pk_mul_f32 v[124:125], v[124:125], v[188:189] op_sel_hi:[1,0]
    v_pk_mul_f32 v[126:127], v[126:127], v[188:189] op_sel_hi:[1,0]
    s_cbranch_vccnz L_w2_671
    s_bitcmp1_b32 s34, 0
    s_cbranch_scc1 L_w1_671
    s_waitcnt vmcnt(3)
L_w1_671:
    s_waitcnt vmcnt(4)
L_w2_671:
    s_waitcnt vmcnt(5)
    buffer_load_dwordx4 v12, s[8:11], s57 offen offset:3072 nt lds
    s_add_u32 s49, s49, s100
    s_lshr_b32 s34, s49, 4
    s_and_b32 s49, s49, 15
    s_cmp_ge_u32 s34, 2
    s_cselect_b64 vcc, -1, 0
    s_xor_b32 s57, s99, 937984
    s_add_u32 m0, s56, 12288
    s_cbranch_vccnz L_w2_672
    s_bitcmp1_b32 s34, 0
    s_cbranch_scc1 L_w1_672
    s_waitcnt vmcnt(3)
L_w1_672:
    s_waitcnt vmcnt(4)
L_w2_672:
    s_waitcnt vmcnt(5)
    buffer_load_dwordx4 v12, s[8:11], s57 offen offset:0 nt lds
    s_cbranch_vccnz L_w2_673
    s_bitcmp1_b32 s34, 0
    s_cbranch_scc1 L_w1_673
    s_waitcnt vmcnt(3)
L_w1_673:
    s_waitcnt vmcnt(4)
L_w2_673:
    s_waitcnt vmcnt(5)
    buffer_load_dwordx4 v12, s[8:11], s57 offen offset:1024 nt lds
    ds_read_b64_tr_b16 v[128:129], v24 offset:0
    ds_read_b64_tr_b16 v[130:131], v24 offset:2048
    ds_read_b64_tr_b16 v[132:133], v25 offset:0
    ds_read_b64_tr_b16 v[134:135], v25 offset:2048
    ds_read_b64_tr_b16 v[136:137], v26 offset:0
    ds_read_b64_tr_b16 v[138:139], v26 offset:2048
    ds_read_b64_tr_b16 v[140:141], v27 offset:0
    ds_read_b64_tr_b16 v[142:143], v27 offset:2048
    ds_read_b64_tr_b16 v[144:145], v24 offset:4096
    ds_read_b64_tr_b16 v[146:147], v24 offset:6144
    s_waitcnt lgkmcnt(8)
    v_mfma_f32_32x32x16_bf16 v[64:79], v[128:131], a[216:219], v[64:79]
    ds_read_b64_tr_b16 v[148:149], v25 offset:4096
    s_cbranch_vccnz L_w2_674
    s_bitcmp1_b32 s34, 0
    s_cbranch_scc1 L_w1_674
    s_waitcnt vmcnt(3)
L_w1_674:
    s_waitcnt vmcnt(4)
L_w2_674:
    s_waitcnt vmcnt(5)
    buffer_load_dwordx4 v12, s[8:11], s57 offen offset:2048 nt lds
    ds_read_b64_tr_b16 v[150:151], v25 offset:6144
    s_waitcnt lgkmcnt(8)
    v_mfma_f32_32x32x16_bf16 v[80:95], v[132:135], a[216:219], v[80:95]
    ds_read_b64_tr_b16 v[152:153], v26 offset:4096
    ds_read_b64_tr_b16 v[154:155], v26 offset:6144
    s_waitcnt lgkmcnt(8)
    v_mfma_f32_32x32x16_bf16 v[96:111], v[136:139], a[216:219], v[96:111]
    s_cbranch_vccnz L_w2_675
    s_bitcmp1_b32 s34, 0
    s_cbranch_scc1 L_w1_675
    s_waitcnt vmcnt(3)
L_w1_675:
    s_waitcnt vmcnt(4)
L_w2_675:
    s_waitcnt vmcnt(5)
    buffer_load_dwordx4 v12, s[8:11], s57 offen offset:3072 nt lds
    ds_read_b64_tr_b16 v[156:157], v27 offset:4096
    ds_read_b64_tr_b16 v[158:159], v27 offset:6144
    s_waitcnt lgkmcnt(8)
    v_mfma_f32_32x32x16_bf16 v[112:127], v[140:143], a[216:219], v[112:127]
    s_waitcnt lgkmcnt(6)
    v_mfma_f32_32x32x16_bf16 v[64:79], v[144:147], a[220:223], v[64:79]
    s_add_u32 s49, s49, s100
    s_lshr_b32 s34, s49, 4
    s_and_b32 s49, s49, 15
    s_cmp_ge_u32 s34, 2
    s_cselect_b64 vcc, -1, 0
    s_xor_b32 s57, s99, 983040
    s_add_u32 m0, s56, 16384
    s_cbranch_vccnz L_w2_676
    s_bitcmp1_b32 s34, 0
    s_cbranch_scc1 L_w1_676
    s_waitcnt vmcnt(3)
L_w1_676:
    s_waitcnt vmcnt(4)
L_w2_676:
    s_waitcnt vmcnt(5)
    buffer_load_dwordx4 v12, s[8:11], s57 offen offset:0 nt lds
    s_waitcnt lgkmcnt(4)
    v_mfma_f32_32x32x16_bf16 v[80:95], v[148:151], a[220:223], v[80:95]
    s_waitcnt lgkmcnt(2)
    v_mfma_f32_32x32x16_bf16 v[96:111], v[152:155], a[220:223], v[96:111]
    s_waitcnt lgkmcnt(0)
    v_mfma_f32_32x32x16_bf16 v[112:127], v[156:159], a[220:223], v[112:127]
    s_cbranch_vccnz L_w2_677
    s_bitcmp1_b32 s34, 0
    s_cbranch_scc1 L_w1_677
    s_waitcnt vmcnt(3)
L_w1_677:
    s_waitcnt vmcnt(4)
L_w2_677:
    s_waitcnt vmcnt(5)
    buffer_load_dwordx4 v12, s[8:11], s57 offen offset:1024 nt lds
    v_pk_mul_f32 v[64:65], v[64:65], v[188:189] op_sel:[0,1] op_sel_hi:[1,1]
    v_pk_mul_f32 v[66:67], v[66:67], v[188:189] op_sel:[0,1] op_sel_hi:[1,1]
    v_pk_mul_f32 v[68:69], v[68:69], v[188:189] op_sel:[0,1] op_sel_hi:[1,1]
    v_pk_mul_f32 v[70:71], v[70:71], v[188:189] op_sel:[0,1] op_sel_hi:[1,1]
    v_pk_mul_f32 v[72:73], v[72:73], v[188:189] op_sel:[0,1] op_sel_hi:[1,1]
    v_pk_mul_f32 v[74:75], v[74:75], v[188:189] op_sel:[0,1] op_sel_hi:[1,1]
    v_pk_mul_f32 v[76:77], v[76:77], v[188:189] op_sel:[0,1] op_sel_hi:[1,1]
    v_pk_mul_f32 v[78:79], v[78:79], v[188:189] op_sel:[0,1] op_sel_hi:[1,1]
    v_pk_mul_f32 v[80:81], v[80:81], v[188:189] op_sel:[0,1] op_sel_hi:[1,1]
    v_pk_mul_f32 v[82:83], v[82:83], v[188:189] op_sel:[0,1] op_sel_hi:[1,1]
    v_pk_mul_f32 v[84:85], v[84:85], v[188:189] op_sel:[0,1] op_sel_hi:[1,1]
    v_pk_mul_f32 v[86:87], v[86:87], v[188:189] op_sel:[0,1] op_sel_hi:[1,1]
    v_pk_mul_f32 v[88:89], v[88:89], v[188:189] op_sel:[0,1] op_sel_hi:[1,1]
    v_pk_mul_f32 v[90:91], v[90:91], v[188:189] op_sel:[0,1] op_sel_hi:[1,1]
    v_pk_mul_f32 v[92:93], v[92:93], v[188:189] op_sel:[0,1] op_sel_hi:[1,1]
    v_pk_mul_f32 v[94:95], v[94:95], v[188:189] op_sel:[0,1] op_sel_hi:[1,1]
    v_pk_mul_f32 v[96:97], v[96:97], v[188:189] op_sel:[0,1] op_sel_hi:[1,1]
    v_pk_mul_f32 v[98:99], v[98:99], v[188:189] op_sel:[0,1] op_sel_hi:[1,1]
    v_pk_mul_f32 v[100:101], v[100:101], v[188:189] op_sel:[0,1] op_sel_hi:[1,1]
    v_pk_mul_f32 v[102:103], v[102:103], v[188:189] op_sel:[0,1] op_sel_hi:[1,1]
    s_cbranch_vccnz L_w2_678
    s_bitcmp1_b32 s34, 0
    s_cbranch_scc1 L_w1_678
    s_waitcnt vmcnt(3)
L_w1_678:
    s_waitcnt vmcnt(4)
L_w2_678:
    s_waitcnt vmcnt(5)
    buffer_load_dwordx4 v12, s[8:11], s57 offen offset:2048 nt lds
    v_pk_mul_f32 v[104:105], v[104:105], v[188:189] op_sel:[0,1] op_sel_hi:[1,1]
    v_pk_mul_f32 v[106:107], v[106:107], v[188:189] op_sel:[0,1] op_sel_hi:[1,1]
    v_pk_mul_f32 v[108:109], v[108:109], v[188:189] op_sel:[0,1] op_sel_hi:[1,1]
    v_pk_mul_f32 v[110:111], v[110:111], v[188:189] op_sel:[0,1] op_sel_hi:[1,1]
    v_pk_mul_f32 v[112:113], v[112:113], v[188:189] op_sel:[0,1] op_sel_hi:[1,1]
    v_pk_mul_f32 v[114:115], v[114:115], v[188:189] op_sel:[0,1] op_sel_hi:[1,1]
    v_pk_mul_f32 v[116:117], v[116:117], v[188:189] op_sel:[0,1] op_sel_hi:[1,1]
    v_pk_mul_f32 v[118:119], v[118:119], v[188:189] op_sel:[0,1] op_sel_hi:[1,1]
    v_pk_mul_f32 v[120:121], v[120:121], v[188:189] op_sel:[0,1] op_sel_hi:[1,1]
    v_pk_mul_f32 v[122:123], v[122:123], v[188:189] op_sel:[0,1] op_sel_hi:[1,1]
    v_pk_mul_f32 v[124:125], v[124:125], v[188:189] op_sel:[0,1] op_sel_hi:[1,1]
    v_pk_mul_f32 v[126:127], v[126:127], v[188:189] op_sel:[0,1] op_sel_hi:[1,1]
    s_cbranch_vccnz L_w2_679
    s_bitcmp1_b32 s34, 0
    s_cbranch_scc1 L_w1_679
    s_waitcnt vmcnt(3)
L_w1_679:
    s_waitcnt vmcnt(4)
L_w2_679:
    s_waitcnt vmcnt(5)
    buffer_load_dwordx4 v12, s[8:11], s57 offen offset:3072 nt lds
    s_add_u32 s49, s49, s100
    s_lshr_b32 s34, s49, 4
    s_and_b32 s49, s49, 15
    s_cmp_ge_u32 s34, 2
    s_cselect_b64 vcc, -1, 0
    s_xor_b32 s57, s99, 987136
    s_add_u32 m0, s56, 20480
    s_cbranch_vccnz L_w2_680
    s_bitcmp1_b32 s34, 0
    s_cbranch_scc1 L_w1_680
    s_waitcnt vmcnt(3)
L_w1_680:
    s_waitcnt vmcnt(4)
L_w2_680:
    s_waitcnt vmcnt(5)
    buffer_load_dwordx4 v12, s[8:11], s57 offen offset:0 nt lds
    s_cbranch_vccnz L_w2_681
    s_bitcmp1_b32 s34, 0
    s_cbranch_scc1 L_w1_681
    s_waitcnt vmcnt(3)
L_w1_681:
    s_waitcnt vmcnt(4)
L_w2_681:
    s_waitcnt vmcnt(5)
    buffer_load_dwordx4 v12, s[8:11], s57 offen offset:1024 nt lds
    ds_read_b64_tr_b16 v[128:129], v24 offset:8192
    ds_read_b64_tr_b16 v[130:131], v24 offset:10240
    ds_read_b64_tr_b16 v[132:133], v25 offset:8192
    ds_read_b64_tr_b16 v[134:135], v25 offset:10240
    ds_read_b64_tr_b16 v[136:137], v26 offset:8192
    ds_read_b64_tr_b16 v[138:139], v26 offset:10240
    ds_read_b64_tr_b16 v[140:141], v27 offset:8192
    ds_read_b64_tr_b16 v[142:143], v27 offset:10240
    ds_read_b64_tr_b16 v[144:145], v24 offset:12288
    ds_read_b64_tr_b16 v[146:147], v24 offset:14336
    s_waitcnt lgkmcnt(8)
    v_mfma_f32_32x32x16_bf16 v[64:79], v[128:131], a[224:227], v[64:79]
    ds_read_b64_tr_b16 v[148:149], v25 offset:12288
    ds_read_b64_tr_b16 v[150:151], v25 offset:14336
    s_waitcnt lgkmcnt(8)
    v_mfma_f32_32x32x16_bf16 v[80:95], v[132:135], a[224:227], v[80:95]
    s_cbranch_vccnz L_w2_682
    s_bitcmp1_b32 s34, 0
    s_cbranch_scc1 L_w1_682
    s_waitcnt vmcnt(3)
L_w1_682:
    s_waitcnt vmcnt(4)
L_w2_682:
    s_waitcnt vmcnt(5)
    buffer_load_dwordx4 v12, s[8:11], s57 offen offset:2048 nt lds
    ds_read_b64_tr_b16 v[152:153], v26 offset:12288
    ds_read_b64_tr_b16 v[154:155], v26 offset:14336
    s_waitcnt lgkmcnt(8)
    v_mfma_f32_32x32x16_bf16 v[96:111], v[136:139], a[224:227], v[96:111]
    ds_read_b64_tr_b16 v[156:157], v27 offset:12288
    ds_read_b64_tr_b16 v[158:159], v27 offset:14336
    s_waitcnt lgkmcnt(8)
    v_mfma_f32_32x32x16_bf16 v[112:127], v[140:143], a[224:227], v[112:127]
    s_waitcnt lgkmcnt(6)
    v_mfma_f32_32x32x16_bf16 v[64:79], v[144:147], a[228:231], v[64:79]
    s_cbranch_vccnz L_w2_683
    s_bitcmp1_b32 s34, 0
    s_cbranch_scc1 L_w1_683
    s_waitcnt vmcnt(3)
L_w1_683:
    s_waitcnt vmcnt(4)
L_w2_683:
    s_waitcnt vmcnt(5)
    buffer_load_dwordx4 v12, s[8:11], s57 offen offset:3072 nt lds
    s_waitcnt lgkmcnt(4)
    v_mfma_f32_32x32x16_bf16 v[80:95], v[148:151], a[228:231], v[80:95]
    s_waitcnt lgkmcnt(2)
    v_mfma_f32_32x32x16_bf16 v[96:111], v[152:155], a[228:231], v[96:111]
    s_waitcnt lgkmcnt(0)
    v_mfma_f32_32x32x16_bf16 v[112:127], v[156:159], a[228:231], v[112:127]
    s_xor_b32 s57, s99, 999424
    s_add_u32 m0, s56, 24576
    s_nop 0
    buffer_load_dwordx4 v12, s[8:11], s57 offen offset:0 nt lds
    v_pk_mul_f32 v[64:65], v[64:65], v[190:191] op_sel_hi:[1,0]
    v_pk_mul_f32 v[66:67], v[66:67], v[190:191] op_sel_hi:[1,0]
    v_pk_mul_f32 v[68:69], v[68:69], v[190:191] op_sel_hi:[1,0]
    v_pk_mul_f32 v[70:71], v[70:71], v[190:191] op_sel_hi:[1,0]
    v_pk_mul_f32 v[72:73], v[72:73], v[190:191] op_sel_hi:[1,0]
    v_pk_mul_f32 v[74:75], v[74:75], v[190:191] op_sel_hi:[1,0]
    v_pk_mul_f32 v[76:77], v[76:77], v[190:191] op_sel_hi:[1,0]
    v_pk_mul_f32 v[78:79], v[78:79], v[190:191] op_sel_hi:[1,0]
    v_pk_mul_f32 v[80:81], v[80:81], v[190:191] op_sel_hi:[1,0]
    v_pk_mul_f32 v[82:83], v[82:83], v[190:191] op_sel_hi:[1,0]
    v_pk_mul_f32 v[84:85], v[84:85], v[190:191] op_sel_hi:[1,0]
    v_pk_mul_f32 v[86:87], v[86:87], v[190:191] op_sel_hi:[1,0]
    v_pk_mul_f32 v[88:89], v[88:89], v[190:191] op_sel_hi:[1,0]
    v_pk_mul_f32 v[90:91], v[90:91], v[190:191] op_sel_hi:[1,0]
    v_pk_mul_f32 v[92:93], v[92:93], v[190:191] op_sel_hi:[1,0]
    v_pk_mul_f32 v[94:95], v[94:95], v[190:191] op_sel_hi:[1,0]
    v_pk_mul_f32 v[96:97], v[96:97], v[190:191] op_sel_hi:[1,0]
    v_pk_mul_f32 v[98:99], v[98:99], v[190:191] op_sel_hi:[1,0]
    v_pk_mul_f32 v[100:101], v[100:101], v[190:191] op_sel_hi:[1,0]
    v_pk_mul_f32 v[102:103], v[102:103], v[190:191] op_sel_hi:[1,0]
    v_pk_mul_f32 v[104:105], v[104:105], v[190:191] op_sel_hi:[1,0]
    v_pk_mul_f32 v[106:107], v[106:107], v[190:191] op_sel_hi:[1,0]
    v_pk_mul_f32 v[108:109], v[108:109], v[190:191] op_sel_hi:[1,0]
    v_pk_mul_f32 v[110:111], v[110:111], v[190:191] op_sel_hi:[1,0]
    v_pk_mul_f32 v[112:113], v[112:113], v[190:191] op_sel_hi:[1,0]
    v_pk_mul_f32 v[114:115], v[114:115], v[190:191] op_sel_hi:[1,0]
    buffer_load_dwordx4 v12, s[8:11], s57 offen offset:1024 nt lds
    v_pk_mul_f32 v[116:117], v[116:117], v[190:191] op_sel_hi:[1,0]
    v_pk_mul_f32 v[118:119], v[118:119], v[190:191] op_sel_hi:[1,0]
    v_pk_mul_f32 v[120:121], v[120:121], v[190:191] op_sel_hi:[1,0]
    v_pk_mul_f32 v[122:123], v[122:123], v[190:191] op_sel_hi:[1,0]
    v_pk_mul_f32 v[124:125], v[124:125], v[190:191] op_sel_hi:[1,0]
    v_pk_mul_f32 v[126:127], v[126:127], v[190:191] op_sel_hi:[1,0]
    v_add_u32 v1, s56, v248
    v_add_u32 v2, s67, v248
    ds_write_b128 v2, v[32:35] offset:0
    ds_write_b128 v2, v[36:39] offset:1024
    ds_write_b128 v2, v[48:51] offset:2048
    ds_write_b128 v2, v[52:55] offset:3072
    ds_write_b128 v1, v[64:67] offset:0
    ds_write_b128 v1, v[68:71] offset:1024
    ds_write_b128 v1, v[72:75] offset:2048
    ds_write_b128 v1, v[76:79] offset:3072
    ds_write_b128 v1, v[80:83] offset:4096
    ds_write_b128 v1, v[84:87] offset:5120
    s_waitcnt lgkmcnt(4)
    ds_write_b128 v1, v[88:91] offset:6144
    ds_write_b128 v1, v[92:95] offset:7168
    ds_write_b128 v1, v[96:99] offset:8192
    ds_write_b128 v1, v[100:103] offset:9216
    ds_write_b128 v1, v[104:107] offset:10240
    ds_write_b128 v1, v[108:111] offset:11264
    s_waitcnt lgkmcnt(4)
    s_waitcnt vmcnt(7)
    buffer_load_dwordx4 v12, s[8:11], s57 offen offset:2048 nt lds
    ds_write_b128 v1, v[112:115] offset:12288
    ds_write_b128 v1, v[116:119] offset:13312
    ds_write_b128 v1, v[120:123] offset:14336
    ds_write_b128 v1, v[124:127] offset:15360
    v_add_u32 v16, 0x10000, v239
    v_add_u32 v17, 0x10000, v240
    v_add_u32 v18, 0x10000, v241
    s_mul_i32 s3, s53, 1184
    v_add_u32 v19, s3, v248
    v_add_u32 v20, 0x10000, v19
    v_lshlrev_b32 v21, 11, v254
    v_lshlrev_b32 v22, 3, v254
    s_lshl_b32 s75, s63, 9
    s_add_u32 s75, s75, 131456
    s_and_b32 s3, s63, 0xe3
    s_lshl_b32 s3, s3, 9
    s_add_u32 s71, s3, 131456
    s_add_u32 s68, s74, 8192
    s_add_u32 s69, s74, 12800
    s_lshl_b32 s3, 1, s53
    s_andn2_b32 s76, 0xff, s3
    s_waitcnt vmcnt(7)
    buffer_load_dwordx4 v12, s[8:11], s57 offen offset:3072 nt lds
    s_lshl_b32 s3, s54, 3
    s_add_u32 s3, s3, s53
    s_mul_i32 s70, s3, 2304
    s_mul_i32 s3, s55, 288
    s_add_u32 s70, s70, s3
    s_lshl_b32 s3, s52, 12
    v_add_u32 v2, s3, v248
    v_add_u32 v3, 0x10000, v2
    v_add_u32 v4, 131072, v248
    s_lshl_b32 s3, s52, 6
    v_xor_b32 v5, s3, v24
    v_subrev_u32 v5, s56, v5
    v_add_u32 v6, 0x10000, v5
    v_mul_u32_u24 v1, 592, v250
    v_lshl_add_u32 v1, v253, 4, v1
    v_and_b32 v7, 1, v251
    v_mul_u32_u24 v7, 288, v7
    v_add3_u32 v1, v1, v7, s56
    s_and_b32 s69, s52, 1
    s_lshl_b32 s3, s53, 1
    s_add_u32 s3, s3, s69
    s_mul_i32 s3, s3, 592
    v_lshrrev_b32 v19, 1, v254
    v_lshlrev_b32 v19, 4, v19
    v_and_b32 v7, 1, v254
    v_mul_u32_u24 v7, 288, v7
    v_add3_u32 v19, v19, v7, s3
    v_add_u32 v20, 0x10000, v19
    s_mul_i32 s3, s69, 288
    s_add_u32 s68, s68, s3
    s_mul_i32 s3, s69, 1152
    s_add_u32 s70, s70, s3
    s_mov_b32 s69, 0xffff0000
    s_xor_b32 s57, s99, 1003520
    s_add_u32 m0, s56, 28672
    s_waitcnt vmcnt(7)
    buffer_load_dwordx4 v12, s[8:11], s57 offen offset:0 nt lds
    s_waitcnt vmcnt(7)
    buffer_load_dwordx4 v12, s[8:11], s57 offen offset:1024 nt lds
    s_waitcnt vmcnt(7)
    buffer_load_dwordx4 v12, s[8:11], s57 offen offset:2048 nt lds
    s_waitcnt vmcnt(7)
    buffer_load_dwordx4 v12, s[8:11], s57 offen offset:3072 nt lds
    s_waitcnt lgkmcnt(0)
    s_barrier
    ds_read_b128 v[64:67], v2 offset:0
    ds_read_b128 v[80:83], v2 offset:32768
    ds_read_b128 v[96:99], v3 offset:0
    ds_read_b128 v[112:115], v3 offset:32768
    ds_read_b128 v[68:71], v2 offset:1024
    ds_read_b128 v[84:87], v2 offset:33792
    ds_read_b128 v[100:103], v3 offset:1024
    ds_read_b128 v[116:119], v3 offset:33792
    ds_read_b128 v[72:75], v2 offset:2048
    ds_read_b128 v[88:91], v2 offset:34816
    ds_read_b128 v[104:107], v3 offset:2048
    ds_read_b128 v[120:123], v3 offset:34816
    s_waitcnt lgkmcnt(8)
    ds_read_b128 v[76:79], v2 offset:3072
    ds_read_b128 v[92:95], v2 offset:35840
    ds_read_b128 v[108:111], v3 offset:3072
    ds_read_b128 v[124:127], v3 offset:35840
    s_waitcnt lgkmcnt(8)
    ds_read_b128 a[144:147], v4 offset:0
    ds_read_b128 a[148:151], v4 offset:1024
    ds_read_b128 a[152:155], v4 offset:5120
    ds_read_b128 a[156:159], v4 offset:6144
    s_waitcnt lgkmcnt(8)
    v_pk_add_f32 v[64:65], v[64:65], v[80:81]
    v_pk_add_f32 v[96:97], v[96:97], v[112:113]
    v_pk_add_f32 v[66:67], v[66:67], v[82:83]
    v_pk_add_f32 v[98:99], v[98:99], v[114:115]
    v_pk_add_f32 v[64:65], v[64:65], v[96:97]
    v_pk_add_f32 v[66:67], v[66:67], v[98:99]
    ds_read_b128 a[160:163], v4 offset:10240
    ds_read_b128 a[164:167], v4 offset:11264
    ds_read_b128 a[168:171], v4 offset:15360
    ds_read_b128 a[172:175], v4 offset:16384
    s_waitcnt lgkmcnt(8)
    v_pk_add_f32 v[68:69], v[68:69], v[84:85]
    v_pk_add_f32 v[100:101], v[100:101], v[116:117]
    v_pk_add_f32 v[70:71], v[70:71], v[86:87]
    v_pk_add_f32 v[102:103], v[102:103], v[118:119]
    v_pk_add_f32 v[68:69], v[68:69], v[100:101]
    v_pk_add_f32 v[70:71], v[70:71], v[102:103]
    ds_read_b128 a[176:179], v4 offset:2048
    ds_read_b128 a[180:183], v4 offset:3072
    ds_read_b128 a[184:187], v4 offset:7168
    ds_read_b128 a[188:191], v4 offset:8192
    s_waitcnt lgkmcnt(8)
    v_pk_add_f32 v[72:73], v[72:73], v[88:89]
    v_pk_add_f32 v[104:105], v[104:105], v[120:121]
    v_pk_add_f32 v[74:75], v[74:75], v[90:91]
    v_pk_add_f32 v[106:107], v[106:107], v[122:123]
    v_pk_add_f32 v[72:73], v[72:73], v[104:105]
    v_pk_add_f32 v[74:75], v[74:75], v[106:107]
    ds_read_b128 a[192:195], v4 offset:12288
    ds_read_b128 a[196:199], v4 offset:13312
    ds_read_b128 a[200:203], v4 offset:17408
    ds_read_b128 a[204:207], v4 offset:18432
    s_waitcnt lgkmcnt(8)
    v_pk_add_f32 v[76:77], v[76:77], v[92:93]
    v_pk_add_f32 v[108:109], v[108:109], v[124:125]
    v_pk_add_f32 v[78:79], v[78:79], v[94:95]
    v_pk_add_f32 v[110:111], v[110:111], v[126:127]
    v_pk_add_f32 v[76:77], v[76:77], v[108:109]
    v_pk_add_f32 v[78:79], v[78:79], v[110:111]
    s_waitcnt lgkmcnt(4)
    ds_read_b64_tr_b16 v[128:129], v5 offset:16384
    ds_read_b64_tr_b16 v[130:131], v5 offset:18432
    ds_read_b64_tr_b16 v[132:133], v5 offset:49152
    ds_read_b64_tr_b16 v[134:135], v5 offset:51200
    ds_read_b64_tr_b16 v[136:137], v6 offset:16384
    ds_read_b64_tr_b16 v[138:139], v6 offset:18432
    ds_read_b64_tr_b16 v[140:141], v6 offset:49152
    ds_read_b64_tr_b16 v[142:143], v6 offset:51200
    ds_read_b64_tr_b16 v[144:145], v5 offset:20480
    ds_read_b64_tr_b16 v[146:147], v5 offset:22528
    s_waitcnt lgkmcnt(8)
    v_mfma_f32_32x32x16_bf16 v[64:79], v[128:131], a[144:147], v[64:79]
    ds_read_b64_tr_b16 v[148:149], v5 offset:53248
    ds_read_b64_tr_b16 v[150:151], v5 offset:55296
    s_waitcnt lgkmcnt(8)
    v_mfma_f32_32x32x16_bf16 v[64:79], v[132:135], a[152:155], v[64:79]
    ds_read_b64_tr_b16 v[152:153], v6 offset:20480
    ds_read_b64_tr_b16 v[154:155], v6 offset:22528
    s_waitcnt lgkmcnt(8)
    v_mfma_f32_32x32x16_bf16 v[64:79], v[136:139], a[160:163], v[64:79]
    ds_read_b64_tr_b16 v[156:157], v6 offset:53248
    ds_read_b64_tr_b16 v[158:159], v6 offset:55296
    s_waitcnt lgkmcnt(8)
    v_mfma_f32_32x32x16_bf16 v[64:79], v[140:143], a[168:171], v[64:79]
    s_waitcnt lgkmcnt(6)
    v_mfma_f32_32x32x16_bf16 v[64:79], v[144:147], a[148:151], v[64:79]
    s_waitcnt lgkmcnt(4)
    v_mfma_f32_32x32x16_bf16 v[64:79], v[148:151], a[156:159], v[64:79]
    s_waitcnt lgkmcnt(2)
    v_mfma_f32_32x32x16_bf16 v[64:79], v[152:155], a[164:167], v[64:79]
    s_waitcnt lgkmcnt(0)
    v_mfma_f32_32x32x16_bf16 v[64:79], v[156:159], a[172:175], v[64:79]
    s_waitcnt vmcnt(4)
    s_barrier
    ds_read_b64_tr_b16 v[128:129], v5 offset:24576
    ds_read_b64_tr_b16 v[130:131], v5 offset:26624
    ds_read_b64_tr_b16 v[132:133], v5 offset:57344
    ds_read_b64_tr_b16 v[134:135], v5 offset:59392
    ds_read_b64_tr_b16 v[136:137], v6 offset:24576
    ds_read_b64_tr_b16 v[138:139], v6 offset:26624
    ds_read_b64_tr_b16 v[140:141], v6 offset:57344
    ds_read_b64_tr_b16 v[142:143], v6 offset:59392
    s_waitcnt lgkmcnt(6)
    v_mfma_f32_32x32x16_bf16 v[64:79], v[128:131], a[176:179], v[64:79]
    s_waitcnt lgkmcnt(4)
    v_mfma_f32_32x32x16_bf16 v[64:79], v[132:135], a[184:187], v[64:79]
    s_waitcnt lgkmcnt(2)
    v_mfma_f32_32x32x16_bf16 v[64:79], v[136:139], a[192:195], v[64:79]
    s_waitcnt lgkmcnt(0)
    v_mfma_f32_32x32x16_bf16 v[64:79], v[140:143], a[200:203], v[64:79]
    s_waitcnt vmcnt(0)
    s_barrier
    ds_read_b64_tr_b16 v[144:145], v5 offset:28672
    ds_read_b64_tr_b16 v[146:147], v5 offset:30720
    ds_read_b64_tr_b16 v[148:149], v5 offset:61440
    ds_read_b64_tr_b16 v[150:151], v5 offset:63488
    ds_read_b64_tr_b16 v[152:153], v6 offset:28672
    ds_read_b64_tr_b16 v[154:155], v6 offset:30720
    ds_read_b64_tr_b16 v[156:157], v6 offset:61440
    ds_read_b64_tr_b16 v[158:159], v6 offset:63488
    s_waitcnt lgkmcnt(6)
    v_mfma_f32_32x32x16_bf16 v[64:79], v[144:147], a[180:183], v[64:79]
    s_waitcnt lgkmcnt(4)
    v_mfma_f32_32x32x16_bf16 v[64:79], v[148:151], a[188:191], v[64:79]
    s_waitcnt lgkmcnt(2)
    v_mfma_f32_32x32x16_bf16 v[64:79], v[152:155], a[196:199], v[64:79]
    s_waitcnt lgkmcnt(0)
    v_mfma_f32_32x32x16_bf16 v[64:79], v[156:159], a[204:207], v[64:79]
    s_cmp_lg_u32 s48, 0
    s_nop 10
    v_cvt_pk_bf16_f32 v32, v64, v65
    v_cvt_pk_bf16_f32 v36, v72, v73
    v_cvt_pk_bf16_f32 v33, v66, v67
    v_cvt_pk_bf16_f32 v37, v74, v75
    v_cvt_pk_bf16_f32 v34, v68, v69
    v_cvt_pk_bf16_f32 v38, v76, v77
    v_cvt_pk_bf16_f32 v35, v70, v71
    v_cvt_pk_bf16_f32 v39, v78, v79
    v_permlane16_swap_b32 v32, v36
    v_permlane16_swap_b32 v33, v37
    v_permlane16_swap_b32 v34, v38
    v_permlane16_swap_b32 v35, v39
    s_cbranch_scc1 L_far
    buffer_store_dwordx4 v[32:35], v248, s[24:27], s73 offen offset:0
    buffer_store_dwordx4 v[36:39], v248, s[24:27], s73 offen offset:1024
    s_branch L_pub
L_far:
    buffer_store_dwordx4 v[32:35], v248, s[24:27], s73 offen offset:0 sc1
    buffer_store_dwordx4 v[36:39], v248, s[24:27], s73 offen offset:1024 sc1
L_pub:
    buffer_load_dwordx4 v[196:199], v248, s[24:27], s96 offen offset:0 sc1
    buffer_load_dwordx4 v[200:203], v248, s[24:27], s96 offen offset:1024 sc1
    buffer_load_dwordx4 v[204:207], v248, s[24:27], s97 offen offset:0 sc1
    buffer_load_dwordx4 v[208:211], v248, s[24:27], s97 offen offset:1024 sc1
    buffer_load_dwordx4 v[212:215], v248, s[24:27], s98 offen offset:0 sc1
    buffer_load_dwordx4 v[216:219], v248, s[24:27], s98 offen offset:1024 sc1
    v_mfma_f32_16x16x32_bf16 v[160:163], a[0:3], v[32:35], 0
    v_mfma_f32_16x16x32_bf16 v[160:163], a[36:39], v[36:39], v[160:163]
    v_mfma_f32_16x16x32_bf16 v[164:167], a[4:7], v[32:35], 0
    v_mfma_f32_16x16x32_bf16 v[164:167], a[40:43], v[36:39], v[164:167]
    v_mfma_f32_16x16x32_bf16 v[168:171], a[8:11], v[32:35], 0
    v_mfma_f32_16x16x32_bf16 v[168:171], a[44:47], v[36:39], v[168:171]
    v_mfma_f32_16x16x32_bf16 v[172:175], a[12:15], v[32:35], 0
    v_mfma_f32_16x16x32_bf16 v[172:175], a[48:51], v[36:39], v[172:175]
    v_mfma_f32_16x16x32_bf16 v[176:179], a[16:19], v[32:35], 0
    v_mfma_f32_16x16x32_bf16 v[176:179], a[52:55], v[36:39], v[176:179]
    v_mfma_f32_16x16x32_bf16 v[180:183], a[20:23], v[32:35], 0
    v_mfma_f32_16x16x32_bf16 v[180:183], a[56:59], v[36:39], v[180:183]
    v_mfma_f32_16x16x32_bf16 v[184:187], a[24:27], v[32:35], 0
    v_mfma_f32_16x16x32_bf16 v[184:187], a[60:63], v[36:39], v[184:187]
    v_mfma_f32_16x16x32_bf16 v[188:191], a[28:31], v[32:35], 0
    v_mfma_f32_16x16x32_bf16 v[188:191], a[64:67], v[36:39], v[188:191]
    v_mfma_f32_16x16x32_bf16 v[192:195], a[32:35], v[32:35], 0
    v_mfma_f32_16x16x32_bf16 v[192:195], a[68:71], v[36:39], v[192:195]
L_p1:
    s_waitcnt vmcnt(4)
    v_max3_u32 v2, v196, v197, 0
    v_max3_u32 v3, v198, v199, 0
    v_max3_u32 v2, v200, v201, v2
    v_max3_u32 v3, v202, v203, v3
    s_waitcnt vmcnt(2)
    v_max3_u32 v2, v204, v205, v2
    v_max3_u32 v3, v206, v207, v3
    v_max3_u32 v2, v208, v209, v2
    v_max3_u32 v3, v210, v211, v3
    s_waitcnt vmcnt(0)
    v_max3_u32 v2, v212, v213, v2
    v_max3_u32 v3, v214, v215, v3
    v_max3_u32 v2, v216, v217, v2
    v_max3_u32 v3, v218, v219, v3
    v_max_u32 v2, v2, v3
    v_cmp_eq_u32 vcc, -1, v2
    s_cbranch_vccz L_p1_ok
    s_sub_u32 s66, s66, 1
    s_and_b32 s3, s66, 63
    s_cbranch_scc1 L_p1r
    s_mov_b64 exec, 1
    buffer_atomic_add v243, off, s[24:27], s78
    s_mov_b64 exec, -1
    s_cmp_gt_i32 s66, 0
    s_cbranch_scc0 L_p1_ok
L_p1r:
    buffer_load_dwordx4 v[196:199], v248, s[24:27], s96 offen offset:0 sc1
    buffer_load_dwordx4 v[200:203], v248, s[24:27], s96 offen offset:1024 sc1
    buffer_load_dwordx4 v[204:207], v248, s[24:27], s97 offen offset:0 sc1
    buffer_load_dwordx4 v[208:211], v248, s[24:27], s97 offen offset:1024 sc1
    buffer_load_dwordx4 v[212:215], v248, s[24:27], s98 offen offset:0 sc1
    buffer_load_dwordx4 v[216:219], v248, s[24:27], s98 offen offset:1024 sc1
    s_branch L_p1
L_p1_ok:
    v_mfma_f32_16x16x32_bf16 v[160:163], a[0:3], v[196:199], v[160:163]
    v_mfma_f32_16x16x32_bf16 v[160:163], a[36:39], v[200:203], v[160:163]
    v_mfma_f32_16x16x32_bf16 v[160:163], a[72:75], v[204:207], v[160:163]
    v_mfma_f32_16x16x32_bf16 v[160:163], a[108:111], v[208:211], v[160:163]
    v_mfma_f32_16x16x32_bf16 v[160:163], a[72:75], v[212:215], v[160:163]
    v_mfma_f32_16x16x32_bf16 v[160:163], a[108:111], v[216:219], v[160:163]
    v_mfma_f32_16x16x32_bf16 v[164:167], a[4:7], v[196:199], v[164:167]
    v_mfma_f32_16x16x32_bf16 v[164:167], a[40:43], v[200:203], v[164:167]
    v_mfma_f32_16x16x32_bf16 v[164:167], a[76:79], v[204:207], v[164:167]
    v_mfma_f32_16x16x32_bf16 v[164:167], a[112:115], v[208:211], v[164:167]
    v_mfma_f32_16x16x32_bf16 v[164:167], a[76:79], v[212:215], v[164:167]
    v_mfma_f32_16x16x32_bf16 v[164:167], a[112:115], v[216:219], v[164:167]
    v_mfma_f32_16x16x32_bf16 v[168:171], a[8:11], v[196:199], v[168:171]
    v_mfma_f32_16x16x32_bf16 v[168:171], a[44:47], v[200:203], v[168:171]
    v_mfma_f32_16x16x32_bf16 v[168:171], a[80:83], v[204:207], v[168:171]
    v_mfma_f32_16x16x32_bf16 v[168:171], a[116:119], v[208:211], v[168:171]
    v_mfma_f32_16x16x32_bf16 v[168:171], a[80:83], v[212:215], v[168:171]
    v_mfma_f32_16x16x32_bf16 v[168:171], a[116:119], v[216:219], v[168:171]
    ds_write_b128 v1, v[160:163] offset:0
    v_mfma_f32_16x16x32_bf16 v[172:175], a[12:15], v[196:199], v[172:175]
    v_mfma_f32_16x16x32_bf16 v[172:175], a[48:51], v[200:203], v[172:175]
    v_mfma_f32_16x16x32_bf16 v[172:175], a[84:87], v[204:207], v[172:175]
    v_mfma_f32_16x16x32_bf16 v[172:175], a[120:123], v[208:211], v[172:175]
    v_mfma_f32_16x16x32_bf16 v[172:175], a[84:87], v[212:215], v[172:175]
    v_mfma_f32_16x16x32_bf16 v[172:175], a[120:123], v[216:219], v[172:175]
    ds_write_b128 v1, v[164:167] offset:32
    v_mfma_f32_16x16x32_bf16 v[176:179], a[16:19], v[196:199], v[176:179]
    v_mfma_f32_16x16x32_bf16 v[176:179], a[52:55], v[200:203], v[176:179]
    v_mfma_f32_16x16x32_bf16 v[176:179], a[88:91], v[204:207], v[176:179]
    v_mfma_f32_16x16x32_bf16 v[176:179], a[124:127], v[208:211], v[176:179]
    v_mfma_f32_16x16x32_bf16 v[176:179], a[88:91], v[212:215], v[176:179]
    v_mfma_f32_16x16x32_bf16 v[176:179], a[124:127], v[216:219], v[176:179]
    ds_write_b128 v1, v[168:171] offset:64
    v_mfma_f32_16x16x32_bf16 v[180:183], a[20:23], v[196:199], v[180:183]
    v_mfma_f32_16x16x32_bf16 v[180:183], a[56:59], v[200:203], v[180:183]
    v_mfma_f32_16x16x32_bf16 v[180:183], a[92:95], v[204:207], v[180:183]
    v_mfma_f32_16x16x32_bf16 v[180:183], a[128:131], v[208:211], v[180:183]
    v_mfma_f32_16x16x32_bf16 v[180:183], a[92:95], v[212:215], v[180:183]
    v_mfma_f32_16x16x32_bf16 v[180:183], a[128:131], v[216:219], v[180:183]
    ds_write_b128 v1, v[172:175] offset:96
    v_mfma_f32_16x16x32_bf16 v[184:187], a[24:27], v[196:199], v[184:187]
    v_mfma_f32_16x16x32_bf16 v[184:187], a[60:63], v[200:203], v[184:187]
    v_mfma_f32_16x16x32_bf16 v[184:187], a[96:99], v[204:207], v[184:187]
    v_mfma_f32_16x16x32_bf16 v[184:187], a[132:135], v[208:211], v[184:187]
    v_mfma_f32_16x16x32_bf16 v[184:187], a[96:99], v[212:215], v[184:187]
    v_mfma_f32_16x16x32_bf16 v[184:187], a[132:135], v[216:219], v[184:187]
    ds_write_b128 v1, v[176:179] offset:128
    s_cmp_lg_u32 s52, 0
    s_cbranch_scc1 L_nh
    s_mov_b64 exec, 1
    buffer_store_dword v243, off, s[24:27], s75 sc1
    s_mov_b64 exec, -1
L_nh:
    v_mfma_f32_16x16x32_bf16 v[188:191], a[28:31], v[196:199], v[188:191]
    v_mfma_f32_16x16x32_bf16 v[188:191], a[64:67], v[200:203], v[188:191]
    v_mfma_f32_16x16x32_bf16 v[188:191], a[100:103], v[204:207], v[188:191]
    v_mfma_f32_16x16x32_bf16 v[188:191], a[136:139], v[208:211], v[188:191]
    v_mfma_f32_16x16x32_bf16 v[188:191], a[100:103], v[212:215], v[188:191]
    v_mfma_f32_16x16x32_bf16 v[188:191], a[136:139], v[216:219], v[188:191]
    ds_write_b128 v1, v[180:183] offset:160
    v_mfma_f32_16x16x32_bf16 v[192:195], a[32:35], v[196:199], v[192:195]
    v_mfma_f32_16x16x32_bf16 v[192:195], a[68:71], v[200:203], v[192:195]
    v_mfma_f32_16x16x32_bf16 v[192:195], a[104:107], v[204:207], v[192:195]
    v_mfma_f32_16x16x32_bf16 v[192:195], a[140:143], v[208:211], v[192:195]
    v_mfma_f32_16x16x32_bf16 v[192:195], a[104:107], v[212:215], v[192:195]
    v_mfma_f32_16x16x32_bf16 v[192:195], a[140:143], v[216:219], v[192:195]
    ds_write_b128 v1, v[184:187] offset:192
    ds_write_b128 v1, v[188:191] offset:224
    s_nop 5
    ds_write_b128 v1, v[192:195] offset:256
    s_cmp_ge_u32 s52, 2
    s_cbranch_scc1 L_fw
    s_waitcnt lgkmcnt(0)
    s_barrier
    ds_read_b128 v[64:67], v239 offset:0
    ds_read_b128 v[68:71], v239 offset:32768
    ds_read_b128 v[72:75], v16 offset:0
    ds_read_b128 v[76:79], v16 offset:32768
    ds_read_b128 v[80:83], v239 offset:288
    ds_read_b128 v[84:87], v239 offset:33056
    ds_read_b128 v[88:91], v16 offset:288
    ds_read_b128 v[92:95], v16 offset:33056
    ds_read_b128 v[96:99], v240 offset:0
    ds_read_b128 v[100:103], v240 offset:32768
    ds_read_b128 v[104:107], v17 offset:0
    ds_read_b128 v[108:111], v17 offset:32768
    s_waitcnt lgkmcnt(8)
    ds_read_b128 v[112:115], v240 offset:288
    ds_read_b128 v[116:119], v240 offset:33056
    ds_read_b128 v[120:123], v17 offset:288
    ds_read_b128 v[124:127], v17 offset:33056
    s_waitcnt lgkmcnt(12)
    v_pk_add_f32 v[64:65], v[64:65], v[68:69]
    v_pk_add_f32 v[72:73], v[72:73], v[76:77]
    v_pk_add_f32 v[66:67], v[66:67], v[70:71]
    v_pk_add_f32 v[74:75], v[74:75], v[78:79]
    v_pk_add_f32 v[64:65], v[64:65], v[72:73]
    v_pk_add_f32 v[66:67], v[66:67], v[74:75]
    v_cvt_pk_bf16_f32 v128, v64, v65
    v_cvt_pk_bf16_f32 v129, v66, v67
    s_waitcnt lgkmcnt(8)
    v_pk_add_f32 v[80:81], v[80:81], v[84:85]
    v_pk_add_f32 v[88:89], v[88:89], v[92:93]
    v_pk_add_f32 v[82:83], v[82:83], v[86:87]
    v_pk_add_f32 v[90:91], v[90:91], v[94:95]
    v_pk_add_f32 v[80:81], v[80:81], v[88:89]
    v_pk_add_f32 v[82:83], v[82:83], v[90:91]
    v_cvt_pk_bf16_f32 v130, v80, v81
    v_cvt_pk_bf16_f32 v131, v82, v83
    buffer_store_dwordx4 v[128:131], v236, s[24:27], s47 offen sc1
    s_waitcnt lgkmcnt(4)
    v_pk_add_f32 v[96:97], v[96:97], v[100:101]
    v_pk_add_f32 v[104:105], v[104:105], v[108:109]
    v_pk_add_f32 v[98:99], v[98:99], v[102:103]
    v_pk_add_f32 v[106:107], v[106:107], v[110:111]
    v_pk_add_f32 v[96:97], v[96:97], v[104:105]
    v_pk_add_f32 v[98:99], v[98:99], v[106:107]
    v_cvt_pk_bf16_f32 v132, v96, v97
    v_cvt_pk_bf16_f32 v133, v98, v99
    s_waitcnt lgkmcnt(0)
    v_pk_add_f32 v[112:113], v[112:113], v[116:117]
    v_pk_add_f32 v[120:121], v[120:121], v[124:125]
    v_pk_add_f32 v[114:115], v[114:115], v[118:119]
    v_pk_add_f32 v[122:123], v[122:123], v[126:127]
    v_pk_add_f32 v[112:113], v[112:113], v[120:121]
    v_pk_add_f32 v[114:115], v[114:115], v[122:123]
    v_cvt_pk_bf16_f32 v134, v112, v113
    v_cvt_pk_bf16_f32 v135, v114, v115
    buffer_store_dwordx4 v[132:135], v237, s[24:27], s47 offen sc1
    s_endpgm
L_fw:
    s_mov_b64 exec, s[76:77]
    buffer_load_dwordx4 v[4:7], v21, s[24:27], s71 offen sc1
    s_mov_b32 exec_lo, -1
    s_mov_b32 exec_hi, 0xf
    s_waitcnt lgkmcnt(0)
    s_barrier
    ds_read_b128 v[64:67], v19 offset:0
    ds_read_b128 v[68:71], v19 offset:32768
    ds_read_b128 v[72:75], v20 offset:0
    ds_read_b128 v[76:79], v20 offset:32768
    s_waitcnt lgkmcnt(0)
    v_pk_add_f32 v[64:65], v[64:65], v[68:69]
    v_pk_add_f32 v[72:73], v[72:73], v[76:77]
    v_pk_add_f32 v[66:67], v[66:67], v[70:71]
    v_pk_add_f32 v[74:75], v[74:75], v[78:79]
    v_pk_add_f32 v[64:65], v[64:65], v[72:73]
    v_pk_add_f32 v[66:67], v[66:67], v[74:75]
    s_mov_b64 exec, s[76:77]
    s_branch L_q2c
L_q2:
    buffer_load_dwordx4 v[4:7], v21, s[24:27], s71 offen sc1
L_q2c:
    s_waitcnt vmcnt(0)
    v_cmp_eq_u32 vcc, -1, v4
    s_cbranch_vccz L_q2_ok
    s_sub_u32 s66, s66, 1
    s_and_b32 s3, s66, 63
    s_cbranch_scc1 L_q2
    s_mov_b64 exec, 1
    buffer_atomic_add v243, off, s[24:27], s78
    s_mov_b64 exec, s[76:77]
    s_cmp_gt_i32 s66, 0
    s_cbranch_scc1 L_q2
L_q2_ok:
    s_mov_b32 exec_lo, -1
    s_mov_b32 exec_hi, 0xf
L_p2:
    buffer_load_dwordx2 v[128:129], v22, s[24:27], s68 offen offset:0 sc1
    buffer_load_dwordx2 v[130:131], v22, s[24:27], s68 offen offset:576 sc1
    buffer_load_dwordx2 v[132:133], v22, s[24:27], s68 offen offset:1152 sc1
    buffer_load_dwordx2 v[134:135], v22, s[24:27], s68 offen offset:1728 sc1
    buffer_load_dwordx2 v[136:137], v22, s[24:27], s68 offen offset:2304 sc1
    buffer_load_dwordx2 v[138:139], v22, s[24:27], s68 offen offset:2880 sc1
    buffer_load_dwordx2 v[140:141], v22, s[24:27], s68 offen offset:3456 sc1
    s_waitcnt vmcnt(6)
    v_lshlrev_b32 v144, 16, v128
    v_and_b32 v145, s69, v128
    v_lshlrev_b32 v146, 16, v129
    v_and_b32 v147, s69, v129
    v_max3_u32 v2, v128, v129, 0
    v_pk_add_f32 v[192:193], v[64:65], v[144:145]
    v_pk_add_f32 v[194:195], v[66:67], v[146:147]
    s_waitcnt vmcnt(5)
    v_lshlrev_b32 v148, 16, v130
    v_and_b32 v149, s69, v130
    v_lshlrev_b32 v150, 16, v131
    v_and_b32 v151, s69, v131
    v_max3_u32 v2, v130, v131, v2
    v_pk_add_f32 v[192:193], v[192:193], v[148:149]
    v_pk_add_f32 v[194:195], v[194:195], v[150:151]
    s_waitcnt vmcnt(4)
    v_lshlrev_b32 v144, 16, v132
    v_and_b32 v145, s69, v132
    v_lshlrev_b32 v146, 16, v133
    v_and_b32 v147, s69, v133
    v_max3_u32 v2, v132, v133, v2
    v_pk_add_f32 v[192:193], v[192:193], v[144:145]
    v_pk_add_f32 v[194:195], v[194:195], v[146:147]
    s_waitcnt vmcnt(3)
    v_lshlrev_b32 v148, 16, v134
    v_and_b32 v149, s69, v134
    v_lshlrev_b32 v150, 16, v135
    v_and_b32 v151, s69, v135
    v_max3_u32 v2, v134, v135, v2
    v_pk_add_f32 v[192:193], v[192:193], v[148:149]
    v_pk_add_f32 v[194:195], v[194:195], v[150:151]
    s_waitcnt vmcnt(2)
    v_lshlrev_b32 v144, 16, v136
    v_and_b32 v145, s69, v136
    v_lshlrev_b32 v146, 16, v137
    v_and_b32 v147, s69, v137
    v_max3_u32 v2, v136, v137, v2
    v_pk_add_f32 v[192:193], v[192:193], v[144:145]
    v_pk_add_f32 v[194:195], v[194:195], v[146:147]
    s_waitcnt vmcnt(1)
    v_lshlrev_b32 v148, 16, v138
    v_and_b32 v149, s69, v138
    v_lshlrev_b32 v150, 16, v139
    v_and_b32 v151, s69, v139
    v_max3_u32 v2, v138, v139, v2
    v_pk_add_f32 v[192:193], v[192:193], v[148:149]
    v_pk_add_f32 v[194:195], v[194:195], v[150:151]
    s_waitcnt vmcnt(0)
    v_lshlrev_b32 v144, 16, v140
    v_and_b32 v145, s69, v140
    v_lshlrev_b32 v146, 16, v141
    v_and_b32 v147, s69, v141
    v_max3_u32 v2, v140, v141, v2
    v_pk_add_f32 v[192:193], v[192:193], v[144:145]
    v_pk_add_f32 v[194:195], v[194:195], v[146:147]
    v_cmp_eq_u32 vcc, -1, v2
    v_cvt_pk_bf16_f32 v4, v192, v193
    v_cvt_pk_bf16_f32 v5, v194, v195
    s_cbranch_vccz L_p2_ok
    s_sub_u32 s66, s66, 1
    s_and_b32 s3, s66, 63
    s_cbranch_scc1 L_p2
    s_mov_b64 exec, 1
    buffer_atomic_add v243, off, s[24:27], s78
    s_mov_b32 exec_lo, -1
    s_mov_b32 exec_hi, 0xf
    s_cmp_gt_i32 s66, 0
    s_cbranch_scc1 L_p2
L_p2_ok:
    buffer_store_dwordx2 v[4:5], v22, s[28:31], s70 offen offset:0
L_end:
    s_endpgm
.section .rodata,"a"
.p2align 6
.amdhsa_kernel standalone__gqa_block_cached__sampling_kernel
  .amdhsa_next_free_vgpr 512
  .amdhsa_next_free_sgpr 102
  .amdhsa_accum_offset 256
  .amdhsa_group_segment_fixed_size 0
  .amdhsa_kernarg_size 64
  .amdhsa_user_sgpr_count 2
  .amdhsa_user_sgpr_kernarg_segment_ptr 1
  .amdhsa_system_sgpr_workgroup_id_x 1
  .amdhsa_float_denorm_mode_32 3
.end_amdhsa_kernel
```
